```python
import torch

def _softmax(x, axis=-1):
    return torch.softmax(x, dim=axis)
def _gelu(x):
    return torch.nn.functional.gelu(x, approximate="tanh")
def _silu(x):
    return torch.nn.functional.silu(x)
def _sigmoid(x):
    return torch.sigmoid(x)
def _layernorm(x, axis=-1, eps=1e-5):
    m = x.mean(dim=axis, keepdim=True)
    v = x.var(dim=axis, keepdim=True, unbiased=False)
    return (x - m) / torch.sqrt(v + eps)
def _scatter_add(tgt, idx, src, axis=0):
    return tgt.clone().index_add_(axis, idx, src)
def _segment_sum(src, seg, n):
    out = torch.zeros((n,) + src.shape[1:], dtype=src.dtype)
    return out.index_add_(0, seg, src)
def _pad(x, pw):
    flat = tuple(v for pair in reversed(pw) for v in pair)
    return torch.nn.functional.pad(x, flat)

kernel_name = 'interleave_layers__ssm_conv_s4__mixer_token_mlp__prompt'

def setup_inputs():

    _w = (lambda a: (lambda t: t.to(torch.bfloat16) if t.is_floating_point() else t)(torch.as_tensor(a)))
    def _A_setup():
        B, L, D, N = 1, 2048, 448, 256
        A_re = -(lambda _x: torch.exp(torch.as_tensor(_x)))((lambda *s: torch.randn(*s, dtype=torch.bfloat16) * 3.2)(D, N))
        A_im = torch.pi * (lambda *s: torch.randn(*s, dtype=torch.bfloat16) * 0.05)(D, N)
        B_re = (lambda *s: torch.randn(*s, dtype=torch.bfloat16) * 0.05)(D, N)
        B_im = (lambda *s: torch.randn(*s, dtype=torch.bfloat16) * 0.05)(D, N)
        C_re = (lambda *s: torch.randn(*s, dtype=torch.bfloat16) * 0.05)(D, N)
        C_im = (lambda *s: torch.randn(*s, dtype=torch.bfloat16) * 0.05)(D, N)
        log_dt = (lambda *s: torch.randn(*s, dtype=torch.bfloat16) * 0.05)(D) * 0.5 - 4.0
        Dskip = (lambda *s: torch.randn(*s, dtype=torch.bfloat16) * 0.05)(D)
        return {
            "u": _w((lambda *s: torch.randn(*s, dtype=torch.bfloat16) * 0.05)(B, L, D)),
            "A_re": _w(A_re),
            "A_im": _w(A_im),
            "B_re": _w(B_re),
            "B_im": _w(B_im),
            "C_re": _w(C_re),
            "C_im": _w(C_im),
            "log_dt": _w(log_dt),
            "Dskip": _w(Dskip),
        }
    _A_in = _A_setup()

    def _B_setup():
        B, S, D, F = 1, 2048, 448, 1792
        return {
            "x": _w((lambda *s: torch.randn(*s, dtype=torch.bfloat16) * 0.05)(B, S, D)),
            "w1": _w((lambda *s: torch.randn(*s, dtype=torch.bfloat16) * 0.4)(S, F) * (S ** -0.5)),
            "b1": _w((lambda *s: torch.randn(*s, dtype=torch.bfloat16) * 0.2)(F) * 0.02),
            "w2": _w((lambda *s: torch.randn(*s, dtype=torch.bfloat16) * 0.2)(F, S) * (F ** -0.5)),
            "b2": _w((lambda *s: torch.randn(*s, dtype=torch.bfloat16) * 0.2)(S) * 0.02),
        }
    _B_in = _B_setup()

    return {
        "A_u": _A_in["u"],
        "A_A_re": _A_in["A_re"],
        "A_A_im": _A_in["A_im"],
        "A_B_re": _A_in["B_re"],
        "A_B_im": _A_in["B_im"],
        "A_C_re": _A_in["C_re"],
        "A_C_im": _A_in["C_im"],
        "A_log_dt": _A_in["log_dt"],
        "A_Dskip": _A_in["Dskip"],
        "B_x": _B_in["x"],
        "B_w1": _B_in["w1"],
        "B_b1": _B_in["b1"],
        "B_w2": _B_in["w2"],
        "B_b2": _B_in["b2"],
    }

def reference(A_u, A_A_re, A_A_im, A_B_re, A_B_im, A_C_re, A_C_im, A_log_dt, A_Dskip, B_x, B_w1, B_b1, B_w2, B_b2):
    def _A_ref(u, A_re, A_im, B_re, B_im, C_re, C_im, log_dt, Dskip):
        Bsz, L, D = u.shape
        dt = torch.exp(log_dt)[:, None]
        A = A_re + 1j * A_im
        Bc = B_re + 1j * B_im
        Cc = C_re + 1j * C_im
        logdA = dt * A
        dB = dt * Bc
        l = (lambda x, dt: x.to(dt))(torch.arange(L), A_re.dtype)
        P = torch.exp(logdA[:, :, None] * l[None, None, :])
        K = torch.einsum("dn,dnl,dn->dl", Cc, P, dB).real
        L2 = 2 * L
        Kp = _pad(K, ((0, 0), (0, L)))
        up = (lambda x, *d: x.permute(*d))(u, 0, 2, 1)
        up = _pad(up, ((0, 0), (0, 0), (0, L)))
        Kf = (lambda x, axes=(-2,-1): torch.fft.rfft2(x.float(), dim=axes))(Kp[:, None, :], axes=(-2, -1))
        Uf = (lambda x, axes=(-2,-1): torch.fft.rfft2(x.float(), dim=axes))(up[:, :, None, :], axes=(-2, -1))
        Yf = Uf * Kf[None, :, :, :]
        y = (lambda x, s, axes=(-2,-1): torch.fft.irfft2(x, s=s, dim=axes).to(torch.bfloat16))(Yf, (1, L2), axes=(-2, -1))[:, :, 0, :L]
        y = (lambda x, *d: x.permute(*d))(y, 0, 2, 1) + u * Dskip[None, None, :]
        return y

    def _B_ref(x, w1, b1, w2, b2):
        B, S, D = x.shape
        h = _layernorm(x, axis=-1)
        u = torch.einsum("bsd,sf->bdf", h, w1) + b1
        u = _gelu(u)
        y = torch.einsum("bdf,fs->bds", u, w2) + b2
        return (lambda x, *d: x.permute(*d))(y, 0, 2, 1)

    x = A_u
    x = x + _A_ref(_layernorm(x, axis=-1), A_A_re, A_A_im, A_B_re, A_B_im, A_C_re, A_C_im, A_log_dt, A_Dskip)
    x = x + _B_ref(_layernorm(x, axis=-1), B_w1, B_b1, B_w2, B_b2)
    x = x + _A_ref(_layernorm(x, axis=-1), A_A_re, A_A_im, A_B_re, A_B_im, A_C_re, A_C_im, A_log_dt, A_Dskip)
    x = x + _B_ref(_layernorm(x, axis=-1), B_w1, B_b1, B_w2, B_b2)
    return x
```

```asm
; @launch grid=(256,1,1) block=(256,1,1) lds=163840
.amdgcn_target "amdgcn-amd-amdhsa--gfx950"
.text
.globl interleave_layers__ssm_conv_s4__mixer_token_mlp__prompt_kernel
.p2align 8
.type interleave_layers__ssm_conv_s4__mixer_token_mlp__prompt_kernel,@function
interleave_layers__ssm_conv_s4__mixer_token_mlp__prompt_kernel:
L_entry:
    s_cmp_lt_u32 s2, 256
    s_cbranch_scc1 L_start
    s_endpgm
L_start:
    s_load_dwordx16 s[16:31], s[0:1], 0
    s_load_dwordx16 s[32:47], s[0:1], 64
    s_load_dwordx2 s[48:49], s[0:1], 128
    v_lshrrev_b32 v1, 6, v0
    v_and_b32 v127, 63, v0
    v_readfirstlane_b32 s4, v1
    v_lshlrev_b32_e64 v126, 4, v127
    s_and_b32 s5, s2, 7
    s_lshr_b32 s6, s2, 3
    s_add_u32 s6, s6, 28
    s_and_b32 s6, s6, 31
    s_and_b32 s81, s5, 1
    s_lshr_b32 s82, s5, 1
    s_mul_i32 s7, s5, 28
    s_sub_u32 s86, s6, s81
    s_add_u32 s7, s7, s86
    s_cmp_lt_u32 s86, 28
    s_cselect_b32 s86, 1, 0
    s_mul_i32 s83, s6, 37
    s_lshr_b32 s83, s83, 8
    s_mul_i32 s84, s83, 7
    s_sub_u32 s84, s6, s84
    s_mul_i32 s9, s82, 7
    s_add_u32 s9, s9, s84
    s_lshl_b32 s84, s81, 2
    s_add_u32 s8, s83, s84
    s_lshl_b32 s11, s81, 3
    s_sub_u32 s11, s6, s11
    s_cselect_b32 s88, 0, 1
    s_lshr_b32 s10, s11, 3
    s_and_b32 s10, s10, 3
    s_add_u32 s10, s10, s84
    s_and_b32 s11, s11, 7
    s_lshl_b32 s77, s82, 4
    s_lshl_b32 s82, s82, 3
    s_add_u32 s11, s11, s82
    s_cmp_eq_u32 s6, 0
    s_cselect_b32 s82, 32, s6
    s_mul_i32 s83, s81, 11
    s_add_u32 s83, s83, s82
    s_cmp_lg_u32 s81, 0
    s_cselect_b32 s82, s82, s6
    s_cselect_b32 s83, s83, s6
    s_cselect_b32 s73, 21, 28
    s_cmp_ge_u32 s82, s73
    s_cselect_b32 s73, 1, 0
    s_add_u32 s77, s77, s83
    s_sub_u32 s77, s77, 28
    s_sub_u32 s82, s6, 4
    s_cselect_b32 s88, 0, 1
    s_and_b32 s82, s82, 31
    s_mul_i32 s83, s82, 37
    s_lshr_b32 s83, s83, 8
    s_mul_i32 s84, s83, 7
    s_sub_u32 s10, s82, s84
    s_lshl_b32 s11, s5, 2
    s_add_u32 s11, s11, s83
    s_lshl_b32 s12, s5, 4
    s_add_u32 s12, s12, s6
    s_sub_u32 s12, s12, 8
    s_mul_i32 s83, s81, 7
    s_sub_u32 s83, 28, s83
    s_cmp_lt_u32 s6, s83
    s_cselect_b32 s87, 1, 0
    s_sub_u32 s83, s6, 8
    s_cmp_lt_u32 s83, 16
    s_cselect_b32 s89, 1, 0
    s_min_u32 s7, s7, 223
    s_min_u32 s9, s9, 27
    s_mov_b32 s90, 0xaaaaaaaa
    s_mov_b32 s91, 0xaaaaaaaa
    s_mov_b32 s92, 0xcccccccc
    s_mov_b32 s93, 0xcccccccc
    s_waitcnt lgkmcnt(0)
    s_mov_b32 s0, 0xffff0000
    s_mov_b32 s1, 0xffff
    s_lshl_b32 s81, s7, 2
    s_load_dword s76, s[30:31], s81
    s_load_dword s72, s[32:33], s81
    s_lshl_b32 s81, s7, 10
    s_lshl_b32 s82, s4, 8
    s_add_u32 s81, s81, s82
    v_lshl_add_u32 v3, v127, 2, s81
    global_load_dword v56, v3, s[18:19]
    global_load_dword v57, v3, s[20:21]
    global_load_dword v58, v3, s[22:23]
    global_load_dword v59, v3, s[24:25]
    global_load_dword v60, v3, s[26:27]
    global_load_dword v61, v3, s[28:29]
    s_mov_b32 s64, s16
    s_mov_b32 s65, s17
    s_mov_b32 s66, 1835008
    s_mov_b32 s67, 0x20000
    s_mov_b32 s52, s48
    s_mov_b32 s53, s49
    s_mov_b32 s54, 268435456
    s_mov_b32 s55, 0x20000
    s_mov_b32 s68, s44
    s_mov_b32 s69, s45
    s_mov_b32 s70, 1835008
    s_mov_b32 s71, 0x20000
    buffer_load_dwordx2 v[104:105], off, s[52:55], 0 offset:0 sc1
    s_mov_b32 s56, s36
    s_mov_b32 s57, s37
    s_cmp_lg_u32 s87, 0
    s_cselect_b32 s58, 7340032, 0
    s_mov_b32 s59, 0x20000
    s_mov_b32 s60, s40
    s_mov_b32 s61, s41
    s_cmp_lg_u32 s88, 0
    s_cselect_b32 s62, 7340032, 0
    s_mov_b32 s63, 0x20000
    s_cmp_eq_u32 s86, 0
    s_cbranch_scc1 L_aux_1
    s_lshl_b32 s81, s7, 1
    s_lshr_b32 s82, s4, 1
    s_add_u32 s81, s81, s82
    s_mul_i32 s82, s81, 9363
    s_lshr_b32 s82, s82, 16
    s_mul_i32 s83, s82, 7
    s_sub_u32 s81, s81, s83
    s_lshl_b32 s81, s81, 1
    s_and_b32 s83, s4, 1
    s_add_u32 s81, s81, s83
    s_mul_i32 s83, s82, 28672
    s_lshl_b32 s84, s81, 6
    s_add_u32 s83, s83, s84
    v_lshrrev_b32 v2, 2, v127
    v_mul_u32_u24 v2, 896, v2
    v_and_b32 v3, 3, v127
    v_lshl_add_u32 v2, v3, 4, v2
    s_mul_i32 s22, s4, 15616
    s_mov_b32 m0, s22
    s_mul_i32 s23, s82, 28800
    buffer_load_dwordx4 v2, s[64:67], s83 offen lds
    s_add_u32 m0, m0, 1024
    s_add_u32 s83, s83, 14336
    buffer_load_dwordx4 v2, s[64:67], s83 offen lds
    s_lshl_b32 s81, s81, 11
    s_add_u32 s23, s23, s81
    s_add_u32 s23, s23, 18874368
    v_lshrrev_b32 v2, 4, v127
    v_bfe_u32 v36, v127, 2, 2
    v_lshl_add_u32 v36, v2, 3, v36
    v_lshlrev_b32 v36, 6, v36
    v_lshl_add_u32 v36, v3, 3, v36
    v_add_u32 v36, s22, v36
    v_and_b32 v37, 15, v127
    v_lshlrev_b32 v37, 6, v37
    v_lshl_add_u32 v37, v2, 4, v37
    s_getpc_b64 s[96:97]
L_pc_3:
    s_add_u32 s96, s96, ktab-L_pc_3
    s_addc_u32 s97, s97, 0
    s_lshr_b32 s81, s4, 1
    s_lshl_b32 s81, s81, 5
    v_lshl_add_u32 v75, v0, 5, s81
    s_lshl_b32 s81, s6, 2
    s_add_u32 s81, s81, s4
    s_mul_i32 s81, s81, 640
    v_lshl_add_u32 v1, v127, 7, s81
    s_mov_b32 s82, ktab-L_entry+8192
    v_min_u32 v1, s82, v1
    s_sub_u32 s28, s96, ktab-L_entry
    s_subb_u32 s29, s97, 0
    s_mov_b64 exec, 31
    global_load_dword v1, v1, s[28:29]
    s_mov_b64 exec, -1
    v_lshrrev_b32 v2, 3, v127
    v_and_b32 v3, 7, v127
    v_bfe_u32 v4, v127, 4, 1
    v_lshlrev_b32 v4, 2, v4
    v_xor_b32 v3, v3, v4
    v_lshlrev_b32 v3, 4, v3
    v_mul_u32_u24 v121, 3584, v2
    v_add_u32 v121, v121, v3
    v_lshl_add_u32 v120, v2, 12, v3
    v_bfe_u32 v2, v127, 2, 2
    v_lshrrev_b32 v3, 5, v127
    v_bfe_u32 v4, v127, 4, 1
    v_and_b32 v5, 3, v127
    v_lshlrev_b32 v5, 3, v5
    v_lshl_add_u32 v5, v4, 5, v5
    v_lshrrev_b32 v4, 1, v2
    v_lshl_add_u32 v5, v4, 6, v5
    s_lshr_b32 s81, s4, 1
    s_lshl_b32 s81, s81, 6
    v_xor_b32_e64 v5, s81, v5
    v_lshl_add_u32 v5, v2, 7, v5
    s_mul_i32 s82, s4, 24576
    s_add_u32 s82, s82, 65536
    v_add_u32 v5, s82, v5
    v_lshl_add_u32 v123, v3, 10, v5
    v_xor_b32 v122, 64, v123
    v_lshl_add_u32 v125, v3, 9, v5
    v_xor_b32 v124, 64, v125
    s_mul_i32 s98, s4, 1835008
    s_lshl_b32 s81, s9, 7
    s_add_u32 s98, s98, s81
    s_mul_i32 s99, s4, 1835008
    s_lshl_b32 s81, s11, 7
    s_add_u32 s99, s99, s81
    s_mov_b32 s80, s82
    s_and_b32 s81, s8, 3
    s_lshl_b32 s81, s81, 1
    s_lshr_b32 s82, s8, 2
    s_add_u32 s81, s81, s82
    s_and_b32 s33, s81, 7
    s_and_b32 s81, s10, 3
    s_lshl_b32 s81, s81, 1
    s_lshr_b32 s82, s10, 2
    s_add_u32 s81, s81, s82
    s_min_u32 s35, s81, 6
    s_mov_b32 s35, s10
    s_add_u32 s78, s98, 1835008
    s_mul_i32 s81, s33, 229376
    s_add_u32 s98, s98, s81
    s_add_u32 s79, s99, 1835008
    s_mul_i32 s81, s35, 262144
    s_add_u32 s99, s99, s81
    s_mov_b32 s34, 0x3b124925
    s_mov_b32 s100, 0x3727c5ac
    s_lshl_b32 s81, s4, 10
    v_add_u32 v118, s81, v126
    s_lshr_b32 s81, s4, 1
    s_and_b32 s82, s4, 1
    v_and_b32 v8, 15, v127
    v_lshrrev_b32 v9, 4, v127
    v_not_b32 v10, v8
    v_and_b32 v10, 3, v10
    s_cmp_lg_u32 s81, 0
    s_cselect_b32 s83, 1, 0
    s_mul_i32 s83, s83, 4160
    v_mov_b32 v11, s83
    s_cmp_lg_u32 s81, 0
    s_cselect_b32 s83, 6, 5
    s_mul_i32 s83, s83, 4160
    v_mov_b32 v12, s83
    v_cmp_eq_u32 vcc, 1, v10
    s_nop 1
    v_cndmask_b32 v11, v11, v12, vcc
    s_cmp_lg_u32 s81, 0
    s_cselect_b32 s83, 7, 2
    s_mul_i32 s83, s83, 4160
    v_mov_b32 v12, s83
    v_cmp_eq_u32 vcc, 2, v10
    s_nop 1
    v_cndmask_b32 v11, v11, v12, vcc
    s_cmp_lg_u32 s81, 0
    s_cselect_b32 s83, 4, 3
    s_mul_i32 s83, s83, 4160
    v_mov_b32 v12, s83
    v_cmp_eq_u32 vcc, 3, v10
    s_nop 1
    v_cndmask_b32 v11, v11, v12, vcc
    v_add_u32 v10, v10, v8
    v_lshlrev_b32 v12, 3, v9
    v_sub_u32 v12, v12, v10
    v_lshl_add_u32 v11, v12, 1, v11
    s_lshl_b32 s84, s82, 8
    s_sub_u32 s83, 286, s84
    v_add_u32 v112, s83, v11
    s_mul_i32 s83, s81, 5120
    s_sub_u32 s83, s83, s84
    s_add_u32 s83, s83, 34080
    v_lshlrev_b32 v12, 5, v8
    v_lshl_add_u32 v13, v9, 4, v12
    v_add_u32 v113, s83, v13
    s_lshl_b32 s83, s4, 11
    v_lshl_add_u32 v13, v9, 3, v12
    v_add_u32 v114, s83, v13
    s_xor_b32 s83, s4, 1
    s_lshl_b32 s83, s83, 12
    v_add_u32 v115, s83, v126
    s_lshl_b32 s83, s4, 12
    v_add_u32 v116, s83, v126
    v_and_b32 v10, 1, v9
    v_lshlrev_b32 v10, 3, v10
    v_lshrrev_b32 v11, 1, v8
    v_add_u32 v10, v10, v11
    v_mul_u32_u24 v10, 28800, v10
    v_and_b32 v11, 1, v8
    v_lshl_add_u32 v10, v11, 5, v10
    v_lshrrev_b32 v11, 1, v9
    v_lshl_add_u32 v117, v11, 4, v10
    s_mul_i32 s82, s82, 921600
    s_lshl_b32 s83, s7, 1
    s_add_u32 s81, s81, s83
    s_lshl_b32 s81, s81, 6
    s_add_u32 s81, s81, s82
    s_add_u32 s13, s81, 4194304
    s_add_u32 s21, s13, 460800
    s_lshl_b32 s16, s4, 10
    s_add_u32 s16, s16, 4096
    s_add_u32 s17, s16, 4096
    s_add_u32 s18, s16, 8192
    s_add_u32 s19, s16, 12288
    s_mul_i32 s20, s4, 460800
    s_lshl_b32 s83, s7, 7
    s_add_u32 s20, s20, s83
    s_add_u32 s20, s20, 18874368
    v_lshrrev_b32 v10, 2, v127
    v_mul_u32_u24 v10, 28800, v10
    v_and_b32 v11, 3, v127
    v_lshl_add_u32 v119, v11, 4, v10
    s_lshl_b32 s81, s4, 4
    v_and_b32 v2, 15, v127
    v_add_u32 v2, s81, v2
    v_mul_u32_u24 v2, 7, v2
    s_lshr_b32 s81, s7, 5
    v_add_u32 v2, s81, v2
    v_lshrrev_b32 v2, 1, v2
    s_lshl_b32 s81, s4, 3
    s_add_u32 s81, s81, 224
    v_and_b32 v63, 7, v127
    v_add_u32 v63, s81, v63
    v_cmp_gt_u32 vcc, 16, v127
    s_nop 1
    v_cndmask_b32 v63, v63, v2, vcc
    v_lshrrev_b32 v2, 3, v127
    v_mul_u32_u24 v2, 28800, v2
    v_and_b32 v3, 7, v127
    v_lshl_add_u32 v2, v3, 4, v2
    s_mul_i32 s81, s4, 460800
    s_lshl_b32 s82, s7, 7
    s_add_u32 s81, s81, s82
    s_add_u32 s81, s81, 4194304
    s_add_u32 s82, s81, 230400
    v_mov_b32 v4, -1
    v_mov_b32 v5, -1
    v_mov_b32 v6, -1
    v_mov_b32 v7, -1
    buffer_store_dwordx4 v[4:7], v2, s[52:55], s81 offen sc1
    buffer_store_dwordx4 v[4:7], v2, s[52:55], s82 offen sc1
    s_waitcnt vmcnt(3)
    ds_read_b64_tr_b16 v[40:41], v36 offset:0
    ds_read_b64_tr_b16 v[42:43], v36 offset:256
    ds_read_b64_tr_b16 v[44:45], v36 offset:32
    ds_read_b64_tr_b16 v[46:47], v36 offset:288
    s_waitcnt lgkmcnt(0)
    buffer_store_dwordx4 v[40:43], v37, s[52:55], s23 offen offset:0 sc1
    buffer_store_dwordx4 v[44:47], v37, s[52:55], s23 offen offset:1024 sc1
    s_mul_i32 s81, s4, 15616
    v_lshl_add_u32 v73, v127, 2, s81
    v_and_b32 v2, 15, v127
    v_mul_u32_u24 v2, 272, v2
    v_lshrrev_b32 v3, 4, v127
    v_lshl_add_u32 v2, v3, 4, v2
    v_add_u32 v74, s81, v2
    s_mov_b32 m0, s22
    s_lshr_b32 s81, s4, 1
    s_lshl_b32 s81, s81, 4
    s_lshr_b32 s81, s76, s81
    s_lshl_b32 s81, s81, 16
    v_mov_b32 v2, 0x3fb8aa3b
    v_mul_f32 v2, s81, v2
    v_exp_f32 v2, v2
    s_nop 0
    v_cvt_pk_bf16_f32 v2, v2, v2
    v_lshlrev_b32 v72, 16, v2
    s_and_b32 s74, s72, 0xffff0000
    s_lshl_b32 s72, s72, 16
    v_lshlrev_b32 v70, 16, v56
    v_lshlrev_b32 v71, 16, v57
    v_lshlrev_b32 v24, 16, v58
    v_lshlrev_b32 v25, 16, v59
    v_lshlrev_b32 v26, 16, v60
    v_lshlrev_b32 v27, 16, v61
    v_mul_f32 v70, v72, v70
    v_mul_f32 v71, v72, v71
    v_pk_mul_f32 v[24:25], v[24:25], v[72:73] op_sel_hi:[1,0]
    v_mul_f32 v70, 0x3fb8aa3b, v70
    v_mul_f32 v71, 0x3e22f983, v71
    v_pk_mul_f32 v[32:33], v[26:27], v[24:25] op_sel:[1,1] op_sel_hi:[1,0] neg_lo:[0,1]
    v_pk_fma_f32 v[32:33], v[26:27], v[24:25], v[32:33] op_sel_hi:[0,1,1]
    v_fract_f32 v64, v71
    v_exp_f32 v62, v70
    v_cos_f32 v2, v64
    v_sin_f32 v3, v64
    s_nop 0
    v_pk_mul_f32 v[2:3], v[2:3], v[62:63] op_sel_hi:[1,0]
    v_mul_f32 v62, 0x43000000, v70
    v_mul_f32 v64, 0x43000000, v71
    v_fract_f32 v64, v64
    v_exp_f32 v62, v62
    v_cos_f32 v28, v64
    v_sin_f32_e64 v29, v64
    s_nop 0
    v_pk_mul_f32 v[28:29], v[28:29], v[62:63] op_sel_hi:[1,0]
    v_pk_mul_f32 v[4:5], v[2:3], v[2:3] op_sel:[1,1] op_sel_hi:[1,0] neg_lo:[0,1]
    v_pk_mul_f32 v[30:31], v[28:29], v[28:29] op_sel:[1,1] op_sel_hi:[1,0] neg_lo:[0,1]
    v_pk_fma_f32 v[4:5], v[2:3], v[2:3], v[4:5] op_sel_hi:[0,1,1]
    v_pk_fma_f32 v[30:31], v[28:29], v[28:29], v[30:31] op_sel_hi:[0,1,1]
    v_pk_mul_f32 v[8:9], v[4:5], v[4:5] op_sel:[1,1] op_sel_hi:[1,0] neg_lo:[0,1]
    v_pk_mul_f32 v[6:7], v[4:5], v[2:3] op_sel:[1,1] op_sel_hi:[1,0] neg_lo:[0,1]
    v_pk_fma_f32 v[8:9], v[4:5], v[4:5], v[8:9] op_sel_hi:[0,1,1]
    v_pk_fma_f32 v[6:7], v[4:5], v[2:3], v[6:7] op_sel_hi:[0,1,1]
    v_pk_mul_f32 v[16:17], v[8:9], v[8:9] op_sel:[1,1] op_sel_hi:[1,0] neg_lo:[0,1]
    v_pk_mul_f32 v[34:35], v[32:33], v[28:29] op_sel:[1,1] op_sel_hi:[1,0] neg_lo:[0,1]
    v_pk_fma_f32 v[16:17], v[8:9], v[8:9], v[16:17] op_sel_hi:[0,1,1]
    v_pk_fma_f32 v[34:35], v[32:33], v[28:29], v[34:35] op_sel_hi:[0,1,1]
    v_mov_b32 v69, 0x3f80
    v_pk_mul_f32 v[18:19], v[16:17], v[16:17] op_sel:[1,1] op_sel_hi:[1,0] neg_lo:[0,1]
    v_pk_mul_f32 v[10:11], v[8:9], v[2:3] op_sel:[1,1] op_sel_hi:[1,0] neg_lo:[0,1]
    ds_write_b32 v73, v69
    v_pk_fma_f32 v[18:19], v[16:17], v[16:17], v[18:19] op_sel_hi:[0,1,1]
    v_pk_fma_f32 v[10:11], v[8:9], v[2:3], v[10:11] op_sel_hi:[0,1,1]
    v_cvt_pk_bf16_f32 v66, v16, -v17
    v_pk_mul_f32 v[20:21], v[18:19], v[16:17] op_sel:[1,1] op_sel_hi:[1,0] neg_lo:[0,1]
    v_pk_mul_f32 v[22:23], v[18:19], v[18:19] op_sel:[1,1] op_sel_hi:[1,0] neg_lo:[0,1]
    ds_write_addtid_b32 v66 offset:272
    v_pk_fma_f32 v[20:21], v[18:19], v[16:17], v[20:21] op_sel_hi:[0,1,1]
    v_pk_fma_f32 v[22:23], v[18:19], v[18:19], v[22:23] op_sel_hi:[0,1,1]
    v_cvt_pk_bf16_f32 v67, v18, -v19
    v_pk_mul_f32 v[12:13], v[8:9], v[4:5] op_sel:[1,1] op_sel_hi:[1,0] neg_lo:[0,1]
    v_pk_mul_f32 v[14:15], v[8:9], v[6:7] op_sel:[1,1] op_sel_hi:[1,0] neg_lo:[0,1]
    ds_write_addtid_b32 v67 offset:544
    v_pk_fma_f32 v[12:13], v[8:9], v[4:5], v[12:13] op_sel_hi:[0,1,1]
    v_pk_fma_f32 v[14:15], v[8:9], v[6:7], v[14:15] op_sel_hi:[0,1,1]
    v_cvt_pk_bf16_f32 v68, v20, -v21
    v_cvt_pk_bf16_f32 v69, v22, -v23
    v_pk_mul_f32 v[24:25], v[16:17], v[22:23] op_sel:[1,1] op_sel_hi:[1,0] neg_lo:[0,1]
    ds_write_addtid_b32 v68 offset:816
    v_pk_mul_f32 v[26:27], v[18:19], v[22:23] op_sel:[1,1] op_sel_hi:[1,0] neg_lo:[0,1]
    v_pk_fma_f32 v[24:25], v[16:17], v[22:23], v[24:25] op_sel_hi:[0,1,1]
    v_pk_fma_f32 v[26:27], v[18:19], v[22:23], v[26:27] op_sel_hi:[0,1,1]
    ds_write_addtid_b32 v69 offset:1088
    v_cvt_pk_bf16_f32 v66, v24, -v25
    v_cvt_pk_bf16_f32 v67, v26, -v27
    v_pk_mul_f32 v[36:37], v[20:21], v[22:23] op_sel:[1,1] op_sel_hi:[1,0] neg_lo:[0,1]
    ds_write_addtid_b32 v66 offset:1360
    v_pk_mul_f32 v[16:17], v[22:23], v[22:23] op_sel:[1,1] op_sel_hi:[1,0] neg_lo:[0,1]
    v_pk_fma_f32 v[36:37], v[20:21], v[22:23], v[36:37] op_sel_hi:[0,1,1]
    v_pk_fma_f32 v[16:17], v[22:23], v[22:23], v[16:17] op_sel_hi:[0,1,1]
    ds_write_addtid_b32 v67 offset:1632
    v_cvt_pk_bf16_f32 v68, v36, -v37
    v_cvt_pk_bf16_f32 v69, v16, -v17
    v_pk_mul_f32 v[18:19], v[24:25], v[22:23] op_sel:[1,1] op_sel_hi:[1,0] neg_lo:[0,1]
    ds_write_addtid_b32 v68 offset:1904
    v_pk_mul_f32 v[20:21], v[26:27], v[22:23] op_sel:[1,1] op_sel_hi:[1,0] neg_lo:[0,1]
    v_pk_fma_f32 v[18:19], v[24:25], v[22:23], v[18:19] op_sel_hi:[0,1,1]
    v_pk_fma_f32 v[20:21], v[26:27], v[22:23], v[20:21] op_sel_hi:[0,1,1]
    ds_write_addtid_b32 v69 offset:2176
    v_cvt_pk_bf16_f32 v66, v18, -v19
    v_cvt_pk_bf16_f32 v67, v20, -v21
    v_pk_mul_f32 v[24:25], v[36:37], v[22:23] op_sel:[1,1] op_sel_hi:[1,0] neg_lo:[0,1]
    ds_write_addtid_b32 v66 offset:2448
    v_pk_mul_f32 v[26:27], v[16:17], v[22:23] op_sel:[1,1] op_sel_hi:[1,0] neg_lo:[0,1]
    v_pk_fma_f32 v[24:25], v[36:37], v[22:23], v[24:25] op_sel_hi:[0,1,1]
    v_pk_fma_f32 v[26:27], v[16:17], v[22:23], v[26:27] op_sel_hi:[0,1,1]
    ds_write_addtid_b32 v67 offset:2720
    v_cvt_pk_bf16_f32 v68, v24, -v25
    v_cvt_pk_bf16_f32 v69, v26, -v27
    v_pk_mul_f32 v[36:37], v[18:19], v[22:23] op_sel:[1,1] op_sel_hi:[1,0] neg_lo:[0,1]
    ds_write_addtid_b32 v68 offset:2992
    v_pk_mul_f32 v[16:17], v[20:21], v[22:23] op_sel:[1,1] op_sel_hi:[1,0] neg_lo:[0,1]
    v_pk_fma_f32 v[36:37], v[18:19], v[22:23], v[36:37] op_sel_hi:[0,1,1]
    v_pk_fma_f32 v[16:17], v[20:21], v[22:23], v[16:17] op_sel_hi:[0,1,1]
    ds_write_addtid_b32 v69 offset:3264
    v_cvt_pk_bf16_f32 v66, v36, -v37
    v_cvt_pk_bf16_f32 v67, v16, -v17
    v_pk_mul_f32 v[18:19], v[24:25], v[22:23] op_sel:[1,1] op_sel_hi:[1,0] neg_lo:[0,1]
    ds_write_addtid_b32 v66 offset:3536
    v_pk_fma_f32 v[18:19], v[24:25], v[22:23], v[18:19] op_sel_hi:[0,1,1]
    v_cvt_pk_bf16_f32 v68, v18, -v19
    ds_write_addtid_b32 v67 offset:3808
    ds_write_addtid_b32 v68 offset:4080
    ds_read_b128 v[88:91], v74 offset:0
    ds_read_b128 v[92:95], v74 offset:64
    ds_read_b128 v[96:99], v74 offset:128
    ds_read_b128 v[100:103], v74 offset:192
    v_cvt_pk_bf16_f32 v69, v32, v33
    v_cvt_pk_bf16_f32 v66, v34, v35
    v_pk_mul_f32 v[24:25], v[32:33], v[2:3] op_sel:[1,1] op_sel_hi:[1,0] neg_lo:[0,1]
    ds_write_addtid_b32 v69 offset:4352
    v_pk_mul_f32 v[26:27], v[34:35], v[2:3] op_sel:[1,1] op_sel_hi:[1,0] neg_lo:[0,1]
    v_pk_fma_f32 v[24:25], v[32:33], v[2:3], v[24:25] op_sel_hi:[0,1,1]
    v_pk_fma_f32 v[26:27], v[34:35], v[2:3], v[26:27] op_sel_hi:[0,1,1]
    ds_write_addtid_b32 v66 offset:6528
    v_cvt_pk_bf16_f32 v67, v24, v25
    v_cvt_pk_bf16_f32 v68, v26, v27
    v_pk_mul_f32 v[24:25], v[32:33], v[4:5] op_sel:[1,1] op_sel_hi:[1,0] neg_lo:[0,1]
    ds_write_addtid_b32 v67 offset:4624
    v_pk_mul_f32 v[26:27], v[34:35], v[4:5] op_sel:[1,1] op_sel_hi:[1,0] neg_lo:[0,1]
    v_pk_fma_f32 v[24:25], v[32:33], v[4:5], v[24:25] op_sel_hi:[0,1,1]
    v_pk_fma_f32 v[26:27], v[34:35], v[4:5], v[26:27] op_sel_hi:[0,1,1]
    ds_write_addtid_b32 v68 offset:6800
    v_cvt_pk_bf16_f32 v69, v24, v25
    v_cvt_pk_bf16_f32 v66, v26, v27
    v_pk_mul_f32 v[24:25], v[32:33], v[6:7] op_sel:[1,1] op_sel_hi:[1,0] neg_lo:[0,1]
    ds_write_addtid_b32 v69 offset:4896
    v_pk_mul_f32 v[26:27], v[34:35], v[6:7] op_sel:[1,1] op_sel_hi:[1,0] neg_lo:[0,1]
    v_pk_fma_f32 v[24:25], v[32:33], v[6:7], v[24:25] op_sel_hi:[0,1,1]
    v_pk_fma_f32 v[26:27], v[34:35], v[6:7], v[26:27] op_sel_hi:[0,1,1]
    ds_write_addtid_b32 v66 offset:7072
    v_cvt_pk_bf16_f32 v67, v24, v25
    v_cvt_pk_bf16_f32 v68, v26, v27
    v_pk_mul_f32 v[24:25], v[32:33], v[8:9] op_sel:[1,1] op_sel_hi:[1,0] neg_lo:[0,1]
    ds_write_addtid_b32 v67 offset:5168
    v_pk_mul_f32 v[26:27], v[34:35], v[8:9] op_sel:[1,1] op_sel_hi:[1,0] neg_lo:[0,1]
    v_pk_fma_f32 v[24:25], v[32:33], v[8:9], v[24:25] op_sel_hi:[0,1,1]
    v_pk_fma_f32 v[26:27], v[34:35], v[8:9], v[26:27] op_sel_hi:[0,1,1]
    ds_write_addtid_b32 v68 offset:7344
    v_cvt_pk_bf16_f32 v69, v24, v25
    v_cvt_pk_bf16_f32 v66, v26, v27
    v_pk_mul_f32 v[24:25], v[32:33], v[10:11] op_sel:[1,1] op_sel_hi:[1,0] neg_lo:[0,1]
    ds_write_addtid_b32 v69 offset:5440
    v_pk_mul_f32 v[26:27], v[34:35], v[10:11] op_sel:[1,1] op_sel_hi:[1,0] neg_lo:[0,1]
    v_pk_fma_f32 v[24:25], v[32:33], v[10:11], v[24:25] op_sel_hi:[0,1,1]
    v_pk_fma_f32 v[26:27], v[34:35], v[10:11], v[26:27] op_sel_hi:[0,1,1]
    ds_write_addtid_b32 v66 offset:7616
    v_cvt_pk_bf16_f32 v67, v24, v25
    v_cvt_pk_bf16_f32 v68, v26, v27
    v_pk_mul_f32 v[24:25], v[32:33], v[12:13] op_sel:[1,1] op_sel_hi:[1,0] neg_lo:[0,1]
    ds_write_addtid_b32 v67 offset:5712
    v_pk_mul_f32 v[26:27], v[34:35], v[12:13] op_sel:[1,1] op_sel_hi:[1,0] neg_lo:[0,1]
    v_pk_fma_f32 v[24:25], v[32:33], v[12:13], v[24:25] op_sel_hi:[0,1,1]
    v_pk_fma_f32 v[26:27], v[34:35], v[12:13], v[26:27] op_sel_hi:[0,1,1]
    ds_write_addtid_b32 v68 offset:7888
    v_cvt_pk_bf16_f32 v69, v24, v25
    v_cvt_pk_bf16_f32 v66, v26, v27
    v_pk_mul_f32 v[24:25], v[32:33], v[14:15] op_sel:[1,1] op_sel_hi:[1,0] neg_lo:[0,1]
    ds_write_addtid_b32 v69 offset:5984
    v_pk_mul_f32 v[26:27], v[34:35], v[14:15] op_sel:[1,1] op_sel_hi:[1,0] neg_lo:[0,1]
    v_pk_fma_f32 v[24:25], v[32:33], v[14:15], v[24:25] op_sel_hi:[0,1,1]
    v_pk_fma_f32 v[26:27], v[34:35], v[14:15], v[26:27] op_sel_hi:[0,1,1]
    ds_write_addtid_b32 v66 offset:8160
    v_cvt_pk_bf16_f32 v67, v24, v25
    v_cvt_pk_bf16_f32 v68, v26, v27
    ds_write_addtid_b32 v67 offset:6256
    ds_write_addtid_b32 v68 offset:8432
    ds_read_b128 v[40:43], v74 offset:4352
    ds_read_b128 v[44:47], v74 offset:4416
    ds_read_b128 v[48:51], v74 offset:4480
    ds_read_b128 v[52:55], v74 offset:4544
    v_readfirstlane_b32 s14, v104
    v_readfirstlane_b32 s15, v105
    s_add_u32 s14, s14, 1
    s_addc_u32 s15, s15, 0
    s_lshl_b32 s81, s7, 6
    s_lshl_b32 s82, s4, 15
    s_add_u32 s81, s81, s82
    s_add_u32 s81, s81, 1048576
    v_lshlrev_b32 v108, 12, v127
    v_and_b32 v108, 0x4000, v108
    v_and_b32 v104, 3, v127
    v_lshl_add_u32 v108, v104, 4, v108
    v_mov_b32 v104, s14
    v_mov_b32 v105, s15
    v_mov_b32 v106, s14
    v_mov_b32 v107, s15
    s_waitcnt vmcnt(0)
    s_waitcnt lgkmcnt(0)
    s_barrier
    s_mov_b64 exec, 0xff
    buffer_store_dwordx4 v[104:107], v108, s[52:55], s81 offen sc1
    s_mov_b64 exec, -1
    s_nop 0
    global_load_dwordx4 v[104:107], v75, s[96:97]
    global_load_dwordx4 v[108:111], v75, s[96:97] offset:16
    global_load_dwordx2 v[0:1], v75, s[96:97] offset:32
    v_pk_mul_f32 v[36:37], v[32:33], v[30:31] op_sel:[1,1] op_sel_hi:[1,0] neg_lo:[0,1]
    v_pk_mul_f32 v[38:39], v[34:35], v[30:31] op_sel:[1,1] op_sel_hi:[1,0] neg_lo:[0,1]
    v_pk_fma_f32 v[36:37], v[32:33], v[30:31], v[36:37] op_sel_hi:[0,1,1]
    v_pk_fma_f32 v[38:39], v[34:35], v[30:31], v[38:39] op_sel_hi:[0,1,1]
    v_cvt_pk_bf16_f32 v69, v36, v37
    s_add_u32 m0, s80, 0
    s_nop 0
    buffer_load_dwordx4 v121, s[56:59], s98 offen lds
    s_mov_b32 m0, s22
    v_cvt_pk_bf16_f32 v66, v38, v39
    v_pk_mul_f32 v[24:25], v[36:37], v[4:5] op_sel:[1,1] op_sel_hi:[1,0] neg_lo:[0,1]
    ds_write_addtid_b32 v69 offset:8704
    v_pk_mul_f32 v[26:27], v[38:39], v[4:5] op_sel:[1,1] op_sel_hi:[1,0] neg_lo:[0,1]
    v_pk_fma_f32 v[24:25], v[36:37], v[4:5], v[24:25] op_sel_hi:[0,1,1]
    v_pk_fma_f32 v[26:27], v[38:39], v[4:5], v[26:27] op_sel_hi:[0,1,1]
    ds_write_addtid_b32 v66 offset:9792
    v_cvt_pk_bf16_f32 v67, v24, v25
    v_cvt_pk_bf16_f32 v68, v26, v27
    v_pk_mul_f32 v[24:25], v[36:37], v[8:9] op_sel:[1,1] op_sel_hi:[1,0] neg_lo:[0,1]
    ds_write_addtid_b32 v67 offset:8976
    v_pk_mul_f32 v[26:27], v[38:39], v[8:9] op_sel:[1,1] op_sel_hi:[1,0] neg_lo:[0,1]
    v_pk_fma_f32 v[24:25], v[36:37], v[8:9], v[24:25] op_sel_hi:[0,1,1]
    v_pk_fma_f32 v[26:27], v[38:39], v[8:9], v[26:27] op_sel_hi:[0,1,1]
    ds_write_addtid_b32 v68 offset:10064
    v_cvt_pk_bf16_f32 v69, v24, v25
    v_cvt_pk_bf16_f32 v66, v26, v27
    v_pk_mul_f32 v[24:25], v[36:37], v[12:13] op_sel:[1,1] op_sel_hi:[1,0] neg_lo:[0,1]
    ds_write_addtid_b32 v69 offset:9248
    v_pk_mul_f32 v[26:27], v[38:39], v[12:13] op_sel:[1,1] op_sel_hi:[1,0] neg_lo:[0,1]
    v_pk_fma_f32 v[24:25], v[36:37], v[12:13], v[24:25] op_sel_hi:[0,1,1]
    v_pk_fma_f32 v[26:27], v[38:39], v[12:13], v[26:27] op_sel_hi:[0,1,1]
    ds_write_addtid_b32 v66 offset:10336
    v_cvt_pk_bf16_f32 v67, v24, v25
    v_cvt_pk_bf16_f32 v68, v26, v27
    v_mfma_f32_16x16x32_bf16 v[76:79], v[40:43], v[88:91], 0
    ds_write_addtid_b32 v67 offset:9520
    v_mfma_f32_16x16x32_bf16 v[76:79], v[44:47], v[92:95], v[76:79]
    v_mfma_f32_16x16x32_bf16 v[76:79], v[48:51], v[96:99], v[76:79]
    s_add_u32 m0, s80, 1024
    s_add_u32 s98, s98, 28672
    buffer_load_dwordx4 v121, s[56:59], s98 offen lds
    s_mov_b32 m0, s22
    v_mfma_f32_16x16x32_bf16 v[76:79], v[52:55], v[100:103], v[76:79]
    ds_write_addtid_b32 v68 offset:10608
    v_pk_mul_f32 v[32:33], v[36:37], v[30:31] op_sel:[1,1] op_sel_hi:[1,0] neg_lo:[0,1]
    v_pk_mul_f32 v[34:35], v[38:39], v[30:31] op_sel:[1,1] op_sel_hi:[1,0] neg_lo:[0,1]
    v_pk_fma_f32 v[32:33], v[36:37], v[30:31], v[32:33] op_sel_hi:[0,1,1]
    v_pk_fma_f32 v[34:35], v[38:39], v[30:31], v[34:35] op_sel_hi:[0,1,1]
    v_cvt_pk_bf16_f32 v69, v32, v33
    v_cvt_pk_bf16_f32 v66, v34, v35
    v_pk_mul_f32 v[24:25], v[32:33], v[8:9] op_sel:[1,1] op_sel_hi:[1,0] neg_lo:[0,1]
    ds_write_addtid_b32 v69 offset:10880
    v_pk_mul_f32 v[26:27], v[34:35], v[8:9] op_sel:[1,1] op_sel_hi:[1,0] neg_lo:[0,1]
    v_pk_fma_f32 v[24:25], v[32:33], v[8:9], v[24:25] op_sel_hi:[0,1,1]
    v_pk_fma_f32 v[26:27], v[34:35], v[8:9], v[26:27] op_sel_hi:[0,1,1]
    ds_write_addtid_b32 v66 offset:11424
    v_cvt_pk_bf16_f32 v67, v24, v25
    v_cvt_pk_bf16_f32 v68, v26, v27
    v_pk_mul_f32 v[36:37], v[32:33], v[30:31] op_sel:[1,1] op_sel_hi:[1,0] neg_lo:[0,1]
    ds_write_addtid_b32 v67 offset:11152
    v_pk_mul_f32 v[38:39], v[34:35], v[30:31] op_sel:[1,1] op_sel_hi:[1,0] neg_lo:[0,1]
    v_pk_fma_f32 v[36:37], v[32:33], v[30:31], v[36:37] op_sel_hi:[0,1,1]
    v_pk_fma_f32 v[38:39], v[34:35], v[30:31], v[38:39] op_sel_hi:[0,1,1]
    ds_write_addtid_b32 v68 offset:11696
    v_cvt_pk_bf16_f32 v69, v36, v37
    v_cvt_pk_bf16_f32 v66, v38, v39
    v_pk_mul_f32 v[24:25], v[36:37], v[8:9] op_sel:[1,1] op_sel_hi:[1,0] neg_lo:[0,1]
    ds_write_addtid_b32 v69 offset:11968
    v_pk_mul_f32 v[26:27], v[38:39], v[8:9] op_sel:[1,1] op_sel_hi:[1,0] neg_lo:[0,1]
    v_pk_fma_f32 v[24:25], v[36:37], v[8:9], v[24:25] op_sel_hi:[0,1,1]
    v_pk_fma_f32 v[26:27], v[38:39], v[8:9], v[26:27] op_sel_hi:[0,1,1]
    ds_write_addtid_b32 v66 offset:12512
    v_cvt_pk_bf16_f32 v67, v24, v25
    s_add_u32 m0, s80, 2048
    s_add_u32 s98, s98, 28672
    buffer_load_dwordx4 v121, s[56:59], s98 offen lds
    s_mov_b32 m0, s22
    v_cvt_pk_bf16_f32 v68, v26, v27
    ds_write_addtid_b32 v67 offset:12240
    ds_write_addtid_b32 v68 offset:12784
    ds_read_b128 v[40:43], v74 offset:8704
    ds_read_b128 v[44:47], v74 offset:8768
    ds_read_b128 v[48:51], v74 offset:8832
    ds_read_b128 v[52:55], v74 offset:8896
    v_pk_mul_f32 v[32:33], v[36:37], v[30:31] op_sel:[1,1] op_sel_hi:[1,0] neg_lo:[0,1]
    v_pk_mul_f32 v[34:35], v[38:39], v[30:31] op_sel:[1,1] op_sel_hi:[1,0] neg_lo:[0,1]
    v_pk_fma_f32 v[32:33], v[36:37], v[30:31], v[32:33] op_sel_hi:[0,1,1]
    v_pk_fma_f32 v[34:35], v[38:39], v[30:31], v[34:35] op_sel_hi:[0,1,1]
    v_cvt_pk_bf16_f32 v69, v32, v33
    v_cvt_pk_bf16_f32 v66, v34, v35
    v_pk_mul_f32 v[36:37], v[32:33], v[30:31] op_sel:[1,1] op_sel_hi:[1,0] neg_lo:[0,1]
    ds_write_addtid_b32 v69 offset:13056
    v_pk_mul_f32 v[38:39], v[34:35], v[30:31] op_sel:[1,1] op_sel_hi:[1,0] neg_lo:[0,1]
    v_pk_fma_f32 v[36:37], v[32:33], v[30:31], v[36:37] op_sel_hi:[0,1,1]
    v_pk_fma_f32 v[38:39], v[34:35], v[30:31], v[38:39] op_sel_hi:[0,1,1]
    ds_write_addtid_b32 v66 offset:13328
    v_cvt_pk_bf16_f32 v67, v36, v37
    v_cvt_pk_bf16_f32 v68, v38, v39
    v_pk_mul_f32 v[32:33], v[36:37], v[30:31] op_sel:[1,1] op_sel_hi:[1,0] neg_lo:[0,1]
    ds_write_addtid_b32 v67 offset:13600
    v_pk_mul_f32 v[34:35], v[38:39], v[30:31] op_sel:[1,1] op_sel_hi:[1,0] neg_lo:[0,1]
    v_pk_fma_f32 v[32:33], v[36:37], v[30:31], v[32:33] op_sel_hi:[0,1,1]
    v_pk_fma_f32 v[34:35], v[38:39], v[30:31], v[34:35] op_sel_hi:[0,1,1]
    ds_write_addtid_b32 v68 offset:13872
    v_cvt_pk_bf16_f32 v69, v32, v33
    v_cvt_pk_bf16_f32 v66, v34, v35
    v_pk_mul_f32 v[36:37], v[32:33], v[30:31] op_sel:[1,1] op_sel_hi:[1,0] neg_lo:[0,1]
    ds_write_addtid_b32 v69 offset:14144
    v_pk_mul_f32 v[38:39], v[34:35], v[30:31] op_sel:[1,1] op_sel_hi:[1,0] neg_lo:[0,1]
    v_pk_fma_f32 v[36:37], v[32:33], v[30:31], v[36:37] op_sel_hi:[0,1,1]
    v_pk_fma_f32 v[38:39], v[34:35], v[30:31], v[38:39] op_sel_hi:[0,1,1]
    s_add_u32 m0, s80, 3072
    s_add_u32 s98, s98, 28672
    buffer_load_dwordx4 v121, s[56:59], s98 offen lds
    s_mov_b32 m0, s22
    s_nop 0
    ds_write_addtid_b32 v66 offset:14416
    v_cvt_pk_bf16_f32 v67, v36, v37
    v_cvt_pk_bf16_f32 v68, v38, v39
    v_pk_mul_f32 v[32:33], v[36:37], v[30:31] op_sel:[1,1] op_sel_hi:[1,0] neg_lo:[0,1]
    ds_write_addtid_b32 v67 offset:14688
    v_pk_fma_f32 v[32:33], v[36:37], v[30:31], v[32:33] op_sel_hi:[0,1,1]
    v_cvt_pk_bf16_f32 v69, v32, v33
    s_waitcnt lgkmcnt(7)
    v_mfma_f32_16x16x32_bf16 v[80:83], v[40:43], v[88:91], 0
    ds_write_addtid_b32 v68 offset:14960
    v_mfma_f32_16x16x32_bf16 v[80:83], v[44:47], v[92:95], v[80:83]
    v_mfma_f32_16x16x32_bf16 v[80:83], v[48:51], v[96:99], v[80:83]
    v_mfma_f32_16x16x32_bf16 v[80:83], v[52:55], v[100:103], v[80:83]
    ds_write_addtid_b32 v69 offset:15232
    ds_read_b128 v[40:43], v74 offset:13056
    ds_read_b128 v[44:47], v74 offset:13120
    ds_read_b128 v[48:51], v74 offset:13184
    ds_read_b128 v[52:55], v74 offset:13248
    v_and_b32 v70, s0, v56
    v_and_b32 v71, s0, v57
    v_and_b32 v24, s0, v58
    v_and_b32 v25, s0, v59
    v_and_b32 v26, s0, v60
    v_and_b32 v27, s0, v61
    v_mul_f32_e64 v70, v72, v70
    s_add_u32 m0, s80, 4096
    s_add_u32 s98, s98, 28672
    buffer_load_dwordx4 v121, s[56:59], s98 offen lds
    s_mov_b32 m0, s22
    v_mul_f32 v71, v72, v71
    v_pk_mul_f32 v[24:25], v[24:25], v[72:73] op_sel_hi:[1,0]
    v_mul_f32 v70, 0x3fb8aa3b, v70
    v_mul_f32 v71, 0x3e22f983, v71
    v_pk_mul_f32 v[32:33], v[26:27], v[24:25] op_sel:[1,1] op_sel_hi:[1,0] neg_lo:[0,1]
    v_pk_fma_f32 v[32:33], v[26:27], v[24:25], v[32:33] op_sel_hi:[0,1,1]
    v_fract_f32 v64, v71
    v_exp_f32 v62, v70
    v_cos_f32 v2, v64
    v_sin_f32_e64 v3, v64
    s_nop 0
    v_pk_mul_f32 v[2:3], v[2:3], v[62:63] op_sel_hi:[1,0]
    s_waitcnt lgkmcnt(0)
    v_mfma_f32_16x16x32_bf16 v[84:87], v[40:43], v[88:91], 0
    v_mfma_f32_16x16x32_bf16 v[84:87], v[44:47], v[92:95], v[84:87]
    v_mfma_f32_16x16x32_bf16 v[84:87], v[48:51], v[96:99], v[84:87]
    v_mfma_f32_16x16x32_bf16 v[84:87], v[52:55], v[100:103], v[84:87]
    v_mul_f32 v62, 0x43000000, v70
    v_mul_f32 v64, 0x43000000, v71
    v_fract_f32 v64, v64
    v_exp_f32 v62, v62
    v_cos_f32_e64 v28, v64
    s_add_u32 m0, s80, 5120
    s_add_u32 s98, s98, 28672
    buffer_load_dwordx4 v121, s[56:59], s98 offen lds
    s_mov_b32 m0, s22
    v_sin_f32_e64 v29, v64
    s_nop 0
    v_pk_mul_f32 v[28:29], v[28:29], v[62:63] op_sel_hi:[1,0]
    v_pk_mul_f32 v[4:5], v[2:3], v[2:3] op_sel:[1,1] op_sel_hi:[1,0] neg_lo:[0,1]
    v_pk_mul_f32 v[30:31], v[28:29], v[28:29] op_sel:[1,1] op_sel_hi:[1,0] neg_lo:[0,1]
    v_pk_fma_f32 v[4:5], v[2:3], v[2:3], v[4:5] op_sel_hi:[0,1,1]
    v_pk_fma_f32 v[30:31], v[28:29], v[28:29], v[30:31] op_sel_hi:[0,1,1]
    v_pk_mul_f32 v[8:9], v[4:5], v[4:5] op_sel:[1,1] op_sel_hi:[1,0] neg_lo:[0,1]
    v_pk_mul_f32 v[6:7], v[4:5], v[2:3] op_sel:[1,1] op_sel_hi:[1,0] neg_lo:[0,1]
    v_pk_fma_f32 v[8:9], v[4:5], v[4:5], v[8:9] op_sel_hi:[0,1,1]
    v_pk_fma_f32 v[6:7], v[4:5], v[2:3], v[6:7] op_sel_hi:[0,1,1]
    v_pk_mul_f32 v[16:17], v[8:9], v[8:9] op_sel:[1,1] op_sel_hi:[1,0] neg_lo:[0,1]
    v_pk_mul_f32 v[34:35], v[32:33], v[28:29] op_sel:[1,1] op_sel_hi:[1,0] neg_lo:[0,1]
    v_pk_fma_f32 v[16:17], v[8:9], v[8:9], v[16:17] op_sel_hi:[0,1,1]
    v_pk_fma_f32 v[34:35], v[32:33], v[28:29], v[34:35] op_sel_hi:[0,1,1]
    v_mov_b32 v69, 0x3f80
    v_pk_mul_f32 v[18:19], v[16:17], v[16:17] op_sel:[1,1] op_sel_hi:[1,0] neg_lo:[0,1]
    v_pk_mul_f32 v[10:11], v[8:9], v[2:3] op_sel:[1,1] op_sel_hi:[1,0] neg_lo:[0,1]
    ds_write_b32 v73, v69
    v_pk_fma_f32 v[18:19], v[16:17], v[16:17], v[18:19] op_sel_hi:[0,1,1]
    v_pk_fma_f32 v[10:11], v[8:9], v[2:3], v[10:11] op_sel_hi:[0,1,1]
    v_cvt_pk_bf16_f32 v66, v16, -v17
    v_pk_mul_f32 v[20:21], v[18:19], v[16:17] op_sel:[1,1] op_sel_hi:[1,0] neg_lo:[0,1]
    v_pk_mul_f32 v[22:23], v[18:19], v[18:19] op_sel:[1,1] op_sel_hi:[1,0] neg_lo:[0,1]
    ds_write_addtid_b32 v66 offset:272
    v_pk_fma_f32 v[20:21], v[18:19], v[16:17], v[20:21] op_sel_hi:[0,1,1]
    v_pk_fma_f32 v[22:23], v[18:19], v[18:19], v[22:23] op_sel_hi:[0,1,1]
    v_cvt_pk_bf16_f32 v67, v18, -v19
    v_pk_mul_f32 v[12:13], v[8:9], v[4:5] op_sel:[1,1] op_sel_hi:[1,0] neg_lo:[0,1]
    v_pk_mul_f32 v[14:15], v[8:9], v[6:7] op_sel:[1,1] op_sel_hi:[1,0] neg_lo:[0,1]
    ds_write_addtid_b32 v67 offset:544
    v_pk_fma_f32 v[12:13], v[8:9], v[4:5], v[12:13] op_sel_hi:[0,1,1]
    v_pk_fma_f32 v[14:15], v[8:9], v[6:7], v[14:15] op_sel_hi:[0,1,1]
    v_cvt_pk_bf16_f32 v68, v20, -v21
    s_add_u32 m0, s80, 6144
    s_add_u32 s98, s98, 28672
    buffer_load_dwordx4 v121, s[56:59], s98 offen lds
    s_mov_b32 m0, s22
    v_cvt_pk_bf16_f32 v69, v22, -v23
    v_pk_mul_f32 v[24:25], v[16:17], v[22:23] op_sel:[1,1] op_sel_hi:[1,0] neg_lo:[0,1]
    ds_write_addtid_b32 v68 offset:816
    v_pk_mul_f32 v[26:27], v[18:19], v[22:23] op_sel:[1,1] op_sel_hi:[1,0] neg_lo:[0,1]
    v_pk_fma_f32 v[24:25], v[16:17], v[22:23], v[24:25] op_sel_hi:[0,1,1]
    v_pk_fma_f32 v[26:27], v[18:19], v[22:23], v[26:27] op_sel_hi:[0,1,1]
    ds_write_addtid_b32 v69 offset:1088
    v_cvt_pk_bf16_f32 v66, v24, -v25
    v_cvt_pk_bf16_f32 v67, v26, -v27
    v_pk_mul_f32 v[36:37], v[20:21], v[22:23] op_sel:[1,1] op_sel_hi:[1,0] neg_lo:[0,1]
    ds_write_addtid_b32 v66 offset:1360
    v_pk_mul_f32 v[16:17], v[22:23], v[22:23] op_sel:[1,1] op_sel_hi:[1,0] neg_lo:[0,1]
    v_pk_fma_f32 v[36:37], v[20:21], v[22:23], v[36:37] op_sel_hi:[0,1,1]
    v_pk_fma_f32 v[16:17], v[22:23], v[22:23], v[16:17] op_sel_hi:[0,1,1]
    ds_write_addtid_b32 v67 offset:1632
    v_cvt_pk_bf16_f32 v68, v36, -v37
    v_cvt_pk_bf16_f32 v69, v16, -v17
    v_pk_mul_f32 v[18:19], v[24:25], v[22:23] op_sel:[1,1] op_sel_hi:[1,0] neg_lo:[0,1]
    ds_write_addtid_b32 v68 offset:1904
    v_pk_mul_f32 v[20:21], v[26:27], v[22:23] op_sel:[1,1] op_sel_hi:[1,0] neg_lo:[0,1]
    v_pk_fma_f32 v[18:19], v[24:25], v[22:23], v[18:19] op_sel_hi:[0,1,1]
    v_pk_fma_f32 v[20:21], v[26:27], v[22:23], v[20:21] op_sel_hi:[0,1,1]
    ds_write_addtid_b32 v69 offset:2176
    v_cvt_pk_bf16_f32 v66, v18, -v19
    v_cvt_pk_bf16_f32 v67, v20, -v21
    v_pk_mul_f32 v[24:25], v[36:37], v[22:23] op_sel:[1,1] op_sel_hi:[1,0] neg_lo:[0,1]
    ds_write_addtid_b32 v66 offset:2448
    v_pk_mul_f32 v[26:27], v[16:17], v[22:23] op_sel:[1,1] op_sel_hi:[1,0] neg_lo:[0,1]
    v_pk_fma_f32 v[24:25], v[36:37], v[22:23], v[24:25] op_sel_hi:[0,1,1]
    v_pk_fma_f32 v[26:27], v[16:17], v[22:23], v[26:27] op_sel_hi:[0,1,1]
    ds_write_addtid_b32 v67 offset:2720
    v_cvt_pk_bf16_f32 v68, v24, -v25
    v_cvt_pk_bf16_f32 v69, v26, -v27
    v_pk_mul_f32 v[36:37], v[18:19], v[22:23] op_sel:[1,1] op_sel_hi:[1,0] neg_lo:[0,1]
    s_add_u32 m0, s80, 7168
    s_add_u32 s98, s98, 28672
    buffer_load_dwordx4 v121, s[56:59], s98 offen lds
    s_mov_b32 m0, s22
    s_nop 0
    ds_write_addtid_b32 v68 offset:2992
    v_pk_mul_f32 v[16:17], v[20:21], v[22:23] op_sel:[1,1] op_sel_hi:[1,0] neg_lo:[0,1]
    v_pk_fma_f32 v[36:37], v[18:19], v[22:23], v[36:37] op_sel_hi:[0,1,1]
    v_pk_fma_f32 v[16:17], v[20:21], v[22:23], v[16:17] op_sel_hi:[0,1,1]
    ds_write_addtid_b32 v69 offset:3264
    v_cvt_pk_bf16_f32 v66, v36, -v37
    v_cvt_pk_bf16_f32 v67, v16, -v17
    v_pk_mul_f32 v[18:19], v[24:25], v[22:23] op_sel:[1,1] op_sel_hi:[1,0] neg_lo:[0,1]
    ds_write_addtid_b32 v66 offset:3536
    v_pk_fma_f32 v[18:19], v[24:25], v[22:23], v[18:19] op_sel_hi:[0,1,1]
    v_cvt_pk_bf16_f32 v68, v18, -v19
    ds_write_addtid_b32 v67 offset:3808
    ds_write_addtid_b32 v68 offset:4080
    ds_read_b128 v[88:91], v74 offset:0
    ds_read_b128 v[92:95], v74 offset:64
    ds_read_b128 v[96:99], v74 offset:128
    ds_read_b128 v[100:103], v74 offset:192
    v_cvt_pk_bf16_f32 v69, v32, v33
    v_cvt_pk_bf16_f32 v66, v34, v35
    v_pk_mul_f32 v[24:25], v[32:33], v[2:3] op_sel:[1,1] op_sel_hi:[1,0] neg_lo:[0,1]
    ds_write_addtid_b32 v69 offset:4352
    v_pk_mul_f32 v[26:27], v[34:35], v[2:3] op_sel:[1,1] op_sel_hi:[1,0] neg_lo:[0,1]
    v_pk_fma_f32 v[24:25], v[32:33], v[2:3], v[24:25] op_sel_hi:[0,1,1]
    v_pk_fma_f32 v[26:27], v[34:35], v[2:3], v[26:27] op_sel_hi:[0,1,1]
    ds_write_addtid_b32 v66 offset:6528
    v_cvt_pk_bf16_f32 v67, v24, v25
    v_cvt_pk_bf16_f32 v68, v26, v27
    v_pk_mul_f32 v[24:25], v[32:33], v[4:5] op_sel:[1,1] op_sel_hi:[1,0] neg_lo:[0,1]
    ds_write_addtid_b32 v67 offset:4624
    v_pk_mul_f32 v[26:27], v[34:35], v[4:5] op_sel:[1,1] op_sel_hi:[1,0] neg_lo:[0,1]
    v_pk_fma_f32 v[24:25], v[32:33], v[4:5], v[24:25] op_sel_hi:[0,1,1]
    v_pk_fma_f32 v[26:27], v[34:35], v[4:5], v[26:27] op_sel_hi:[0,1,1]
    ds_write_addtid_b32 v68 offset:6800
    v_cvt_pk_bf16_f32 v69, v24, v25
    v_cvt_pk_bf16_f32 v66, v26, v27
    v_pk_mul_f32 v[24:25], v[32:33], v[6:7] op_sel:[1,1] op_sel_hi:[1,0] neg_lo:[0,1]
    ds_write_addtid_b32 v69 offset:4896
    v_pk_mul_f32 v[26:27], v[34:35], v[6:7] op_sel:[1,1] op_sel_hi:[1,0] neg_lo:[0,1]
    v_pk_fma_f32 v[24:25], v[32:33], v[6:7], v[24:25] op_sel_hi:[0,1,1]
    v_pk_fma_f32 v[26:27], v[34:35], v[6:7], v[26:27] op_sel_hi:[0,1,1]
    ds_write_addtid_b32 v66 offset:7072
    v_cvt_pk_bf16_f32 v67, v24, v25
    v_cvt_pk_bf16_f32 v68, v26, v27
    v_pk_mul_f32 v[24:25], v[32:33], v[8:9] op_sel:[1,1] op_sel_hi:[1,0] neg_lo:[0,1]
    ds_write_addtid_b32 v67 offset:5168
    v_pk_mul_f32 v[26:27], v[34:35], v[8:9] op_sel:[1,1] op_sel_hi:[1,0] neg_lo:[0,1]
    v_pk_fma_f32 v[24:25], v[32:33], v[8:9], v[24:25] op_sel_hi:[0,1,1]
    v_pk_fma_f32 v[26:27], v[34:35], v[8:9], v[26:27] op_sel_hi:[0,1,1]
    ds_write_addtid_b32 v68 offset:7344
    v_cvt_pk_bf16_f32 v69, v24, v25
    v_cvt_pk_bf16_f32 v66, v26, v27
    v_pk_mul_f32 v[24:25], v[32:33], v[10:11] op_sel:[1,1] op_sel_hi:[1,0] neg_lo:[0,1]
    ds_write_addtid_b32 v69 offset:5440
    v_pk_mul_f32 v[26:27], v[34:35], v[10:11] op_sel:[1,1] op_sel_hi:[1,0] neg_lo:[0,1]
    v_pk_fma_f32 v[24:25], v[32:33], v[10:11], v[24:25] op_sel_hi:[0,1,1]
    v_pk_fma_f32 v[26:27], v[34:35], v[10:11], v[26:27] op_sel_hi:[0,1,1]
    ds_write_addtid_b32 v66 offset:7616
    v_cvt_pk_bf16_f32 v67, v24, v25
    v_cvt_pk_bf16_f32 v68, v26, v27
    v_pk_mul_f32 v[24:25], v[32:33], v[12:13] op_sel:[1,1] op_sel_hi:[1,0] neg_lo:[0,1]
    ds_write_addtid_b32 v67 offset:5712
    v_pk_mul_f32 v[26:27], v[34:35], v[12:13] op_sel:[1,1] op_sel_hi:[1,0] neg_lo:[0,1]
    v_pk_fma_f32 v[24:25], v[32:33], v[12:13], v[24:25] op_sel_hi:[0,1,1]
    v_pk_fma_f32 v[26:27], v[34:35], v[12:13], v[26:27] op_sel_hi:[0,1,1]
    ds_write_addtid_b32 v68 offset:7888
    v_cvt_pk_bf16_f32 v69, v24, v25
    v_cvt_pk_bf16_f32 v66, v26, v27
    v_pk_mul_f32 v[24:25], v[32:33], v[14:15] op_sel:[1,1] op_sel_hi:[1,0] neg_lo:[0,1]
    ds_write_addtid_b32 v69 offset:5984
    v_pk_mul_f32 v[26:27], v[34:35], v[14:15] op_sel:[1,1] op_sel_hi:[1,0] neg_lo:[0,1]
    v_pk_fma_f32 v[24:25], v[32:33], v[14:15], v[24:25] op_sel_hi:[0,1,1]
    v_pk_fma_f32 v[26:27], v[34:35], v[14:15], v[26:27] op_sel_hi:[0,1,1]
    ds_write_addtid_b32 v66 offset:8160
    v_cvt_pk_bf16_f32 v67, v24, v25
    v_cvt_pk_bf16_f32 v68, v26, v27
    ds_write_addtid_b32 v67 offset:6256
    ds_write_addtid_b32 v68 offset:8432
    ds_read_b128 v[40:43], v74 offset:4352
    ds_read_b128 v[44:47], v74 offset:4416
    ds_read_b128 v[48:51], v74 offset:4480
    ds_read_b128 v[52:55], v74 offset:4544
    v_pk_mul_f32 v[36:37], v[32:33], v[30:31] op_sel:[1,1] op_sel_hi:[1,0] neg_lo:[0,1]
    v_pk_mul_f32 v[38:39], v[34:35], v[30:31] op_sel:[1,1] op_sel_hi:[1,0] neg_lo:[0,1]
    v_pk_fma_f32 v[36:37], v[32:33], v[30:31], v[36:37] op_sel_hi:[0,1,1]
    v_pk_fma_f32 v[38:39], v[34:35], v[30:31], v[38:39] op_sel_hi:[0,1,1]
    v_cvt_pk_bf16_f32 v69, v36, v37
    v_cvt_pk_bf16_f32 v66, v38, v39
    v_pk_mul_f32 v[24:25], v[36:37], v[4:5] op_sel:[1,1] op_sel_hi:[1,0] neg_lo:[0,1]
    ds_write_addtid_b32 v69 offset:8704
    v_pk_mul_f32 v[26:27], v[38:39], v[4:5] op_sel:[1,1] op_sel_hi:[1,0] neg_lo:[0,1]
    v_pk_fma_f32 v[24:25], v[36:37], v[4:5], v[24:25] op_sel_hi:[0,1,1]
    v_pk_fma_f32 v[26:27], v[38:39], v[4:5], v[26:27] op_sel_hi:[0,1,1]
    ds_write_addtid_b32 v66 offset:9792
    v_cvt_pk_bf16_f32 v67, v24, v25
    v_cvt_pk_bf16_f32 v68, v26, v27
    v_pk_mul_f32 v[24:25], v[36:37], v[8:9] op_sel:[1,1] op_sel_hi:[1,0] neg_lo:[0,1]
    ds_write_addtid_b32 v67 offset:8976
    v_pk_mul_f32 v[26:27], v[38:39], v[8:9] op_sel:[1,1] op_sel_hi:[1,0] neg_lo:[0,1]
    v_pk_fma_f32 v[24:25], v[36:37], v[8:9], v[24:25] op_sel_hi:[0,1,1]
    v_pk_fma_f32 v[26:27], v[38:39], v[8:9], v[26:27] op_sel_hi:[0,1,1]
    ds_write_addtid_b32 v68 offset:10064
    v_cvt_pk_bf16_f32 v69, v24, v25
    v_cvt_pk_bf16_f32 v66, v26, v27
    v_pk_mul_f32 v[24:25], v[36:37], v[12:13] op_sel:[1,1] op_sel_hi:[1,0] neg_lo:[0,1]
    ds_write_addtid_b32 v69 offset:9248
    v_pk_mul_f32 v[26:27], v[38:39], v[12:13] op_sel:[1,1] op_sel_hi:[1,0] neg_lo:[0,1]
    v_pk_fma_f32 v[24:25], v[36:37], v[12:13], v[24:25] op_sel_hi:[0,1,1]
    v_pk_fma_f32 v[26:27], v[38:39], v[12:13], v[26:27] op_sel_hi:[0,1,1]
    ds_write_addtid_b32 v66 offset:10336
    v_cvt_pk_bf16_f32 v67, v24, v25
    v_cvt_pk_bf16_f32 v68, v26, v27
    s_waitcnt lgkmcnt(6)
    v_mfma_f32_16x16x32_bf16 v[76:79], v[40:43], v[88:91], v[76:79]
    ds_write_addtid_b32 v67 offset:9520
    v_mfma_f32_16x16x32_bf16 v[76:79], v[44:47], v[92:95], v[76:79]
    v_mfma_f32_16x16x32_bf16 v[76:79], v[48:51], v[96:99], v[76:79]
    v_mfma_f32_16x16x32_bf16 v[76:79], v[52:55], v[100:103], v[76:79]
    ds_write_addtid_b32 v68 offset:10608
    v_pk_mul_f32 v[32:33], v[36:37], v[30:31] op_sel:[1,1] op_sel_hi:[1,0] neg_lo:[0,1]
    v_pk_mul_f32 v[34:35], v[38:39], v[30:31] op_sel:[1,1] op_sel_hi:[1,0] neg_lo:[0,1]
    v_pk_fma_f32 v[32:33], v[36:37], v[30:31], v[32:33] op_sel_hi:[0,1,1]
    v_pk_fma_f32 v[34:35], v[38:39], v[30:31], v[34:35] op_sel_hi:[0,1,1]
    v_cvt_pk_bf16_f32 v69, v32, v33
    v_cvt_pk_bf16_f32 v66, v34, v35
    v_pk_mul_f32 v[24:25], v[32:33], v[8:9] op_sel:[1,1] op_sel_hi:[1,0] neg_lo:[0,1]
    ds_write_addtid_b32 v69 offset:10880
    v_pk_mul_f32 v[26:27], v[34:35], v[8:9] op_sel:[1,1] op_sel_hi:[1,0] neg_lo:[0,1]
    v_pk_fma_f32 v[24:25], v[32:33], v[8:9], v[24:25] op_sel_hi:[0,1,1]
    v_pk_fma_f32 v[26:27], v[34:35], v[8:9], v[26:27] op_sel_hi:[0,1,1]
    ds_write_addtid_b32 v66 offset:11424
    v_cvt_pk_bf16_f32 v67, v24, v25
    v_cvt_pk_bf16_f32 v68, v26, v27
    v_pk_mul_f32 v[36:37], v[32:33], v[30:31] op_sel:[1,1] op_sel_hi:[1,0] neg_lo:[0,1]
    ds_write_addtid_b32 v67 offset:11152
    v_pk_mul_f32 v[38:39], v[34:35], v[30:31] op_sel:[1,1] op_sel_hi:[1,0] neg_lo:[0,1]
    v_pk_fma_f32 v[36:37], v[32:33], v[30:31], v[36:37] op_sel_hi:[0,1,1]
    v_pk_fma_f32 v[38:39], v[34:35], v[30:31], v[38:39] op_sel_hi:[0,1,1]
    ds_write_addtid_b32 v68 offset:11696
    v_cvt_pk_bf16_f32 v69, v36, v37
    v_cvt_pk_bf16_f32 v66, v38, v39
    v_pk_mul_f32 v[24:25], v[36:37], v[8:9] op_sel:[1,1] op_sel_hi:[1,0] neg_lo:[0,1]
    ds_write_addtid_b32 v69 offset:11968
    v_pk_mul_f32 v[26:27], v[38:39], v[8:9] op_sel:[1,1] op_sel_hi:[1,0] neg_lo:[0,1]
    v_pk_fma_f32 v[24:25], v[36:37], v[8:9], v[24:25] op_sel_hi:[0,1,1]
    v_pk_fma_f32 v[26:27], v[38:39], v[8:9], v[26:27] op_sel_hi:[0,1,1]
    ds_write_addtid_b32 v66 offset:12512
    v_cvt_pk_bf16_f32 v67, v24, v25
    v_cvt_pk_bf16_f32 v68, v26, v27
    ds_write_addtid_b32 v67 offset:12240
    ds_write_addtid_b32 v68 offset:12784
    ds_read_b128 v[40:43], v74 offset:8704
    ds_read_b128 v[44:47], v74 offset:8768
    ds_read_b128 v[48:51], v74 offset:8832
    ds_read_b128 v[52:55], v74 offset:8896
    v_pk_mul_f32 v[32:33], v[36:37], v[30:31] op_sel:[1,1] op_sel_hi:[1,0] neg_lo:[0,1]
    v_pk_mul_f32 v[34:35], v[38:39], v[30:31] op_sel:[1,1] op_sel_hi:[1,0] neg_lo:[0,1]
    v_pk_fma_f32 v[32:33], v[36:37], v[30:31], v[32:33] op_sel_hi:[0,1,1]
    v_pk_fma_f32 v[34:35], v[38:39], v[30:31], v[34:35] op_sel_hi:[0,1,1]
    v_cvt_pk_bf16_f32 v69, v32, v33
    v_cvt_pk_bf16_f32 v66, v34, v35
    v_pk_mul_f32 v[36:37], v[32:33], v[30:31] op_sel:[1,1] op_sel_hi:[1,0] neg_lo:[0,1]
    ds_write_addtid_b32 v69 offset:13056
    v_pk_mul_f32 v[38:39], v[34:35], v[30:31] op_sel:[1,1] op_sel_hi:[1,0] neg_lo:[0,1]
    v_pk_fma_f32 v[36:37], v[32:33], v[30:31], v[36:37] op_sel_hi:[0,1,1]
    v_pk_fma_f32 v[38:39], v[34:35], v[30:31], v[38:39] op_sel_hi:[0,1,1]
    ds_write_addtid_b32 v66 offset:13328
    v_cvt_pk_bf16_f32 v67, v36, v37
    v_cvt_pk_bf16_f32 v68, v38, v39
    v_pk_mul_f32 v[32:33], v[36:37], v[30:31] op_sel:[1,1] op_sel_hi:[1,0] neg_lo:[0,1]
    ds_write_addtid_b32 v67 offset:13600
    v_pk_mul_f32 v[34:35], v[38:39], v[30:31] op_sel:[1,1] op_sel_hi:[1,0] neg_lo:[0,1]
    v_pk_fma_f32 v[32:33], v[36:37], v[30:31], v[32:33] op_sel_hi:[0,1,1]
    v_pk_fma_f32 v[34:35], v[38:39], v[30:31], v[34:35] op_sel_hi:[0,1,1]
    ds_write_addtid_b32 v68 offset:13872
    v_cvt_pk_bf16_f32 v69, v32, v33
    v_cvt_pk_bf16_f32 v66, v34, v35
    v_pk_mul_f32 v[36:37], v[32:33], v[30:31] op_sel:[1,1] op_sel_hi:[1,0] neg_lo:[0,1]
    ds_write_addtid_b32 v69 offset:14144
    v_pk_mul_f32 v[38:39], v[34:35], v[30:31] op_sel:[1,1] op_sel_hi:[1,0] neg_lo:[0,1]
    v_pk_fma_f32 v[36:37], v[32:33], v[30:31], v[36:37] op_sel_hi:[0,1,1]
    v_pk_fma_f32 v[38:39], v[34:35], v[30:31], v[38:39] op_sel_hi:[0,1,1]
    ds_write_addtid_b32 v66 offset:14416
    v_cvt_pk_bf16_f32 v67, v36, v37
    v_cvt_pk_bf16_f32 v68, v38, v39
    v_pk_mul_f32 v[32:33], v[36:37], v[30:31] op_sel:[1,1] op_sel_hi:[1,0] neg_lo:[0,1]
    ds_write_addtid_b32 v67 offset:14688
    v_pk_fma_f32 v[32:33], v[36:37], v[30:31], v[32:33] op_sel_hi:[0,1,1]
    v_cvt_pk_bf16_f32 v69, v32, v33
    s_waitcnt lgkmcnt(7)
    v_mfma_f32_16x16x32_bf16 v[80:83], v[40:43], v[88:91], v[80:83]
    ds_write_addtid_b32 v68 offset:14960
    v_mfma_f32_16x16x32_bf16 v[80:83], v[44:47], v[92:95], v[80:83]
    v_mfma_f32_16x16x32_bf16 v[80:83], v[48:51], v[96:99], v[80:83]
    v_mfma_f32_16x16x32_bf16 v[80:83], v[52:55], v[100:103], v[80:83]
    ds_write_addtid_b32 v69 offset:15232
    ds_read_b128 v[40:43], v74 offset:13056
    ds_read_b128 v[44:47], v74 offset:13120
    ds_read_b128 v[48:51], v74 offset:13184
    ds_read_b128 v[52:55], v74 offset:13248
    s_lshl_b32 s84, s5, 14
    s_add_u32 s84, s84, 1048576
    v_lshl_add_u32 v63, v63, 6, s84
    buffer_load_dwordx2 v[64:65], v63, s[52:55], 0 offen sc1
    s_mul_i32 s81, s4, 15616
    v_add_u32 v74, s81, v126
    v_mov_b32 v66, 0
    s_waitcnt vmcnt(11)
    v_and_b32 v2, s1, v104
    v_lshrrev_b32 v3, 16, v104
    v_and_b32 v4, s1, v105
    v_lshrrev_b32 v5, 16, v105
    v_and_b32 v6, s1, v106
    v_lshrrev_b32 v7, 16, v106
    v_and_b32 v8, s1, v107
    v_lshrrev_b32 v9, 16, v107
    s_waitcnt vmcnt(10)
    v_and_b32 v10, s1, v108
    v_lshrrev_b32 v11, 16, v108
    v_and_b32 v12, s1, v109
    v_lshrrev_b32 v13, 16, v109
    v_and_b32 v14, s1, v110
    v_lshrrev_b32 v15, 16, v110
    v_and_b32 v16, s1, v111
    v_lshrrev_b32 v17, 16, v111
    ds_write_b128 v74, v[76:79] offset:12288
    ds_write_b128 v74, v[80:83] offset:13312
    s_waitcnt lgkmcnt(2)
    v_mfma_f32_16x16x32_bf16 v[84:87], v[40:43], v[88:91], v[84:87]
    v_mfma_f32_16x16x32_bf16 v[84:87], v[44:47], v[92:95], v[84:87]
    v_mfma_f32_16x16x32_bf16 v[84:87], v[48:51], v[96:99], v[84:87]
    v_mfma_f32_16x16x32_bf16 v[84:87], v[52:55], v[100:103], v[84:87]
    ds_write_b32 v73, v66 offset:15360
    s_waitcnt vmcnt(9)
    v_and_b32 v18, 0xffff, v0
    v_lshrrev_b32 v19, 16, v0
    v_and_b32 v20, 0xffff, v1
    s_nop 2
    ds_write_b128 v74, v[84:87] offset:14336
    s_waitcnt lgkmcnt(0)
    s_barrier
    ds_read2st64_b32 v[22:23], v2 offset0:48 offset1:109
    ds_read2st64_b32 v[24:25], v3 offset0:48 offset1:109
    ds_read2st64_b32 v[26:27], v4 offset0:48 offset1:109
    ds_read2st64_b32 v[28:29], v5 offset0:48 offset1:109
    ds_read2st64_b32 v[30:31], v6 offset0:48 offset1:109
    ds_read2st64_b32 v[32:33], v7 offset0:48 offset1:109
    ds_read2st64_b32 v[34:35], v8 offset0:48 offset1:109
    ds_read2st64_b32 v[36:37], v9 offset0:48 offset1:109
    ds_read2st64_b32 v[38:39], v10 offset0:48 offset1:109
    ds_read2st64_b32 v[40:41], v11 offset0:48 offset1:109
    ds_read2st64_b32 v[42:43], v12 offset0:48 offset1:109
    ds_read2st64_b32 v[44:45], v13 offset0:48 offset1:109
    ds_read2st64_b32 v[46:47], v14 offset0:48 offset1:109
    ds_read2st64_b32 v[48:49], v15 offset0:48 offset1:109
    ds_read2st64_b32 v[50:51], v16 offset0:48 offset1:109
    ds_read2st64_b32 v[52:53], v17 offset0:48 offset1:109
    ds_read2st64_b32 v[54:55], v18 offset0:48 offset1:109
    ds_read2st64_b32 v[56:57], v19 offset0:48 offset1:109
    ds_read2st64_b32 v[58:59], v20 offset0:48 offset1:109
    s_waitcnt vmcnt(0)
    v_cmp_ne_u64 vcc, s[14:15], v[64:65]
    s_nop 0
    s_cbranch_vccz L_pok_4
    s_mov_b32 s85, 0
L_plp_5:
    buffer_load_dwordx2 v[64:65], v63, s[52:55], 0 offen sc1
    s_waitcnt vmcnt(0)
    v_cmp_ne_u64 vcc, s[14:15], v[64:65]
    s_add_u32 s85, s85, 1
    s_cbranch_vccz L_pok_4
    s_cmp_lt_u32 s85, 0x100000
    s_cbranch_scc1 L_plp_5
L_pok_4:
    buffer_load_dwordx4 v[64:67], v126, s[52:55], s16 offen sc1
    buffer_load_dwordx4 v[68:71], v126, s[52:55], s17 offen sc1
    buffer_load_dwordx4 v[72:75], v126, s[52:55], s18 offen sc1
    buffer_load_dwordx4 v[76:79], v126, s[52:55], s19 offen sc1
    buffer_load_dwordx4 v[80:83], v119, s[52:55], s20 offen sc1
    buffer_load_dwordx4 v[84:87], v119, s[52:55], s20 offen offset:64 sc1
    s_lshr_b32 s81, s4, 1
    s_and_b32 s82, s4, 1
    s_lshl_b32 s82, s82, 11
    v_lshl_add_u32 v63, v127, 5, s82
    s_cmp_lg_u32 s81, 0
    s_cselect_b32 s83, 1, 0
    s_mul_i32 s83, s83, 4160
    v_add_u32 v60, s83, v63
    s_cmp_lg_u32 s81, 0
    s_cselect_b32 s83, 6, 5
    s_mul_i32 s83, s83, 4160
    v_add_u32 v61, s83, v63
    s_cmp_lg_u32 s81, 0
    s_cselect_b32 s83, 7, 2
    s_mul_i32 s83, s83, 4160
    v_add_u32 v62, s83, v63
    s_cmp_lg_u32 s81, 0
    s_cselect_b32 s83, 4, 3
    s_mul_i32 s83, s83, 4160
    v_add_u32 v63, s83, v63
    v_mov_b32 v104, 0
    v_mov_b32 v105, 0
    v_mov_b32 v106, 0
    v_mov_b32 v107, 0
    v_bfe_u32 v108, v127, 1, 3
    v_mul_u32_u24 v108, 4160, v108
    v_and_b32 v109, 1, v127
    v_lshl_add_u32 v108, v109, 4, v108
    s_and_b32 s81, s4, 1
    s_mul_i32 s81, s81, 5120
    v_add_u32 v109, s81, v126
    s_waitcnt lgkmcnt(0)
    v_add_f32 v22, v22, v23
    v_add_f32 v24, v24, v25
    v_cvt_pk_bf16_f32 v2, v22, v24
    v_add_f32 v26, v26, v27
    v_cvt_pk_bf16_f32 v12, v24, v26
    v_add_f32 v28, v28, v29
    v_cvt_pk_bf16_f32 v3, v26, v28
    v_add_f32 v30, v30, v31
    v_cvt_pk_bf16_f32 v13, v28, v30
    v_add_f32 v32, v32, v33
    v_cvt_pk_bf16_f32 v4, v30, v32
    v_add_f32 v34, v34, v35
    v_cvt_pk_bf16_f32 v14, v32, v34
    v_add_f32 v36, v36, v37
    v_cvt_pk_bf16_f32 v5, v34, v36
    v_add_f32 v38, v38, v39
    v_cvt_pk_bf16_f32 v15, v36, v38
    v_add_f32 v40, v40, v41
    v_cvt_pk_bf16_f32 v6, v38, v40
    v_add_f32 v42, v42, v43
    v_cvt_pk_bf16_f32 v16, v40, v42
    v_add_f32 v44, v44, v45
    v_cvt_pk_bf16_f32 v7, v42, v44
    v_add_f32 v46, v46, v47
    v_cvt_pk_bf16_f32 v17, v44, v46
    v_add_f32 v48, v48, v49
    v_cvt_pk_bf16_f32 v8, v46, v48
    v_add_f32 v50, v50, v51
    v_cvt_pk_bf16_f32 v18, v48, v50
    v_add_f32 v52, v52, v53
    v_cvt_pk_bf16_f32 v9, v50, v52
    v_add_f32 v54, v54, v55
    v_cvt_pk_bf16_f32 v19, v52, v54
    v_add_f32 v56, v56, v57
    v_cvt_pk_bf16_f32 v10, v54, v56
    v_add_f32_e64 v58, v58, v59
    v_cvt_pk_bf16_f32 v20, v56, v58
    s_barrier
    v_pk_mov_b32 v[88:89], v[2:3], v[4:5] op_sel:[1,0]
    v_pk_mov_b32 v[90:91], v[4:5], v[6:7] op_sel:[1,0]
    v_pk_mov_b32 v[92:93], v[6:7], v[8:9] op_sel:[1,0]
    v_pk_mov_b32 v[94:95], v[8:9], v[10:11] op_sel:[1,0]
    v_pk_mov_b32 v[96:97], v[12:13], v[14:15] op_sel:[1,0]
    v_pk_mov_b32 v[98:99], v[14:15], v[16:17] op_sel:[1,0]
    v_pk_mov_b32 v[100:101], v[16:17], v[18:19] op_sel:[1,0]
    v_pk_mov_b32 v[102:103], v[18:19], v[20:21] op_sel:[1,0]
    ds_write_b128 v60, v[2:5]
    ds_write_b128 v60, v[6:9] offset:16
    s_waitcnt vmcnt(5)
    v_pk_mul_f32 v[64:65], v[64:65], s[34:35] op_sel_hi:[1,0]
    ds_write_b128 v61, v[12:15]
    s_waitcnt vmcnt(4)
    v_pk_mul_f32 v[68:69], v[68:69], s[34:35] op_sel_hi:[1,0]
    s_waitcnt vmcnt(3)
    v_pk_mul_f32 v[72:73], v[72:73], s[34:35] op_sel_hi:[1,0]
    s_waitcnt vmcnt(2)
    v_pk_mul_f32 v[76:77], v[76:77], s[34:35] op_sel_hi:[1,0]
    v_pk_fma_f32 v[40:41], v[64:65], v[64:65], s[100:101] op_sel_hi:[1,1,0] neg_lo:[1,0,0] neg_hi:[1,0,0]
    ds_write_b128 v61, v[16:19] offset:16
    v_pk_fma_f32 v[42:43], v[68:69], v[68:69], s[100:101] op_sel_hi:[1,1,0] neg_lo:[1,0,0] neg_hi:[1,0,0]
    v_pk_fma_f32 v[44:45], v[72:73], v[72:73], s[100:101] op_sel_hi:[1,1,0] neg_lo:[1,0,0] neg_hi:[1,0,0]
    v_pk_fma_f32 v[46:47], v[76:77], v[76:77], s[100:101] op_sel_hi:[1,1,0] neg_lo:[1,0,0] neg_hi:[1,0,0]
    v_pk_fma_f32 v[66:67], v[66:67], s[34:35], v[40:41] op_sel_hi:[1,0,1]
    ds_write_b128 v108, v[104:107] offset:4096
    v_pk_fma_f32 v[70:71], v[70:71], s[34:35], v[42:43] op_sel_hi:[1,0,1]
    v_pk_fma_f32 v[74:75], v[74:75], s[34:35], v[44:45] op_sel_hi:[1,0,1]
    v_pk_fma_f32 v[78:79], v[78:79], s[34:35], v[46:47] op_sel_hi:[1,0,1]
    v_max_f32 v66, s100, v66
    ds_write_b128 v109, v[104:107] offset:33280
    v_max_f32 v67, s100, v67
    v_max_f32 v70, s100, v70
    v_max_f32 v71, s100, v71
    v_max_f32 v74, s100, v74
    ds_write_b128 v62, v[88:91]
    v_max_f32 v75, s100, v75
    v_max_f32 v78, s100, v78
    v_max_f32 v79, s100, v79
    v_cvt_pk_bf16_f32 v65, v64, v65
    ds_write_b128 v62, v[92:95] offset:16
    v_cvt_pk_bf16_f32 v69, v68, v69
    v_cvt_pk_bf16_f32 v73, v72, v73
    v_cvt_pk_bf16_f32 v77, v76, v77
    v_lshlrev_b32 v64, 16, v65
    ds_write_b128 v63, v[96:99]
    v_and_b32 v65, s0, v65
    v_lshlrev_b32 v68, 16, v69
    v_and_b32 v69, s0, v69
    v_lshlrev_b32 v72, 16, v73
    ds_write_b128 v63, v[100:103] offset:16
    v_and_b32 v73, s0, v73
    v_lshlrev_b32 v76, 16, v77
    v_and_b32 v77, s0, v77
    v_rsq_f32 v32, v66
    v_rsq_f32 v33, v67
    v_rsq_f32 v34, v70
    v_rsq_f32 v35, v71
    v_rsq_f32 v36, v74
    v_rsq_f32 v37, v75
    v_rsq_f32 v38, v78
    v_rsq_f32 v39, v79
    s_waitcnt vmcnt(1)
    v_lshlrev_b32 v0, 16, v80
    v_and_b32 v1, s0, v80
    v_lshlrev_b32 v2, 16, v81
    v_and_b32 v3, s0, v81
    v_lshlrev_b32 v4, 16, v82
    v_and_b32 v5, s0, v82
    v_lshlrev_b32 v6, 16, v83
    v_and_b32 v7, s0, v83
    s_waitcnt vmcnt(0)
    v_lshlrev_b32 v8, 16, v84
    v_and_b32 v9, s0, v84
    v_lshlrev_b32 v10, 16, v85
    v_and_b32 v11, s0, v85
    v_lshlrev_b32 v12, 16, v86
    v_and_b32 v13, s0, v86
    v_lshlrev_b32 v14, 16, v87
    v_and_b32 v15, s0, v87
    v_pk_mul_f32 v[40:41], v[64:65], v[32:33] neg_lo:[1,0] neg_hi:[1,0]
    v_pk_mul_f32 v[42:43], v[68:69], v[34:35] neg_lo:[1,0] neg_hi:[1,0]
    v_pk_mul_f32 v[44:45], v[72:73], v[36:37] neg_lo:[1,0] neg_hi:[1,0]
    v_pk_mul_f32 v[46:47], v[76:77], v[38:39] neg_lo:[1,0] neg_hi:[1,0]
    v_pk_fma_f32 v[16:17], v[0:1], v[32:33], v[40:41]
    v_pk_fma_f32 v[18:19], v[2:3], v[34:35], v[42:43]
    v_pk_fma_f32 v[20:21], v[4:5], v[36:37], v[44:45]
    v_pk_fma_f32 v[22:23], v[6:7], v[38:39], v[46:47]
    v_cvt_pk_bf16_f32 v48, v16, v17
    v_cvt_pk_bf16_f32 v49, v18, v19
    v_cvt_pk_bf16_f32 v50, v20, v21
    v_cvt_pk_bf16_f32 v51, v22, v23
    ds_write_b128 v118, v[48:51] offset:34304
    v_pk_fma_f32 v[24:25], v[8:9], v[32:33], v[40:41]
    v_pk_fma_f32 v[26:27], v[10:11], v[34:35], v[42:43]
    v_pk_fma_f32 v[28:29], v[12:13], v[36:37], v[44:45]
    v_pk_fma_f32 v[30:31], v[14:15], v[38:39], v[46:47]
    v_cvt_pk_bf16_f32 v52, v24, v25
    v_cvt_pk_bf16_f32 v53, v26, v27
    v_cvt_pk_bf16_f32 v54, v28, v29
    v_cvt_pk_bf16_f32 v55, v30, v31
    ds_write_b128 v118, v[52:55] offset:39424
    v_pk_fma_f32 v[16:17], v[16:17], s[72:73], v[0:1] op_sel_hi:[1,0,1]
    v_pk_fma_f32 v[18:19], v[18:19], s[72:73], v[2:3] op_sel_hi:[1,0,1]
    v_pk_fma_f32 v[20:21], v[20:21], s[72:73], v[4:5] op_sel_hi:[1,0,1]
    v_pk_fma_f32 v[22:23], v[22:23], s[72:73], v[6:7] op_sel_hi:[1,0,1]
    v_cvt_pk_bf16_f32 v88, v16, v17
    v_cvt_pk_bf16_f32 v89, v18, v19
    v_cvt_pk_bf16_f32 v90, v20, v21
    v_cvt_pk_bf16_f32 v91, v22, v23
    v_pk_fma_f32 v[24:25], v[24:25], s[74:75], v[8:9] op_sel_hi:[1,0,1]
    v_pk_fma_f32 v[26:27], v[26:27], s[74:75], v[10:11] op_sel_hi:[1,0,1]
    v_pk_fma_f32 v[28:29], v[28:29], s[74:75], v[12:13] op_sel_hi:[1,0,1]
    v_pk_fma_f32 v[30:31], v[30:31], s[74:75], v[14:15] op_sel_hi:[1,0,1]
    v_cvt_pk_bf16_f32 v92, v24, v25
    v_cvt_pk_bf16_f32 v93, v26, v27
    v_cvt_pk_bf16_f32 v94, v28, v29
    v_cvt_pk_bf16_f32 v95, v30, v31
    s_waitcnt lgkmcnt(0)
    s_barrier
    ds_read_b64 v[64:65], v112 offset:192
    ds_read_b64 v[66:67], v112 offset:200
    ds_read_b128 v[32:35], v113 offset:192
    ds_read_b64 v[68:69], v112 offset:704
    ds_read_b64 v[70:71], v112 offset:712
    ds_read_b128 v[36:39], v113 offset:704
    ds_read_b64 v[72:73], v112 offset:1216
    ds_read_b64 v[74:75], v112 offset:1224
    ds_read_b128 v[40:43], v113 offset:1216
    ds_read_b64 v[76:77], v112 offset:1728
    ds_read_b64 v[78:79], v112 offset:1736
    ds_read_b128 v[44:47], v113 offset:1728
    ds_read_b64 v[80:81], v112 offset:2240
    ds_read_b64 v[82:83], v112 offset:2248
    ds_read_b128 v[48:51], v113 offset:2240
    ds_read_b128 v[52:55], v113 offset:2752
    ds_read_b128 v[56:59], v113 offset:3264
    ds_read_b128 v[60:63], v113 offset:3776
    s_waitcnt lgkmcnt(15)
    v_mfma_f32_16x16x32_bf16 v[28:31], v[64:67], v[32:35], 0
    ds_read_b64 v[84:85], v112 offset:2752
    ds_read_b64 v[86:87], v112 offset:2760
    s_waitcnt lgkmcnt(14)
    v_mfma_f32_16x16x32_bf16 v[24:27], v[68:71], v[32:35], 0
    ds_read_b64 v[64:65], v112 offset:3264
    ds_read_b64 v[66:67], v112 offset:3272
    v_mfma_f32_16x16x32_bf16 v[28:31], v[68:71], v[36:39], v[28:31]
    s_waitcnt lgkmcnt(12)
    v_mfma_f32_16x16x32_bf16 v[20:23], v[72:75], v[32:35], 0
    ds_read_b64 v[68:69], v112 offset:3776
    ds_read_b64 v[70:71], v112 offset:3784
    v_mfma_f32_16x16x32_bf16 v[24:27], v[72:75], v[36:39], v[24:27]
    s_add_u32 m0, s80, 8192
    s_nop 0
    buffer_load_dwordx4 v120, s[60:63], s99 offen lds
    v_mfma_f32_16x16x32_bf16 v[28:31], v[72:75], v[40:43], v[28:31]
    s_waitcnt lgkmcnt(6)
    v_mfma_f32_16x16x32_bf16 v[16:19], v[76:79], v[32:35], 0
    ds_read_b64 v[72:73], v112 offset:128
    ds_read_b64 v[74:75], v112 offset:136
    v_mfma_f32_16x16x32_bf16 v[20:23], v[76:79], v[36:39], v[20:23]
    ds_write_b128 v118, v[88:91] offset:43520
    v_mfma_f32_16x16x32_bf16 v[24:27], v[76:79], v[40:43], v[24:27]
    ds_write_b128 v118, v[92:95] offset:47616
    v_mfma_f32_16x16x32_bf16 v[28:31], v[76:79], v[44:47], v[28:31]
    s_lshl_b32 s81, s7, 6
    v_mfma_f32_16x16x32_bf16 v[12:15], v[80:83], v[32:35], 0
    ds_read_b64 v[76:77], v112 offset:640
    ds_read_b64 v[78:79], v112 offset:648
    v_mfma_f32_16x16x32_bf16 v[16:19], v[80:83], v[36:39], v[16:19]
    s_lshl_b32 s82, s4, 15
    v_mfma_f32_16x16x32_bf16 v[20:23], v[80:83], v[40:43], v[20:23]
    s_add_u32 m0, s80, 9216
    s_add_u32 s99, s99, 32768
    buffer_load_dwordx4 v120, s[60:63], s99 offen lds
    s_add_u32 s81, s81, s82
    v_mfma_f32_16x16x32_bf16 v[24:27], v[80:83], v[44:47], v[24:27]
    s_add_u32 s81, s81, 2490368
    v_mfma_f32_16x16x32_bf16 v[28:31], v[80:83], v[48:51], v[28:31]
    v_lshlrev_b32 v104, 12, v127
    s_waitcnt lgkmcnt(4)
    v_mfma_f32_16x16x32_bf16 v[8:11], v[84:87], v[32:35], 0
    ds_read_b64 v[80:81], v112 offset:1152
    ds_read_b64 v[82:83], v112 offset:1160
    v_mfma_f32_16x16x32_bf16 v[12:15], v[84:87], v[36:39], v[12:15]
    v_and_b32 v104, 0x4000, v104
    v_mfma_f32_16x16x32_bf16 v[16:19], v[84:87], v[40:43], v[16:19]
    v_and_b32_e64 v100, 3, v127
    v_mfma_f32_16x16x32_bf16 v[20:23], v[84:87], v[44:47], v[20:23]
    v_lshl_add_u32 v104, v100, 4, v104
    v_mfma_f32_16x16x32_bf16 v[24:27], v[84:87], v[48:51], v[24:27]
    v_add_u32_e64 v104, s81, v104
    s_add_u32 m0, s80, 10240
    s_add_u32 s99, s99, 32768
    buffer_load_dwordx4 v120, s[60:63], s99 offen lds
    v_mfma_f32_16x16x32_bf16 v[28:31], v[84:87], v[52:55], v[28:31]
    v_mov_b32_e64 v100, s14
    v_mfma_f32_16x16x32_bf16 v[4:7], v[64:67], v[32:35], 0
    ds_read_b64 v[84:85], v112 offset:1664
    ds_read_b64 v[86:87], v112 offset:1672
    v_mfma_f32_16x16x32_bf16 v[8:11], v[64:67], v[36:39], v[8:11]
    v_mov_b32 v101, s15
    v_mfma_f32_16x16x32_bf16 v[12:15], v[64:67], v[40:43], v[12:15]
    v_mov_b32 v102, s14
    v_mfma_f32_16x16x32_bf16 v[16:19], v[64:67], v[44:47], v[16:19]
    v_mov_b32_e64 v103, s15
    v_mfma_f32_16x16x32_bf16 v[20:23], v[64:67], v[48:51], v[20:23]
    v_mfma_f32_16x16x32_bf16 v[24:27], v[64:67], v[52:55], v[24:27]
    v_mfma_f32_16x16x32_bf16 v[28:31], v[64:67], v[56:59], v[28:31]
    s_add_u32 m0, s80, 11264
    s_add_u32 s99, s99, 32768
    buffer_load_dwordx4 v120, s[60:63], s99 offen lds
    v_mfma_f32_16x16x32_bf16 v[0:3], v[68:71], v[32:35], 0
    ds_read_b64 v[64:65], v112 offset:2176
    ds_read_b64 v[66:67], v112 offset:2184
    ds_read_b128 v[32:35], v113 offset:128
    v_mfma_f32_16x16x32_bf16 v[4:7], v[68:71], v[36:39], v[4:7]
    ds_read_b128 v[36:39], v113 offset:640
    v_mfma_f32_16x16x32_bf16 v[8:11], v[68:71], v[40:43], v[8:11]
    ds_read_b128 v[40:43], v113 offset:1152
    v_mfma_f32_16x16x32_bf16 v[12:15], v[68:71], v[44:47], v[12:15]
    ds_read_b128 v[44:47], v113 offset:1664
    v_mfma_f32_16x16x32_bf16 v[16:19], v[68:71], v[48:51], v[16:19]
    ds_read_b128 v[48:51], v113 offset:2176
    v_mfma_f32_16x16x32_bf16 v[20:23], v[68:71], v[52:55], v[20:23]
    ds_read_b128 v[52:55], v113 offset:2688
    v_mfma_f32_16x16x32_bf16 v[24:27], v[68:71], v[56:59], v[24:27]
    ds_read_b128 v[56:59], v113 offset:3200
    s_add_u32 m0, s80, 12288
    s_add_u32 s99, s99, 32768
    buffer_load_dwordx4 v120, s[60:63], s99 offen lds
    v_mfma_f32_16x16x32_bf16 v[28:31], v[68:71], v[60:63], v[28:31]
    ds_read_b128 v[60:63], v113 offset:3712
    s_waitcnt lgkmcnt(6)
    v_mfma_f32_16x16x32_bf16 v[28:31], v[72:75], v[32:35], v[28:31]
    ds_read_b64 v[68:69], v112 offset:2688
    ds_read_b64 v[70:71], v112 offset:2696
    v_mfma_f32_16x16x32_bf16 v[24:27], v[76:79], v[32:35], v[24:27]
    ds_read_b64 v[72:73], v112 offset:3200
    ds_read_b64 v[74:75], v112 offset:3208
    v_mfma_f32_16x16x32_bf16 v[28:31], v[76:79], v[36:39], v[28:31]
    v_mfma_f32_16x16x32_bf16 v[20:23], v[80:83], v[32:35], v[20:23]
    ds_read_b64 v[76:77], v112 offset:3712
    ds_read_b64 v[78:79], v112 offset:3720
    v_mfma_f32_16x16x32_bf16 v[24:27], v[80:83], v[36:39], v[24:27]
    s_waitcnt lgkmcnt(7)
    v_mfma_f32_16x16x32_bf16 v[28:31], v[80:83], v[40:43], v[28:31]
    v_mfma_f32_16x16x32_bf16 v[16:19], v[84:87], v[32:35], v[16:19]
    s_add_u32 m0, s80, 13312
    s_add_u32 s99, s99, 32768
    buffer_load_dwordx4 v120, s[60:63], s99 offen lds
    ds_read_b64 v[80:81], v112 offset:64
    ds_read_b64 v[82:83], v112 offset:72
    v_mfma_f32_16x16x32_bf16 v[20:23], v[84:87], v[36:39], v[20:23]
    v_mfma_f32_16x16x32_bf16 v[24:27], v[84:87], v[40:43], v[24:27]
    v_mfma_f32_16x16x32_bf16 v[28:31], v[84:87], v[44:47], v[28:31]
    v_mfma_f32_16x16x32_bf16 v[12:15], v[64:67], v[32:35], v[12:15]
    ds_read_b64 v[84:85], v112 offset:576
    ds_read_b64 v[86:87], v112 offset:584
    v_mfma_f32_16x16x32_bf16 v[16:19], v[64:67], v[36:39], v[16:19]
    v_mfma_f32_16x16x32_bf16 v[20:23], v[64:67], v[40:43], v[20:23]
    v_mfma_f32_16x16x32_bf16 v[24:27], v[64:67], v[44:47], v[24:27]
    v_mfma_f32_16x16x32_bf16 v[28:31], v[64:67], v[48:51], v[28:31]
    s_waitcnt lgkmcnt(4)
    v_mfma_f32_16x16x32_bf16 v[8:11], v[68:71], v[32:35], v[8:11]
    s_add_u32 m0, s80, 14336
    s_add_u32 s99, s99, 32768
    buffer_load_dwordx4 v120, s[60:63], s99 offen lds
    ds_read_b64 v[64:65], v112 offset:1088
    ds_read_b64 v[66:67], v112 offset:1096
    v_mfma_f32_16x16x32_bf16 v[12:15], v[68:71], v[36:39], v[12:15]
    v_mfma_f32_16x16x32_bf16 v[16:19], v[68:71], v[40:43], v[16:19]
    v_mfma_f32_16x16x32_bf16 v[20:23], v[68:71], v[44:47], v[20:23]
    v_mfma_f32_16x16x32_bf16 v[24:27], v[68:71], v[48:51], v[24:27]
    v_mfma_f32_16x16x32_bf16 v[28:31], v[68:71], v[52:55], v[28:31]
    v_mfma_f32_16x16x32_bf16 v[4:7], v[72:75], v[32:35], v[4:7]
    ds_read_b64 v[68:69], v112 offset:1600
    ds_read_b64 v[70:71], v112 offset:1608
    v_mfma_f32_16x16x32_bf16 v[8:11], v[72:75], v[36:39], v[8:11]
    v_mfma_f32_16x16x32_bf16 v[12:15], v[72:75], v[40:43], v[12:15]
    v_mfma_f32_16x16x32_bf16 v[16:19], v[72:75], v[44:47], v[16:19]
    s_add_u32 m0, s80, 15360
    s_add_u32 s99, s99, 32768
    buffer_load_dwordx4 v120, s[60:63], s99 offen lds
    v_mfma_f32_16x16x32_bf16 v[20:23], v[72:75], v[48:51], v[20:23]
    v_mfma_f32_16x16x32_bf16 v[24:27], v[72:75], v[52:55], v[24:27]
    v_mfma_f32_16x16x32_bf16 v[28:31], v[72:75], v[56:59], v[28:31]
    v_mfma_f32_16x16x32_bf16 v[0:3], v[76:79], v[32:35], v[0:3]
    ds_read_b64 v[72:73], v112 offset:2112
    ds_read_b64 v[74:75], v112 offset:2120
    ds_read_b128 v[32:35], v113 offset:64
    v_mfma_f32_16x16x32_bf16 v[4:7], v[76:79], v[36:39], v[4:7]
    ds_read_b128 v[36:39], v113 offset:576
    v_mfma_f32_16x16x32_bf16 v[8:11], v[76:79], v[40:43], v[8:11]
    ds_read_b128 v[40:43], v113 offset:1088
    v_mfma_f32_16x16x32_bf16 v[12:15], v[76:79], v[44:47], v[12:15]
    ds_read_b128 v[44:47], v113 offset:1600
    v_mfma_f32_16x16x32_bf16 v[16:19], v[76:79], v[48:51], v[16:19]
    s_add_u32 m0, s80, 16384
    s_add_u32 s98, s98, 28672
    s_cmp_eq_u32 s98, s78
    s_cselect_b32 s3, 1835008, 0
    s_sub_u32 s98, s98, s3
    buffer_load_dwordx4 v121, s[56:59], s98 offen lds
    ds_read_b128 v[48:51], v113 offset:2112
    v_mfma_f32_16x16x32_bf16 v[20:23], v[76:79], v[52:55], v[20:23]
    ds_read_b128 v[52:55], v113 offset:2624
    v_mfma_f32_16x16x32_bf16 v[24:27], v[76:79], v[56:59], v[24:27]
    ds_read_b128 v[56:59], v113 offset:3136
    v_mfma_f32_16x16x32_bf16 v[28:31], v[76:79], v[60:63], v[28:31]
    ds_read_b128 v[60:63], v113 offset:3648
    s_waitcnt lgkmcnt(5)
    v_mfma_f32_16x16x32_bf16 v[28:31], v[80:83], v[32:35], v[28:31]
    ds_read_b64 v[76:77], v112 offset:2624
    ds_read_b64 v[78:79], v112 offset:2632
    v_mfma_f32_16x16x32_bf16 v[24:27], v[84:87], v[32:35], v[24:27]
    ds_read_b64 v[80:81], v112 offset:3136
    ds_read_b64 v[82:83], v112 offset:3144
    v_mfma_f32_16x16x32_bf16 v[28:31], v[84:87], v[36:39], v[28:31]
    v_mfma_f32_16x16x32_bf16 v[20:23], v[64:67], v[32:35], v[20:23]
    ds_read_b64 v[84:85], v112 offset:3648
    s_add_u32 m0, s80, 17408
    s_add_u32 s98, s98, 28672
    buffer_load_dwordx4 v121, s[56:59], s98 offen lds
    ds_read_b64 v[86:87], v112 offset:3656
    v_mfma_f32_16x16x32_bf16 v[24:27], v[64:67], v[36:39], v[24:27]
    v_mfma_f32_16x16x32_bf16 v[28:31], v[64:67], v[40:43], v[28:31]
    v_mfma_f32_16x16x32_bf16 v[16:19], v[68:71], v[32:35], v[16:19]
    ds_read_b64 v[64:65], v112 offset:0
    ds_read_b64 v[66:67], v112 offset:8
    v_mfma_f32_16x16x32_bf16 v[20:23], v[68:71], v[36:39], v[20:23]
    s_barrier
    v_mfma_f32_16x16x32_bf16 v[24:27], v[68:71], v[40:43], v[24:27]
    ds_read_b64 v[88:89], v114 offset:43520
    s_waitcnt lgkmcnt(5)
    v_mfma_f32_16x16x32_bf16 v[28:31], v[68:71], v[44:47], v[28:31]
    ds_read_b64 v[90:91], v114 offset:44032
    v_mfma_f32_16x16x32_bf16 v[12:15], v[72:75], v[32:35], v[12:15]
    ds_read_b64 v[68:69], v112 offset:512
    ds_read_b64 v[70:71], v112 offset:520
    v_mfma_f32_16x16x32_bf16 v[16:19], v[72:75], v[36:39], v[16:19]
    s_add_u32 m0, s80, 18432
    s_add_u32 s98, s98, 28672
    buffer_load_dwordx4 v121, s[56:59], s98 offen lds
    ds_read_b64 v[92:93], v114 offset:44544
    v_mfma_f32_16x16x32_bf16 v[20:23], v[72:75], v[40:43], v[20:23]
    ds_read_b64 v[94:95], v114 offset:45056
    v_mfma_f32_16x16x32_bf16 v[24:27], v[72:75], v[44:47], v[24:27]
    v_mfma_f32_16x16x32_bf16 v[28:31], v[72:75], v[48:51], v[28:31]
    v_mfma_f32_16x16x32_bf16 v[8:11], v[76:79], v[32:35], v[8:11]
    ds_read_b64 v[72:73], v112 offset:1024
    ds_read_b64 v[74:75], v112 offset:1032
    v_mfma_f32_16x16x32_bf16 v[12:15], v[76:79], v[36:39], v[12:15]
    v_mfma_f32_16x16x32_bf16 v[16:19], v[76:79], v[40:43], v[16:19]
    v_mfma_f32_16x16x32_bf16 v[20:23], v[76:79], v[44:47], v[20:23]
    v_mfma_f32_16x16x32_bf16 v[24:27], v[76:79], v[48:51], v[24:27]
    v_mfma_f32_16x16x32_bf16 v[28:31], v[76:79], v[52:55], v[28:31]
    s_add_u32 m0, s80, 19456
    s_add_u32 s98, s98, 28672
    buffer_load_dwordx4 v121, s[56:59], s98 offen lds
    v_mfma_f32_16x16x32_bf16 v[4:7], v[80:83], v[32:35], v[4:7]
    ds_read_b64 v[76:77], v112 offset:1536
    ds_read_b64 v[78:79], v112 offset:1544
    v_mfma_f32_16x16x32_bf16 v[8:11], v[80:83], v[36:39], v[8:11]
    v_mfma_f32_16x16x32_bf16 v[12:15], v[80:83], v[40:43], v[12:15]
    v_mfma_f32_16x16x32_bf16 v[16:19], v[80:83], v[44:47], v[16:19]
    v_mfma_f32_16x16x32_bf16 v[20:23], v[80:83], v[48:51], v[20:23]
    v_mfma_f32_16x16x32_bf16 v[24:27], v[80:83], v[52:55], v[24:27]
    v_mfma_f32_16x16x32_bf16 v[28:31], v[80:83], v[56:59], v[28:31]
    s_waitcnt lgkmcnt(2)
    v_mfma_f32_16x16x32_bf16 v[0:3], v[84:87], v[32:35], v[0:3]
    ds_read_b64 v[80:81], v112 offset:2048
    ds_read_b64 v[82:83], v112 offset:2056
    ds_read_b128 v[32:35], v113 offset:0
    s_add_u32 m0, s80, 20480
    s_add_u32 s98, s98, 28672
    buffer_load_dwordx4 v121, s[56:59], s98 offen lds
    v_mfma_f32_16x16x32_bf16 v[4:7], v[84:87], v[36:39], v[4:7]
    ds_read_b128 v[36:39], v113 offset:512
    v_mfma_f32_16x16x32_bf16 v[8:11], v[84:87], v[40:43], v[8:11]
    ds_read_b128 v[40:43], v113 offset:1024
    v_mfma_f32_16x16x32_bf16 v[12:15], v[84:87], v[44:47], v[12:15]
    ds_read_b128 v[44:47], v113 offset:1536
    v_mfma_f32_16x16x32_bf16 v[16:19], v[84:87], v[48:51], v[16:19]
    ds_read_b128 v[48:51], v113 offset:2048
    v_mfma_f32_16x16x32_bf16 v[20:23], v[84:87], v[52:55], v[20:23]
    ds_read_b128 v[52:55], v113 offset:2560
    v_mfma_f32_16x16x32_bf16 v[24:27], v[84:87], v[56:59], v[24:27]
    ds_read_b128 v[56:59], v113 offset:3072
    v_mfma_f32_16x16x32_bf16 v[28:31], v[84:87], v[60:63], v[28:31]
    ds_read_b128 v[60:63], v113 offset:3584
    s_waitcnt lgkmcnt(7)
    v_mfma_f32_16x16x32_bf16 v[28:31], v[64:67], v[32:35], v[28:31]
    s_add_u32 m0, s80, 21504
    s_add_u32 s98, s98, 28672
    buffer_load_dwordx4 v121, s[56:59], s98 offen lds
    ds_read_b64 v[84:85], v112 offset:2560
    ds_read_b64 v[86:87], v112 offset:2568
    v_mfma_f32_16x16x32_bf16 v[24:27], v[68:71], v[32:35], v[24:27]
    ds_read_b64 v[64:65], v112 offset:3072
    ds_read_b64 v[66:67], v112 offset:3080
    s_waitcnt lgkmcnt(7)
    v_mfma_f32_16x16x32_bf16 v[28:31], v[68:71], v[36:39], v[28:31]
    v_mfma_f32_16x16x32_bf16 v[20:23], v[72:75], v[32:35], v[20:23]
    ds_read_b64 v[68:69], v112 offset:3584
    ds_read_b64 v[70:71], v112 offset:3592
    v_mfma_f32_16x16x32_bf16 v[24:27], v[72:75], v[36:39], v[24:27]
    v_mfma_f32_16x16x32_bf16 v[28:31], v[72:75], v[40:43], v[28:31]
    v_mfma_f32_16x16x32_bf16 v[16:19], v[76:79], v[32:35], v[16:19]
    v_mfma_f32_16x16x32_bf16 v[20:23], v[76:79], v[36:39], v[20:23]
    s_barrier
    v_mfma_f32_16x16x32_bf16 v[24:27], v[76:79], v[40:43], v[24:27]
    s_add_u32 m0, s80, 22528
    s_add_u32 s98, s98, 28672
    buffer_load_dwordx4 v121, s[56:59], s98 offen lds
    v_mfma_f32_16x16x32_bf16 v[28:31], v[76:79], v[44:47], v[28:31]
    v_mfma_f32_16x16x32_bf16 v[12:15], v[80:83], v[32:35], v[12:15]
    v_mfma_f32_16x16x32_bf16 v[16:19], v[80:83], v[36:39], v[16:19]
    v_mfma_f32_16x16x32_bf16 v[20:23], v[80:83], v[40:43], v[20:23]
    v_mfma_f32_16x16x32_bf16 v[24:27], v[80:83], v[44:47], v[24:27]
    v_mfma_f32_16x16x32_bf16 v[28:31], v[80:83], v[48:51], v[28:31]
    s_waitcnt lgkmcnt(0)
    v_mfma_f32_16x16x32_bf16 v[8:11], v[84:87], v[32:35], v[8:11]
    v_mfma_f32_16x16x32_bf16 v[12:15], v[84:87], v[36:39], v[12:15]
    v_mfma_f32_16x16x32_bf16 v[16:19], v[84:87], v[40:43], v[16:19]
    v_mfma_f32_16x16x32_bf16 v[20:23], v[84:87], v[44:47], v[20:23]
    s_add_u32 m0, s80, 23552
    s_add_u32 s98, s98, 28672
    buffer_load_dwordx4 v121, s[56:59], s98 offen lds
    v_mfma_f32_16x16x32_bf16 v[24:27], v[84:87], v[48:51], v[24:27]
    v_mfma_f32_16x16x32_bf16 v[28:31], v[84:87], v[52:55], v[28:31]
    v_mfma_f32_16x16x32_bf16 v[4:7], v[64:67], v[32:35], v[4:7]
    v_mfma_f32_16x16x32_bf16 v[8:11], v[64:67], v[36:39], v[8:11]
    v_mfma_f32_16x16x32_bf16 v[12:15], v[64:67], v[40:43], v[12:15]
    v_mfma_f32_16x16x32_bf16 v[16:19], v[64:67], v[44:47], v[16:19]
    v_mfma_f32_16x16x32_bf16 v[20:23], v[64:67], v[48:51], v[20:23]
    v_mfma_f32_16x16x32_bf16 v[24:27], v[64:67], v[52:55], v[24:27]
    v_mfma_f32_16x16x32_bf16 v[28:31], v[64:67], v[56:59], v[28:31]
    v_mfma_f32_16x16x32_bf16 v[0:3], v[68:71], v[32:35], v[0:3]
    v_mfma_f32_16x16x32_bf16 v[4:7], v[68:71], v[36:39], v[4:7]
    v_mfma_f32_16x16x32_bf16 v[8:11], v[68:71], v[40:43], v[8:11]
    v_mfma_f32_16x16x32_bf16 v[12:15], v[68:71], v[44:47], v[12:15]
    v_mfma_f32_16x16x32_bf16 v[16:19], v[68:71], v[48:51], v[16:19]
    v_mfma_f32_16x16x32_bf16 v[20:23], v[68:71], v[52:55], v[20:23]
    v_mfma_f32_16x16x32_bf16 v[24:27], v[68:71], v[56:59], v[24:27]
    v_mfma_f32_16x16x32_bf16 v[28:31], v[68:71], v[60:63], v[28:31]
    s_mov_b64 exec, 0xff
    buffer_store_dwordx4 v[100:103], v104, s[52:55], 0 offen sc1
    s_mov_b64 exec, -1
    v_lshlrev_b32 v64, 16, v88
    v_and_b32 v65, s0, v88
    v_lshlrev_b32 v66, 16, v89
    v_and_b32 v67, s0, v89
    v_lshlrev_b32 v68, 16, v90
    v_and_b32 v69, s0, v90
    v_lshlrev_b32 v70, 16, v91
    v_and_b32 v71, s0, v91
    v_lshlrev_b32 v72, 16, v92
    v_and_b32 v73, s0, v92
    v_lshlrev_b32 v74, 16, v93
    v_and_b32 v75, s0, v93
    v_lshlrev_b32 v76, 16, v94
    v_and_b32 v77, s0, v94
    v_lshlrev_b32 v78, 16, v95
    v_and_b32 v79, s0, v95
    s_bitcmp1_b32 s4, 0
    s_cbranch_scc1 L_cx_6
    ds_write_b128 v115, v[16:19] offset:43520
    v_pk_add_f32 v[64:65], v[64:65], v[0:1]
    v_pk_add_f32 v[66:67], v[66:67], v[2:3]
    ds_write_b128 v115, v[20:23] offset:44544
    v_pk_add_f32 v[68:69], v[68:69], v[4:5]
    v_pk_add_f32 v[70:71], v[70:71], v[6:7]
    ds_write_b128 v115, v[24:27] offset:45568
    v_pk_add_f32 v[72:73], v[72:73], v[8:9]
    v_pk_add_f32 v[74:75], v[74:75], v[10:11]
    ds_write_b128 v115, v[28:31] offset:46592
    v_pk_add_f32 v[76:77], v[76:77], v[12:13]
    v_pk_add_f32 v[78:79], v[78:79], v[14:15]
    s_branch L_cy_7
L_cx_6:
    ds_write_b128 v115, v[0:3] offset:43520
    v_pk_add_f32 v[64:65], v[64:65], v[16:17]
    v_pk_add_f32 v[66:67], v[66:67], v[18:19]
    ds_write_b128 v115, v[4:7] offset:44544
    v_pk_add_f32 v[68:69], v[68:69], v[20:21]
    v_pk_add_f32 v[70:71], v[70:71], v[22:23]
    ds_write_b128 v115, v[8:11] offset:45568
    v_pk_add_f32 v[72:73], v[72:73], v[24:25]
    v_pk_add_f32 v[74:75], v[74:75], v[26:27]
    ds_write_b128 v115, v[12:15] offset:46592
    v_pk_add_f32 v[76:77], v[76:77], v[28:29]
    v_pk_add_f32 v[78:79], v[78:79], v[30:31]
L_cy_7:
    s_waitcnt lgkmcnt(0)
    s_barrier
    ds_read_b128 v[32:35], v116 offset:43520
    ds_read_b128 v[36:39], v116 offset:44544
    ds_read_b128 v[40:43], v116 offset:45568
    ds_read_b128 v[44:47], v116 offset:46592
    s_waitcnt lgkmcnt(3)
    v_pk_add_f32 v[64:65], v[64:65], v[32:33]
    v_pk_add_f32 v[66:67], v[66:67], v[34:35]
    v_cvt_pk_bf16_f32 v56, v64, v65
    v_cvt_pk_bf16_f32 v57, v66, v67
    s_waitcnt lgkmcnt(2)
    v_pk_add_f32 v[68:69], v[68:69], v[36:37]
    v_pk_add_f32 v[70:71], v[70:71], v[38:39]
    v_cvt_pk_bf16_f32 v58, v68, v69
    v_cvt_pk_bf16_f32 v59, v70, v71
    s_nop 0
    v_permlane16_swap_b32 v56, v58
    v_permlane16_swap_b32 v57, v59
    buffer_store_dwordx4 v[56:59], v117, s[52:55], s13 offen sc1
    s_waitcnt lgkmcnt(1)
    v_pk_add_f32 v[72:73], v[72:73], v[40:41]
    v_pk_add_f32 v[74:75], v[74:75], v[42:43]
    v_cvt_pk_bf16_f32 v60, v72, v73
    v_cvt_pk_bf16_f32 v61, v74, v75
    s_waitcnt lgkmcnt(0)
    v_pk_add_f32 v[76:77], v[76:77], v[44:45]
    v_pk_add_f32 v[78:79], v[78:79], v[46:47]
    v_cvt_pk_bf16_f32 v62, v76, v77
    v_cvt_pk_bf16_f32 v63, v78, v79
    s_nop 0
    v_permlane16_swap_b32 v60, v62
    v_permlane16_swap_b32 v61, v63
    buffer_store_dwordx4 v[60:63], v117, s[52:55], s21 offen sc1
    s_barrier
    s_branch L_join_2
L_aux_1:
    s_and_b32 s75, s6, 3
    s_lshl_b32 s75, s75, 3
    s_add_u32 s75, s75, s5
    s_lshl_b32 s16, s75, 2
    s_add_u32 s16, s16, s4
    s_mul_i32 s82, s16, 14336
    s_mul_i32 s17, s4, 14592
    s_mov_b32 m0, s17
    s_mov_b32 exec_hi, 0xffffff
    buffer_load_dwordx4 v126, s[64:67], s82 offen lds
    s_add_u32 m0, m0, 912
    s_add_u32 s82, s82, 896
    buffer_load_dwordx4 v126, s[64:67], s82 offen lds
    s_add_u32 m0, m0, 912
    s_add_u32 s82, s82, 896
    buffer_load_dwordx4 v126, s[64:67], s82 offen lds
    s_add_u32 m0, m0, 912
    s_add_u32 s82, s82, 896
    buffer_load_dwordx4 v126, s[64:67], s82 offen lds
    s_add_u32 m0, m0, 912
    s_add_u32 s82, s82, 896
    buffer_load_dwordx4 v126, s[64:67], s82 offen lds
    s_add_u32 m0, m0, 912
    s_add_u32 s82, s82, 896
    buffer_load_dwordx4 v126, s[64:67], s82 offen lds
    s_add_u32 m0, m0, 912
    s_add_u32 s82, s82, 896
    buffer_load_dwordx4 v126, s[64:67], s82 offen lds
    s_add_u32 m0, m0, 912
    s_add_u32 s82, s82, 896
    buffer_load_dwordx4 v126, s[64:67], s82 offen lds
    s_add_u32 m0, m0, 912
    s_add_u32 s82, s82, 896
    buffer_load_dwordx4 v126, s[64:67], s82 offen lds
    s_add_u32 m0, m0, 912
    s_add_u32 s82, s82, 896
    buffer_load_dwordx4 v126, s[64:67], s82 offen lds
    s_add_u32 m0, m0, 912
    s_add_u32 s82, s82, 896
    buffer_load_dwordx4 v126, s[64:67], s82 offen lds
    s_add_u32 m0, m0, 912
    s_add_u32 s82, s82, 896
    buffer_load_dwordx4 v126, s[64:67], s82 offen lds
    s_add_u32 m0, m0, 912
    s_add_u32 s82, s82, 896
    buffer_load_dwordx4 v126, s[64:67], s82 offen lds
    s_add_u32 m0, m0, 912
    s_add_u32 s82, s82, 896
    buffer_load_dwordx4 v126, s[64:67], s82 offen lds
    s_add_u32 m0, m0, 912
    s_add_u32 s82, s82, 896
    buffer_load_dwordx4 v126, s[64:67], s82 offen lds
    s_add_u32 m0, m0, 912
    s_add_u32 s82, s82, 896
    buffer_load_dwordx4 v126, s[64:67], s82 offen lds
    s_mov_b64 exec, -1
    s_getpc_b64 s[96:97]
L_pc_8:
    s_add_u32 s96, s96, ktab-L_pc_8
    s_addc_u32 s97, s97, 0
    s_lshl_b32 s81, s6, 2
    s_add_u32 s81, s81, s4
    s_mul_i32 s81, s81, 640
    v_lshl_add_u32 v1, v127, 7, s81
    s_mov_b32 s82, ktab-L_entry+8192
    v_min_u32 v1, s82, v1
    s_sub_u32 s28, s96, ktab-L_entry
    s_subb_u32 s29, s97, 0
    s_mov_b64 exec, 31
    global_load_dword v1, v1, s[28:29]
    s_mov_b64 exec, -1
    v_lshrrev_b32 v2, 3, v127
    v_and_b32 v3, 7, v127
    v_bfe_u32 v4, v127, 4, 1
    v_lshlrev_b32 v4, 2, v4
    v_xor_b32 v3, v3, v4
    v_lshlrev_b32 v3, 4, v3
    v_mul_u32_u24 v121, 3584, v2
    v_add_u32 v121, v121, v3
    v_lshl_add_u32 v120, v2, 12, v3
    v_bfe_u32 v2, v127, 2, 2
    v_lshrrev_b32 v3, 5, v127
    v_bfe_u32 v4, v127, 4, 1
    v_and_b32 v5, 3, v127
    v_lshlrev_b32 v5, 3, v5
    v_lshl_add_u32 v5, v4, 5, v5
    v_lshrrev_b32 v4, 1, v2
    v_lshl_add_u32 v5, v4, 6, v5
    s_lshr_b32 s81, s4, 1
    s_lshl_b32 s81, s81, 6
    v_xor_b32_e64 v5, s81, v5
    v_lshl_add_u32 v5, v2, 7, v5
    s_mul_i32 s82, s4, 24576
    s_add_u32 s82, s82, 65536
    v_add_u32 v5, s82, v5
    v_lshl_add_u32 v123, v3, 10, v5
    v_xor_b32 v122, 64, v123
    v_lshl_add_u32 v125, v3, 9, v5
    v_xor_b32 v124, 64, v125
    s_mul_i32 s98, s4, 1835008
    s_lshl_b32 s81, s9, 7
    s_add_u32 s98, s98, s81
    s_mul_i32 s99, s4, 1835008
    s_lshl_b32 s81, s11, 7
    s_add_u32 s99, s99, s81
    s_mov_b32 s80, s82
    s_and_b32 s81, s8, 3
    s_lshl_b32 s81, s81, 1
    s_lshr_b32 s82, s8, 2
    s_add_u32 s81, s81, s82
    s_and_b32 s33, s81, 7
    s_and_b32 s81, s10, 3
    s_lshl_b32 s81, s81, 1
    s_lshr_b32 s82, s10, 2
    s_add_u32 s81, s81, s82
    s_min_u32 s35, s81, 6
    s_mov_b32 s35, s10
    s_add_u32 s78, s98, 1835008
    s_mul_i32 s81, s33, 229376
    s_add_u32 s98, s98, s81
    s_add_u32 s79, s99, 1835008
    s_mul_i32 s81, s35, 262144
    s_add_u32 s99, s99, s81
    v_mov_b32 v76, 0
    v_mov_b32 v77, 0
    v_mov_b32 v78, 0
    v_mov_b32_e64 v79, 0
    s_lshl_b32 s82, s16, 8
    s_add_u32 s82, s82, 32768
    s_lshl_b32 s18, s75, 7
    s_add_u32 s18, s18, 4096
    s_mov_b64 exec, 0xffff
    buffer_store_dwordx4 v[76:79], v126, s[52:55], s82 offen sc1
    s_mov_b64 exec, -1
    v_and_b32 v2, 15, v127
    v_lshrrev_b32 v3, 4, v127
    v_mul_u32_u24 v4, 912, v2
    v_lshl_add_u32 v4, v3, 4, v4
    v_add_u32 v4, s17, v4
    v_lshrrev_b32 v6, 2, v2
    v_cmp_eq_u32 vcc, v6, v3
    v_bfe_u32 v6, v2, 1, 2
    v_lshlrev_b32 v6, 7, v6
    v_lshrrev_b32 v7, 3, v2
    v_lshl_add_u32 v6, v7, 4, v6
    v_and_b32 v7, 1, v2
    v_lshl_add_u32 v6, v7, 2, v6
    s_lshl_b32 s81, s4, 5
    s_add_u32 s81, s81, 60000
    v_add_u32 v6, s81, v6
    v_mov_b32 v7, 61024
    v_cndmask_b32 v6, v7, v6, vcc
    v_lshrrev_b32 v117, 3, v127
    v_cmp_eq_u32 vcc, s4, v117
    v_lshlrev_b32 v117, 12, v117
    v_and_b32 v7, 7, v127
    v_lshl_add_u32 v117, v7, 4, v117
    v_mov_b32 v7, 1073741824
    v_cndmask_b32 v117, v7, v117, vcc
    v_mov_b32 v80, 0x3f803f80
    v_mov_b32 v81, 0x3f803f80
    v_mov_b32 v82, 0x3f803f80
    v_mov_b32 v83, 0x3f803f80
    s_waitcnt vmcnt(2)
    ds_read_b128 v[8:11], v4 offset:0
    ds_read_b128 v[12:15], v4 offset:64
    ds_read_b128 v[16:19], v4 offset:128
    ds_read_b128 v[20:23], v4 offset:192
    ds_read_b128 v[24:27], v4 offset:256
    ds_read_b128 v[28:31], v4 offset:320
    ds_read_b128 v[32:35], v4 offset:384
    ds_read_b128 v[36:39], v4 offset:448
    ds_read_b128 v[40:43], v4 offset:512
    ds_read_b128 v[44:47], v4 offset:576
    ds_read_b128 v[48:51], v4 offset:640
    ds_read_b128 v[52:55], v4 offset:704
    ds_read_b128 v[56:59], v4 offset:768
    ds_read_b128 v[60:63], v4 offset:832
    s_waitcnt lgkmcnt(0)
    v_mfma_f32_16x16x32_bf16 v[64:67], v[80:83], v[8:11], 0
    v_mfma_f32_16x16x32_bf16 v[68:71], v[8:11], v[8:11], 0
    v_mfma_f32_16x16x32_bf16 v[64:67], v[80:83], v[12:15], v[64:67]
    v_mfma_f32_16x16x32_bf16 v[68:71], v[12:15], v[12:15], v[68:71]
    v_mfma_f32_16x16x32_bf16 v[64:67], v[80:83], v[16:19], v[64:67]
    v_mfma_f32_16x16x32_bf16 v[68:71], v[16:19], v[16:19], v[68:71]
    v_mfma_f32_16x16x32_bf16 v[64:67], v[80:83], v[20:23], v[64:67]
    v_mfma_f32_16x16x32_bf16 v[68:71], v[20:23], v[20:23], v[68:71]
    v_mfma_f32_16x16x32_bf16 v[64:67], v[80:83], v[24:27], v[64:67]
    v_mfma_f32_16x16x32_bf16 v[68:71], v[24:27], v[24:27], v[68:71]
    v_mfma_f32_16x16x32_bf16 v[64:67], v[80:83], v[28:31], v[64:67]
    v_mfma_f32_16x16x32_bf16 v[68:71], v[28:31], v[28:31], v[68:71]
    v_mfma_f32_16x16x32_bf16 v[64:67], v[80:83], v[32:35], v[64:67]
    v_mfma_f32_16x16x32_bf16 v[68:71], v[32:35], v[32:35], v[68:71]
    v_mfma_f32_16x16x32_bf16 v[64:67], v[80:83], v[36:39], v[64:67]
    v_mfma_f32_16x16x32_bf16 v[68:71], v[36:39], v[36:39], v[68:71]
    v_mfma_f32_16x16x32_bf16 v[64:67], v[80:83], v[40:43], v[64:67]
    v_mfma_f32_16x16x32_bf16 v[68:71], v[40:43], v[40:43], v[68:71]
    v_mfma_f32_16x16x32_bf16 v[64:67], v[80:83], v[44:47], v[64:67]
    v_mfma_f32_16x16x32_bf16 v[68:71], v[44:47], v[44:47], v[68:71]
    v_mfma_f32_16x16x32_bf16 v[64:67], v[80:83], v[48:51], v[64:67]
    v_mfma_f32_16x16x32_bf16 v[68:71], v[48:51], v[48:51], v[68:71]
    v_mfma_f32_16x16x32_bf16 v[64:67], v[80:83], v[52:55], v[64:67]
    v_mfma_f32_16x16x32_bf16 v[68:71], v[52:55], v[52:55], v[68:71]
    v_mfma_f32_16x16x32_bf16 v[64:67], v[80:83], v[56:59], v[64:67]
    v_mfma_f32_16x16x32_bf16 v[68:71], v[56:59], v[56:59], v[68:71]
    v_mfma_f32_16x16x32_bf16 v[64:67], v[80:83], v[60:63], v[64:67]
    v_mfma_f32_16x16x32_bf16 v[68:71], v[60:63], v[60:63], v[68:71]
    s_nop 7
    v_cndmask_b32 v68, v68, v69, s[90:91]
    v_cndmask_b32 v70, v70, v71, s[90:91]
    v_cndmask_b32 v68, v68, v70, s[92:93]
    ds_write2_b32 v6, v64, v68 offset0:0 offset1:2
    s_waitcnt lgkmcnt(0)
    s_barrier
    ds_read_b128 v[64:67], v126 offset:60000
    s_waitcnt lgkmcnt(0)
    buffer_store_dwordx4 v[64:67], v117, s[52:55], s18 offen sc1
    v_readfirstlane_b32 s14, v104
    v_readfirstlane_b32 s15, v105
    s_add_u32 s14, s14, 1
    s_addc_u32 s15, s15, 0
    s_add_u32 s81, s75, 224
    s_lshl_b32 s81, s81, 6
    s_lshl_b32 s82, s4, 15
    s_add_u32 s81, s81, s82
    s_add_u32 s81, s81, 1048576
    v_lshlrev_b32 v76, 12, v127
    v_and_b32 v76, 0x4000, v76
    v_and_b32 v72, 3, v127
    v_lshl_add_u32 v76, v72, 4, v76
    v_mov_b32 v72, s14
    v_mov_b32 v73, s15
    v_mov_b32 v74, s14
    v_mov_b32 v75, s15
    s_waitcnt vmcnt(0)
    s_barrier
    s_mov_b64 exec, 0xff
    buffer_store_dwordx4 v[72:75], v76, s[52:55], s81 offen sc1
    s_mov_b64 exec, -1
    s_cmp_lg_u32 s87, 0
    s_cbranch_scc1 L_nf_9
    s_lshr_b32 s16, s75, 1
    s_sub_u32 s17, s75, 4
    s_cmp_lt_u32 s75, 8
    s_cselect_b32 s16, s16, s17
    s_lshl_b32 s81, s16, 12
    s_lshl_b32 s82, s4, 10
    s_add_u32 s81, s81, s82
    s_add_u32 s81, s81, 6291456
    v_mov_b32 v80, -1
    v_mov_b32 v81, -1
    v_mov_b32 v82, -1
    v_mov_b32_e64 v83, -1
    buffer_store_dwordx4 v[80:83], v126, s[52:55], s81 offen sc1
    s_add_u32 s81, s81, 114688
    buffer_store_dwordx4 v[80:83], v126, s[52:55], s81 offen sc1
    s_add_u32 s81, s81, 114688
    buffer_store_dwordx4 v[80:83], v126, s[52:55], s81 offen sc1
    s_add_u32 s81, s81, 114688
    buffer_store_dwordx4 v[80:83], v126, s[52:55], s81 offen sc1
    s_add_u32 s81, s81, 114688
    buffer_store_dwordx4 v[80:83], v126, s[52:55], s81 offen sc1
    s_add_u32 s81, s81, 114688
    buffer_store_dwordx4 v[80:83], v126, s[52:55], s81 offen sc1
    s_add_u32 s81, s81, 114688
    buffer_store_dwordx4 v[80:83], v126, s[52:55], s81 offen sc1
    s_add_u32 s81, s81, 114688
    buffer_store_dwordx4 v[80:83], v126, s[52:55], s81 offen sc1
    s_add_u32 s81, s81, 114688
    buffer_store_dwordx4 v[80:83], v126, s[52:55], s81 offen sc1
    s_add_u32 s81, s81, 114688
    buffer_store_dwordx4 v[80:83], v126, s[52:55], s81 offen sc1
    s_add_u32 s81, s81, 114688
    buffer_store_dwordx4 v[80:83], v126, s[52:55], s81 offen sc1
    s_add_u32 s81, s81, 114688
    buffer_store_dwordx4 v[80:83], v126, s[52:55], s81 offen sc1
    s_add_u32 s81, s81, 114688
    buffer_store_dwordx4 v[80:83], v126, s[52:55], s81 offen sc1
    s_add_u32 s81, s81, 114688
    buffer_store_dwordx4 v[80:83], v126, s[52:55], s81 offen sc1
    s_add_u32 s81, s81, 114688
    buffer_store_dwordx4 v[80:83], v126, s[52:55], s81 offen sc1
    s_add_u32 s81, s81, 114688
    buffer_store_dwordx4 v[80:83], v126, s[52:55], s81 offen sc1
    s_lshl_b32 s81, s16, 12
    s_lshl_b32 s82, s4, 10
    s_add_u32 s81, s81, s82
    s_add_u32 s81, s81, 8388608
    v_mov_b32 v80, -1
    v_mov_b32 v81, -1
    v_mov_b32 v82, -1
    v_mov_b32_e64 v83, -1
    buffer_store_dwordx4 v[80:83], v126, s[52:55], s81 offen sc1
    s_add_u32 s81, s81, 114688
    buffer_store_dwordx4 v[80:83], v126, s[52:55], s81 offen sc1
    s_add_u32 s81, s81, 114688
    buffer_store_dwordx4 v[80:83], v126, s[52:55], s81 offen sc1
    s_add_u32 s81, s81, 114688
    buffer_store_dwordx4 v[80:83], v126, s[52:55], s81 offen sc1
    s_add_u32 s81, s81, 114688
    buffer_store_dwordx4 v[80:83], v126, s[52:55], s81 offen sc1
    s_add_u32 s81, s81, 114688
    buffer_store_dwordx4 v[80:83], v126, s[52:55], s81 offen sc1
    s_add_u32 s81, s81, 114688
    buffer_store_dwordx4 v[80:83], v126, s[52:55], s81 offen sc1
    s_add_u32 s81, s81, 114688
    buffer_store_dwordx4 v[80:83], v126, s[52:55], s81 offen sc1
    s_add_u32 s81, s81, 114688
    buffer_store_dwordx4 v[80:83], v126, s[52:55], s81 offen sc1
    s_add_u32 s81, s81, 114688
    buffer_store_dwordx4 v[80:83], v126, s[52:55], s81 offen sc1
    s_add_u32 s81, s81, 114688
    buffer_store_dwordx4 v[80:83], v126, s[52:55], s81 offen sc1
    s_add_u32 s81, s81, 114688
    buffer_store_dwordx4 v[80:83], v126, s[52:55], s81 offen sc1
    s_add_u32 s81, s81, 114688
    buffer_store_dwordx4 v[80:83], v126, s[52:55], s81 offen sc1
    s_add_u32 s81, s81, 114688
    buffer_store_dwordx4 v[80:83], v126, s[52:55], s81 offen sc1
    s_lshl_b32 s81, s16, 6
    s_lshl_b32 s82, s4, 15
    s_add_u32 s81, s81, s82
    s_add_u32 s81, s81, 3407872
    v_lshlrev_b32 v76, 12, v127
    v_and_b32 v76, 0x4000, v76
    v_and_b32 v72, 3, v127
    v_lshl_add_u32 v76, v72, 4, v76
    v_mov_b32 v72, s14
    v_mov_b32 v73, s15
    v_mov_b32 v74, s14
    v_mov_b32 v75, s15
    s_waitcnt vmcnt(0)
    s_barrier
    s_mov_b64 exec, 0xff
    buffer_store_dwordx4 v[72:75], v76, s[52:55], s81 offen sc1
    s_mov_b64 exec, -1
L_nf_9:
    s_cmp_eq_u32 s87, 0
    s_cbranch_scc1 L_aw_10
    s_add_u32 m0, s80, 0
    s_nop 0
    buffer_load_dwordx4 v121, s[56:59], s98 offen lds
    s_add_u32 m0, s80, 1024
    s_add_u32 s98, s98, 28672
    buffer_load_dwordx4 v121, s[56:59], s98 offen lds
    s_add_u32 m0, s80, 2048
    s_add_u32 s98, s98, 28672
    buffer_load_dwordx4 v121, s[56:59], s98 offen lds
    s_add_u32 m0, s80, 3072
    s_add_u32 s98, s98, 28672
    buffer_load_dwordx4 v121, s[56:59], s98 offen lds
    s_add_u32 m0, s80, 4096
    s_add_u32 s98, s98, 28672
    buffer_load_dwordx4 v121, s[56:59], s98 offen lds
    s_add_u32 m0, s80, 5120
    s_add_u32 s98, s98, 28672
    buffer_load_dwordx4 v121, s[56:59], s98 offen lds
    s_add_u32 m0, s80, 6144
    s_add_u32 s98, s98, 28672
    buffer_load_dwordx4 v121, s[56:59], s98 offen lds
    s_add_u32 m0, s80, 7168
    s_add_u32 s98, s98, 28672
    buffer_load_dwordx4 v121, s[56:59], s98 offen lds
    s_add_u32 m0, s80, 8192
    s_add_u32 s98, s98, 28672
    s_cmp_eq_u32 s98, s78
    s_cselect_b32 s3, 1835008, 0
    s_sub_u32 s98, s98, s3
    buffer_load_dwordx4 v121, s[56:59], s98 offen lds
    s_add_u32 m0, s80, 9216
    s_add_u32 s98, s98, 28672
    buffer_load_dwordx4 v121, s[56:59], s98 offen lds
    s_add_u32 m0, s80, 10240
    s_add_u32 s98, s98, 28672
    buffer_load_dwordx4 v121, s[56:59], s98 offen lds
    s_add_u32 m0, s80, 11264
    s_add_u32 s98, s98, 28672
    buffer_load_dwordx4 v121, s[56:59], s98 offen lds
    s_add_u32 m0, s80, 12288
    s_add_u32 s98, s98, 28672
    buffer_load_dwordx4 v121, s[56:59], s98 offen lds
    s_add_u32 m0, s80, 13312
    s_add_u32 s98, s98, 28672
    buffer_load_dwordx4 v121, s[56:59], s98 offen lds
    s_add_u32 m0, s80, 14336
    s_add_u32 s98, s98, 28672
    buffer_load_dwordx4 v121, s[56:59], s98 offen lds
    s_add_u32 m0, s80, 15360
    s_add_u32 s98, s98, 28672
    buffer_load_dwordx4 v121, s[56:59], s98 offen lds
    s_add_u32 m0, s80, 16384
    s_add_u32 s98, s98, 28672
    s_cmp_eq_u32 s98, s78
    s_cselect_b32 s3, 1835008, 0
    s_sub_u32 s98, s98, s3
    buffer_load_dwordx4 v121, s[56:59], s98 offen lds
    s_add_u32 m0, s80, 17408
    s_add_u32 s98, s98, 28672
    buffer_load_dwordx4 v121, s[56:59], s98 offen lds
    s_add_u32 m0, s80, 18432
    s_add_u32 s98, s98, 28672
    buffer_load_dwordx4 v121, s[56:59], s98 offen lds
    s_add_u32 m0, s80, 19456
    s_add_u32 s98, s98, 28672
    buffer_load_dwordx4 v121, s[56:59], s98 offen lds
    s_add_u32 m0, s80, 20480
    s_add_u32 s98, s98, 28672
    buffer_load_dwordx4 v121, s[56:59], s98 offen lds
    s_add_u32 m0, s80, 21504
    s_add_u32 s98, s98, 28672
    buffer_load_dwordx4 v121, s[56:59], s98 offen lds
    s_add_u32 m0, s80, 22528
    s_add_u32 s98, s98, 28672
    buffer_load_dwordx4 v121, s[56:59], s98 offen lds
    s_add_u32 m0, s80, 23552
    s_add_u32 s98, s98, 28672
    buffer_load_dwordx4 v121, s[56:59], s98 offen lds
    s_waitcnt vmcnt(22)
    ds_read_b64_tr_b16 a[0:1], v123 offset:0
    ds_read_b64_tr_b16 a[2:3], v123 offset:512
    ds_read_b64_tr_b16 a[4:5], v122 offset:0
    ds_read_b64_tr_b16 a[6:7], v122 offset:512
    s_waitcnt vmcnt(20)
    ds_read_b64_tr_b16 a[8:9], v123 offset:2048
    ds_read_b64_tr_b16 a[10:11], v123 offset:2560
    ds_read_b64_tr_b16 a[12:13], v122 offset:2048
    ds_read_b64_tr_b16 a[14:15], v122 offset:2560
    s_add_u32 m0, s80, 0
    s_add_u32 s98, s98, 28672
    s_cmp_eq_u32 s98, s78
    s_cselect_b32 s3, 1835008, 0
    s_sub_u32 s98, s98, s3
    s_waitcnt lgkmcnt(4)
    buffer_load_dwordx4 v121, s[56:59], s98 offen lds
    s_add_u32 m0, s80, 1024
    s_add_u32 s98, s98, 28672
    buffer_load_dwordx4 v121, s[56:59], s98 offen lds
    s_waitcnt vmcnt(20)
    ds_read_b64_tr_b16 a[16:17], v123 offset:4096
    ds_read_b64_tr_b16 a[18:19], v123 offset:4608
    ds_read_b64_tr_b16 a[20:21], v122 offset:4096
    ds_read_b64_tr_b16 a[22:23], v122 offset:4608
    s_add_u32 m0, s80, 2048
    s_add_u32 s98, s98, 28672
    s_waitcnt lgkmcnt(4)
    buffer_load_dwordx4 v121, s[56:59], s98 offen lds
    s_add_u32 m0, s80, 3072
    s_add_u32 s98, s98, 28672
    buffer_load_dwordx4 v121, s[56:59], s98 offen lds
    s_waitcnt vmcnt(20)
    ds_read_b64_tr_b16 a[24:25], v123 offset:6144
    ds_read_b64_tr_b16 a[26:27], v123 offset:6656
    ds_read_b64_tr_b16 a[28:29], v122 offset:6144
    ds_read_b64_tr_b16 a[30:31], v122 offset:6656
    s_add_u32 m0, s80, 4096
    s_add_u32 s98, s98, 28672
    s_waitcnt lgkmcnt(4)
    buffer_load_dwordx4 v121, s[56:59], s98 offen lds
    s_add_u32 m0, s80, 5120
    s_add_u32 s98, s98, 28672
    buffer_load_dwordx4 v121, s[56:59], s98 offen lds
    s_waitcnt vmcnt(20)
    ds_read_b64_tr_b16 a[32:33], v123 offset:8192
    ds_read_b64_tr_b16 a[34:35], v123 offset:8704
    ds_read_b64_tr_b16 a[36:37], v122 offset:8192
    ds_read_b64_tr_b16 a[38:39], v122 offset:8704
    s_add_u32 m0, s80, 6144
    s_add_u32 s98, s98, 28672
    s_waitcnt lgkmcnt(4)
    buffer_load_dwordx4 v121, s[56:59], s98 offen lds
    s_add_u32 m0, s80, 7168
    s_add_u32 s98, s98, 28672
    buffer_load_dwordx4 v121, s[56:59], s98 offen lds
    s_waitcnt vmcnt(20)
    ds_read_b64_tr_b16 a[40:41], v123 offset:10240
    ds_read_b64_tr_b16 a[42:43], v123 offset:10752
    ds_read_b64_tr_b16 a[44:45], v122 offset:10240
    ds_read_b64_tr_b16 a[46:47], v122 offset:10752
    s_add_u32 m0, s80, 8192
    s_add_u32 s98, s98, 28672
    s_cmp_eq_u32 s98, s78
    s_cselect_b32 s3, 1835008, 0
    s_sub_u32 s98, s98, s3
    s_waitcnt lgkmcnt(4)
    buffer_load_dwordx4 v121, s[56:59], s98 offen lds
    s_add_u32 m0, s80, 9216
    s_add_u32 s98, s98, 28672
    buffer_load_dwordx4 v121, s[56:59], s98 offen lds
    s_waitcnt vmcnt(20)
    ds_read_b64_tr_b16 a[48:49], v123 offset:12288
    ds_read_b64_tr_b16 a[50:51], v123 offset:12800
    ds_read_b64_tr_b16 a[52:53], v122 offset:12288
    ds_read_b64_tr_b16 a[54:55], v122 offset:12800
    s_add_u32 m0, s80, 10240
    s_add_u32 s98, s98, 28672
    s_waitcnt lgkmcnt(4)
    buffer_load_dwordx4 v121, s[56:59], s98 offen lds
    s_add_u32 m0, s80, 11264
    s_add_u32 s98, s98, 28672
    buffer_load_dwordx4 v121, s[56:59], s98 offen lds
    s_waitcnt vmcnt(20)
    ds_read_b64_tr_b16 a[56:57], v123 offset:14336
    ds_read_b64_tr_b16 a[58:59], v123 offset:14848
    ds_read_b64_tr_b16 a[60:61], v122 offset:14336
    ds_read_b64_tr_b16 a[62:63], v122 offset:14848
    s_add_u32 m0, s80, 12288
    s_add_u32 s98, s98, 28672
    s_waitcnt lgkmcnt(4)
    buffer_load_dwordx4 v121, s[56:59], s98 offen lds
    s_add_u32 m0, s80, 13312
    s_add_u32 s98, s98, 28672
    buffer_load_dwordx4 v121, s[56:59], s98 offen lds
    s_waitcnt vmcnt(20)
    ds_read_b64_tr_b16 a[64:65], v123 offset:16384
    ds_read_b64_tr_b16 a[66:67], v123 offset:16896
    ds_read_b64_tr_b16 a[68:69], v122 offset:16384
    ds_read_b64_tr_b16 a[70:71], v122 offset:16896
    s_add_u32 m0, s80, 14336
    s_add_u32 s98, s98, 28672
    s_waitcnt lgkmcnt(4)
    buffer_load_dwordx4 v121, s[56:59], s98 offen lds
    s_add_u32 m0, s80, 15360
    s_add_u32 s98, s98, 28672
    buffer_load_dwordx4 v121, s[56:59], s98 offen lds
    s_waitcnt vmcnt(20)
    ds_read_b64_tr_b16 a[72:73], v123 offset:18432
    ds_read_b64_tr_b16 a[74:75], v123 offset:18944
    ds_read_b64_tr_b16 a[76:77], v122 offset:18432
    ds_read_b64_tr_b16 a[78:79], v122 offset:18944
    s_add_u32 m0, s80, 16384
    s_add_u32 s98, s98, 28672
    s_cmp_eq_u32 s98, s78
    s_cselect_b32 s3, 1835008, 0
    s_sub_u32 s98, s98, s3
    s_waitcnt lgkmcnt(4)
    buffer_load_dwordx4 v121, s[56:59], s98 offen lds
    s_add_u32 m0, s80, 17408
    s_add_u32 s98, s98, 28672
    buffer_load_dwordx4 v121, s[56:59], s98 offen lds
    s_waitcnt vmcnt(20)
    ds_read_b64_tr_b16 a[80:81], v123 offset:20480
    ds_read_b64_tr_b16 a[82:83], v123 offset:20992
    ds_read_b64_tr_b16 a[84:85], v122 offset:20480
    ds_read_b64_tr_b16 a[86:87], v122 offset:20992
    s_add_u32 m0, s80, 18432
    s_add_u32 s98, s98, 28672
    s_waitcnt lgkmcnt(4)
    buffer_load_dwordx4 v121, s[56:59], s98 offen lds
    s_add_u32 m0, s80, 19456
    s_add_u32 s98, s98, 28672
    buffer_load_dwordx4 v121, s[56:59], s98 offen lds
    s_waitcnt vmcnt(20)
    ds_read_b64_tr_b16 a[88:89], v123 offset:22528
    ds_read_b64_tr_b16 a[90:91], v123 offset:23040
    ds_read_b64_tr_b16 a[92:93], v122 offset:22528
    ds_read_b64_tr_b16 a[94:95], v122 offset:23040
    s_add_u32 m0, s80, 20480
    s_add_u32 s98, s98, 28672
    s_waitcnt lgkmcnt(4)
    buffer_load_dwordx4 v121, s[56:59], s98 offen lds
    s_add_u32 m0, s80, 21504
    s_add_u32 s98, s98, 28672
    buffer_load_dwordx4 v121, s[56:59], s98 offen lds
    s_waitcnt vmcnt(20)
    ds_read_b64_tr_b16 a[96:97], v123 offset:0
    ds_read_b64_tr_b16 a[98:99], v123 offset:512
    ds_read_b64_tr_b16 a[100:101], v122 offset:0
    ds_read_b64_tr_b16 a[102:103], v122 offset:512
    s_add_u32 m0, s80, 22528
    s_add_u32 s98, s98, 28672
    s_waitcnt lgkmcnt(4)
    buffer_load_dwordx4 v121, s[56:59], s98 offen lds
    s_add_u32 m0, s80, 23552
    s_add_u32 s98, s98, 28672
    buffer_load_dwordx4 v121, s[56:59], s98 offen lds
    s_waitcnt vmcnt(20)
    ds_read_b64_tr_b16 a[104:105], v123 offset:2048
    ds_read_b64_tr_b16 a[106:107], v123 offset:2560
    ds_read_b64_tr_b16 a[108:109], v122 offset:2048
    ds_read_b64_tr_b16 a[110:111], v122 offset:2560
    s_add_u32 m0, s80, 0
    s_add_u32 s98, s98, 28672
    s_cmp_eq_u32 s98, s78
    s_cselect_b32 s3, 1835008, 0
    s_sub_u32 s98, s98, s3
    s_waitcnt lgkmcnt(4)
    buffer_load_dwordx4 v121, s[56:59], s98 offen lds
    s_add_u32 m0, s80, 1024
    s_add_u32 s98, s98, 28672
    buffer_load_dwordx4 v121, s[56:59], s98 offen lds
    s_waitcnt vmcnt(20)
    ds_read_b64_tr_b16 a[112:113], v123 offset:4096
    ds_read_b64_tr_b16 a[114:115], v123 offset:4608
    ds_read_b64_tr_b16 a[116:117], v122 offset:4096
    ds_read_b64_tr_b16 a[118:119], v122 offset:4608
    s_add_u32 m0, s80, 2048
    s_add_u32 s98, s98, 28672
    s_waitcnt lgkmcnt(4)
    buffer_load_dwordx4 v121, s[56:59], s98 offen lds
    s_add_u32 m0, s80, 3072
    s_add_u32 s98, s98, 28672
    buffer_load_dwordx4 v121, s[56:59], s98 offen lds
    s_waitcnt vmcnt(20)
    ds_read_b64_tr_b16 a[120:121], v123 offset:6144
    ds_read_b64_tr_b16 a[122:123], v123 offset:6656
    ds_read_b64_tr_b16 a[124:125], v122 offset:6144
    ds_read_b64_tr_b16 a[126:127], v122 offset:6656
    s_add_u32 m0, s80, 4096
    s_add_u32 s98, s98, 28672
    s_waitcnt lgkmcnt(4)
    buffer_load_dwordx4 v121, s[56:59], s98 offen lds
    s_add_u32 m0, s80, 5120
    s_add_u32 s98, s98, 28672
    buffer_load_dwordx4 v121, s[56:59], s98 offen lds
    s_waitcnt vmcnt(20)
    ds_read_b64_tr_b16 a[128:129], v123 offset:8192
    ds_read_b64_tr_b16 a[130:131], v123 offset:8704
    ds_read_b64_tr_b16 a[132:133], v122 offset:8192
    ds_read_b64_tr_b16 a[134:135], v122 offset:8704
    s_add_u32 m0, s80, 6144
    s_add_u32 s98, s98, 28672
    s_waitcnt lgkmcnt(4)
    buffer_load_dwordx4 v121, s[56:59], s98 offen lds
    s_add_u32 m0, s80, 7168
    s_add_u32 s98, s98, 28672
    buffer_load_dwordx4 v121, s[56:59], s98 offen lds
    s_waitcnt vmcnt(20)
    ds_read_b64_tr_b16 a[136:137], v123 offset:10240
    ds_read_b64_tr_b16 a[138:139], v123 offset:10752
    ds_read_b64_tr_b16 a[140:141], v122 offset:10240
    ds_read_b64_tr_b16 a[142:143], v122 offset:10752
    s_add_u32 m0, s80, 8192
    s_add_u32 s98, s98, 28672
    s_cmp_eq_u32 s98, s78
    s_cselect_b32 s3, 1835008, 0
    s_sub_u32 s98, s98, s3
    s_waitcnt lgkmcnt(4)
    buffer_load_dwordx4 v121, s[56:59], s98 offen lds
    s_add_u32 m0, s80, 9216
    s_add_u32 s98, s98, 28672
    buffer_load_dwordx4 v121, s[56:59], s98 offen lds
    s_waitcnt vmcnt(20)
    ds_read_b64_tr_b16 a[144:145], v123 offset:12288
    ds_read_b64_tr_b16 a[146:147], v123 offset:12800
    ds_read_b64_tr_b16 a[148:149], v122 offset:12288
    ds_read_b64_tr_b16 a[150:151], v122 offset:12800
    s_add_u32 m0, s80, 10240
    s_add_u32 s98, s98, 28672
    s_waitcnt lgkmcnt(4)
    buffer_load_dwordx4 v121, s[56:59], s98 offen lds
    s_add_u32 m0, s80, 11264
    s_add_u32 s98, s98, 28672
    buffer_load_dwordx4 v121, s[56:59], s98 offen lds
    s_waitcnt vmcnt(20)
    ds_read_b64_tr_b16 a[152:153], v123 offset:14336
    ds_read_b64_tr_b16 a[154:155], v123 offset:14848
    ds_read_b64_tr_b16 a[156:157], v122 offset:14336
    ds_read_b64_tr_b16 a[158:159], v122 offset:14848
    s_add_u32 m0, s80, 12288
    s_add_u32 s98, s98, 28672
    s_waitcnt lgkmcnt(4)
    buffer_load_dwordx4 v121, s[56:59], s98 offen lds
    s_add_u32 m0, s80, 13312
    s_add_u32 s98, s98, 28672
    buffer_load_dwordx4 v121, s[56:59], s98 offen lds
    s_waitcnt vmcnt(20)
    ds_read_b64_tr_b16 a[160:161], v123 offset:16384
    ds_read_b64_tr_b16 a[162:163], v123 offset:16896
    ds_read_b64_tr_b16 a[164:165], v122 offset:16384
    ds_read_b64_tr_b16 a[166:167], v122 offset:16896
    s_add_u32 m0, s80, 14336
    s_add_u32 s98, s98, 28672
    s_waitcnt lgkmcnt(4)
    buffer_load_dwordx4 v121, s[56:59], s98 offen lds
    s_add_u32 m0, s80, 15360
    s_add_u32 s98, s98, 28672
    buffer_load_dwordx4 v121, s[56:59], s98 offen lds
    s_waitcnt vmcnt(20)
    ds_read_b64_tr_b16 a[168:169], v123 offset:18432
    ds_read_b64_tr_b16 a[170:171], v123 offset:18944
    ds_read_b64_tr_b16 a[172:173], v122 offset:18432
    ds_read_b64_tr_b16 a[174:175], v122 offset:18944
    s_waitcnt vmcnt(18)
    ds_read_b64_tr_b16 a[176:177], v123 offset:20480
    ds_read_b64_tr_b16 a[178:179], v123 offset:20992
    ds_read_b64_tr_b16 a[180:181], v122 offset:20480
    ds_read_b64_tr_b16 a[182:183], v122 offset:20992
    s_waitcnt vmcnt(16)
    ds_read_b64_tr_b16 a[184:185], v123 offset:22528
    ds_read_b64_tr_b16 a[186:187], v123 offset:23040
    ds_read_b64_tr_b16 a[188:189], v122 offset:22528
    ds_read_b64_tr_b16 a[190:191], v122 offset:23040
    s_waitcnt vmcnt(14)
    ds_read_b64_tr_b16 a[192:193], v123 offset:0
    ds_read_b64_tr_b16 a[194:195], v123 offset:512
    ds_read_b64_tr_b16 a[196:197], v122 offset:0
    ds_read_b64_tr_b16 a[198:199], v122 offset:512
    s_waitcnt vmcnt(12)
    ds_read_b64_tr_b16 a[200:201], v123 offset:2048
    ds_read_b64_tr_b16 a[202:203], v123 offset:2560
    ds_read_b64_tr_b16 a[204:205], v122 offset:2048
    ds_read_b64_tr_b16 a[206:207], v122 offset:2560
    s_waitcnt vmcnt(10)
    ds_read_b64_tr_b16 a[208:209], v123 offset:4096
    ds_read_b64_tr_b16 a[210:211], v123 offset:4608
    ds_read_b64_tr_b16 a[212:213], v122 offset:4096
    ds_read_b64_tr_b16 a[214:215], v122 offset:4608
    s_waitcnt vmcnt(8)
    ds_read_b64_tr_b16 a[216:217], v123 offset:6144
    ds_read_b64_tr_b16 a[218:219], v123 offset:6656
    ds_read_b64_tr_b16 a[220:221], v122 offset:6144
    ds_read_b64_tr_b16 a[222:223], v122 offset:6656
    s_waitcnt vmcnt(6)
    ds_read_b64_tr_b16 a[224:225], v123 offset:8192
    ds_read_b64_tr_b16 a[226:227], v123 offset:8704
    ds_read_b64_tr_b16 a[228:229], v122 offset:8192
    ds_read_b64_tr_b16 a[230:231], v122 offset:8704
    s_waitcnt vmcnt(4)
    ds_read_b64_tr_b16 a[232:233], v123 offset:10240
    ds_read_b64_tr_b16 a[234:235], v123 offset:10752
    ds_read_b64_tr_b16 a[236:237], v122 offset:10240
    ds_read_b64_tr_b16 a[238:239], v122 offset:10752
    s_waitcnt vmcnt(2)
    ds_read_b64_tr_b16 a[240:241], v123 offset:12288
    ds_read_b64_tr_b16 a[242:243], v123 offset:12800
    ds_read_b64_tr_b16 a[244:245], v122 offset:12288
    ds_read_b64_tr_b16 a[246:247], v122 offset:12800
    s_waitcnt vmcnt(0)
    ds_read_b64_tr_b16 a[248:249], v123 offset:14336
    ds_read_b64_tr_b16 a[250:251], v123 offset:14848
    ds_read_b64_tr_b16 a[252:253], v122 offset:14336
    ds_read_b64_tr_b16 a[254:255], v122 offset:14848
    s_branch L_ax_11
L_aw_10:
    s_add_u32 m0, s80, 16384
    s_nop 0
    buffer_load_dwordx4 v120, s[60:63], s99 offen lds
    s_add_u32 m0, s80, 17408
    s_add_u32 s99, s99, 32768
    buffer_load_dwordx4 v120, s[60:63], s99 offen lds
    s_add_u32 m0, s80, 18432
    s_add_u32 s99, s99, 32768
    buffer_load_dwordx4 v120, s[60:63], s99 offen lds
    s_add_u32 m0, s80, 19456
    s_add_u32 s99, s99, 32768
    buffer_load_dwordx4 v120, s[60:63], s99 offen lds
    s_add_u32 m0, s80, 20480
    s_add_u32 s99, s99, 32768
    buffer_load_dwordx4 v120, s[60:63], s99 offen lds
    s_add_u32 m0, s80, 21504
    s_add_u32 s99, s99, 32768
    buffer_load_dwordx4 v120, s[60:63], s99 offen lds
    s_add_u32 m0, s80, 22528
    s_add_u32 s99, s99, 32768
    buffer_load_dwordx4 v120, s[60:63], s99 offen lds
    s_add_u32 m0, s80, 23552
    s_add_u32 s99, s99, 32768
    buffer_load_dwordx4 v120, s[60:63], s99 offen lds
    s_add_u32 m0, s80, 0
    s_add_u32 s99, s99, 32768
    s_cmp_eq_u32 s99, s79
    s_cselect_b32 s3, 1835008, 0
    s_sub_u32 s99, s99, s3
    buffer_load_dwordx4 v120, s[60:63], s99 offen lds
    s_add_u32 m0, s80, 1024
    s_add_u32 s99, s99, 32768
    buffer_load_dwordx4 v120, s[60:63], s99 offen lds
    s_add_u32 m0, s80, 2048
    s_add_u32 s99, s99, 32768
    buffer_load_dwordx4 v120, s[60:63], s99 offen lds
    s_add_u32 m0, s80, 3072
    s_add_u32 s99, s99, 32768
    buffer_load_dwordx4 v120, s[60:63], s99 offen lds
    s_add_u32 m0, s80, 4096
    s_add_u32 s99, s99, 32768
    buffer_load_dwordx4 v120, s[60:63], s99 offen lds
    s_add_u32 m0, s80, 5120
    s_add_u32 s99, s99, 32768
    buffer_load_dwordx4 v120, s[60:63], s99 offen lds
    s_add_u32 m0, s80, 6144
    s_add_u32 s99, s99, 32768
    buffer_load_dwordx4 v120, s[60:63], s99 offen lds
    s_add_u32 m0, s80, 7168
    s_add_u32 s99, s99, 32768
    buffer_load_dwordx4 v120, s[60:63], s99 offen lds
    s_add_u32 m0, s80, 8192
    s_add_u32 s99, s99, 32768
    s_cmp_eq_u32 s99, s79
    s_cselect_b32 s3, 1835008, 0
    s_sub_u32 s99, s99, s3
    buffer_load_dwordx4 v120, s[60:63], s99 offen lds
    s_add_u32 m0, s80, 9216
    s_add_u32 s99, s99, 32768
    buffer_load_dwordx4 v120, s[60:63], s99 offen lds
    s_add_u32 m0, s80, 10240
    s_add_u32 s99, s99, 32768
    buffer_load_dwordx4 v120, s[60:63], s99 offen lds
    s_add_u32 m0, s80, 11264
    s_add_u32 s99, s99, 32768
    buffer_load_dwordx4 v120, s[60:63], s99 offen lds
    s_add_u32 m0, s80, 12288
    s_add_u32 s99, s99, 32768
    buffer_load_dwordx4 v120, s[60:63], s99 offen lds
    s_add_u32 m0, s80, 13312
    s_add_u32 s99, s99, 32768
    buffer_load_dwordx4 v120, s[60:63], s99 offen lds
    s_add_u32 m0, s80, 14336
    s_add_u32 s99, s99, 32768
    buffer_load_dwordx4 v120, s[60:63], s99 offen lds
    s_add_u32 m0, s80, 15360
    s_add_u32 s99, s99, 32768
    buffer_load_dwordx4 v120, s[60:63], s99 offen lds
L_ax_11:
    s_waitcnt vmcnt(0)
L_join_2:
    s_cmp_eq_u32 s73, 0
    s_cbranch_scc1 L_skip_12
    s_mul_i32 s81, s4, 56
    v_min_u32 v116, 55, v127
    v_add_u32 v116, s81, v116
    v_and_b32 v118, 7, v127
    v_mul_u32_u24 v118, 7, v118
    v_add_u32 v118, s81, v118
    s_mul_i32 s16, s77, 28800
    s_lshl_b32 s83, s77, 12
    s_mul_i32 s81, s4, 7168
    s_add_u32 s16, s16, s81
    s_add_u32 s16, s16, 4194304
    s_add_u32 s17, s16, 4096
    s_add_u32 s83, s83, 6291456
    s_mul_i32 s30, s4, 7
    s_add_u32 s81, s30, 0
    s_lshr_b32 s82, s81, 2
    s_lshl_b32 s82, s82, 18
    s_add_u32 s23, s82, s83
    s_and_b32 s82, s81, 2
    s_lshl_b32 s82, s82, 9
    s_add_u32 s23, s23, s82
    s_and_b32 s82, s81, 1
    s_lshl_b32 s82, s82, 8
    s_add_u32 s23, s23, s82
    s_add_u32 s81, s30, 1
    s_lshr_b32 s82, s81, 2
    s_lshl_b32 s82, s82, 18
    s_add_u32 s24, s82, s83
    s_and_b32 s82, s81, 2
    s_lshl_b32 s82, s82, 9
    s_add_u32 s24, s24, s82
    s_and_b32 s82, s81, 1
    s_lshl_b32 s82, s82, 8
    s_add_u32 s24, s24, s82
    s_add_u32 s81, s30, 2
    s_lshr_b32 s82, s81, 2
    s_lshl_b32 s82, s82, 18
    s_add_u32 s25, s82, s83
    s_and_b32 s82, s81, 2
    s_lshl_b32 s82, s82, 9
    s_add_u32 s25, s25, s82
    s_and_b32 s82, s81, 1
    s_lshl_b32 s82, s82, 8
    s_add_u32 s25, s25, s82
    s_add_u32 s81, s30, 3
    s_lshr_b32 s82, s81, 2
    s_lshl_b32 s82, s82, 18
    s_add_u32 s26, s82, s83
    s_and_b32 s82, s81, 2
    s_lshl_b32 s82, s82, 9
    s_add_u32 s26, s26, s82
    s_and_b32 s82, s81, 1
    s_lshl_b32 s82, s82, 8
    s_add_u32 s26, s26, s82
    s_add_u32 s81, s30, 4
    s_lshr_b32 s82, s81, 2
    s_lshl_b32 s82, s82, 18
    s_add_u32 s27, s82, s83
    s_and_b32 s82, s81, 2
    s_lshl_b32 s82, s82, 9
    s_add_u32 s27, s27, s82
    s_and_b32 s82, s81, 1
    s_lshl_b32 s82, s82, 8
    s_add_u32 s27, s27, s82
    s_add_u32 s81, s30, 5
    s_lshr_b32 s82, s81, 2
    s_lshl_b32 s82, s82, 18
    s_add_u32 s28, s82, s83
    s_and_b32 s82, s81, 2
    s_lshl_b32 s82, s82, 9
    s_add_u32 s28, s28, s82
    s_and_b32 s82, s81, 1
    s_lshl_b32 s82, s82, 8
    s_add_u32 s28, s28, s82
    s_add_u32 s81, s30, 6
    s_lshr_b32 s82, s81, 2
    s_lshl_b32 s82, s82, 18
    s_add_u32 s29, s82, s83
    s_and_b32 s82, s81, 2
    s_lshl_b32 s82, s82, 9
    s_add_u32 s29, s29, s82
    s_and_b32 s82, s81, 1
    s_lshl_b32 s82, s82, 8
    s_add_u32 s29, s29, s82
    v_lshrrev_b32 v1, 2, v127
    v_lshlrev_b32 v109, 4, v1
    v_and_b32 v2, 1, v127
    v_lshl_add_u32 v109, v2, 9, v109
    v_bfe_u32 v2, v127, 1, 1
    v_lshl_add_u32 v109, v2, 11, v109
    v_and_b32 v1, 7, v1
    v_and_b32 v2, 3, v127
    v_lshl_add_u32 v1, v2, 3, v1
    v_lshrrev_b32 v3, 5, v127
    v_lshl_add_u32 v1, v3, 5, v1
    s_lshl_b32 s82, s4, 8
    s_add_u32 s82, s82, 57856
    v_lshl_add_u32 v110, v1, 2, s82
    v_and_b32 v1, 31, v127
    v_lshlrev_b32 v111, 2, v1
    v_add_u32 v111, 57856, v111
    s_add_u32 s82, s82, 1024
    v_lshl_add_u32 v112, v127, 2, s82
    v_lshl_add_u32 v117, v2, 5, s82
    s_mov_b32 s18, 0
    s_mov_b32 s19, -1
    s_lshl_b32 s81, s77, 6
    s_lshl_b32 s82, s4, 15
    s_add_u32 s81, s81, s82
    s_add_u32 s81, s81, 2621440
    v_lshlrev_b32 v108, 12, v127
    v_and_b32 v108, 0x4000, v108
    v_and_b32 v104, 3, v127
    v_lshl_add_u32 v108, v104, 4, v108
    v_add_u32 v108, s81, v108
    v_mov_b32 v104, s14
    v_mov_b32 v105, s15
    v_mov_b32 v106, s14
    v_mov_b32 v107, s15
    v_min_u32 v102, 27, v127
    s_lshl_b32 s84, s5, 14
    s_add_u32 s84, s84, 3407872
    v_lshl_add_u32 v102, v102, 6, s84
    buffer_load_dwordx2 v[100:101], v102, s[52:55], 0 offen sc1
    s_lshl_b32 s84, s5, 14
    s_add_u32 s84, s84, 1048576
    v_lshl_add_u32 v116, v116, 6, s84
    buffer_load_dwordx2 v[98:99], v116, s[52:55], 0 offen sc1
    s_lshl_b32 s84, s5, 14
    s_add_u32 s84, s84, 2490368
    v_lshl_add_u32 v118, v118, 6, s84
    buffer_load_dwordx2 v[114:115], v118, s[52:55], 0 offen sc1
    s_waitcnt vmcnt(0)
    v_cmp_ne_u64 vcc, s[14:15], v[114:115]
    s_nop 0
    s_cbranch_vccz L_pok_13
    s_mov_b32 s85, 0
L_plp_14:
    buffer_load_dwordx2 v[114:115], v118, s[52:55], 0 offen sc1
    s_waitcnt vmcnt(0)
    v_cmp_ne_u64 vcc, s[14:15], v[114:115]
    s_add_u32 s85, s85, 1
    s_cbranch_vccz L_pok_13
    s_cmp_lt_u32 s85, 0x100000
    s_cbranch_scc1 L_plp_14
L_pok_13:
    v_cmp_ne_u64 vcc, s[14:15], v[100:101]
    s_nop 0
    s_cbranch_vccz L_pok_15
    s_mov_b32 s85, 0
L_plp_16:
    buffer_load_dwordx2 v[100:101], v102, s[52:55], 0 offen sc1
    s_waitcnt vmcnt(0)
    v_cmp_ne_u64 vcc, s[14:15], v[100:101]
    s_add_u32 s85, s85, 1
    s_cbranch_vccz L_pok_15
    s_cmp_lt_u32 s85, 0x100000
    s_cbranch_scc1 L_plp_16
L_pok_15:
    v_cmp_ne_u64 vcc, s[14:15], v[98:99]
    s_nop 0
    s_cbranch_vccz L_pok_17
    s_mov_b32 s85, 0
L_plp_18:
    buffer_load_dwordx2 v[98:99], v116, s[52:55], 0 offen sc1
    s_waitcnt vmcnt(0)
    v_cmp_ne_u64_e64 vcc, s[14:15], v[98:99]
    s_add_u32 s85, s85, 1
    s_cbranch_vccz L_pok_17
    s_cmp_lt_u32 s85, 0x100000
    s_cbranch_scc1 L_plp_18
L_pok_17:
    s_mov_b32 s85, 0
L_lna_19:
    buffer_load_dwordx4 v[0:3], v126, s[52:55], s16 offen offset:0 sc1
    buffer_load_dwordx4 v[4:7], v126, s[52:55], s16 offen offset:1024 sc1
    buffer_load_dwordx4 v[8:11], v126, s[52:55], s16 offen offset:2048 sc1
    buffer_load_dwordx4 v[12:15], v126, s[52:55], s16 offen offset:3072 sc1
    buffer_load_dwordx4 v[16:19], v126, s[52:55], s17 offen offset:0 sc1
    buffer_load_dwordx4 v[20:23], v126, s[52:55], s17 offen offset:1024 sc1
    buffer_load_dwordx4 v[24:27], v126, s[52:55], s17 offen offset:2048 sc1
    s_waitcnt vmcnt(6)
    v_lshlrev_b32 v28, 16, v0
    v_and_b32 v29, s0, v0
    v_lshlrev_b32 v30, 16, v1
    v_and_b32 v31, s0, v1
    v_lshlrev_b32 v32, 16, v2
    v_and_b32 v33, s0, v2
    v_lshlrev_b32 v34, 16, v3
    v_and_b32_e64 v35, s0, v3
    v_pk_mul_f32 v[92:93], v[28:29], v[28:29]
    v_pk_mul_f32 v[94:95], v[30:31], v[30:31]
    v_pk_mul_f32 v[96:97], v[32:33], v[32:33]
    v_pk_mul_f32 v[98:99], v[34:35], v[34:35]
    s_waitcnt vmcnt(5)
    v_lshlrev_b32 v36, 16, v4
    v_and_b32 v37, s0, v4
    v_lshlrev_b32 v38, 16, v5
    v_and_b32 v39, s0, v5
    v_lshlrev_b32 v40, 16, v6
    v_and_b32 v41, s0, v6
    v_lshlrev_b32 v42, 16, v7
    v_and_b32_e64 v43, s0, v7
    v_pk_fma_f32 v[92:93], v[36:37], v[36:37], v[92:93]
    v_pk_add_f32 v[84:85], v[28:29], v[36:37]
    v_pk_fma_f32 v[94:95], v[38:39], v[38:39], v[94:95]
    v_pk_add_f32 v[86:87], v[30:31], v[38:39]
    v_pk_fma_f32 v[96:97], v[40:41], v[40:41], v[96:97]
    v_pk_add_f32 v[88:89], v[32:33], v[40:41]
    v_pk_fma_f32 v[98:99], v[42:43], v[42:43], v[98:99]
    v_pk_add_f32 v[90:91], v[34:35], v[42:43]
    s_waitcnt vmcnt(4)
    v_lshlrev_b32 v44, 16, v8
    v_and_b32 v45, s0, v8
    v_lshlrev_b32 v46, 16, v9
    v_and_b32 v47, s0, v9
    v_lshlrev_b32 v48, 16, v10
    v_and_b32 v49, s0, v10
    v_lshlrev_b32 v50, 16, v11
    v_and_b32_e64 v51, s0, v11
    v_pk_fma_f32 v[92:93], v[44:45], v[44:45], v[92:93]
    v_pk_add_f32 v[84:85], v[84:85], v[44:45]
    v_pk_fma_f32 v[94:95], v[46:47], v[46:47], v[94:95]
    v_pk_add_f32 v[86:87], v[86:87], v[46:47]
    v_pk_fma_f32 v[96:97], v[48:49], v[48:49], v[96:97]
    v_pk_add_f32 v[88:89], v[88:89], v[48:49]
    v_pk_fma_f32 v[98:99], v[50:51], v[50:51], v[98:99]
    v_pk_add_f32 v[90:91], v[90:91], v[50:51]
    s_waitcnt vmcnt(3)
    v_lshlrev_b32 v52, 16, v12
    v_and_b32 v53, s0, v12
    v_lshlrev_b32 v54, 16, v13
    v_and_b32 v55, s0, v13
    v_lshlrev_b32 v56, 16, v14
    v_and_b32 v57, s0, v14
    v_lshlrev_b32 v58, 16, v15
    v_and_b32_e64 v59, s0, v15
    v_pk_fma_f32 v[92:93], v[52:53], v[52:53], v[92:93]
    v_pk_add_f32 v[84:85], v[84:85], v[52:53]
    v_pk_fma_f32 v[94:95], v[54:55], v[54:55], v[94:95]
    v_pk_add_f32 v[86:87], v[86:87], v[54:55]
    v_pk_fma_f32 v[96:97], v[56:57], v[56:57], v[96:97]
    v_pk_add_f32 v[88:89], v[88:89], v[56:57]
    v_pk_fma_f32 v[98:99], v[58:59], v[58:59], v[98:99]
    v_pk_add_f32 v[90:91], v[90:91], v[58:59]
    s_waitcnt vmcnt(2)
    v_lshlrev_b32 v60, 16, v16
    v_and_b32 v61, s0, v16
    v_lshlrev_b32 v62, 16, v17
    v_and_b32 v63, s0, v17
    v_lshlrev_b32 v64, 16, v18
    v_and_b32 v65, s0, v18
    v_lshlrev_b32 v66, 16, v19
    v_and_b32_e64 v67, s0, v19
    v_pk_fma_f32 v[92:93], v[60:61], v[60:61], v[92:93]
    v_pk_add_f32 v[84:85], v[84:85], v[60:61]
    v_pk_fma_f32 v[94:95], v[62:63], v[62:63], v[94:95]
    v_pk_add_f32 v[86:87], v[86:87], v[62:63]
    v_pk_fma_f32 v[96:97], v[64:65], v[64:65], v[96:97]
    v_pk_add_f32 v[88:89], v[88:89], v[64:65]
    v_pk_fma_f32 v[98:99], v[66:67], v[66:67], v[98:99]
    v_pk_add_f32 v[90:91], v[90:91], v[66:67]
    s_waitcnt vmcnt(1)
    v_lshlrev_b32 v68, 16, v20
    v_and_b32 v69, s0, v20
    v_lshlrev_b32 v70, 16, v21
    v_and_b32 v71, s0, v21
    v_lshlrev_b32 v72, 16, v22
    v_and_b32 v73, s0, v22
    v_lshlrev_b32 v74, 16, v23
    v_and_b32_e64 v75, s0, v23
    v_pk_fma_f32 v[92:93], v[68:69], v[68:69], v[92:93]
    v_pk_add_f32 v[84:85], v[84:85], v[68:69]
    v_pk_fma_f32 v[94:95], v[70:71], v[70:71], v[94:95]
    v_pk_add_f32 v[86:87], v[86:87], v[70:71]
    v_pk_fma_f32 v[96:97], v[72:73], v[72:73], v[96:97]
    v_pk_add_f32 v[88:89], v[88:89], v[72:73]
    v_pk_fma_f32 v[98:99], v[74:75], v[74:75], v[98:99]
    v_pk_add_f32 v[90:91], v[90:91], v[74:75]
    s_waitcnt vmcnt(0)
    v_lshlrev_b32 v76, 16, v24
    v_and_b32 v77, s0, v24
    v_lshlrev_b32 v78, 16, v25
    v_and_b32 v79, s0, v25
    v_lshlrev_b32 v80, 16, v26
    v_and_b32 v81, s0, v26
    v_lshlrev_b32 v82, 16, v27
    v_and_b32_e64 v83, s0, v27
    v_pk_fma_f32 v[92:93], v[76:77], v[76:77], v[92:93]
    v_pk_add_f32 v[84:85], v[84:85], v[76:77]
    v_pk_fma_f32 v[94:95], v[78:79], v[78:79], v[94:95]
    v_pk_add_f32 v[86:87], v[86:87], v[78:79]
    v_pk_fma_f32 v[96:97], v[80:81], v[80:81], v[96:97]
    v_pk_add_f32 v[88:89], v[88:89], v[80:81]
    v_pk_fma_f32 v[98:99], v[82:83], v[82:83], v[98:99]
    v_pk_add_f32 v[90:91], v[90:91], v[82:83]
    v_max3_u32 v113, v3, v7, v11
    v_max3_u32 v113, v113, v15, v19
    v_max3_u32 v113, v113, v23, v27
    v_cmp_eq_u32 vcc, -1, v113
    v_permlane32_swap_b32 v84, v92
    v_permlane32_swap_b32 v85, v93
    s_cbranch_vccnz L_lns_21
L_lnb_20:
    v_permlane32_swap_b32 v86, v94
    v_permlane32_swap_b32 v87, v95
    v_permlane32_swap_b32 v88, v96
    v_permlane32_swap_b32 v89, v97
    v_permlane32_swap_b32 v90, v98
    v_permlane32_swap_b32 v91, v99
    v_pk_add_f32 v[84:85], v[84:85], v[92:93]
    v_pk_add_f32 v[86:87], v[86:87], v[94:95]
    v_pk_add_f32 v[88:89], v[88:89], v[96:97]
    v_pk_add_f32 v[90:91], v[90:91], v[98:99]
    s_nop 0
    v_permlane16_swap_b32 v84, v88
    v_permlane16_swap_b32 v85, v89
    v_permlane16_swap_b32 v86, v90
    v_permlane16_swap_b32 v87, v91
    v_pk_add_f32 v[84:85], v[84:85], v[88:89]
    v_pk_add_f32 v[86:87], v[86:87], v[90:91]
    s_nop 0
    v_add_f32_dpp v100, v84, v84 row_ror:8 row_mask:0xf bank_mask:0x3
    v_add_f32_dpp v101, v85, v85 row_ror:8 row_mask:0xf bank_mask:0x3
    s_nop 0
    v_add_f32_dpp v100, v86, v86 row_ror:8 row_mask:0xf bank_mask:0xc
    v_add_f32_dpp v101, v87, v87 row_ror:8 row_mask:0xf bank_mask:0xc
    s_nop 0
    v_add_f32_dpp v84, v100, v100 row_shl:4 row_mask:0xf bank_mask:0x5
    s_nop 1
    v_add_f32_dpp v84, v101, v101 row_shr:4 row_mask:0xf bank_mask:0xa
    ds_write_b32 v110, v84
    s_waitcnt lgkmcnt(0)
    s_barrier
    s_mov_b64 exec, 0xff
    buffer_store_dwordx4 v[104:107], v108, s[52:55], 0 offen sc1
    s_mov_b64 exec, -1
    ds_read2_b32 v[0:1], v111 offset0:0 offset1:32
    ds_read2_b32 v[2:3], v111 offset0:64 offset1:96
    ds_read2_b32 v[4:5], v111 offset0:128 offset1:160
    ds_read2_b32 v[6:7], v111 offset0:192 offset1:224
    s_waitcnt lgkmcnt(2)
    v_pk_add_f32 v[0:1], v[0:1], v[2:3]
    s_waitcnt lgkmcnt(0)
    v_pk_add_f32 v[4:5], v[4:5], v[6:7]
    v_pk_add_f32 v[0:1], v[0:1], v[4:5]
    v_mul_f32 v0, 0x3b124925, v0
    v_mul_f32 v1, 0x3b124925, v1
    v_fma_f32 v1, -v0, v0, v1
    v_max_f32 v1, 0, v1
    v_add_f32 v2, 0x3727c5ac, v1
    v_fmamk_f32 v2, v2, 0x3727c5ac, v1
    v_rsq_f32_e64 v2, v2
    s_nop 0
    v_mul_f32 v3, -v0, v2
    v_cndmask_b32 v2, v2, v3, s[18:19]
    ds_write_b32 v112, v2
    ds_read_b128 v[84:87], v117
    ds_read_b128 v[92:95], v117 offset:128
    ds_read_b128 v[88:91], v117 offset:16
    ds_read_b128 v[96:99], v117 offset:144
    s_waitcnt lgkmcnt(2)
    v_pk_fma_f32 v[28:29], v[28:29], v[84:85], v[92:93]
    v_pk_fma_f32 v[30:31], v[30:31], v[86:87], v[94:95]
    s_waitcnt lgkmcnt(0)
    v_pk_fma_f32 v[32:33], v[32:33], v[88:89], v[96:97]
    v_pk_fma_f32 v[34:35], v[34:35], v[90:91], v[98:99]
    v_cvt_pk_bf16_f32 v0, v28, v29
    v_cvt_pk_bf16_f32 v1, v30, v31
    v_cvt_pk_bf16_f32 v2, v32, v33
    v_cvt_pk_bf16_f32 v3, v34, v35
    buffer_store_dwordx4 v[0:3], v109, s[52:55], s23 offen sc1
    v_pk_fma_f32 v[36:37], v[36:37], v[84:85], v[92:93]
    v_pk_fma_f32 v[38:39], v[38:39], v[86:87], v[94:95]
    v_pk_fma_f32 v[40:41], v[40:41], v[88:89], v[96:97]
    v_pk_fma_f32 v[42:43], v[42:43], v[90:91], v[98:99]
    v_cvt_pk_bf16_f32 v4, v36, v37
    v_cvt_pk_bf16_f32 v5, v38, v39
    v_cvt_pk_bf16_f32 v6, v40, v41
    v_cvt_pk_bf16_f32 v7, v42, v43
    buffer_store_dwordx4 v[4:7], v109, s[52:55], s24 offen sc1
    v_pk_fma_f32 v[44:45], v[44:45], v[84:85], v[92:93]
    v_pk_fma_f32 v[46:47], v[46:47], v[86:87], v[94:95]
    v_pk_fma_f32 v[48:49], v[48:49], v[88:89], v[96:97]
    v_pk_fma_f32 v[50:51], v[50:51], v[90:91], v[98:99]
    v_cvt_pk_bf16_f32 v8, v44, v45
    v_cvt_pk_bf16_f32 v9, v46, v47
    v_cvt_pk_bf16_f32 v10, v48, v49
    v_cvt_pk_bf16_f32 v11, v50, v51
    buffer_store_dwordx4 v[8:11], v109, s[52:55], s25 offen sc1
    v_pk_fma_f32 v[52:53], v[52:53], v[84:85], v[92:93]
    v_pk_fma_f32 v[54:55], v[54:55], v[86:87], v[94:95]
    v_pk_fma_f32 v[56:57], v[56:57], v[88:89], v[96:97]
    v_pk_fma_f32 v[58:59], v[58:59], v[90:91], v[98:99]
    v_cvt_pk_bf16_f32 v12, v52, v53
    v_cvt_pk_bf16_f32 v13, v54, v55
    v_cvt_pk_bf16_f32 v14, v56, v57
    v_cvt_pk_bf16_f32 v15, v58, v59
    buffer_store_dwordx4 v[12:15], v109, s[52:55], s26 offen sc1
    v_pk_fma_f32 v[60:61], v[60:61], v[84:85], v[92:93]
    v_pk_fma_f32 v[62:63], v[62:63], v[86:87], v[94:95]
    v_pk_fma_f32 v[64:65], v[64:65], v[88:89], v[96:97]
    v_pk_fma_f32 v[66:67], v[66:67], v[90:91], v[98:99]
    v_cvt_pk_bf16_f32 v16, v60, v61
    v_cvt_pk_bf16_f32 v17, v62, v63
    v_cvt_pk_bf16_f32 v18, v64, v65
    v_cvt_pk_bf16_f32 v19, v66, v67
    buffer_store_dwordx4 v[16:19], v109, s[52:55], s27 offen sc1
    v_pk_fma_f32 v[68:69], v[68:69], v[84:85], v[92:93]
    v_pk_fma_f32 v[70:71], v[70:71], v[86:87], v[94:95]
    v_pk_fma_f32 v[72:73], v[72:73], v[88:89], v[96:97]
    v_pk_fma_f32 v[74:75], v[74:75], v[90:91], v[98:99]
    v_cvt_pk_bf16_f32 v20, v68, v69
    v_cvt_pk_bf16_f32 v21, v70, v71
    v_cvt_pk_bf16_f32 v22, v72, v73
    v_cvt_pk_bf16_f32 v23, v74, v75
    buffer_store_dwordx4 v[20:23], v109, s[52:55], s28 offen sc1
    v_pk_fma_f32 v[76:77], v[76:77], v[84:85], v[92:93]
    v_pk_fma_f32 v[78:79], v[78:79], v[86:87], v[94:95]
    v_pk_fma_f32 v[80:81], v[80:81], v[88:89], v[96:97]
    v_pk_fma_f32 v[82:83], v[82:83], v[90:91], v[98:99]
    v_cvt_pk_bf16_f32 v24, v76, v77
    v_cvt_pk_bf16_f32 v25, v78, v79
    v_cvt_pk_bf16_f32 v26, v80, v81
    v_cvt_pk_bf16_f32 v27, v82, v83
    buffer_store_dwordx4 v[24:27], v109, s[52:55], s29 offen sc1
L_skip_12:
    s_mov_b32 s29, 0x3f80
    v_lshrrev_b32 v7, 5, v127
    v_and_b32 v8, 31, v127
    v_lshlrev_b32 v7, 2, v7
    v_sub_u32 v8, v8, v7
    v_and_b32 v7, 1, v8
    v_lshlrev_b32 v7, 4, v7
    v_lshlrev_b32 v7, v7, s29
    v_ashrrev_i32_e64 v8, 1, v8
    v_cmp_eq_u32 s[16:17], 0, v8
    v_cmp_eq_u32 s[30:31], 1, v8
    v_cmp_eq_u32 s[50:51], 4, v8
    v_cndmask_b32 v0, 0, v7, s[16:17]
    v_cmp_eq_u32 s[16:17], 5, v8
    v_cndmask_b32 v1, 0, v7, s[30:31]
    v_cmp_eq_u32 s[30:31], 8, v8
    v_cndmask_b32 v2, 0, v7, s[50:51]
    v_cmp_eq_u32 s[50:51], 9, v8
    v_cndmask_b32 v3, 0, v7, s[16:17]
    v_cmp_eq_u32 s[16:17], 12, v8
    v_cndmask_b32 v4, 0, v7, s[30:31]
    v_cmp_eq_u32 s[30:31], 13, v8
    v_cndmask_b32 v5, 0, v7, s[50:51]
    v_cndmask_b32 v6, 0, v7, s[16:17]
    v_cndmask_b32 v7, 0, v7, s[30:31]
    ds_write_b128 v126, v[0:3] offset:61440
    ds_write_b128 v126, v[4:7] offset:62464
    s_cmp_eq_u32 s86, 0
    s_cbranch_scc1 L_ba_22
    ds_read_b64_tr_b16 a[0:1], v123 offset:0
    ds_read_b64_tr_b16 a[2:3], v123 offset:512
    ds_read_b64_tr_b16 a[4:5], v122 offset:0
    ds_read_b64_tr_b16 a[6:7], v122 offset:512
    ds_read_b64_tr_b16 a[8:9], v123 offset:2048
    ds_read_b64_tr_b16 a[10:11], v123 offset:2560
    ds_read_b64_tr_b16 a[12:13], v122 offset:2048
    ds_read_b64_tr_b16 a[14:15], v122 offset:2560
    s_add_u32 m0, s80, 0
    s_add_u32 s98, s98, 28672
    s_cmp_eq_u32 s98, s78
    s_cselect_b32 s3, 1835008, 0
    s_sub_u32 s98, s98, s3
    s_waitcnt lgkmcnt(4)
    buffer_load_dwordx4 v121, s[56:59], s98 offen lds
    s_add_u32 m0, s80, 1024
    s_add_u32 s98, s98, 28672
    buffer_load_dwordx4 v121, s[56:59], s98 offen lds
    ds_read_b64_tr_b16 a[16:17], v123 offset:4096
    ds_read_b64_tr_b16 a[18:19], v123 offset:4608
    ds_read_b64_tr_b16 a[20:21], v122 offset:4096
    ds_read_b64_tr_b16 a[22:23], v122 offset:4608
    s_add_u32 m0, s80, 2048
    s_add_u32 s98, s98, 28672
    s_waitcnt lgkmcnt(4)
    buffer_load_dwordx4 v121, s[56:59], s98 offen lds
    s_add_u32 m0, s80, 3072
    s_add_u32 s98, s98, 28672
    buffer_load_dwordx4 v121, s[56:59], s98 offen lds
    ds_read_b64_tr_b16 a[24:25], v123 offset:6144
    ds_read_b64_tr_b16 a[26:27], v123 offset:6656
    ds_read_b64_tr_b16 a[28:29], v122 offset:6144
    ds_read_b64_tr_b16 a[30:31], v122 offset:6656
    s_add_u32 m0, s80, 4096
    s_add_u32 s98, s98, 28672
    s_waitcnt lgkmcnt(4)
    buffer_load_dwordx4 v121, s[56:59], s98 offen lds
    s_add_u32 m0, s80, 5120
    s_add_u32 s98, s98, 28672
    buffer_load_dwordx4 v121, s[56:59], s98 offen lds
    s_waitcnt vmcnt(23)
    ds_read_b64_tr_b16 v[128:129], v125 offset:8192
    ds_read_b64_tr_b16 v[130:131], v125 offset:9216
    ds_read_b64_tr_b16 v[132:133], v124 offset:8192
    ds_read_b64_tr_b16 v[134:135], v124 offset:9216
    s_add_u32 m0, s80, 6144
    s_add_u32 s98, s98, 28672
    s_waitcnt lgkmcnt(4)
    buffer_load_dwordx4 v121, s[56:59], s98 offen lds
    s_add_u32 m0, s80, 7168
    s_add_u32 s98, s98, 28672
    buffer_load_dwordx4 v121, s[56:59], s98 offen lds
    s_waitcnt vmcnt(23)
    ds_read_b64_tr_b16 v[136:137], v125 offset:10240
    ds_read_b64_tr_b16 v[138:139], v125 offset:11264
    ds_read_b64_tr_b16 v[140:141], v124 offset:10240
    ds_read_b64_tr_b16 v[142:143], v124 offset:11264
    s_add_u32 m0, s80, 8192
    s_add_u32 s98, s98, 28672
    s_cmp_eq_u32 s98, s78
    s_cselect_b32 s3, 1835008, 0
    s_sub_u32 s98, s98, s3
    s_waitcnt lgkmcnt(4)
    buffer_load_dwordx4 v121, s[56:59], s98 offen lds
    s_add_u32 m0, s80, 9216
    s_add_u32 s98, s98, 28672
    buffer_load_dwordx4 v121, s[56:59], s98 offen lds
    s_waitcnt vmcnt(23)
    ds_read_b64_tr_b16 v[144:145], v125 offset:12288
    ds_read_b64_tr_b16 v[146:147], v125 offset:13312
    ds_read_b64_tr_b16 v[148:149], v124 offset:12288
    ds_read_b64_tr_b16 v[150:151], v124 offset:13312
    s_add_u32 m0, s80, 10240
    s_add_u32 s98, s98, 28672
    s_waitcnt lgkmcnt(4)
    buffer_load_dwordx4 v121, s[56:59], s98 offen lds
    s_add_u32 m0, s80, 11264
    s_add_u32 s98, s98, 28672
    buffer_load_dwordx4 v121, s[56:59], s98 offen lds
    s_waitcnt vmcnt(23)
    ds_read_b64_tr_b16 v[152:153], v125 offset:14336
    ds_read_b64_tr_b16 v[154:155], v125 offset:15360
    ds_read_b64_tr_b16 v[156:157], v124 offset:14336
    ds_read_b64_tr_b16 v[158:159], v124 offset:15360
    s_add_u32 m0, s80, 12288
    s_add_u32 s98, s98, 28672
    s_waitcnt lgkmcnt(4)
    buffer_load_dwordx4 v121, s[56:59], s98 offen lds
    s_add_u32 m0, s80, 13312
    s_add_u32 s98, s98, 28672
    buffer_load_dwordx4 v121, s[56:59], s98 offen lds
    s_waitcnt vmcnt(23)
    ds_read_b64_tr_b16 a[32:33], v123 offset:16384
    ds_read_b64_tr_b16 a[34:35], v123 offset:16896
    ds_read_b64_tr_b16 a[36:37], v122 offset:16384
    ds_read_b64_tr_b16 a[38:39], v122 offset:16896
    s_add_u32 m0, s80, 14336
    s_add_u32 s98, s98, 28672
    s_waitcnt lgkmcnt(4)
    buffer_load_dwordx4 v121, s[56:59], s98 offen lds
    s_add_u32 m0, s80, 15360
    s_add_u32 s98, s98, 28672
    buffer_load_dwordx4 v121, s[56:59], s98 offen lds
    s_waitcnt vmcnt(23)
    ds_read_b64_tr_b16 a[40:41], v123 offset:18432
    ds_read_b64_tr_b16 a[42:43], v123 offset:18944
    ds_read_b64_tr_b16 a[44:45], v122 offset:18432
    ds_read_b64_tr_b16 a[46:47], v122 offset:18944
    s_add_u32 m0, s80, 16384
    s_add_u32 s98, s98, 28672
    s_cmp_eq_u32 s98, s78
    s_cselect_b32 s3, 1835008, 0
    s_sub_u32 s98, s98, s3
    s_waitcnt lgkmcnt(4)
    buffer_load_dwordx4 v121, s[56:59], s98 offen lds
    s_add_u32 m0, s80, 17408
    s_add_u32 s98, s98, 28672
    buffer_load_dwordx4 v121, s[56:59], s98 offen lds
    s_waitcnt vmcnt(23)
    ds_read_b64_tr_b16 a[48:49], v123 offset:20480
    ds_read_b64_tr_b16 a[50:51], v123 offset:20992
    ds_read_b64_tr_b16 a[52:53], v122 offset:20480
    ds_read_b64_tr_b16 a[54:55], v122 offset:20992
    s_add_u32 m0, s80, 18432
    s_add_u32 s98, s98, 28672
    s_waitcnt lgkmcnt(4)
    buffer_load_dwordx4 v121, s[56:59], s98 offen lds
    s_add_u32 m0, s80, 19456
    s_add_u32 s98, s98, 28672
    buffer_load_dwordx4 v121, s[56:59], s98 offen lds
    s_waitcnt vmcnt(23)
    ds_read_b64_tr_b16 a[56:57], v123 offset:22528
    ds_read_b64_tr_b16 a[58:59], v123 offset:23040
    ds_read_b64_tr_b16 a[60:61], v122 offset:22528
    ds_read_b64_tr_b16 a[62:63], v122 offset:23040
    s_add_u32 m0, s80, 20480
    s_add_u32 s98, s98, 28672
    s_waitcnt lgkmcnt(4)
    buffer_load_dwordx4 v121, s[56:59], s98 offen lds
    s_add_u32 m0, s80, 21504
    s_add_u32 s98, s98, 28672
    buffer_load_dwordx4 v121, s[56:59], s98 offen lds
    s_waitcnt vmcnt(20)
    ds_read_b64_tr_b16 a[64:65], v123 offset:0
    ds_read_b64_tr_b16 a[66:67], v123 offset:512
    ds_read_b64_tr_b16 a[68:69], v122 offset:0
    ds_read_b64_tr_b16 a[70:71], v122 offset:512
    s_add_u32 m0, s80, 22528
    s_add_u32 s98, s98, 28672
    s_waitcnt lgkmcnt(4)
    buffer_load_dwordx4 v121, s[56:59], s98 offen lds
    s_add_u32 m0, s80, 23552
    s_add_u32 s98, s98, 28672
    buffer_load_dwordx4 v121, s[56:59], s98 offen lds
    s_waitcnt vmcnt(20)
    ds_read_b64_tr_b16 a[72:73], v123 offset:2048
    ds_read_b64_tr_b16 a[74:75], v123 offset:2560
    ds_read_b64_tr_b16 a[76:77], v122 offset:2048
    ds_read_b64_tr_b16 a[78:79], v122 offset:2560
    s_add_u32 m0, s80, 0
    s_add_u32 s98, s98, 28672
    s_cmp_eq_u32 s98, s78
    s_cselect_b32 s3, 1835008, 0
    s_sub_u32 s98, s98, s3
    s_waitcnt lgkmcnt(4)
    buffer_load_dwordx4 v121, s[56:59], s98 offen lds
    s_add_u32 m0, s80, 1024
    s_add_u32 s98, s98, 28672
    buffer_load_dwordx4 v121, s[56:59], s98 offen lds
    s_waitcnt vmcnt(20)
    ds_read_b64_tr_b16 a[80:81], v123 offset:4096
    ds_read_b64_tr_b16 a[82:83], v123 offset:4608
    ds_read_b64_tr_b16 a[84:85], v122 offset:4096
    ds_read_b64_tr_b16 a[86:87], v122 offset:4608
    s_add_u32 m0, s80, 2048
    s_add_u32 s98, s98, 28672
    s_waitcnt lgkmcnt(4)
    buffer_load_dwordx4 v121, s[56:59], s98 offen lds
    s_add_u32 m0, s80, 3072
    s_add_u32 s98, s98, 28672
    buffer_load_dwordx4 v121, s[56:59], s98 offen lds
    s_waitcnt vmcnt(20)
    ds_read_b64_tr_b16 a[88:89], v123 offset:6144
    ds_read_b64_tr_b16 a[90:91], v123 offset:6656
    ds_read_b64_tr_b16 a[92:93], v122 offset:6144
    ds_read_b64_tr_b16 a[94:95], v122 offset:6656
    s_add_u32 m0, s80, 4096
    s_add_u32 s98, s98, 28672
    s_waitcnt lgkmcnt(4)
    buffer_load_dwordx4 v121, s[56:59], s98 offen lds
    s_add_u32 m0, s80, 5120
    s_add_u32 s98, s98, 28672
    buffer_load_dwordx4 v121, s[56:59], s98 offen lds
    s_waitcnt vmcnt(20)
    ds_read_b64_tr_b16 a[96:97], v123 offset:8192
    ds_read_b64_tr_b16 a[98:99], v123 offset:8704
    ds_read_b64_tr_b16 a[100:101], v122 offset:8192
    ds_read_b64_tr_b16 a[102:103], v122 offset:8704
    s_add_u32 m0, s80, 6144
    s_add_u32 s98, s98, 28672
    s_waitcnt lgkmcnt(4)
    buffer_load_dwordx4 v121, s[56:59], s98 offen lds
    s_add_u32 m0, s80, 7168
    s_add_u32 s98, s98, 28672
    buffer_load_dwordx4 v121, s[56:59], s98 offen lds
    s_waitcnt vmcnt(20)
    ds_read_b64_tr_b16 a[104:105], v123 offset:10240
    ds_read_b64_tr_b16 a[106:107], v123 offset:10752
    ds_read_b64_tr_b16 a[108:109], v122 offset:10240
    ds_read_b64_tr_b16 a[110:111], v122 offset:10752
    s_add_u32 m0, s80, 8192
    s_add_u32 s98, s98, 28672
    s_cmp_eq_u32 s98, s78
    s_cselect_b32 s3, 1835008, 0
    s_sub_u32 s98, s98, s3
    s_waitcnt lgkmcnt(4)
    buffer_load_dwordx4 v121, s[56:59], s98 offen lds
    s_add_u32 m0, s80, 9216
    s_add_u32 s98, s98, 28672
    buffer_load_dwordx4 v121, s[56:59], s98 offen lds
    s_waitcnt vmcnt(20)
    ds_read_b64_tr_b16 a[112:113], v123 offset:12288
    ds_read_b64_tr_b16 a[114:115], v123 offset:12800
    ds_read_b64_tr_b16 a[116:117], v122 offset:12288
    ds_read_b64_tr_b16 a[118:119], v122 offset:12800
    s_add_u32 m0, s80, 10240
    s_add_u32 s98, s98, 28672
    s_waitcnt lgkmcnt(4)
    buffer_load_dwordx4 v121, s[56:59], s98 offen lds
    s_add_u32 m0, s80, 11264
    s_add_u32 s98, s98, 28672
    buffer_load_dwordx4 v121, s[56:59], s98 offen lds
    s_waitcnt vmcnt(20)
    ds_read_b64_tr_b16 a[120:121], v123 offset:14336
    ds_read_b64_tr_b16 a[122:123], v123 offset:14848
    ds_read_b64_tr_b16 a[124:125], v122 offset:14336
    ds_read_b64_tr_b16 a[126:127], v122 offset:14848
    s_add_u32 m0, s80, 12288
    s_add_u32 s98, s98, 28672
    s_waitcnt lgkmcnt(4)
    buffer_load_dwordx4 v121, s[56:59], s98 offen lds
    s_add_u32 m0, s80, 13312
    s_add_u32 s98, s98, 28672
    buffer_load_dwordx4 v121, s[56:59], s98 offen lds
    s_waitcnt vmcnt(20)
    ds_read_b64_tr_b16 a[128:129], v123 offset:16384
    ds_read_b64_tr_b16 a[130:131], v123 offset:16896
    ds_read_b64_tr_b16 a[132:133], v122 offset:16384
    ds_read_b64_tr_b16 a[134:135], v122 offset:16896
    s_add_u32 m0, s80, 14336
    s_add_u32 s98, s98, 28672
    s_waitcnt lgkmcnt(4)
    buffer_load_dwordx4 v121, s[56:59], s98 offen lds
    s_add_u32 m0, s80, 15360
    s_add_u32 s98, s98, 28672
    buffer_load_dwordx4 v121, s[56:59], s98 offen lds
    s_waitcnt vmcnt(20)
    ds_read_b64_tr_b16 a[136:137], v123 offset:18432
    ds_read_b64_tr_b16 a[138:139], v123 offset:18944
    ds_read_b64_tr_b16 a[140:141], v122 offset:18432
    ds_read_b64_tr_b16 a[142:143], v122 offset:18944
    s_add_u32 m0, s80, 16384
    s_add_u32 s98, s98, 28672
    s_cmp_eq_u32 s98, s78
    s_cselect_b32 s3, 1835008, 0
    s_sub_u32 s98, s98, s3
    s_waitcnt lgkmcnt(4)
    buffer_load_dwordx4 v121, s[56:59], s98 offen lds
    s_add_u32 m0, s80, 17408
    s_add_u32 s98, s98, 28672
    buffer_load_dwordx4 v121, s[56:59], s98 offen lds
    s_waitcnt vmcnt(20)
    ds_read_b64_tr_b16 a[144:145], v123 offset:20480
    ds_read_b64_tr_b16 a[146:147], v123 offset:20992
    ds_read_b64_tr_b16 a[148:149], v122 offset:20480
    ds_read_b64_tr_b16 a[150:151], v122 offset:20992
    s_add_u32 m0, s80, 18432
    s_add_u32 s98, s98, 28672
    s_waitcnt lgkmcnt(4)
    buffer_load_dwordx4 v121, s[56:59], s98 offen lds
    s_add_u32 m0, s80, 19456
    s_add_u32 s98, s98, 28672
    buffer_load_dwordx4 v121, s[56:59], s98 offen lds
    s_waitcnt vmcnt(20)
    ds_read_b64_tr_b16 a[152:153], v123 offset:22528
    ds_read_b64_tr_b16 a[154:155], v123 offset:23040
    ds_read_b64_tr_b16 a[156:157], v122 offset:22528
    ds_read_b64_tr_b16 a[158:159], v122 offset:23040
    s_add_u32 m0, s80, 20480
    s_add_u32 s98, s98, 28672
    s_waitcnt lgkmcnt(4)
    buffer_load_dwordx4 v121, s[56:59], s98 offen lds
    s_add_u32 m0, s80, 21504
    s_add_u32 s98, s98, 28672
    buffer_load_dwordx4 v121, s[56:59], s98 offen lds
    s_waitcnt vmcnt(20)
    ds_read_b64_tr_b16 a[160:161], v123 offset:0
    ds_read_b64_tr_b16 a[162:163], v123 offset:512
    ds_read_b64_tr_b16 a[164:165], v122 offset:0
    ds_read_b64_tr_b16 a[166:167], v122 offset:512
    s_add_u32 m0, s80, 22528
    s_add_u32 s98, s98, 28672
    s_waitcnt lgkmcnt(4)
    buffer_load_dwordx4 v121, s[56:59], s98 offen lds
    s_add_u32 m0, s80, 23552
    s_add_u32 s98, s98, 28672
    buffer_load_dwordx4 v121, s[56:59], s98 offen lds
    s_waitcnt vmcnt(20)
    ds_read_b64_tr_b16 a[168:169], v123 offset:2048
    ds_read_b64_tr_b16 a[170:171], v123 offset:2560
    ds_read_b64_tr_b16 a[172:173], v122 offset:2048
    ds_read_b64_tr_b16 a[174:175], v122 offset:2560
    s_add_u32 m0, s80, 0
    s_add_u32 s99, s99, 32768
    s_cmp_eq_u32 s99, s79
    s_cselect_b32 s3, 1835008, 0
    s_sub_u32 s99, s99, s3
    s_waitcnt lgkmcnt(4)
    buffer_load_dwordx4 v120, s[60:63], s99 offen lds
    s_add_u32 m0, s80, 1024
    s_add_u32 s99, s99, 32768
    buffer_load_dwordx4 v120, s[60:63], s99 offen lds
    s_waitcnt vmcnt(20)
    ds_read_b64_tr_b16 a[176:177], v123 offset:4096
    ds_read_b64_tr_b16 a[178:179], v123 offset:4608
    ds_read_b64_tr_b16 a[180:181], v122 offset:4096
    ds_read_b64_tr_b16 a[182:183], v122 offset:4608
    s_add_u32 m0, s80, 2048
    s_add_u32 s99, s99, 32768
    s_waitcnt lgkmcnt(4)
    buffer_load_dwordx4 v120, s[60:63], s99 offen lds
    s_add_u32 m0, s80, 3072
    s_add_u32 s99, s99, 32768
    buffer_load_dwordx4 v120, s[60:63], s99 offen lds
    s_waitcnt vmcnt(20)
    ds_read_b64_tr_b16 a[184:185], v123 offset:6144
    ds_read_b64_tr_b16 a[186:187], v123 offset:6656
    ds_read_b64_tr_b16 a[188:189], v122 offset:6144
    ds_read_b64_tr_b16 a[190:191], v122 offset:6656
    s_add_u32 m0, s80, 4096
    s_add_u32 s99, s99, 32768
    s_waitcnt lgkmcnt(4)
    buffer_load_dwordx4 v120, s[60:63], s99 offen lds
    s_add_u32 m0, s80, 5120
    s_add_u32 s99, s99, 32768
    buffer_load_dwordx4 v120, s[60:63], s99 offen lds
    s_waitcnt vmcnt(20)
    ds_read_b64_tr_b16 a[192:193], v123 offset:8192
    ds_read_b64_tr_b16 a[194:195], v123 offset:8704
    ds_read_b64_tr_b16 a[196:197], v122 offset:8192
    ds_read_b64_tr_b16 a[198:199], v122 offset:8704
    s_add_u32 m0, s80, 6144
    s_add_u32 s99, s99, 32768
    s_waitcnt lgkmcnt(4)
    buffer_load_dwordx4 v120, s[60:63], s99 offen lds
    s_add_u32 m0, s80, 7168
    s_add_u32 s99, s99, 32768
    buffer_load_dwordx4 v120, s[60:63], s99 offen lds
    s_waitcnt vmcnt(20)
    ds_read_b64_tr_b16 a[200:201], v123 offset:10240
    ds_read_b64_tr_b16 a[202:203], v123 offset:10752
    ds_read_b64_tr_b16 a[204:205], v122 offset:10240
    ds_read_b64_tr_b16 a[206:207], v122 offset:10752
    s_add_u32 m0, s80, 8192
    s_add_u32 s99, s99, 32768
    s_cmp_eq_u32 s99, s79
    s_cselect_b32 s3, 1835008, 0
    s_sub_u32 s99, s99, s3
    s_waitcnt lgkmcnt(4)
    buffer_load_dwordx4 v120, s[60:63], s99 offen lds
    s_add_u32 m0, s80, 9216
    s_add_u32 s99, s99, 32768
    buffer_load_dwordx4 v120, s[60:63], s99 offen lds
    s_waitcnt vmcnt(20)
    ds_read_b64_tr_b16 a[208:209], v123 offset:12288
    ds_read_b64_tr_b16 a[210:211], v123 offset:12800
    ds_read_b64_tr_b16 a[212:213], v122 offset:12288
    ds_read_b64_tr_b16 a[214:215], v122 offset:12800
    s_add_u32 m0, s80, 10240
    s_add_u32 s99, s99, 32768
    s_waitcnt lgkmcnt(4)
    buffer_load_dwordx4 v120, s[60:63], s99 offen lds
    s_add_u32 m0, s80, 11264
    s_add_u32 s99, s99, 32768
    buffer_load_dwordx4 v120, s[60:63], s99 offen lds
    s_waitcnt vmcnt(20)
    ds_read_b64_tr_b16 a[216:217], v123 offset:14336
    ds_read_b64_tr_b16 a[218:219], v123 offset:14848
    ds_read_b64_tr_b16 a[220:221], v122 offset:14336
    ds_read_b64_tr_b16 a[222:223], v122 offset:14848
    s_add_u32 m0, s80, 12288
    s_add_u32 s99, s99, 32768
    s_waitcnt lgkmcnt(4)
    buffer_load_dwordx4 v120, s[60:63], s99 offen lds
    s_add_u32 m0, s80, 13312
    s_add_u32 s99, s99, 32768
    buffer_load_dwordx4 v120, s[60:63], s99 offen lds
    s_waitcnt vmcnt(20)
    ds_read_b64_tr_b16 a[224:225], v123 offset:16384
    ds_read_b64_tr_b16 a[226:227], v123 offset:16896
    ds_read_b64_tr_b16 a[228:229], v122 offset:16384
    ds_read_b64_tr_b16 a[230:231], v122 offset:16896
    s_add_u32 m0, s80, 14336
    s_add_u32 s99, s99, 32768
    s_waitcnt lgkmcnt(4)
    buffer_load_dwordx4 v120, s[60:63], s99 offen lds
    s_add_u32 m0, s80, 15360
    s_add_u32 s99, s99, 32768
    buffer_load_dwordx4 v120, s[60:63], s99 offen lds
    s_waitcnt vmcnt(20)
    ds_read_b64_tr_b16 a[232:233], v123 offset:18432
    ds_read_b64_tr_b16 a[234:235], v123 offset:18944
    ds_read_b64_tr_b16 a[236:237], v122 offset:18432
    ds_read_b64_tr_b16 a[238:239], v122 offset:18944
    s_add_u32 m0, s80, 16384
    s_add_u32 s99, s99, 32768
    s_cmp_eq_u32 s99, s79
    s_cselect_b32 s3, 1835008, 0
    s_sub_u32 s99, s99, s3
    s_waitcnt lgkmcnt(4)
    buffer_load_dwordx4 v120, s[60:63], s99 offen lds
    s_add_u32 m0, s80, 17408
    s_add_u32 s99, s99, 32768
    buffer_load_dwordx4 v120, s[60:63], s99 offen lds
    s_waitcnt vmcnt(20)
    ds_read_b64_tr_b16 a[240:241], v123 offset:20480
    ds_read_b64_tr_b16 a[242:243], v123 offset:20992
    ds_read_b64_tr_b16 a[244:245], v122 offset:20480
    ds_read_b64_tr_b16 a[246:247], v122 offset:20992
    s_add_u32 m0, s80, 18432
    s_add_u32 s99, s99, 32768
    s_waitcnt lgkmcnt(4)
    buffer_load_dwordx4 v120, s[60:63], s99 offen lds
    s_add_u32 m0, s80, 19456
    s_add_u32 s99, s99, 32768
    buffer_load_dwordx4 v120, s[60:63], s99 offen lds
    s_waitcnt vmcnt(20)
    ds_read_b64_tr_b16 a[248:249], v123 offset:22528
    ds_read_b64_tr_b16 a[250:251], v123 offset:23040
    ds_read_b64_tr_b16 a[252:253], v122 offset:22528
    ds_read_b64_tr_b16 a[254:255], v122 offset:23040
    s_add_u32 m0, s80, 20480
    s_add_u32 s99, s99, 32768
    s_waitcnt lgkmcnt(4)
    buffer_load_dwordx4 v120, s[60:63], s99 offen lds
    s_add_u32 m0, s80, 21504
    s_add_u32 s99, s99, 32768
    buffer_load_dwordx4 v120, s[60:63], s99 offen lds
    s_waitcnt vmcnt(20)
    ds_read_b64_tr_b16 v[160:161], v125 offset:0
    ds_read_b64_tr_b16 v[162:163], v125 offset:1024
    ds_read_b64_tr_b16 v[164:165], v124 offset:0
    ds_read_b64_tr_b16 v[166:167], v124 offset:1024
    s_add_u32 m0, s80, 22528
    s_add_u32 s99, s99, 32768
    s_waitcnt lgkmcnt(4)
    buffer_load_dwordx4 v120, s[60:63], s99 offen lds
    s_add_u32 m0, s80, 23552
    s_add_u32 s99, s99, 32768
    buffer_load_dwordx4 v120, s[60:63], s99 offen lds
    s_waitcnt vmcnt(20)
    ds_read_b64_tr_b16 v[168:169], v125 offset:2048
    ds_read_b64_tr_b16 v[170:171], v125 offset:3072
    ds_read_b64_tr_b16 v[172:173], v124 offset:2048
    ds_read_b64_tr_b16 v[174:175], v124 offset:3072
    s_add_u32 m0, s80, 0
    s_add_u32 s99, s99, 32768
    s_cmp_eq_u32 s99, s79
    s_cselect_b32 s3, 1835008, 0
    s_sub_u32 s99, s99, s3
    s_waitcnt lgkmcnt(4)
    buffer_load_dwordx4 v120, s[60:63], s99 offen lds
    s_add_u32 m0, s80, 1024
    s_add_u32 s99, s99, 32768
    buffer_load_dwordx4 v120, s[60:63], s99 offen lds
    s_waitcnt vmcnt(20)
    ds_read_b64_tr_b16 v[176:177], v125 offset:4096
    ds_read_b64_tr_b16 v[178:179], v125 offset:5120
    ds_read_b64_tr_b16 v[180:181], v124 offset:4096
    ds_read_b64_tr_b16 v[182:183], v124 offset:5120
    s_add_u32 m0, s80, 2048
    s_add_u32 s99, s99, 32768
    s_waitcnt lgkmcnt(4)
    buffer_load_dwordx4 v120, s[60:63], s99 offen lds
    s_add_u32 m0, s80, 3072
    s_add_u32 s99, s99, 32768
    buffer_load_dwordx4 v120, s[60:63], s99 offen lds
    s_waitcnt vmcnt(20)
    ds_read_b64_tr_b16 v[184:185], v125 offset:6144
    ds_read_b64_tr_b16 v[186:187], v125 offset:7168
    ds_read_b64_tr_b16 v[188:189], v124 offset:6144
    ds_read_b64_tr_b16 v[190:191], v124 offset:7168
    s_add_u32 m0, s80, 4096
    s_add_u32 s99, s99, 32768
    s_waitcnt lgkmcnt(4)
    buffer_load_dwordx4 v120, s[60:63], s99 offen lds
    s_add_u32 m0, s80, 5120
    s_add_u32 s99, s99, 32768
    buffer_load_dwordx4 v120, s[60:63], s99 offen lds
    s_waitcnt vmcnt(20)
    ds_read_b64_tr_b16 v[192:193], v125 offset:8192
    ds_read_b64_tr_b16 v[194:195], v125 offset:9216
    ds_read_b64_tr_b16 v[196:197], v124 offset:8192
    ds_read_b64_tr_b16 v[198:199], v124 offset:9216
    s_add_u32 m0, s80, 6144
    s_add_u32 s99, s99, 32768
    s_waitcnt lgkmcnt(4)
    buffer_load_dwordx4 v120, s[60:63], s99 offen lds
    s_add_u32 m0, s80, 7168
    s_add_u32 s99, s99, 32768
    buffer_load_dwordx4 v120, s[60:63], s99 offen lds
    s_waitcnt vmcnt(20)
    ds_read_b64_tr_b16 v[200:201], v125 offset:10240
    ds_read_b64_tr_b16 v[202:203], v125 offset:11264
    ds_read_b64_tr_b16 v[204:205], v124 offset:10240
    ds_read_b64_tr_b16 v[206:207], v124 offset:11264
    s_add_u32 m0, s80, 8192
    s_add_u32 s99, s99, 32768
    s_cmp_eq_u32 s99, s79
    s_cselect_b32 s3, 1835008, 0
    s_sub_u32 s99, s99, s3
    s_waitcnt lgkmcnt(4)
    buffer_load_dwordx4 v120, s[60:63], s99 offen lds
    s_add_u32 m0, s80, 9216
    s_add_u32 s99, s99, 32768
    buffer_load_dwordx4 v120, s[60:63], s99 offen lds
    s_waitcnt vmcnt(20)
    ds_read_b64_tr_b16 v[208:209], v125 offset:12288
    ds_read_b64_tr_b16 v[210:211], v125 offset:13312
    ds_read_b64_tr_b16 v[212:213], v124 offset:12288
    ds_read_b64_tr_b16 v[214:215], v124 offset:13312
    s_add_u32 m0, s80, 10240
    s_add_u32 s99, s99, 32768
    s_waitcnt lgkmcnt(4)
    buffer_load_dwordx4 v120, s[60:63], s99 offen lds
    s_add_u32 m0, s80, 11264
    s_add_u32 s99, s99, 32768
    buffer_load_dwordx4 v120, s[60:63], s99 offen lds
    s_waitcnt vmcnt(20)
    ds_read_b64_tr_b16 v[216:217], v125 offset:14336
    ds_read_b64_tr_b16 v[218:219], v125 offset:15360
    ds_read_b64_tr_b16 v[220:221], v124 offset:14336
    ds_read_b64_tr_b16 v[222:223], v124 offset:15360
    s_add_u32 m0, s80, 12288
    s_add_u32 s99, s99, 32768
    s_waitcnt lgkmcnt(4)
    buffer_load_dwordx4 v120, s[60:63], s99 offen lds
    s_add_u32 m0, s80, 13312
    s_add_u32 s99, s99, 32768
    buffer_load_dwordx4 v120, s[60:63], s99 offen lds
    s_waitcnt vmcnt(20)
    ds_read_b64_tr_b16 v[224:225], v125 offset:16384
    ds_read_b64_tr_b16 v[226:227], v125 offset:17408
    ds_read_b64_tr_b16 v[228:229], v124 offset:16384
    ds_read_b64_tr_b16 v[230:231], v124 offset:17408
    s_add_u32 m0, s80, 14336
    s_add_u32 s99, s99, 32768
    s_waitcnt lgkmcnt(4)
    buffer_load_dwordx4 v120, s[60:63], s99 offen lds
    v_min_u32_e64 v62, 27, v127
    s_lshl_b32 s84, s5, 14
    s_add_u32 s84, s84, 3407872
    v_lshl_add_u32 v62, v62, 6, s84
    buffer_load_dwordx2 v[60:61], v62, s[52:55], 0 offen sc1
    s_and_b32 s81, s4, 1
    s_lshl_b32 s81, s81, 10
    v_add_u32 v123, s81, v126
    v_xor_b32 v122, 0x400, v123
    s_lshr_b32 s81, s4, 1
    s_lshl_b32 s81, s81, 6
    s_lshl_b32 s82, s9, 7
    s_add_u32 s81, s81, s82
    v_lshrrev_b32 v16, 5, v127
    v_lshl_add_u32 v16, v16, 3, s81
    global_load_dwordx2 v[20:21], v16, s[38:39] offset:0
    global_load_dwordx2 v[22:23], v16, s[38:39] offset:16
    global_load_dwordx2 v[24:25], v16, s[38:39] offset:32
    global_load_dwordx2 v[26:27], v16, s[38:39] offset:48
    s_lshl_b32 s81, s4, 5
    v_and_b32 v34, 31, v127
    v_add_u32 v34, s81, v34
    v_and_b32 v35, 28, v127
    v_add_u32 v35, s81, v35
    s_lshl_b32 s13, s8, 7
    s_add_u32 s13, s13, s81
    s_lshl_b32 s13, s13, 11
    s_add_u32 s13, s13, 6291456
    v_lshrrev_b32 v34, 1, v34
    v_lshrrev_b32 v35, 1, v35
    s_mov_b32 s34, 0xbdd2d3e8
    s_mul_i32 s21, s8, 112
    s_lshl_b32 s81, s9, 2
    s_add_u32 s21, s21, s81
    s_and_b32 s81, s4, 2
    s_add_u32 s21, s21, s81
    s_lshl_b32 s21, s21, 11
    s_add_u32 s21, s21, 8388608
    s_xor_b32 s24, s4, 1
    s_mul_i32 s24, s24, 6144
    s_xor_b32 s25, s4, 2
    s_mul_i32 s25, s25, 6144
    s_xor_b32 s26, s4, 3
    s_mul_i32 s26, s26, 6144
    s_mul_i32 s23, s4, 6144
    s_mov_b32 s27, s13
    s_add_u32 s28, s13, 65536
    s_lshl_b32 s81, s33, 13
    s_add_u32 s13, s13, s81
    s_mov_b32 s22, s13
    s_add_u32 m0, s80, 15360
    s_add_u32 s99, s99, 32768
    buffer_load_dwordx4 v120, s[60:63], s99 offen lds
    s_waitcnt vmcnt(25)
    ds_read_b64_tr_b16 v[232:233], v125 offset:18432
    ds_read_b64_tr_b16 v[234:235], v125 offset:19456
    ds_read_b64_tr_b16 v[236:237], v124 offset:18432
    ds_read_b64_tr_b16 v[238:239], v124 offset:19456
    s_add_u32 m0, s80, 16384
    s_add_u32 s99, s99, 32768
    s_cmp_eq_u32 s99, s79
    s_cselect_b32 s3, 1835008, 0
    s_sub_u32 s99, s99, s3
    s_waitcnt lgkmcnt(4)
    buffer_load_dwordx4 v120, s[60:63], s99 offen lds
    s_add_u32 m0, s80, 17408
    s_add_u32 s99, s99, 32768
    buffer_load_dwordx4 v120, s[60:63], s99 offen lds
    s_waitcnt vmcnt(25)
    ds_read_b64_tr_b16 v[240:241], v125 offset:20480
    ds_read_b64_tr_b16 v[242:243], v125 offset:21504
    ds_read_b64_tr_b16 v[244:245], v124 offset:20480
    ds_read_b64_tr_b16 v[246:247], v124 offset:21504
    s_add_u32 m0, s80, 18432
    s_add_u32 s99, s99, 32768
    s_waitcnt lgkmcnt(4)
    buffer_load_dwordx4 v120, s[60:63], s99 offen lds
    s_waitcnt vmcnt(7)
    v_lshlrev_b32 v0, 16, v20
    v_and_b32 v1, s0, v20
    v_lshlrev_b32 v2, 16, v21
    v_and_b32 v3, s0, v21
    s_waitcnt vmcnt(6)
    v_lshlrev_b32 v4, 16, v22
    v_and_b32 v5, s0, v22
    v_lshlrev_b32 v6, 16, v23
    v_and_b32 v7, s0, v23
    s_waitcnt vmcnt(5)
    v_lshlrev_b32 v8, 16, v24
    v_and_b32 v9, s0, v24
    v_lshlrev_b32 v10, 16, v25
    v_and_b32 v11, s0, v25
    s_waitcnt vmcnt(4)
    v_lshlrev_b32 v12, 16, v26
    v_and_b32 v13, s0, v26
    v_lshlrev_b32 v14, 16, v27
    v_and_b32_e64 v15, s0, v27
    s_lshl_b32 s84, s5, 14
    s_add_u32 s84, s84, 2621440
    v_lshl_add_u32 v35, v35, 6, s84
    buffer_load_dwordx2 v[32:33], v35, s[52:55], 0 offen sc1
    s_add_u32 m0, s80, 19456
    s_add_u32 s99, s99, 32768
    buffer_load_dwordx4 v120, s[60:63], s99 offen lds
    ds_read_b64_tr_b16 v[248:249], v125 offset:22528
    ds_read_b64_tr_b16 v[250:251], v125 offset:23552
    ds_read_b64_tr_b16 v[252:253], v124 offset:22528
    ds_read_b64_tr_b16 v[254:255], v124 offset:23552
    s_add_u32 m0, s80, 20480
    s_add_u32 s99, s99, 32768
    s_waitcnt lgkmcnt(4)
    buffer_load_dwordx4 v120, s[60:63], s99 offen lds
    s_add_u32 m0, s80, 21504
    s_add_u32 s99, s99, 32768
    buffer_load_dwordx4 v120, s[60:63], s99 offen lds
    s_add_u32 m0, s80, 22528
    s_add_u32 s99, s99, 32768
    s_waitcnt lgkmcnt(0)
    buffer_load_dwordx4 v120, s[60:63], s99 offen lds
    s_add_u32 m0, s80, 23552
    s_add_u32 s99, s99, 32768
    buffer_load_dwordx4 v120, s[60:63], s99 offen lds
    v_cmp_ne_u64 vcc, s[14:15], v[60:61]
    s_nop 0
    s_cbranch_vccz L_pok_25
    s_mov_b32 s85, 0
L_plp_26:
    buffer_load_dwordx2 v[60:61], v62, s[52:55], 0 offen sc1
    s_waitcnt vmcnt(0)
    v_cmp_ne_u64_e64 vcc, s[14:15], v[60:61]
    s_add_u32 s85, s85, 1
    s_cbranch_vccz L_pok_25
    s_cmp_lt_u32 s85, 0x100000
    s_cbranch_scc1 L_plp_26
L_pok_25:
    s_branch L_bb_23
L_ba_22:
    s_cmp_eq_u32 s88, 0
    s_cbranch_scc1 L_bc_24
    s_waitcnt vmcnt(9)
    ds_read_b64_tr_b16 v[128:129], v125 offset:16384
    ds_read_b64_tr_b16 v[130:131], v125 offset:17408
    ds_read_b64_tr_b16 v[132:133], v124 offset:16384
    ds_read_b64_tr_b16 v[134:135], v124 offset:17408
    s_waitcnt vmcnt(7)
    ds_read_b64_tr_b16 v[136:137], v125 offset:18432
    ds_read_b64_tr_b16 v[138:139], v125 offset:19456
    ds_read_b64_tr_b16 v[140:141], v124 offset:18432
    ds_read_b64_tr_b16 v[142:143], v124 offset:19456
    s_add_u32 m0, s80, 16384
    s_add_u32 s99, s99, 32768
    s_cmp_eq_u32 s99, s79
    s_cselect_b32 s3, 1835008, 0
    s_sub_u32 s99, s99, s3
    s_waitcnt lgkmcnt(4)
    buffer_load_dwordx4 v120, s[60:63], s99 offen lds
    s_add_u32 m0, s80, 17408
    s_add_u32 s99, s99, 32768
    buffer_load_dwordx4 v120, s[60:63], s99 offen lds
    s_waitcnt vmcnt(7)
    ds_read_b64_tr_b16 v[144:145], v125 offset:20480
    ds_read_b64_tr_b16 v[146:147], v125 offset:21504
    ds_read_b64_tr_b16 v[148:149], v124 offset:20480
    ds_read_b64_tr_b16 v[150:151], v124 offset:21504
    s_add_u32 m0, s80, 18432
    s_add_u32 s99, s99, 32768
    s_waitcnt lgkmcnt(4)
    buffer_load_dwordx4 v120, s[60:63], s99 offen lds
    s_add_u32 m0, s80, 19456
    s_add_u32 s99, s99, 32768
    buffer_load_dwordx4 v120, s[60:63], s99 offen lds
    s_waitcnt vmcnt(7)
    ds_read_b64_tr_b16 v[152:153], v125 offset:22528
    ds_read_b64_tr_b16 v[154:155], v125 offset:23552
    ds_read_b64_tr_b16 v[156:157], v124 offset:22528
    ds_read_b64_tr_b16 v[158:159], v124 offset:23552
    s_add_u32 m0, s80, 20480
    s_add_u32 s99, s99, 32768
    s_waitcnt lgkmcnt(4)
    buffer_load_dwordx4 v120, s[60:63], s99 offen lds
    s_add_u32 m0, s80, 21504
    s_add_u32 s99, s99, 32768
    buffer_load_dwordx4 v120, s[60:63], s99 offen lds
    ds_read_b64_tr_b16 v[160:161], v125 offset:0
    ds_read_b64_tr_b16 v[162:163], v125 offset:1024
    ds_read_b64_tr_b16 v[164:165], v124 offset:0
    ds_read_b64_tr_b16 v[166:167], v124 offset:1024
    s_add_u32 m0, s80, 22528
    s_add_u32 s99, s99, 32768
    s_waitcnt lgkmcnt(4)
    buffer_load_dwordx4 v120, s[60:63], s99 offen lds
    s_add_u32 m0, s80, 23552
    s_add_u32 s99, s99, 32768
    buffer_load_dwordx4 v120, s[60:63], s99 offen lds
    ds_read_b64_tr_b16 v[168:169], v125 offset:2048
    ds_read_b64_tr_b16 v[170:171], v125 offset:3072
    ds_read_b64_tr_b16 v[172:173], v124 offset:2048
    ds_read_b64_tr_b16 v[174:175], v124 offset:3072
    s_add_u32 m0, s80, 0
    s_add_u32 s99, s99, 32768
    s_cmp_eq_u32 s99, s79
    s_cselect_b32 s3, 1835008, 0
    s_sub_u32 s99, s99, s3
    s_waitcnt lgkmcnt(4)
    buffer_load_dwordx4 v120, s[60:63], s99 offen lds
    s_add_u32 m0, s80, 1024
    s_add_u32 s99, s99, 32768
    buffer_load_dwordx4 v120, s[60:63], s99 offen lds
    ds_read_b64_tr_b16 v[176:177], v125 offset:4096
    ds_read_b64_tr_b16 v[178:179], v125 offset:5120
    ds_read_b64_tr_b16 v[180:181], v124 offset:4096
    ds_read_b64_tr_b16 v[182:183], v124 offset:5120
    s_add_u32 m0, s80, 2048
    s_add_u32 s99, s99, 32768
    s_waitcnt lgkmcnt(4)
    buffer_load_dwordx4 v120, s[60:63], s99 offen lds
    s_add_u32 m0, s80, 3072
    s_add_u32 s99, s99, 32768
    buffer_load_dwordx4 v120, s[60:63], s99 offen lds
    ds_read_b64_tr_b16 v[184:185], v125 offset:6144
    ds_read_b64_tr_b16 v[186:187], v125 offset:7168
    ds_read_b64_tr_b16 v[188:189], v124 offset:6144
    ds_read_b64_tr_b16 v[190:191], v124 offset:7168
    s_add_u32 m0, s80, 4096
    s_add_u32 s99, s99, 32768
    s_waitcnt lgkmcnt(4)
    buffer_load_dwordx4 v120, s[60:63], s99 offen lds
    s_add_u32 m0, s80, 5120
    s_add_u32 s99, s99, 32768
    buffer_load_dwordx4 v120, s[60:63], s99 offen lds
    ds_read_b64_tr_b16 v[192:193], v125 offset:8192
    ds_read_b64_tr_b16 v[194:195], v125 offset:9216
    ds_read_b64_tr_b16 v[196:197], v124 offset:8192
    ds_read_b64_tr_b16 v[198:199], v124 offset:9216
    s_add_u32 m0, s80, 6144
    s_add_u32 s99, s99, 32768
    s_waitcnt lgkmcnt(4)
    buffer_load_dwordx4 v120, s[60:63], s99 offen lds
    s_add_u32 m0, s80, 7168
    s_add_u32 s99, s99, 32768
    buffer_load_dwordx4 v120, s[60:63], s99 offen lds
    ds_read_b64_tr_b16 v[200:201], v125 offset:10240
    ds_read_b64_tr_b16 v[202:203], v125 offset:11264
    ds_read_b64_tr_b16 v[204:205], v124 offset:10240
    ds_read_b64_tr_b16 v[206:207], v124 offset:11264
    s_add_u32 m0, s80, 8192
    s_add_u32 s99, s99, 32768
    s_cmp_eq_u32 s99, s79
    s_cselect_b32 s3, 1835008, 0
    s_sub_u32 s99, s99, s3
    s_waitcnt lgkmcnt(4)
    buffer_load_dwordx4 v120, s[60:63], s99 offen lds
    s_add_u32 m0, s80, 9216
    s_add_u32 s99, s99, 32768
    buffer_load_dwordx4 v120, s[60:63], s99 offen lds
    ds_read_b64_tr_b16 v[208:209], v125 offset:12288
    ds_read_b64_tr_b16 v[210:211], v125 offset:13312
    ds_read_b64_tr_b16 v[212:213], v124 offset:12288
    ds_read_b64_tr_b16 v[214:215], v124 offset:13312
    s_add_u32 m0, s80, 10240
    s_add_u32 s99, s99, 32768
    s_waitcnt lgkmcnt(4)
    buffer_load_dwordx4 v120, s[60:63], s99 offen lds
    s_add_u32 m0, s80, 11264
    s_add_u32 s99, s99, 32768
    buffer_load_dwordx4 v120, s[60:63], s99 offen lds
    ds_read_b64_tr_b16 v[216:217], v125 offset:14336
    ds_read_b64_tr_b16 v[218:219], v125 offset:15360
    ds_read_b64_tr_b16 v[220:221], v124 offset:14336
    ds_read_b64_tr_b16 v[222:223], v124 offset:15360
    s_add_u32 m0, s80, 12288
    s_add_u32 s99, s99, 32768
    s_waitcnt lgkmcnt(4)
    buffer_load_dwordx4 v120, s[60:63], s99 offen lds
    s_add_u32 m0, s80, 13312
    s_add_u32 s99, s99, 32768
    buffer_load_dwordx4 v120, s[60:63], s99 offen lds
    s_waitcnt vmcnt(20)
    ds_read_b64_tr_b16 v[224:225], v125 offset:16384
    ds_read_b64_tr_b16 v[226:227], v125 offset:17408
    ds_read_b64_tr_b16 v[228:229], v124 offset:16384
    ds_read_b64_tr_b16 v[230:231], v124 offset:17408
    s_add_u32 m0, s80, 14336
    s_add_u32 s99, s99, 32768
    s_waitcnt lgkmcnt(4)
    buffer_load_dwordx4 v120, s[60:63], s99 offen lds
    s_add_u32 m0, s80, 15360
    s_add_u32 s99, s99, 32768
    buffer_load_dwordx4 v120, s[60:63], s99 offen lds
    s_waitcnt vmcnt(20)
    ds_read_b64_tr_b16 v[232:233], v125 offset:18432
    ds_read_b64_tr_b16 v[234:235], v125 offset:19456
    ds_read_b64_tr_b16 v[236:237], v124 offset:18432
    ds_read_b64_tr_b16 v[238:239], v124 offset:19456
    s_add_u32 m0, s80, 16384
    s_add_u32 s99, s99, 32768
    s_cmp_eq_u32 s99, s79
    s_cselect_b32 s3, 1835008, 0
    s_sub_u32 s99, s99, s3
    s_waitcnt lgkmcnt(4)
    buffer_load_dwordx4 v120, s[60:63], s99 offen lds
    s_add_u32 m0, s80, 17408
    s_add_u32 s99, s99, 32768
    buffer_load_dwordx4 v120, s[60:63], s99 offen lds
    s_waitcnt vmcnt(20)
    ds_read_b64_tr_b16 v[240:241], v125 offset:20480
    ds_read_b64_tr_b16 v[242:243], v125 offset:21504
    ds_read_b64_tr_b16 v[244:245], v124 offset:20480
    ds_read_b64_tr_b16 v[246:247], v124 offset:21504
    s_add_u32 m0, s80, 18432
    s_add_u32 s99, s99, 32768
    s_waitcnt lgkmcnt(4)
    buffer_load_dwordx4 v120, s[60:63], s99 offen lds
    s_add_u32 m0, s80, 19456
    s_add_u32 s99, s99, 32768
    buffer_load_dwordx4 v120, s[60:63], s99 offen lds
    s_waitcnt vmcnt(20)
    ds_read_b64_tr_b16 v[248:249], v125 offset:22528
    ds_read_b64_tr_b16 v[250:251], v125 offset:23552
    ds_read_b64_tr_b16 v[252:253], v124 offset:22528
    ds_read_b64_tr_b16 v[254:255], v124 offset:23552
    s_add_u32 m0, s80, 20480
    s_add_u32 s99, s99, 32768
    s_waitcnt lgkmcnt(4)
    buffer_load_dwordx4 v120, s[60:63], s99 offen lds
    s_add_u32 m0, s80, 21504
    s_add_u32 s99, s99, 32768
    buffer_load_dwordx4 v120, s[60:63], s99 offen lds
    s_add_u32 m0, s80, 22528
    s_add_u32 s99, s99, 32768
    s_waitcnt lgkmcnt(0)
    buffer_load_dwordx4 v120, s[60:63], s99 offen lds
    s_add_u32 m0, s80, 23552
    s_add_u32 s99, s99, 32768
    buffer_load_dwordx4 v120, s[60:63], s99 offen lds
    s_lshr_b32 s16, s75, 1
    s_sub_u32 s17, s75, 4
    s_cmp_lt_u32 s75, 8
    s_cselect_b32 s16, s16, s17
    s_lshl_b32 s81, s16, 12
    s_lshl_b32 s82, s4, 10
    s_add_u32 s81, s81, s82
    s_add_u32 s81, s81, 16777216
    v_mov_b32 v80, -1
    v_mov_b32 v81, -1
    v_mov_b32 v82, -1
    v_mov_b32_e64 v83, -1
    buffer_store_dwordx4 v[80:83], v126, s[52:55], s81 offen sc1
    s_add_u32 s81, s81, 114688
    buffer_store_dwordx4 v[80:83], v126, s[52:55], s81 offen sc1
    s_add_u32 s81, s81, 114688
    buffer_store_dwordx4 v[80:83], v126, s[52:55], s81 offen sc1
    s_add_u32 s81, s81, 114688
    buffer_store_dwordx4 v[80:83], v126, s[52:55], s81 offen sc1
    s_add_u32 s81, s81, 114688
    buffer_store_dwordx4 v[80:83], v126, s[52:55], s81 offen sc1
    s_add_u32 s81, s81, 114688
    buffer_store_dwordx4 v[80:83], v126, s[52:55], s81 offen sc1
    s_add_u32 s81, s81, 114688
    buffer_store_dwordx4 v[80:83], v126, s[52:55], s81 offen sc1
    s_add_u32 s81, s81, 114688
    buffer_store_dwordx4 v[80:83], v126, s[52:55], s81 offen sc1
    s_add_u32 s81, s81, 114688
    buffer_store_dwordx4 v[80:83], v126, s[52:55], s81 offen sc1
    s_add_u32 s81, s81, 114688
    buffer_store_dwordx4 v[80:83], v126, s[52:55], s81 offen sc1
    s_add_u32 s81, s81, 114688
    buffer_store_dwordx4 v[80:83], v126, s[52:55], s81 offen sc1
    s_add_u32 s81, s81, 114688
    buffer_store_dwordx4 v[80:83], v126, s[52:55], s81 offen sc1
    s_add_u32 s81, s81, 114688
    buffer_store_dwordx4 v[80:83], v126, s[52:55], s81 offen sc1
    s_add_u32 s81, s81, 114688
    buffer_store_dwordx4 v[80:83], v126, s[52:55], s81 offen sc1
    s_add_u32 s81, s81, 114688
    buffer_store_dwordx4 v[80:83], v126, s[52:55], s81 offen sc1
    s_add_u32 s81, s81, 114688
    buffer_store_dwordx4 v[80:83], v126, s[52:55], s81 offen sc1
    s_add_u32 s81, s81, 114688
    buffer_store_dwordx4 v[80:83], v126, s[52:55], s81 offen sc1
    s_lshl_b32 s81, s16, 6
    s_lshl_b32 s82, s4, 15
    s_add_u32 s81, s81, s82
    s_add_u32 s81, s81, 3538944
    v_lshlrev_b32 v76, 12, v127
    v_and_b32 v76, 0x4000, v76
    v_and_b32 v72, 3, v127
    v_lshl_add_u32 v76, v72, 4, v76
    v_mov_b32 v72, s14
    v_mov_b32 v73, s15
    v_mov_b32 v74, s14
    v_mov_b32 v75, s15
    s_waitcnt vmcnt(0)
    s_barrier
    s_mov_b64 exec, 0xff
    buffer_store_dwordx4 v[72:75], v76, s[52:55], s81 offen sc1
    s_mov_b64 exec, -1
L_bc_24:
    s_and_b32 s81, s4, 1
    s_lshl_b32 s81, s81, 10
    v_add_u32 v123, s81, v126
    v_xor_b32 v122, 0x400, v123
    s_lshr_b32 s81, s4, 1
    s_lshl_b32 s81, s81, 6
    s_lshl_b32 s82, s9, 7
    s_add_u32 s81, s81, s82
    v_lshrrev_b32 v16, 5, v127
    v_lshl_add_u32 v16, v16, 3, s81
    global_load_dwordx2 v[20:21], v16, s[38:39] offset:0
    global_load_dwordx2 v[22:23], v16, s[38:39] offset:16
    global_load_dwordx2 v[24:25], v16, s[38:39] offset:32
    global_load_dwordx2 v[26:27], v16, s[38:39] offset:48
    s_lshl_b32 s81, s4, 5
    v_and_b32 v34, 31, v127
    v_add_u32 v34, s81, v34
    v_and_b32 v35, 28, v127
    v_add_u32 v35, s81, v35
    s_lshl_b32 s13, s8, 7
    s_add_u32 s13, s13, s81
    s_lshl_b32 s13, s13, 11
    s_add_u32 s13, s13, 6291456
    v_lshrrev_b32 v34, 1, v34
    v_lshrrev_b32 v35, 1, v35
    s_mov_b32 s34, 0xbdd2d3e8
    s_mul_i32 s21, s8, 112
    s_lshl_b32 s81, s9, 2
    s_add_u32 s21, s21, s81
    s_and_b32 s81, s4, 2
    s_add_u32 s21, s21, s81
    s_lshl_b32 s21, s21, 11
    s_add_u32 s21, s21, 8388608
    s_xor_b32 s24, s4, 1
    s_mul_i32 s24, s24, 6144
    s_xor_b32 s25, s4, 2
    s_mul_i32 s25, s25, 6144
    s_xor_b32 s26, s4, 3
    s_mul_i32 s26, s26, 6144
    s_mul_i32 s23, s4, 6144
    s_mov_b32 s27, s13
    s_add_u32 s28, s13, 65536
    s_lshl_b32 s81, s33, 13
    s_add_u32 s13, s13, s81
    s_mov_b32 s22, s13
    s_waitcnt vmcnt(3)
    v_lshlrev_b32 v0, 16, v20
    v_and_b32 v1, s0, v20
    v_lshlrev_b32 v2, 16, v21
    v_and_b32 v3, s0, v21
    s_waitcnt vmcnt(2)
    v_lshlrev_b32 v4, 16, v22
    v_and_b32 v5, s0, v22
    v_lshlrev_b32 v6, 16, v23
    v_and_b32 v7, s0, v23
    s_waitcnt vmcnt(1)
    v_lshlrev_b32 v8, 16, v24
    v_and_b32 v9, s0, v24
    v_lshlrev_b32 v10, 16, v25
    v_and_b32 v11, s0, v25
    s_waitcnt vmcnt(0)
    v_lshlrev_b32 v12, 16, v26
    v_and_b32 v13, s0, v26
    v_lshlrev_b32 v14, 16, v27
    v_and_b32_e64 v15, s0, v27
    s_lshl_b32 s84, s5, 14
    s_add_u32 s84, s84, 2621440
    v_lshl_add_u32 v35, v35, 6, s84
    buffer_load_dwordx2 v[32:33], v35, s[52:55], 0 offen sc1
L_bb_23:
    s_cmp_eq_u32 s87, 0
    s_cbranch_scc1 L_ng1_27
    s_waitcnt vmcnt(0)
    v_cmp_ne_u64 vcc, s[14:15], v[32:33]
    s_nop 0
    s_cbranch_vccz L_pok_29
    s_mov_b32 s85, 0
L_plp_30:
    buffer_load_dwordx2 v[32:33], v35, s[52:55], 0 offen sc1
    s_waitcnt vmcnt(0)
    v_cmp_ne_u64_e64 vcc, s[14:15], v[32:33]
    s_add_u32 s85, s85, 1
    s_cbranch_vccz L_pok_29
    s_cmp_lt_u32 s85, 0x100000
    s_cbranch_scc1 L_plp_30
L_pok_29:
    s_mov_b32 s85, 0
    buffer_load_dwordx4 v[64:67], v123, s[52:55], s13 offen offset:0 sc1
    buffer_load_dwordx4 v[68:71], v122, s[52:55], s13 offen offset:0 sc1
    buffer_load_dwordx4 v[72:75], v123, s[52:55], s13 offen offset:2048 sc1
    buffer_load_dwordx4 v[76:79], v122, s[52:55], s13 offen offset:2048 sc1
    s_add_u32 s13, s13, 4096
    buffer_load_dwordx4 v[80:83], v123, s[52:55], s13 offen offset:0 sc1
    buffer_load_dwordx4 v[84:87], v122, s[52:55], s13 offen offset:0 sc1
    buffer_load_dwordx4 v[88:91], v123, s[52:55], s13 offen offset:2048 sc1
    buffer_load_dwordx4 v[92:95], v122, s[52:55], s13 offen offset:2048 sc1
    s_add_u32 s13, s13, 4096
    s_cmp_eq_u32 s13, s28
    s_cmov_b32 s13, s27
    buffer_load_dwordx4 v[96:99], v123, s[52:55], s13 offen offset:0 sc1
    buffer_load_dwordx4 v[100:103], v122, s[52:55], s13 offen offset:0 sc1
    buffer_load_dwordx4 v[104:107], v123, s[52:55], s13 offen offset:2048 sc1
    buffer_load_dwordx4 v[108:111], v122, s[52:55], s13 offen offset:2048 sc1
    s_add_u32 s13, s13, 4096
    buffer_load_dwordx4 v[112:115], v123, s[52:55], s13 offen offset:0 sc1
    buffer_load_dwordx4 v[116:119], v122, s[52:55], s13 offen offset:0 sc1
    s_waitcnt vmcnt(12)
    v_max_u32 v121, v67, v71
    v_cmp_eq_u32_e64 vcc, -1, v121
    s_nop 0
    s_cbranch_vccnz L_gs_32
L_gb_31:
    v_mfma_f32_32x32x16_bf16 v[0:15], a[0:3], v[64:67], v[0:15]
    v_mfma_f32_32x32x16_bf16 v[16:31], a[0:3], v[68:71], 0
    v_mfma_f32_32x32x16_bf16 v[32:47], a[4:7], v[64:67], 0
    buffer_load_dwordx4 v[64:67], v123, s[52:55], s13 offen offset:2048 sc1
    s_waitcnt vmcnt(11)
    v_max_u32 v121, v75, v79
    v_cmp_eq_u32 vcc, -1, v121
    v_mfma_f32_32x32x16_bf16 v[48:63], a[4:7], v[68:71], 0
    buffer_load_dwordx4 v[68:71], v122, s[52:55], s13 offen offset:2048 sc1
    s_cbranch_vccnz L_gs_34
L_gb_33:
    v_mfma_f32_32x32x16_bf16 v[0:15], a[8:11], v[72:75], v[0:15]
    v_mfma_f32_32x32x16_bf16 v[16:31], a[8:11], v[76:79], v[16:31]
    v_mfma_f32_32x32x16_bf16 v[32:47], a[12:15], v[72:75], v[32:47]
    s_add_u32 s13, s13, 4096
    s_cmp_eq_u32 s13, s28
    s_cmov_b32 s13, s27
    buffer_load_dwordx4 v[72:75], v123, s[52:55], s13 offen offset:0 sc1
    s_waitcnt vmcnt(11)
    v_max_u32 v121, v83, v87
    v_cmp_eq_u32 vcc, -1, v121
    v_mfma_f32_32x32x16_bf16 v[48:63], a[12:15], v[76:79], v[48:63]
    buffer_load_dwordx4 v[76:79], v122, s[52:55], s13 offen offset:0 sc1
    s_cbranch_vccnz L_gs_36
L_gb_35:
    v_mfma_f32_32x32x16_bf16 v[0:15], a[16:19], v[80:83], v[0:15]
    v_mfma_f32_32x32x16_bf16 v[16:31], a[16:19], v[84:87], v[16:31]
    v_mfma_f32_32x32x16_bf16 v[32:47], a[20:23], v[80:83], v[32:47]
    buffer_load_dwordx4 v[80:83], v123, s[52:55], s13 offen offset:2048 sc1
    s_waitcnt vmcnt(11)
    v_max_u32 v121, v91, v95
    v_cmp_eq_u32 vcc, -1, v121
    v_mfma_f32_32x32x16_bf16 v[48:63], a[20:23], v[84:87], v[48:63]
    buffer_load_dwordx4 v[84:87], v122, s[52:55], s13 offen offset:2048 sc1
    s_cbranch_vccnz L_gs_38
L_gb_37:
    v_mfma_f32_32x32x16_bf16 v[0:15], a[24:27], v[88:91], v[0:15]
    v_mfma_f32_32x32x16_bf16 v[16:31], a[24:27], v[92:95], v[16:31]
    v_mfma_f32_32x32x16_bf16 v[32:47], a[28:31], v[88:91], v[32:47]
    s_add_u32 s13, s13, 4096
    buffer_load_dwordx4 v[88:91], v123, s[52:55], s13 offen offset:0 sc1
    s_waitcnt vmcnt(11)
    v_max_u32 v121, v99, v103
    v_cmp_eq_u32 vcc, -1, v121
    v_mfma_f32_32x32x16_bf16 v[48:63], a[28:31], v[92:95], v[48:63]
    buffer_load_dwordx4 v[92:95], v122, s[52:55], s13 offen offset:0 sc1
    s_cbranch_vccnz L_gs_40
L_gb_39:
    v_mfma_f32_32x32x16_bf16 v[0:15], a[32:35], v[96:99], v[0:15]
    v_mfma_f32_32x32x16_bf16 v[16:31], a[32:35], v[100:103], v[16:31]
    v_mfma_f32_32x32x16_bf16 v[32:47], a[36:39], v[96:99], v[32:47]
    buffer_load_dwordx4 v[96:99], v123, s[52:55], s13 offen offset:2048 sc1
    s_waitcnt vmcnt(11)
    v_max_u32 v121, v107, v111
    v_cmp_eq_u32 vcc, -1, v121
    v_mfma_f32_32x32x16_bf16 v[48:63], a[36:39], v[100:103], v[48:63]
    buffer_load_dwordx4 v[100:103], v122, s[52:55], s13 offen offset:2048 sc1
    s_cbranch_vccnz L_gs_42
L_gb_41:
    v_mfma_f32_32x32x16_bf16 v[0:15], a[40:43], v[104:107], v[0:15]
    v_mfma_f32_32x32x16_bf16 v[16:31], a[40:43], v[108:111], v[16:31]
    v_mfma_f32_32x32x16_bf16 v[32:47], a[44:47], v[104:107], v[32:47]
    s_add_u32 s13, s13, 4096
    s_cmp_eq_u32 s13, s28
    s_cmov_b32 s13, s27
    buffer_load_dwordx4 v[104:107], v123, s[52:55], s13 offen offset:0 sc1
    s_waitcnt vmcnt(11)
    v_max_u32 v121, v115, v119
    v_cmp_eq_u32 vcc, -1, v121
    v_mfma_f32_32x32x16_bf16 v[48:63], a[44:47], v[108:111], v[48:63]
    buffer_load_dwordx4 v[108:111], v122, s[52:55], s13 offen offset:0 sc1
    s_cbranch_vccnz L_gs_44
L_gb_43:
    v_mfma_f32_32x32x16_bf16 v[0:15], a[48:51], v[112:115], v[0:15]
    v_mfma_f32_32x32x16_bf16 v[16:31], a[48:51], v[116:119], v[16:31]
    v_mfma_f32_32x32x16_bf16 v[32:47], a[52:55], v[112:115], v[32:47]
    buffer_load_dwordx4 v[112:115], v123, s[52:55], s13 offen offset:2048 sc1
    s_waitcnt vmcnt(11)
    v_max_u32 v121, v67, v71
    v_cmp_eq_u32 vcc, -1, v121
    v_mfma_f32_32x32x16_bf16 v[48:63], a[52:55], v[116:119], v[48:63]
    buffer_load_dwordx4 v[116:119], v122, s[52:55], s13 offen offset:2048 sc1
    s_cbranch_vccnz L_gs_46
L_gb_45:
    v_mfma_f32_32x32x16_bf16 v[0:15], a[56:59], v[64:67], v[0:15]
    v_mfma_f32_32x32x16_bf16 v[16:31], a[56:59], v[68:71], v[16:31]
    v_mfma_f32_32x32x16_bf16 v[32:47], a[60:63], v[64:67], v[32:47]
    s_add_u32 s13, s13, 4096
    buffer_load_dwordx4 v[64:67], v123, s[52:55], s13 offen offset:0 sc1
    s_waitcnt vmcnt(11)
    v_max_u32 v121, v75, v79
    v_cmp_eq_u32 vcc, -1, v121
    v_mfma_f32_32x32x16_bf16 v[48:63], a[60:63], v[68:71], v[48:63]
    buffer_load_dwordx4 v[68:71], v122, s[52:55], s13 offen offset:0 sc1
    s_cbranch_vccnz L_gs_48
L_gb_47:
    v_mfma_f32_32x32x16_bf16 v[0:15], a[64:67], v[72:75], v[0:15]
    v_mfma_f32_32x32x16_bf16 v[16:31], a[64:67], v[76:79], v[16:31]
    v_mfma_f32_32x32x16_bf16 v[32:47], a[68:71], v[72:75], v[32:47]
    buffer_load_dwordx4 v[72:75], v123, s[52:55], s13 offen offset:2048 sc1
    s_waitcnt vmcnt(11)
    v_max_u32 v121, v83, v87
    v_cmp_eq_u32 vcc, -1, v121
    v_mfma_f32_32x32x16_bf16 v[48:63], a[68:71], v[76:79], v[48:63]
    buffer_load_dwordx4 v[76:79], v122, s[52:55], s13 offen offset:2048 sc1
    s_cbranch_vccnz L_gs_50
L_gb_49:
    v_mfma_f32_32x32x16_bf16 v[0:15], a[72:75], v[80:83], v[0:15]
    v_mfma_f32_32x32x16_bf16 v[16:31], a[72:75], v[84:87], v[16:31]
    v_mfma_f32_32x32x16_bf16 v[32:47], a[76:79], v[80:83], v[32:47]
    s_add_u32 s13, s13, 4096
    s_cmp_eq_u32 s13, s28
    s_cmov_b32 s13, s27
    buffer_load_dwordx4 v[80:83], v123, s[52:55], s13 offen offset:0 sc1
    s_waitcnt vmcnt(11)
    v_max_u32 v121, v91, v95
    v_cmp_eq_u32 vcc, -1, v121
    v_mfma_f32_32x32x16_bf16 v[48:63], a[76:79], v[84:87], v[48:63]
    buffer_load_dwordx4 v[84:87], v122, s[52:55], s13 offen offset:0 sc1
    s_cbranch_vccnz L_gs_52
L_gb_51:
    v_mfma_f32_32x32x16_bf16 v[0:15], a[80:83], v[88:91], v[0:15]
    v_mfma_f32_32x32x16_bf16 v[16:31], a[80:83], v[92:95], v[16:31]
    v_mfma_f32_32x32x16_bf16 v[32:47], a[84:87], v[88:91], v[32:47]
    buffer_load_dwordx4 v[88:91], v123, s[52:55], s13 offen offset:2048 sc1
    s_waitcnt vmcnt(11)
    v_max_u32 v121, v99, v103
    v_cmp_eq_u32 vcc, -1, v121
    v_mfma_f32_32x32x16_bf16 v[48:63], a[84:87], v[92:95], v[48:63]
    buffer_load_dwordx4 v[92:95], v122, s[52:55], s13 offen offset:2048 sc1
    s_cbranch_vccnz L_gs_54
L_gb_53:
    v_mfma_f32_32x32x16_bf16 v[0:15], a[88:91], v[96:99], v[0:15]
    v_mfma_f32_32x32x16_bf16 v[16:31], a[88:91], v[100:103], v[16:31]
    v_mfma_f32_32x32x16_bf16 v[32:47], a[92:95], v[96:99], v[32:47]
    s_add_u32 s13, s13, 4096
    buffer_load_dwordx4 v[96:99], v123, s[52:55], s13 offen offset:0 sc1
    s_waitcnt vmcnt(11)
    v_max_u32 v121, v107, v111
    v_cmp_eq_u32 vcc, -1, v121
    v_mfma_f32_32x32x16_bf16 v[48:63], a[92:95], v[100:103], v[48:63]
    buffer_load_dwordx4 v[100:103], v122, s[52:55], s13 offen offset:0 sc1
    s_cbranch_vccnz L_gs_56
L_gb_55:
    v_mfma_f32_32x32x16_bf16 v[0:15], a[96:99], v[104:107], v[0:15]
    v_mfma_f32_32x32x16_bf16 v[16:31], a[96:99], v[108:111], v[16:31]
    v_mfma_f32_32x32x16_bf16 v[32:47], a[100:103], v[104:107], v[32:47]
    buffer_load_dwordx4 v[104:107], v123, s[52:55], s13 offen offset:2048 sc1
    s_waitcnt vmcnt(11)
    v_max_u32 v121, v115, v119
    v_cmp_eq_u32 vcc, -1, v121
    v_mfma_f32_32x32x16_bf16 v[48:63], a[100:103], v[108:111], v[48:63]
    buffer_load_dwordx4 v[108:111], v122, s[52:55], s13 offen offset:2048 sc1
    s_cbranch_vccnz L_gs_58
L_gb_57:
    v_mfma_f32_32x32x16_bf16 v[0:15], a[104:107], v[112:115], v[0:15]
    v_mfma_f32_32x32x16_bf16 v[16:31], a[104:107], v[116:119], v[16:31]
    v_mfma_f32_32x32x16_bf16 v[32:47], a[108:111], v[112:115], v[32:47]
    s_add_u32 s13, s13, 4096
    s_cmp_eq_u32 s13, s28
    s_cmov_b32 s13, s27
    buffer_load_dwordx4 v[112:115], v123, s[52:55], s13 offen offset:0 sc1
    s_waitcnt vmcnt(11)
    v_max_u32 v121, v67, v71
    v_cmp_eq_u32 vcc, -1, v121
    v_mfma_f32_32x32x16_bf16 v[48:63], a[108:111], v[116:119], v[48:63]
    buffer_load_dwordx4 v[116:119], v122, s[52:55], s13 offen offset:0 sc1
    s_cbranch_vccnz L_gs_60
L_gb_59:
    v_mfma_f32_32x32x16_bf16 v[0:15], a[112:115], v[64:67], v[0:15]
    v_mfma_f32_32x32x16_bf16 v[16:31], a[112:115], v[68:71], v[16:31]
    v_mfma_f32_32x32x16_bf16 v[32:47], a[116:119], v[64:67], v[32:47]
    buffer_load_dwordx4 v[64:67], v123, s[52:55], s13 offen offset:2048 sc1
    s_waitcnt vmcnt(11)
    v_max_u32 v121, v75, v79
    v_cmp_eq_u32 vcc, -1, v121
    v_mfma_f32_32x32x16_bf16 v[48:63], a[116:119], v[68:71], v[48:63]
    buffer_load_dwordx4 v[68:71], v122, s[52:55], s13 offen offset:2048 sc1
    s_cbranch_vccnz L_gs_62
L_gb_61:
    v_mfma_f32_32x32x16_bf16 v[0:15], a[120:123], v[72:75], v[0:15]
    v_mfma_f32_32x32x16_bf16 v[16:31], a[120:123], v[76:79], v[16:31]
    v_mfma_f32_32x32x16_bf16 v[32:47], a[124:127], v[72:75], v[32:47]
    s_add_u32 s13, s13, 4096
    buffer_load_dwordx4 v[72:75], v123, s[52:55], s13 offen offset:0 sc1
    s_waitcnt vmcnt(11)
    v_max_u32 v121, v83, v87
    v_cmp_eq_u32 vcc, -1, v121
    v_mfma_f32_32x32x16_bf16 v[48:63], a[124:127], v[76:79], v[48:63]
    buffer_load_dwordx4 v[76:79], v122, s[52:55], s13 offen offset:0 sc1
    s_cbranch_vccnz L_gs_64
L_gb_63:
    v_mfma_f32_32x32x16_bf16 v[0:15], a[128:131], v[80:83], v[0:15]
    v_mfma_f32_32x32x16_bf16 v[16:31], a[128:131], v[84:87], v[16:31]
    v_mfma_f32_32x32x16_bf16 v[32:47], a[132:135], v[80:83], v[32:47]
    buffer_load_dwordx4 v[80:83], v123, s[52:55], s13 offen offset:2048 sc1
    s_waitcnt vmcnt(11)
    v_max_u32 v121, v91, v95
    v_cmp_eq_u32 vcc, -1, v121
    v_mfma_f32_32x32x16_bf16 v[48:63], a[132:135], v[84:87], v[48:63]
    buffer_load_dwordx4 v[84:87], v122, s[52:55], s13 offen offset:2048 sc1
    s_cbranch_vccnz L_gs_66
L_gb_65:
    v_mfma_f32_32x32x16_bf16 v[0:15], a[136:139], v[88:91], v[0:15]
    v_mfma_f32_32x32x16_bf16 v[16:31], a[136:139], v[92:95], v[16:31]
    v_mfma_f32_32x32x16_bf16 v[32:47], a[140:143], v[88:91], v[32:47]
    s_add_u32 s13, s13, 4096
    s_cmp_eq_u32 s13, s28
    s_cmov_b32 s13, s27
    buffer_load_dwordx4 v[88:91], v123, s[52:55], s13 offen offset:0 sc1
    s_waitcnt vmcnt(11)
    v_max_u32 v121, v99, v103
    v_cmp_eq_u32 vcc, -1, v121
    v_mfma_f32_32x32x16_bf16 v[48:63], a[140:143], v[92:95], v[48:63]
    buffer_load_dwordx4 v[92:95], v122, s[52:55], s13 offen offset:0 sc1
    s_cbranch_vccnz L_gs_68
L_gb_67:
    v_mfma_f32_32x32x16_bf16 v[0:15], a[144:147], v[96:99], v[0:15]
    v_mfma_f32_32x32x16_bf16 v[16:31], a[144:147], v[100:103], v[16:31]
    v_mfma_f32_32x32x16_bf16 v[32:47], a[148:151], v[96:99], v[32:47]
    buffer_load_dwordx4 v[96:99], v123, s[52:55], s13 offen offset:2048 sc1
    s_waitcnt vmcnt(11)
    v_max_u32 v121, v107, v111
    v_cmp_eq_u32 vcc, -1, v121
    v_mfma_f32_32x32x16_bf16 v[48:63], a[148:151], v[100:103], v[48:63]
    buffer_load_dwordx4 v[100:103], v122, s[52:55], s13 offen offset:2048 sc1
    s_cbranch_vccnz L_gs_70
L_gb_69:
    v_mfma_f32_32x32x16_bf16 v[0:15], a[152:155], v[104:107], v[0:15]
    v_mfma_f32_32x32x16_bf16 v[16:31], a[152:155], v[108:111], v[16:31]
    v_mfma_f32_32x32x16_bf16 v[32:47], a[156:159], v[104:107], v[32:47]
    s_add_u32 s13, s13, 4096
    buffer_load_dwordx4 v[104:107], v123, s[52:55], s13 offen offset:0 sc1
    s_waitcnt vmcnt(11)
    v_max_u32 v121, v115, v119
    v_cmp_eq_u32 vcc, -1, v121
    v_mfma_f32_32x32x16_bf16 v[48:63], a[156:159], v[108:111], v[48:63]
    buffer_load_dwordx4 v[108:111], v122, s[52:55], s13 offen offset:0 sc1
    s_cbranch_vccnz L_gs_72
L_gb_71:
    s_waitcnt lgkmcnt(2)
    v_mfma_f32_32x32x16_bf16 v[0:15], a[160:163], v[112:115], v[0:15]
    v_mfma_f32_32x32x16_bf16 v[16:31], a[160:163], v[116:119], v[16:31]
    v_mfma_f32_32x32x16_bf16 v[32:47], a[164:167], v[112:115], v[32:47]
    buffer_load_dwordx4 v[112:115], v123, s[52:55], s13 offen offset:2048 sc1
    s_waitcnt vmcnt(11)
    v_max_u32 v121, v67, v71
    v_cmp_eq_u32 vcc, -1, v121
    v_mfma_f32_32x32x16_bf16 v[48:63], a[164:167], v[116:119], v[48:63]
    buffer_load_dwordx4 v[116:119], v122, s[52:55], s13 offen offset:2048 sc1
    s_cbranch_vccnz L_gs_74
L_gb_73:
    v_mfma_f32_32x32x16_bf16 v[0:15], a[168:171], v[64:67], v[0:15]
    v_mfma_f32_32x32x16_bf16 v[16:31], a[168:171], v[68:71], v[16:31]
    v_mfma_f32_32x32x16_bf16 v[32:47], a[172:175], v[64:67], v[32:47]
    s_add_u32 s13, s13, 4096
    s_cmp_eq_u32 s13, s28
    s_cmov_b32 s13, s27
    buffer_load_dwordx4 v[64:67], v123, s[52:55], s13 offen offset:0 sc1
    s_waitcnt vmcnt(11)
    v_max_u32 v121, v75, v79
    v_cmp_eq_u32 vcc, -1, v121
    v_mfma_f32_32x32x16_bf16 v[48:63], a[172:175], v[68:71], v[48:63]
    buffer_load_dwordx4 v[68:71], v122, s[52:55], s13 offen offset:0 sc1
    s_cbranch_vccnz L_gs_76
L_gb_75:
    v_mfma_f32_32x32x16_bf16 v[0:15], a[176:179], v[72:75], v[0:15]
    v_mfma_f32_32x32x16_bf16 v[16:31], a[176:179], v[76:79], v[16:31]
    v_mfma_f32_32x32x16_bf16 v[32:47], a[180:183], v[72:75], v[32:47]
    buffer_load_dwordx4 v[72:75], v123, s[52:55], s13 offen offset:2048 sc1
    s_waitcnt vmcnt(11)
    v_max_u32 v121, v83, v87
    v_cmp_eq_u32 vcc, -1, v121
    v_mfma_f32_32x32x16_bf16 v[48:63], a[180:183], v[76:79], v[48:63]
    buffer_load_dwordx4 v[76:79], v122, s[52:55], s13 offen offset:2048 sc1
    s_cbranch_vccnz L_gs_78
L_gb_77:
    v_mfma_f32_32x32x16_bf16 v[0:15], a[184:187], v[80:83], v[0:15]
    v_mfma_f32_32x32x16_bf16 v[16:31], a[184:187], v[84:87], v[16:31]
    v_mfma_f32_32x32x16_bf16 v[32:47], a[188:191], v[80:83], v[32:47]
    s_add_u32 s13, s13, 4096
    buffer_load_dwordx4 v[80:83], v123, s[52:55], s13 offen offset:0 sc1
    s_waitcnt vmcnt(11)
    v_max_u32 v121, v91, v95
    v_cmp_eq_u32 vcc, -1, v121
    v_mfma_f32_32x32x16_bf16 v[48:63], a[188:191], v[84:87], v[48:63]
    buffer_load_dwordx4 v[84:87], v122, s[52:55], s13 offen offset:0 sc1
    s_cbranch_vccnz L_gs_80
L_gb_79:
    v_mfma_f32_32x32x16_bf16 v[0:15], a[192:195], v[88:91], v[0:15]
    v_mfma_f32_32x32x16_bf16 v[16:31], a[192:195], v[92:95], v[16:31]
    v_mfma_f32_32x32x16_bf16 v[32:47], a[196:199], v[88:91], v[32:47]
    buffer_load_dwordx4 v[88:91], v123, s[52:55], s13 offen offset:2048 sc1
    s_waitcnt vmcnt(11)
    v_max_u32 v121, v99, v103
    v_cmp_eq_u32 vcc, -1, v121
    v_mfma_f32_32x32x16_bf16 v[48:63], a[196:199], v[92:95], v[48:63]
    buffer_load_dwordx4 v[92:95], v122, s[52:55], s13 offen offset:2048 sc1
    s_cbranch_vccnz L_gs_82
L_gb_81:
    v_mfma_f32_32x32x16_bf16 v[0:15], a[200:203], v[96:99], v[0:15]
    v_mfma_f32_32x32x16_bf16 v[16:31], a[200:203], v[100:103], v[16:31]
    v_mfma_f32_32x32x16_bf16 v[32:47], a[204:207], v[96:99], v[32:47]
    s_waitcnt vmcnt(10)
    v_max_u32 v121, v107, v111
    v_cmp_eq_u32_e64 vcc, -1, v121
    v_mfma_f32_32x32x16_bf16 v[48:63], a[204:207], v[100:103], v[48:63]
    s_cbranch_vccnz L_gs_84
L_gb_83:
    v_mfma_f32_32x32x16_bf16 v[0:15], a[208:211], v[104:107], v[0:15]
    v_mfma_f32_32x32x16_bf16 v[16:31], a[208:211], v[108:111], v[16:31]
    v_mfma_f32_32x32x16_bf16 v[32:47], a[212:215], v[104:107], v[32:47]
    s_waitcnt vmcnt(8)
    v_max_u32 v121, v115, v119
    v_cmp_eq_u32 vcc, -1, v121
    v_mfma_f32_32x32x16_bf16 v[48:63], a[212:215], v[108:111], v[48:63]
    s_cbranch_vccnz L_gs_86
L_gb_85:
    v_mfma_f32_32x32x16_bf16 v[0:15], a[216:219], v[112:115], v[0:15]
    v_mfma_f32_32x32x16_bf16 v[16:31], a[216:219], v[116:119], v[16:31]
    v_mfma_f32_32x32x16_bf16 v[32:47], a[220:223], v[112:115], v[32:47]
    s_waitcnt vmcnt(6)
    v_max_u32 v121, v67, v71
    v_cmp_eq_u32 vcc, -1, v121
    v_mfma_f32_32x32x16_bf16 v[48:63], a[220:223], v[116:119], v[48:63]
    s_cbranch_vccnz L_gs_88
L_gb_87:
    v_mfma_f32_32x32x16_bf16 v[0:15], a[224:227], v[64:67], v[0:15]
    ds_read_b128 v[96:99], v126 offset:61440
    ds_read_b128 v[100:103], v126 offset:62464
    v_mfma_f32_32x32x16_bf16 v[16:31], a[224:227], v[68:71], v[16:31]
    v_mfma_f32_32x32x16_bf16 v[32:47], a[228:231], v[64:67], v[32:47]
    s_waitcnt vmcnt(4)
    v_max_u32 v121, v75, v79
    v_cmp_eq_u32 vcc, -1, v121
    v_mfma_f32_32x32x16_bf16 v[48:63], a[228:231], v[68:71], v[48:63]
    s_cbranch_vccnz L_gs_90
L_gb_89:
    v_mfma_f32_32x32x16_bf16 v[0:15], a[232:235], v[72:75], v[0:15]
    v_mfma_f32_32x32x16_bf16 v[16:31], a[232:235], v[76:79], v[16:31]
    v_mfma_f32_32x32x16_bf16 v[32:47], a[236:239], v[72:75], v[32:47]
    s_waitcnt vmcnt(2)
    v_max_u32 v121, v83, v87
    v_cmp_eq_u32 vcc, -1, v121
    v_mfma_f32_32x32x16_bf16 v[48:63], a[236:239], v[76:79], v[48:63]
    s_cbranch_vccnz L_gs_92
L_gb_91:
    v_mfma_f32_32x32x16_bf16 v[0:15], a[240:243], v[80:83], v[0:15]
    v_add_u32 v64, s23, v126
    v_add_u32 v65, s24, v126
    v_add_u32 v66, s25, v126
    v_add_u32 v67, s26, v126
    v_mfma_f32_32x32x16_bf16 v[16:31], a[240:243], v[84:87], v[16:31]
    v_mfma_f32_32x32x16_bf16 v[32:47], a[244:247], v[80:83], v[32:47]
    s_waitcnt vmcnt(0)
    v_max_u32 v121, v91, v95
    v_cmp_eq_u32 vcc, -1, v121
    v_mfma_f32_32x32x16_bf16 v[48:63], a[244:247], v[84:87], v[48:63]
    s_cbranch_vccnz L_gs_94
L_gb_93:
    v_mfma_f32_32x32x16_bf16 v[16:31], a[248:251], v[92:95], v[16:31]
    v_mfma_f32_32x32x16_bf16 v[32:47], a[252:255], v[88:91], v[32:47]
    v_mfma_f32_32x32x16_bf16 v[48:63], a[252:255], v[92:95], v[48:63]
    v_mfma_f32_32x32x16_bf16 v[0:15], a[248:251], v[88:91], v[0:15]
    v_mov_b32 v80, 0xc0135761
    s_mul_i32 s81, s8, 28
    s_add_u32 s81, s81, s9
    s_lshl_b32 s81, s81, 6
    s_lshl_b32 s82, s4, 15
    s_add_u32 s81, s81, s82
    s_add_u32 s81, s81, 2752512
    v_lshlrev_b32 v76, 12, v127
    v_and_b32 v76, 0x4000, v76
    v_cvt_pk_bf16_f32 v104, v16, v17
    v_cvt_pk_bf16_f32 v105, v18, v19
    v_cvt_pk_bf16_f32 v106, v20, v21
    v_cvt_pk_bf16_f32 v107, v22, v23
    ds_write_b128 v65, v[104:107] offset:33280
    v_and_b32 v72, 3, v127
    v_lshl_add_u32 v76, v72, 4, v76
    v_add_u32 v76, s81, v76
    v_cvt_pk_bf16_f32 v108, v24, v25
    v_cvt_pk_bf16_f32 v109, v26, v27
    v_cvt_pk_bf16_f32 v110, v28, v29
    v_cvt_pk_bf16_f32 v111, v30, v31
    ds_write_b128 v65, v[108:111] offset:34304
    v_mov_b32 v72, s14
    v_mov_b32 v73, s15
    v_mov_b32_e64 v74, s14
    v_cvt_pk_bf16_f32 v112, v32, v33
    v_cvt_pk_bf16_f32 v113, v34, v35
    v_cvt_pk_bf16_f32 v114, v36, v37
    v_cvt_pk_bf16_f32 v115, v38, v39
    ds_write_b128 v66, v[112:115] offset:35328
    v_mov_b32_e64 v75, s15
    v_cvt_pk_bf16_f32 v116, v40, v41
    v_cvt_pk_bf16_f32 v117, v42, v43
    v_cvt_pk_bf16_f32 v118, v44, v45
    v_cvt_pk_bf16_f32 v119, v46, v47
    ds_write_b128 v66, v[116:119] offset:36352
    v_cvt_pk_bf16_f32 v104, v48, v49
    v_cvt_pk_bf16_f32 v105, v50, v51
    v_cvt_pk_bf16_f32 v106, v52, v53
    v_cvt_pk_bf16_f32 v107, v54, v55
    ds_write_b128 v67, v[104:107] offset:37376
    v_cvt_pk_bf16_f32 v108, v56, v57
    v_cvt_pk_bf16_f32 v109, v58, v59
    v_cvt_pk_bf16_f32 v110, v60, v61
    v_cvt_pk_bf16_f32 v111, v62, v63
    ds_write_b128 v67, v[108:111] offset:38400
    s_waitcnt lgkmcnt(0)
    s_barrier
    ds_read_b128 v[16:19], v64 offset:33280
    ds_read_b128 v[24:27], v64 offset:35328
    ds_read_b128 v[32:35], v64 offset:37376
    ds_read_b128 v[20:23], v64 offset:34304
    ds_read_b128 v[28:31], v64 offset:36352
    ds_read_b128 v[36:39], v64 offset:38400
    s_mov_b64 exec, 0xff
    buffer_store_dwordx4 v[72:75], v76, s[52:55], 0 offen sc1
    s_mov_b64 exec, -1
    s_waitcnt lgkmcnt(5)
    s_nop 2
    v_mfma_f32_32x32x16_bf16 v[0:15], v[96:99], v[16:19], v[0:15]
    s_waitcnt lgkmcnt(4)
    v_mfma_f32_32x32x16_bf16 v[0:15], v[96:99], v[24:27], v[0:15]
    s_waitcnt lgkmcnt(3)
    v_mfma_f32_32x32x16_bf16 v[0:15], v[96:99], v[32:35], v[0:15]
    s_waitcnt lgkmcnt(2)
    v_mfma_f32_32x32x16_bf16 v[48:63], v[100:103], v[20:23], 0
    s_waitcnt lgkmcnt(1)
    v_mfma_f32_32x32x16_bf16 v[48:63], v[100:103], v[28:31], v[48:63]
    s_nop 7
    v_pk_mul_f32 v[16:17], v[0:1], v[0:1]
    v_pk_mul_f32 v[18:19], v[2:3], v[2:3]
    v_pk_mul_f32 v[20:21], v[4:5], v[4:5]
    s_waitcnt lgkmcnt(0)
    v_mfma_f32_32x32x16_bf16 v[48:63], v[100:103], v[36:39], v[48:63]
    v_pk_mul_f32 v[22:23], v[6:7], v[6:7]
    v_pk_fma_f32 v[16:17], v[16:17], s[34:35], v[80:81] op_sel_hi:[1,0,0]
    v_pk_fma_f32 v[18:19], v[18:19], s[34:35], v[80:81] op_sel_hi:[1,0,0]
    v_pk_fma_f32 v[20:21], v[20:21], s[34:35], v[80:81] op_sel_hi:[1,0,0]
    v_pk_fma_f32 v[22:23], v[22:23], s[34:35], v[80:81] op_sel_hi:[1,0,0]
    v_pk_mul_f32 v[16:17], v[16:17], v[0:1]
    v_pk_mul_f32 v[18:19], v[18:19], v[2:3]
    v_pk_mul_f32 v[20:21], v[20:21], v[4:5]
    v_pk_mul_f32 v[22:23], v[22:23], v[6:7]
    v_exp_f32 v16, v16
    v_exp_f32 v17, v17
    v_exp_f32 v18, v18
    v_exp_f32 v19, v19
    v_exp_f32 v20, v20
    v_exp_f32 v21, v21
    v_exp_f32 v22, v22
    v_exp_f32_e64 v23, v23
    v_pk_add_f32 v[16:17], v[16:17], 1.0 op_sel_hi:[1,0]
    v_pk_add_f32 v[18:19], v[18:19], 1.0 op_sel_hi:[1,0]
    v_pk_add_f32 v[20:21], v[20:21], 1.0 op_sel_hi:[1,0]
    v_pk_add_f32 v[22:23], v[22:23], 1.0 op_sel_hi:[1,0]
    v_rcp_f32 v16, v16
    v_rcp_f32 v17, v17
    v_rcp_f32 v18, v18
    v_rcp_f32 v19, v19
    v_rcp_f32 v20, v20
    v_rcp_f32 v21, v21
    v_rcp_f32 v22, v22
    v_rcp_f32 v23, v23
    v_pk_mul_f32 v[0:1], v[0:1], v[16:17]
    v_pk_mul_f32 v[2:3], v[2:3], v[18:19]
    v_pk_mul_f32 v[4:5], v[4:5], v[20:21]
    v_pk_mul_f32 v[6:7], v[6:7], v[22:23]
    v_cvt_pk_bf16_f32 v84, v0, v1
    v_cvt_pk_bf16_f32 v85, v2, v3
    v_cvt_pk_bf16_f32 v86, v4, v5
    v_cvt_pk_bf16_f32 v87, v6, v7
    buffer_store_dwordx4 v[84:87], v123, s[52:55], s21 offen offset:0 sc1
    v_pk_add_f32 v[8:9], v[8:9], v[56:57]
    v_pk_add_f32 v[10:11], v[10:11], v[58:59]
    v_pk_add_f32 v[12:13], v[12:13], v[60:61]
    v_pk_add_f32 v[14:15], v[14:15], v[62:63]
    v_pk_mul_f32 v[24:25], v[8:9], v[8:9]
    v_pk_mul_f32 v[26:27], v[10:11], v[10:11]
    v_pk_mul_f32 v[28:29], v[12:13], v[12:13]
    v_pk_mul_f32 v[30:31], v[14:15], v[14:15]
    v_pk_fma_f32 v[24:25], v[24:25], s[34:35], v[80:81] op_sel_hi:[1,0,0]
    v_pk_fma_f32 v[26:27], v[26:27], s[34:35], v[80:81] op_sel_hi:[1,0,0]
    v_pk_fma_f32 v[28:29], v[28:29], s[34:35], v[80:81] op_sel_hi:[1,0,0]
    v_pk_fma_f32 v[30:31], v[30:31], s[34:35], v[80:81] op_sel_hi:[1,0,0]
    v_pk_mul_f32 v[24:25], v[24:25], v[8:9]
    v_pk_mul_f32 v[26:27], v[26:27], v[10:11]
    v_pk_mul_f32 v[28:29], v[28:29], v[12:13]
    v_pk_mul_f32 v[30:31], v[30:31], v[14:15]
    v_exp_f32 v24, v24
    v_exp_f32 v25, v25
    v_exp_f32 v26, v26
    v_exp_f32 v27, v27
    v_exp_f32 v28, v28
    v_exp_f32 v29, v29
    v_exp_f32 v30, v30
    v_exp_f32 v31, v31
    v_pk_add_f32 v[24:25], v[24:25], 1.0 op_sel_hi:[1,0]
    v_pk_add_f32 v[26:27], v[26:27], 1.0 op_sel_hi:[1,0]
    v_pk_add_f32 v[28:29], v[28:29], 1.0 op_sel_hi:[1,0]
    v_pk_add_f32 v[30:31], v[30:31], 1.0 op_sel_hi:[1,0]
    v_rcp_f32 v24, v24
    v_rcp_f32 v25, v25
    v_rcp_f32 v26, v26
    v_rcp_f32 v27, v27
    v_rcp_f32 v28, v28
    v_rcp_f32 v29, v29
    v_rcp_f32 v30, v30
    v_rcp_f32 v31, v31
    v_pk_mul_f32 v[8:9], v[8:9], v[24:25]
    v_pk_mul_f32 v[10:11], v[10:11], v[26:27]
    v_pk_mul_f32 v[12:13], v[12:13], v[28:29]
    v_pk_mul_f32 v[14:15], v[14:15], v[30:31]
    v_cvt_pk_bf16_f32 v88, v8, v9
    v_cvt_pk_bf16_f32 v89, v10, v11
    v_cvt_pk_bf16_f32 v90, v12, v13
    v_cvt_pk_bf16_f32 v91, v14, v15
    buffer_store_dwordx4 v[88:91], v123, s[52:55], s21 offen offset:2048 sc1
    s_barrier
    s_or_b32 s81, s2, s4
    s_cmp_lg_u32 s81, 32
    s_cbranch_scc1 L_nr_95
    v_mov_b32 v110, s14
    v_mov_b32 v111, s15
    s_mov_b64 exec, 1
    buffer_store_dwordx2 v[110:111], off, s[52:55], 0 offset:0 sc1
    s_mov_b64 exec, -1
L_nr_95:
    s_branch L_g1j_28
L_ng1_27:
L_g1j_28:
    s_cmp_eq_u32 s88, 0
    s_cbranch_scc1 L_skip_96
    s_and_b32 s81, s4, 1
    s_lshl_b32 s81, s81, 10
    v_add_u32 v123, s81, v126
    v_xor_b32 v122, 0x400, v123
    s_lshr_b32 s81, s4, 1
    s_lshl_b32 s81, s81, 5
    s_lshl_b32 s82, s11, 6
    s_add_u32 s50, s81, s82
    s_and_b32 s82, s4, 1
    s_lshl_b32 s82, s82, 5
    s_lshl_b32 s83, s10, 6
    s_add_u32 s51, s82, s83
    s_lshr_b32 s83, s50, 5
    s_mul_i32 s83, s83, 28800
    s_lshl_b32 s82, s51, 6
    s_add_u32 s20, s83, s82
    s_add_u32 s30, s20, 4194304
    v_and_b32 v16, 31, v127
    v_lshrrev_b32 v17, 5, v127
    s_lshl_b32 s81, s50, 1
    v_lshlrev_b32_e64 v18, 6, v16
    v_lshl_add_u32 v18, v17, 3, v18
    v_lshl_add_u32 v19, v17, 3, s81
    global_load_dwordx2 v[28:29], v19, s[42:43] offset:0
    global_load_dwordx2 v[30:31], v19, s[42:43] offset:16
    global_load_dwordx2 v[32:33], v19, s[42:43] offset:32
    global_load_dwordx2 v[34:35], v19, s[42:43] offset:48
    s_mul_i32 s81, s10, 28
    s_mul_i32 s82, s4, 7
    s_add_u32 s81, s81, s82
    v_min_u32 v44, 6, v127
    v_add_u32 v44, s81, v44
    v_mov_b32 v45, v44
    s_lshl_b32 s13, s81, 13
    s_add_u32 s13, s13, 8388608
    s_add_u32 s21, s20, 16777216
    s_lshl_b32 s19, s50, 1
    s_add_u32 s19, s19, 32768
    s_xor_b32 s24, s4, 1
    s_mul_i32 s24, s24, 6144
    s_xor_b32 s25, s4, 2
    s_mul_i32 s25, s25, 6144
    s_xor_b32 s26, s4, 3
    s_mul_i32 s26, s26, 6144
    s_mul_i32 s23, s4, 6144
    s_mov_b32 s27, s13
    s_add_u32 s28, s13, 57344
    s_lshl_b32 s81, s35, 13
    s_add_u32 s13, s13, s81
    s_mov_b32 s22, s13
    s_mul_i32 s81, s4, 7
    v_min_u32 v52, 6, v127
    v_add_u32_e64 v52, s81, v52
    s_lshl_b32 s84, s5, 14
    s_add_u32 s84, s84, 3538944
    v_lshl_add_u32 v52, v52, 6, s84
    buffer_load_dwordx2 v[50:51], v52, s[52:55], 0 offen sc1
    s_cmp_eq_u32 s87, 0
    s_cbranch_scc1 L_res_97
    buffer_load_dwordx2 v[20:21], v18, s[52:55], s30 offen offset:0 sc1
    buffer_load_dwordx2 v[22:23], v18, s[52:55], s30 offen offset:16 sc1
    buffer_load_dwordx2 v[24:25], v18, s[52:55], s30 offen offset:32 sc1
    buffer_load_dwordx2 v[26:27], v18, s[52:55], s30 offen offset:48 sc1
    s_waitcnt vmcnt(3)
    v_lshlrev_b32 v0, 16, v20
    v_and_b32 v1, s0, v20
    v_lshlrev_b32 v2, 16, v21
    v_and_b32 v3, s0, v21
    s_waitcnt vmcnt(2)
    v_lshlrev_b32 v4, 16, v22
    v_and_b32 v5, s0, v22
    v_lshlrev_b32 v6, 16, v23
    v_and_b32 v7, s0, v23
    s_waitcnt vmcnt(1)
    v_lshlrev_b32 v8, 16, v24
    v_and_b32 v9, s0, v24
    v_lshlrev_b32 v10, 16, v25
    v_and_b32 v11, s0, v25
    s_waitcnt vmcnt(0)
    v_lshlrev_b32 v12, 16, v26
    v_and_b32 v13, s0, v26
    v_lshlrev_b32 v14, 16, v27
    v_and_b32 v15, s0, v27
    v_lshlrev_b32 v40, 16, v28
    v_and_b32 v41, s0, v28
    v_pk_add_f32 v[0:1], v[0:1], v[40:41]
    v_lshlrev_b32 v40, 16, v29
    v_and_b32 v41, s0, v29
    v_pk_add_f32 v[2:3], v[2:3], v[40:41]
    v_lshlrev_b32 v40, 16, v30
    v_and_b32 v41, s0, v30
    v_pk_add_f32 v[4:5], v[4:5], v[40:41]
    v_lshlrev_b32 v40, 16, v31
    v_and_b32 v41, s0, v31
    v_pk_add_f32 v[6:7], v[6:7], v[40:41]
    v_lshlrev_b32 v40, 16, v32
    v_and_b32 v41, s0, v32
    v_pk_add_f32 v[8:9], v[8:9], v[40:41]
    v_lshlrev_b32 v40, 16, v33
    v_and_b32 v41, s0, v33
    v_pk_add_f32 v[10:11], v[10:11], v[40:41]
    v_lshlrev_b32 v40, 16, v34
    v_and_b32 v41, s0, v34
    v_pk_add_f32 v[12:13], v[12:13], v[40:41]
    v_lshlrev_b32 v40, 16, v35
    v_and_b32_e64 v41, s0, v35
    v_pk_add_f32 v[14:15], v[14:15], v[40:41]
    s_lshl_b32 s84, s5, 14
    s_add_u32 s84, s84, 2752512
    v_lshl_add_u32 v45, v45, 6, s84
    buffer_load_dwordx2 v[42:43], v45, s[52:55], 0 offen sc1
    s_waitcnt vmcnt(0)
    v_cmp_ne_u64 vcc, s[14:15], v[42:43]
    s_nop 0
    s_cbranch_vccz L_pok_99
    s_mov_b32 s85, 0
L_plp_100:
    buffer_load_dwordx2 v[42:43], v45, s[52:55], 0 offen sc1
    s_waitcnt vmcnt(0)
    v_cmp_ne_u64 vcc, s[14:15], v[42:43]
    s_add_u32 s85, s85, 1
    s_cbranch_vccz L_pok_99
    s_cmp_lt_u32 s85, 0x100000
    s_cbranch_scc1 L_plp_100
L_pok_99:
    s_branch L_resj_98
L_res_97:
    s_lshl_b32 s84, s5, 14
    s_add_u32 s84, s84, 2752512
    v_lshl_add_u32 v45, v45, 6, s84
    buffer_load_dwordx2 v[42:43], v45, s[52:55], 0 offen sc1
    s_waitcnt vmcnt(0)
    v_cmp_ne_u64 vcc, s[14:15], v[42:43]
    s_nop 0
    s_cbranch_vccz L_pok_101
    s_mov_b32 s85, 0
L_plp_102:
    buffer_load_dwordx2 v[42:43], v45, s[52:55], 0 offen sc1
    s_waitcnt vmcnt(0)
    v_cmp_ne_u64 vcc, s[14:15], v[42:43]
    s_add_u32 s85, s85, 1
    s_cbranch_vccz L_pok_101
    s_cmp_lt_u32 s85, 0x100000
    s_cbranch_scc1 L_plp_102
L_pok_101:
    buffer_load_dwordx2 v[20:21], v18, s[52:55], s30 offen offset:0 sc1
    buffer_load_dwordx2 v[22:23], v18, s[52:55], s30 offen offset:16 sc1
    buffer_load_dwordx2 v[24:25], v18, s[52:55], s30 offen offset:32 sc1
    buffer_load_dwordx2 v[26:27], v18, s[52:55], s30 offen offset:48 sc1
    s_waitcnt vmcnt(3)
    v_lshlrev_b32 v0, 16, v20
    v_and_b32 v1, s0, v20
    v_lshlrev_b32 v2, 16, v21
    v_and_b32 v3, s0, v21
    s_waitcnt vmcnt(2)
    v_lshlrev_b32 v4, 16, v22
    v_and_b32 v5, s0, v22
    v_lshlrev_b32 v6, 16, v23
    v_and_b32 v7, s0, v23
    s_waitcnt vmcnt(1)
    v_lshlrev_b32 v8, 16, v24
    v_and_b32 v9, s0, v24
    v_lshlrev_b32 v10, 16, v25
    v_and_b32 v11, s0, v25
    s_waitcnt vmcnt(0)
    v_lshlrev_b32 v12, 16, v26
    v_and_b32 v13, s0, v26
    v_lshlrev_b32 v14, 16, v27
    v_and_b32 v15, s0, v27
    v_lshlrev_b32 v40, 16, v28
    v_and_b32 v41, s0, v28
    v_pk_add_f32 v[0:1], v[0:1], v[40:41]
    v_lshlrev_b32 v40, 16, v29
    v_and_b32 v41, s0, v29
    v_pk_add_f32 v[2:3], v[2:3], v[40:41]
    v_lshlrev_b32 v40, 16, v30
    v_and_b32 v41, s0, v30
    v_pk_add_f32 v[4:5], v[4:5], v[40:41]
    v_lshlrev_b32 v40, 16, v31
    v_and_b32 v41, s0, v31
    v_pk_add_f32 v[6:7], v[6:7], v[40:41]
    v_lshlrev_b32 v40, 16, v32
    v_and_b32 v41, s0, v32
    v_pk_add_f32 v[8:9], v[8:9], v[40:41]
    v_lshlrev_b32 v40, 16, v33
    v_and_b32 v41, s0, v33
    v_pk_add_f32 v[10:11], v[10:11], v[40:41]
    v_lshlrev_b32 v40, 16, v34
    v_and_b32 v41, s0, v34
    v_pk_add_f32 v[12:13], v[12:13], v[40:41]
    v_lshlrev_b32 v40, 16, v35
    v_and_b32 v41, s0, v35
    v_pk_add_f32 v[14:15], v[14:15], v[40:41]
L_resj_98:
    v_cmp_ne_u64 vcc, s[14:15], v[50:51]
    s_nop 0
    s_cbranch_vccz L_pok_103
    s_mov_b32 s85, 0
L_plp_104:
    buffer_load_dwordx2 v[50:51], v52, s[52:55], 0 offen sc1
    s_waitcnt vmcnt(0)
    v_cmp_ne_u64 vcc, s[14:15], v[50:51]
    s_add_u32 s85, s85, 1
    s_cbranch_vccz L_pok_103
    s_cmp_lt_u32 s85, 0x100000
    s_cbranch_scc1 L_plp_104
L_pok_103:
    s_mov_b32 s85, 0
    buffer_load_dwordx4 v[64:67], v123, s[52:55], s13 offen offset:0 sc1
    buffer_load_dwordx4 v[68:71], v122, s[52:55], s13 offen offset:0 sc1
    buffer_load_dwordx4 v[72:75], v123, s[52:55], s13 offen offset:2048 sc1
    buffer_load_dwordx4 v[76:79], v122, s[52:55], s13 offen offset:2048 sc1
    s_add_u32 s13, s13, 4096
    buffer_load_dwordx4 v[80:83], v123, s[52:55], s13 offen offset:0 sc1
    buffer_load_dwordx4 v[84:87], v122, s[52:55], s13 offen offset:0 sc1
    buffer_load_dwordx4 v[88:91], v123, s[52:55], s13 offen offset:2048 sc1
    buffer_load_dwordx4 v[92:95], v122, s[52:55], s13 offen offset:2048 sc1
    s_add_u32 s13, s13, 4096
    s_cmp_eq_u32 s13, s28
    s_cmov_b32 s13, s27
    buffer_load_dwordx4 v[96:99], v123, s[52:55], s13 offen offset:0 sc1
    buffer_load_dwordx4 v[100:103], v122, s[52:55], s13 offen offset:0 sc1
    s_waitcnt vmcnt(8)
    v_max_u32 v121, v67, v71
    v_cmp_eq_u32_e64 vcc, -1, v121
    s_nop 0
    s_cbranch_vccnz L_gs_106
L_gb_105:
    v_mfma_f32_32x32x16_bf16 v[0:15], v[128:131], v[64:67], v[0:15]
    v_mfma_f32_32x32x16_bf16 v[16:31], v[128:131], v[68:71], 0
    v_mfma_f32_32x32x16_bf16 v[32:47], v[132:135], v[64:67], 0
    buffer_load_dwordx4 v[64:67], v123, s[52:55], s13 offen offset:2048 sc1
    s_waitcnt vmcnt(7)
    v_max_u32 v121, v75, v79
    v_cmp_eq_u32 vcc, -1, v121
    v_mfma_f32_32x32x16_bf16 v[48:63], v[132:135], v[68:71], 0
    buffer_load_dwordx4 v[68:71], v122, s[52:55], s13 offen offset:2048 sc1
    s_cbranch_vccnz L_gs_108
L_gb_107:
    v_mfma_f32_32x32x16_bf16 v[0:15], v[136:139], v[72:75], v[0:15]
    v_mfma_f32_32x32x16_bf16 v[16:31], v[136:139], v[76:79], v[16:31]
    v_mfma_f32_32x32x16_bf16 v[32:47], v[140:143], v[72:75], v[32:47]
    s_add_u32 s13, s13, 4096
    buffer_load_dwordx4 v[72:75], v123, s[52:55], s13 offen offset:0 sc1
    s_waitcnt vmcnt(7)
    v_max_u32 v121, v83, v87
    v_cmp_eq_u32 vcc, -1, v121
    v_mfma_f32_32x32x16_bf16 v[48:63], v[140:143], v[76:79], v[48:63]
    buffer_load_dwordx4 v[76:79], v122, s[52:55], s13 offen offset:0 sc1
    s_cbranch_vccnz L_gs_110
L_gb_109:
    v_mfma_f32_32x32x16_bf16 v[0:15], v[144:147], v[80:83], v[0:15]
    v_mfma_f32_32x32x16_bf16 v[16:31], v[144:147], v[84:87], v[16:31]
    v_mfma_f32_32x32x16_bf16 v[32:47], v[148:151], v[80:83], v[32:47]
    buffer_load_dwordx4 v[80:83], v123, s[52:55], s13 offen offset:2048 sc1
    s_waitcnt vmcnt(7)
    v_max_u32 v121, v91, v95
    v_cmp_eq_u32 vcc, -1, v121
    v_mfma_f32_32x32x16_bf16 v[48:63], v[148:151], v[84:87], v[48:63]
    buffer_load_dwordx4 v[84:87], v122, s[52:55], s13 offen offset:2048 sc1
    s_cbranch_vccnz L_gs_112
L_gb_111:
    v_mfma_f32_32x32x16_bf16 v[0:15], v[152:155], v[88:91], v[0:15]
    v_mfma_f32_32x32x16_bf16 v[16:31], v[152:155], v[92:95], v[16:31]
    v_mfma_f32_32x32x16_bf16 v[32:47], v[156:159], v[88:91], v[32:47]
    s_add_u32 s13, s13, 4096
    s_cmp_eq_u32 s13, s28
    s_cmov_b32 s13, s27
    buffer_load_dwordx4 v[88:91], v123, s[52:55], s13 offen offset:0 sc1
    s_waitcnt vmcnt(7)
    v_max_u32 v121, v99, v103
    v_cmp_eq_u32 vcc, -1, v121
    v_mfma_f32_32x32x16_bf16 v[48:63], v[156:159], v[92:95], v[48:63]
    buffer_load_dwordx4 v[92:95], v122, s[52:55], s13 offen offset:0 sc1
    s_cbranch_vccnz L_gs_114
L_gb_113:
    v_mfma_f32_32x32x16_bf16 v[0:15], v[160:163], v[96:99], v[0:15]
    v_mfma_f32_32x32x16_bf16 v[16:31], v[160:163], v[100:103], v[16:31]
    v_mfma_f32_32x32x16_bf16 v[32:47], v[164:167], v[96:99], v[32:47]
    buffer_load_dwordx4 v[96:99], v123, s[52:55], s13 offen offset:2048 sc1
    s_waitcnt vmcnt(7)
    v_max_u32 v121, v67, v71
    v_cmp_eq_u32 vcc, -1, v121
    v_mfma_f32_32x32x16_bf16 v[48:63], v[164:167], v[100:103], v[48:63]
    buffer_load_dwordx4 v[100:103], v122, s[52:55], s13 offen offset:2048 sc1
    s_cbranch_vccnz L_gs_116
L_gb_115:
    v_mfma_f32_32x32x16_bf16 v[0:15], v[168:171], v[64:67], v[0:15]
    v_mfma_f32_32x32x16_bf16 v[16:31], v[168:171], v[68:71], v[16:31]
    v_mfma_f32_32x32x16_bf16 v[32:47], v[172:175], v[64:67], v[32:47]
    s_add_u32 s13, s13, 4096
    buffer_load_dwordx4 v[64:67], v123, s[52:55], s13 offen offset:0 sc1
    s_waitcnt vmcnt(7)
    v_max_u32 v121, v75, v79
    v_cmp_eq_u32 vcc, -1, v121
    v_mfma_f32_32x32x16_bf16 v[48:63], v[172:175], v[68:71], v[48:63]
    buffer_load_dwordx4 v[68:71], v122, s[52:55], s13 offen offset:0 sc1
    s_cbranch_vccnz L_gs_118
L_gb_117:
    v_mfma_f32_32x32x16_bf16 v[0:15], v[176:179], v[72:75], v[0:15]
    v_mfma_f32_32x32x16_bf16 v[16:31], v[176:179], v[76:79], v[16:31]
    v_mfma_f32_32x32x16_bf16 v[32:47], v[180:183], v[72:75], v[32:47]
    buffer_load_dwordx4 v[72:75], v123, s[52:55], s13 offen offset:2048 sc1
    s_waitcnt vmcnt(7)
    v_max_u32 v121, v83, v87
    v_cmp_eq_u32 vcc, -1, v121
    v_mfma_f32_32x32x16_bf16 v[48:63], v[180:183], v[76:79], v[48:63]
    buffer_load_dwordx4 v[76:79], v122, s[52:55], s13 offen offset:2048 sc1
    s_cbranch_vccnz L_gs_120
L_gb_119:
    v_mfma_f32_32x32x16_bf16 v[0:15], v[184:187], v[80:83], v[0:15]
    v_mfma_f32_32x32x16_bf16 v[16:31], v[184:187], v[84:87], v[16:31]
    v_mfma_f32_32x32x16_bf16 v[32:47], v[188:191], v[80:83], v[32:47]
    s_add_u32 s13, s13, 4096
    s_cmp_eq_u32 s13, s28
    s_cmov_b32 s13, s27
    buffer_load_dwordx4 v[80:83], v123, s[52:55], s13 offen offset:0 sc1
    s_waitcnt vmcnt(7)
    v_max_u32 v121, v91, v95
    v_cmp_eq_u32 vcc, -1, v121
    v_mfma_f32_32x32x16_bf16 v[48:63], v[188:191], v[84:87], v[48:63]
    buffer_load_dwordx4 v[84:87], v122, s[52:55], s13 offen offset:0 sc1
    s_cbranch_vccnz L_gs_122
L_gb_121:
    v_mfma_f32_32x32x16_bf16 v[0:15], v[192:195], v[88:91], v[0:15]
    v_mfma_f32_32x32x16_bf16 v[16:31], v[192:195], v[92:95], v[16:31]
    v_mfma_f32_32x32x16_bf16 v[32:47], v[196:199], v[88:91], v[32:47]
    buffer_load_dwordx4 v[88:91], v123, s[52:55], s13 offen offset:2048 sc1
    s_waitcnt vmcnt(7)
    v_max_u32 v121, v99, v103
    v_cmp_eq_u32 vcc, -1, v121
    v_mfma_f32_32x32x16_bf16 v[48:63], v[196:199], v[92:95], v[48:63]
    buffer_load_dwordx4 v[92:95], v122, s[52:55], s13 offen offset:2048 sc1
    s_cbranch_vccnz L_gs_124
L_gb_123:
    v_mfma_f32_32x32x16_bf16 v[0:15], v[200:203], v[96:99], v[0:15]
    v_mfma_f32_32x32x16_bf16 v[16:31], v[200:203], v[100:103], v[16:31]
    v_mfma_f32_32x32x16_bf16 v[32:47], v[204:207], v[96:99], v[32:47]
    s_add_u32 s13, s13, 4096
    buffer_load_dwordx4 v[96:99], v123, s[52:55], s13 offen offset:0 sc1
    s_waitcnt vmcnt(7)
    v_max_u32 v121, v67, v71
    v_cmp_eq_u32 vcc, -1, v121
    v_mfma_f32_32x32x16_bf16 v[48:63], v[204:207], v[100:103], v[48:63]
    buffer_load_dwordx4 v[100:103], v122, s[52:55], s13 offen offset:0 sc1
    s_cbranch_vccnz L_gs_126
L_gb_125:
    v_mfma_f32_32x32x16_bf16 v[0:15], v[208:211], v[64:67], v[0:15]
    v_mfma_f32_32x32x16_bf16 v[16:31], v[208:211], v[68:71], v[16:31]
    v_mfma_f32_32x32x16_bf16 v[32:47], v[212:215], v[64:67], v[32:47]
    buffer_load_dwordx4 v[64:67], v123, s[52:55], s13 offen offset:2048 sc1
    s_waitcnt vmcnt(7)
    v_max_u32 v121, v75, v79
    v_cmp_eq_u32 vcc, -1, v121
    v_mfma_f32_32x32x16_bf16 v[48:63], v[212:215], v[68:71], v[48:63]
    buffer_load_dwordx4 v[68:71], v122, s[52:55], s13 offen offset:2048 sc1
    s_cbranch_vccnz L_gs_128
L_gb_127:
    v_mfma_f32_32x32x16_bf16 v[0:15], v[216:219], v[72:75], v[0:15]
    v_mfma_f32_32x32x16_bf16 v[16:31], v[216:219], v[76:79], v[16:31]
    v_mfma_f32_32x32x16_bf16 v[32:47], v[220:223], v[72:75], v[32:47]
    s_add_u32 s13, s13, 4096
    s_cmp_eq_u32 s13, s28
    s_cmov_b32 s13, s27
    buffer_load_dwordx4 v[72:75], v123, s[52:55], s13 offen offset:0 sc1
    s_waitcnt vmcnt(7)
    v_max_u32 v121, v83, v87
    v_cmp_eq_u32 vcc, -1, v121
    v_mfma_f32_32x32x16_bf16 v[48:63], v[220:223], v[76:79], v[48:63]
    buffer_load_dwordx4 v[76:79], v122, s[52:55], s13 offen offset:0 sc1
    s_cbranch_vccnz L_gs_130
L_gb_129:
    v_mfma_f32_32x32x16_bf16 v[0:15], v[224:227], v[80:83], v[0:15]
    v_mfma_f32_32x32x16_bf16 v[16:31], v[224:227], v[84:87], v[16:31]
    v_mfma_f32_32x32x16_bf16 v[32:47], v[228:231], v[80:83], v[32:47]
    buffer_load_dwordx4 v[80:83], v123, s[52:55], s13 offen offset:2048 sc1
    s_waitcnt vmcnt(7)
    v_max_u32 v121, v91, v95
    v_cmp_eq_u32 vcc, -1, v121
    v_mfma_f32_32x32x16_bf16 v[48:63], v[228:231], v[84:87], v[48:63]
    buffer_load_dwordx4 v[84:87], v122, s[52:55], s13 offen offset:2048 sc1
    s_cbranch_vccnz L_gs_132
L_gb_131:
    v_mfma_f32_32x32x16_bf16 v[0:15], v[232:235], v[88:91], v[0:15]
    v_mfma_f32_32x32x16_bf16 v[16:31], v[232:235], v[92:95], v[16:31]
    v_mfma_f32_32x32x16_bf16 v[32:47], v[236:239], v[88:91], v[32:47]
    s_add_u32 s13, s13, 4096
    buffer_load_dwordx4 v[88:91], v123, s[52:55], s13 offen offset:0 sc1
    s_waitcnt vmcnt(7)
    v_max_u32 v121, v99, v103
    v_cmp_eq_u32 vcc, -1, v121
    v_mfma_f32_32x32x16_bf16 v[48:63], v[236:239], v[92:95], v[48:63]
    buffer_load_dwordx4 v[92:95], v122, s[52:55], s13 offen offset:0 sc1
    s_cbranch_vccnz L_gs_134
L_gb_133:
    v_mfma_f32_32x32x16_bf16 v[0:15], v[240:243], v[96:99], v[0:15]
    v_mfma_f32_32x32x16_bf16 v[16:31], v[240:243], v[100:103], v[16:31]
    v_mfma_f32_32x32x16_bf16 v[32:47], v[244:247], v[96:99], v[32:47]
    buffer_load_dwordx4 v[96:99], v123, s[52:55], s13 offen offset:2048 sc1
    s_waitcnt vmcnt(7)
    v_max_u32 v121, v67, v71
    v_cmp_eq_u32 vcc, -1, v121
    v_mfma_f32_32x32x16_bf16 v[48:63], v[244:247], v[100:103], v[48:63]
    buffer_load_dwordx4 v[100:103], v122, s[52:55], s13 offen offset:2048 sc1
    s_cbranch_vccnz L_gs_136
L_gb_135:
    v_mfma_f32_32x32x16_bf16 v[0:15], v[248:251], v[64:67], v[0:15]
    ds_read_b64_tr_b16 v[104:105], v125 offset:0
    v_mfma_f32_32x32x16_bf16 v[16:31], v[248:251], v[68:71], v[16:31]
    ds_read_b64_tr_b16 v[106:107], v125 offset:1024
    v_mfma_f32_32x32x16_bf16 v[32:47], v[252:255], v[64:67], v[32:47]
    ds_read_b64_tr_b16 v[108:109], v124 offset:0
    s_add_u32 s13, s13, 4096
    s_cmp_eq_u32 s13, s28
    s_cmov_b32 s13, s27
    buffer_load_dwordx4 v[64:67], v123, s[52:55], s13 offen offset:0 sc1
    s_waitcnt vmcnt(7)
    v_max_u32 v121, v75, v79
    v_cmp_eq_u32_e64 vcc, -1, v121
    v_mfma_f32_32x32x16_bf16 v[48:63], v[252:255], v[68:71], v[48:63]
    ds_read_b64_tr_b16 v[110:111], v124 offset:1024
    buffer_load_dwordx4 v[68:71], v122, s[52:55], s13 offen offset:0 sc1
    s_cbranch_vccnz L_gs_138
L_gb_137:
    s_waitcnt lgkmcnt(2)
    v_mfma_f32_32x32x16_bf16 v[0:15], v[104:107], v[72:75], v[0:15]
    ds_read_b64_tr_b16 v[112:113], v125 offset:2048
    v_mfma_f32_32x32x16_bf16 v[16:31], v[104:107], v[76:79], v[16:31]
    ds_read_b64_tr_b16 v[114:115], v125 offset:3072
    s_waitcnt lgkmcnt(2)
    v_mfma_f32_32x32x16_bf16 v[32:47], v[108:111], v[72:75], v[32:47]
    ds_read_b64_tr_b16 v[116:117], v124 offset:2048
    buffer_load_dwordx4 v[72:75], v123, s[52:55], s13 offen offset:2048 sc1
    s_waitcnt vmcnt(7)
    v_max_u32 v121, v83, v87
    v_cmp_eq_u32 vcc, -1, v121
    v_mfma_f32_32x32x16_bf16 v[48:63], v[108:111], v[76:79], v[48:63]
    ds_read_b64_tr_b16 v[118:119], v124 offset:3072
    buffer_load_dwordx4 v[76:79], v122, s[52:55], s13 offen offset:2048 sc1
    s_cbranch_vccnz L_gs_140
L_gb_139:
    s_waitcnt lgkmcnt(2)
    v_mfma_f32_32x32x16_bf16 v[0:15], v[112:115], v[80:83], v[0:15]
    ds_read_b64_tr_b16 v[104:105], v125 offset:4096
    v_mfma_f32_32x32x16_bf16 v[16:31], v[112:115], v[84:87], v[16:31]
    ds_read_b64_tr_b16 v[106:107], v125 offset:5120
    s_waitcnt lgkmcnt(2)
    v_mfma_f32_32x32x16_bf16 v[32:47], v[116:119], v[80:83], v[32:47]
    ds_read_b64_tr_b16 v[108:109], v124 offset:4096
    s_add_u32 s13, s13, 4096
    buffer_load_dwordx4 v[80:83], v123, s[52:55], s13 offen offset:0 sc1
    s_waitcnt vmcnt(7)
    v_max_u32 v121, v91, v95
    v_cmp_eq_u32 vcc, -1, v121
    v_mfma_f32_32x32x16_bf16 v[48:63], v[116:119], v[84:87], v[48:63]
    ds_read_b64_tr_b16 v[110:111], v124 offset:5120
    buffer_load_dwordx4 v[84:87], v122, s[52:55], s13 offen offset:0 sc1
    s_cbranch_vccnz L_gs_142
L_gb_141:
    s_waitcnt lgkmcnt(2)
    v_mfma_f32_32x32x16_bf16 v[0:15], v[104:107], v[88:91], v[0:15]
    ds_read_b64_tr_b16 v[112:113], v125 offset:6144
    v_mfma_f32_32x32x16_bf16 v[16:31], v[104:107], v[92:95], v[16:31]
    ds_read_b64_tr_b16 v[114:115], v125 offset:7168
    s_waitcnt lgkmcnt(2)
    v_mfma_f32_32x32x16_bf16 v[32:47], v[108:111], v[88:91], v[32:47]
    ds_read_b64_tr_b16 v[116:117], v124 offset:6144
    buffer_load_dwordx4 v[88:91], v123, s[52:55], s13 offen offset:2048 sc1
    s_waitcnt vmcnt(7)
    v_max_u32 v121, v99, v103
    v_cmp_eq_u32 vcc, -1, v121
    v_mfma_f32_32x32x16_bf16 v[48:63], v[108:111], v[92:95], v[48:63]
    ds_read_b64_tr_b16 v[118:119], v124 offset:7168
    buffer_load_dwordx4 v[92:95], v122, s[52:55], s13 offen offset:2048 sc1
    s_cbranch_vccnz L_gs_144
L_gb_143:
    s_waitcnt lgkmcnt(2)
    v_mfma_f32_32x32x16_bf16 v[0:15], v[112:115], v[96:99], v[0:15]
    ds_read_b64_tr_b16 v[104:105], v125 offset:8192
    v_mfma_f32_32x32x16_bf16 v[16:31], v[112:115], v[100:103], v[16:31]
    ds_read_b64_tr_b16 v[106:107], v125 offset:9216
    s_waitcnt lgkmcnt(2)
    v_mfma_f32_32x32x16_bf16 v[32:47], v[116:119], v[96:99], v[32:47]
    ds_read_b64_tr_b16 v[108:109], v124 offset:8192
    s_add_u32 s13, s13, 4096
    s_cmp_eq_u32 s13, s28
    s_cmov_b32 s13, s27
    buffer_load_dwordx4 v[96:99], v123, s[52:55], s13 offen offset:0 sc1
    s_waitcnt vmcnt(7)
    v_max_u32 v121, v67, v71
    v_cmp_eq_u32 vcc, -1, v121
    v_mfma_f32_32x32x16_bf16 v[48:63], v[116:119], v[100:103], v[48:63]
    ds_read_b64_tr_b16 v[110:111], v124 offset:9216
    buffer_load_dwordx4 v[100:103], v122, s[52:55], s13 offen offset:0 sc1
    s_cbranch_vccnz L_gs_146
L_gb_145:
    s_waitcnt lgkmcnt(2)
    v_mfma_f32_32x32x16_bf16 v[0:15], v[104:107], v[64:67], v[0:15]
    ds_read_b64_tr_b16 v[112:113], v125 offset:10240
    v_mfma_f32_32x32x16_bf16 v[16:31], v[104:107], v[68:71], v[16:31]
    ds_read_b64_tr_b16 v[114:115], v125 offset:11264
    s_waitcnt lgkmcnt(2)
    v_mfma_f32_32x32x16_bf16 v[32:47], v[108:111], v[64:67], v[32:47]
    ds_read_b64_tr_b16 v[116:117], v124 offset:10240
    buffer_load_dwordx4 v[64:67], v123, s[52:55], s13 offen offset:2048 sc1
    s_waitcnt vmcnt(7)
    v_max_u32 v121, v75, v79
    v_cmp_eq_u32 vcc, -1, v121
    v_mfma_f32_32x32x16_bf16 v[48:63], v[108:111], v[68:71], v[48:63]
    ds_read_b64_tr_b16 v[118:119], v124 offset:11264
    buffer_load_dwordx4 v[68:71], v122, s[52:55], s13 offen offset:2048 sc1
    s_cbranch_vccnz L_gs_148
L_gb_147:
    s_waitcnt lgkmcnt(2)
    v_mfma_f32_32x32x16_bf16 v[0:15], v[112:115], v[72:75], v[0:15]
    ds_read_b64_tr_b16 v[104:105], v125 offset:12288
    v_mfma_f32_32x32x16_bf16 v[16:31], v[112:115], v[76:79], v[16:31]
    ds_read_b64_tr_b16 v[106:107], v125 offset:13312
    s_waitcnt lgkmcnt(2)
    v_mfma_f32_32x32x16_bf16 v[32:47], v[116:119], v[72:75], v[32:47]
    ds_read_b64_tr_b16 v[108:109], v124 offset:12288
    s_add_u32 s13, s13, 4096
    buffer_load_dwordx4 v[72:75], v123, s[52:55], s13 offen offset:0 sc1
    s_waitcnt vmcnt(7)
    v_max_u32 v121, v83, v87
    v_cmp_eq_u32 vcc, -1, v121
    v_mfma_f32_32x32x16_bf16 v[48:63], v[116:119], v[76:79], v[48:63]
    ds_read_b64_tr_b16 v[110:111], v124 offset:13312
    buffer_load_dwordx4 v[76:79], v122, s[52:55], s13 offen offset:0 sc1
    s_cbranch_vccnz L_gs_150
L_gb_149:
    s_waitcnt lgkmcnt(2)
    v_mfma_f32_32x32x16_bf16 v[0:15], v[104:107], v[80:83], v[0:15]
    ds_read_b64_tr_b16 v[112:113], v125 offset:14336
    v_mfma_f32_32x32x16_bf16 v[16:31], v[104:107], v[84:87], v[16:31]
    ds_read_b64_tr_b16 v[114:115], v125 offset:15360
    s_waitcnt lgkmcnt(2)
    v_mfma_f32_32x32x16_bf16 v[32:47], v[108:111], v[80:83], v[32:47]
    ds_read_b64_tr_b16 v[116:117], v124 offset:14336
    buffer_load_dwordx4 v[80:83], v123, s[52:55], s13 offen offset:2048 sc1
    s_waitcnt vmcnt(7)
    v_max_u32 v121, v91, v95
    v_cmp_eq_u32 vcc, -1, v121
    v_mfma_f32_32x32x16_bf16 v[48:63], v[108:111], v[84:87], v[48:63]
    ds_read_b64_tr_b16 v[118:119], v124 offset:15360
    buffer_load_dwordx4 v[84:87], v122, s[52:55], s13 offen offset:2048 sc1
    s_cbranch_vccnz L_gs_152
L_gb_151:
    s_waitcnt lgkmcnt(2)
    v_mfma_f32_32x32x16_bf16 v[0:15], v[112:115], v[88:91], v[0:15]
    ds_read_b64_tr_b16 v[104:105], v125 offset:16384
    v_mfma_f32_32x32x16_bf16 v[16:31], v[112:115], v[92:95], v[16:31]
    ds_read_b64_tr_b16 v[106:107], v125 offset:17408
    s_waitcnt lgkmcnt(2)
    v_mfma_f32_32x32x16_bf16 v[32:47], v[116:119], v[88:91], v[32:47]
    ds_read_b64_tr_b16 v[108:109], v124 offset:16384
    s_waitcnt vmcnt(6)
    v_max_u32 v121, v99, v103
    v_cmp_eq_u32 vcc, -1, v121
    v_mfma_f32_32x32x16_bf16 v[48:63], v[116:119], v[92:95], v[48:63]
    ds_read_b64_tr_b16 v[110:111], v124 offset:17408
    s_cbranch_vccnz L_gs_154
L_gb_153:
    s_waitcnt lgkmcnt(2)
    v_mfma_f32_32x32x16_bf16 v[0:15], v[104:107], v[96:99], v[0:15]
    ds_read_b64_tr_b16 v[112:113], v125 offset:18432
    v_mfma_f32_32x32x16_bf16 v[16:31], v[104:107], v[100:103], v[16:31]
    ds_read_b64_tr_b16 v[114:115], v125 offset:19456
    s_waitcnt lgkmcnt(2)
    v_mfma_f32_32x32x16_bf16 v[32:47], v[108:111], v[96:99], v[32:47]
    ds_read_b64_tr_b16 v[116:117], v124 offset:18432
    s_waitcnt vmcnt(4)
    v_max_u32 v121, v67, v71
    v_cmp_eq_u32 vcc, -1, v121
    v_mfma_f32_32x32x16_bf16 v[48:63], v[108:111], v[100:103], v[48:63]
    ds_read_b64_tr_b16 v[118:119], v124 offset:19456
    s_cbranch_vccnz L_gs_156
L_gb_155:
    s_waitcnt lgkmcnt(2)
    v_mfma_f32_32x32x16_bf16 v[0:15], v[112:115], v[64:67], v[0:15]
    ds_read_b64_tr_b16 v[104:105], v125 offset:20480
    ds_read_b128 v[88:91], v126 offset:61440
    ds_read_b128 v[92:95], v126 offset:62464
    v_mfma_f32_32x32x16_bf16 v[16:31], v[112:115], v[68:71], v[16:31]
    ds_read_b64_tr_b16 v[106:107], v125 offset:21504
    s_waitcnt lgkmcnt(4)
    v_mfma_f32_32x32x16_bf16 v[32:47], v[116:119], v[64:67], v[32:47]
    ds_read_b64_tr_b16 v[108:109], v124 offset:20480
    s_waitcnt vmcnt(2)
    v_max_u32 v121, v75, v79
    v_cmp_eq_u32 vcc, -1, v121
    v_mfma_f32_32x32x16_bf16 v[48:63], v[116:119], v[68:71], v[48:63]
    ds_read_b64_tr_b16 v[110:111], v124 offset:21504
    s_cbranch_vccnz L_gs_158
L_gb_157:
    s_waitcnt lgkmcnt(2)
    v_mfma_f32_32x32x16_bf16 v[0:15], v[104:107], v[72:75], v[0:15]
    ds_read_b64_tr_b16 v[112:113], v125 offset:22528
    v_add_u32 v64, s23, v126
    v_add_u32 v65, s24, v126
    v_add_u32 v66, s25, v126
    v_add_u32 v67, s26, v126
    v_mfma_f32_32x32x16_bf16 v[16:31], v[104:107], v[76:79], v[16:31]
    ds_read_b64_tr_b16 v[114:115], v125 offset:23552
    s_waitcnt lgkmcnt(2)
    v_mfma_f32_32x32x16_bf16 v[32:47], v[108:111], v[72:75], v[32:47]
    ds_read_b64_tr_b16 v[116:117], v124 offset:22528
    s_waitcnt vmcnt(0)
    v_max_u32 v121, v83, v87
    v_cmp_eq_u32 vcc, -1, v121
    v_mfma_f32_32x32x16_bf16 v[48:63], v[108:111], v[76:79], v[48:63]
    ds_read_b64_tr_b16 v[118:119], v124 offset:23552
    s_cbranch_vccnz L_gs_160
L_gb_159:
    s_waitcnt lgkmcnt(2)
    v_mfma_f32_32x32x16_bf16 v[16:31], v[112:115], v[84:87], v[16:31]
    s_waitcnt lgkmcnt(0)
    v_mfma_f32_32x32x16_bf16 v[32:47], v[116:119], v[80:83], v[32:47]
    v_mfma_f32_32x32x16_bf16 v[48:63], v[116:119], v[84:87], v[48:63]
    v_mfma_f32_32x32x16_bf16 v[0:15], v[112:115], v[80:83], v[0:15]
    v_and_b32 v68, 31, v127
    v_lshrrev_b32 v69, 5, v127
    v_and_b32 v70, 15, v127
    v_lshlrev_b32_e64 v70, 6, v70
    v_lshl_add_u32 v70, v69, 4, v70
    v_bfe_u32 v71, v127, 4, 1
    v_lshl_add_u32 v70, v71, 5, v70
    v_lshl_add_u32 v71, v69, 2, v71
    v_lshlrev_b32_e64 v71, 12, v71
    v_cvt_pk_bf16_f32 v104, v16, v17
    v_cvt_pk_bf16_f32 v105, v18, v19
    v_cvt_pk_bf16_f32 v106, v20, v21
    v_cvt_pk_bf16_f32 v107, v22, v23
    ds_write_b128 v65, v[104:107] offset:33280
    v_and_b32 v68, 15, v127
    v_lshl_add_u32 v71, v68, 2, v71
    v_mov_b32 v68, 1.0
    v_cvt_pk_bf16_f32 v108, v24, v25
    v_cvt_pk_bf16_f32 v109, v26, v27
    v_cvt_pk_bf16_f32 v110, v28, v29
    v_cvt_pk_bf16_f32 v111, v30, v31
    ds_write_b128 v65, v[108:111] offset:34304
    v_cndmask_b32 v68, v68, 0, s[90:91]
    s_add_u32 s18, s19, 8192
    s_lshl_b32 s81, s10, 5
    v_cvt_pk_bf16_f32 v112, v32, v33
    v_cvt_pk_bf16_f32 v113, v34, v35
    v_cvt_pk_bf16_f32 v114, v36, v37
    v_cvt_pk_bf16_f32 v115, v38, v39
    ds_write_b128 v66, v[112:115] offset:35328
    s_add_u32 s81, s81, s11
    s_lshl_b32 s81, s81, 6
    s_lshl_b32 s82, s4, 15
    v_cvt_pk_bf16_f32 v116, v40, v41
    v_cvt_pk_bf16_f32 v117, v42, v43
    v_cvt_pk_bf16_f32 v118, v44, v45
    v_cvt_pk_bf16_f32 v119, v46, v47
    ds_write_b128 v66, v[116:119] offset:36352
    s_add_u32 s81, s81, s82
    s_add_u32 s81, s81, 2883584
    v_lshlrev_b32 v84, 12, v127
    v_cvt_pk_bf16_f32 v104, v48, v49
    v_cvt_pk_bf16_f32 v105, v50, v51
    v_cvt_pk_bf16_f32 v106, v52, v53
    v_cvt_pk_bf16_f32 v107, v54, v55
    ds_write_b128 v67, v[104:107] offset:37376
    v_and_b32 v84, 0x4000, v84
    v_and_b32_e64 v80, 3, v127
    v_lshl_add_u32 v84, v80, 4, v84
    v_cvt_pk_bf16_f32 v108, v56, v57
    v_cvt_pk_bf16_f32 v109, v58, v59
    v_cvt_pk_bf16_f32 v110, v60, v61
    v_cvt_pk_bf16_f32 v111, v62, v63
    ds_write_b128 v67, v[108:111] offset:38400
    v_add_u32 v84, s81, v84
    v_mov_b32 v80, s14
    v_mov_b32 v81, s15
    v_mov_b32 v82, s14
    v_mov_b32_e64 v83, s15
    s_waitcnt lgkmcnt(0)
    s_barrier
    ds_read_b128 v[16:19], v64 offset:33280
    ds_read_b128 v[20:23], v64 offset:34304
    ds_read_b128 v[24:27], v64 offset:35328
    ds_read_b128 v[28:31], v64 offset:36352
    ds_read_b128 v[32:35], v64 offset:37376
    ds_read_b128 v[36:39], v64 offset:38400
    s_waitcnt lgkmcnt(5)
    v_mfma_f32_32x32x16_bf16 v[0:15], v[88:91], v[16:19], v[0:15]
    s_waitcnt lgkmcnt(4)
    v_mfma_f32_32x32x16_bf16 v[0:15], v[92:95], v[20:23], v[0:15]
    s_waitcnt lgkmcnt(3)
    v_mfma_f32_32x32x16_bf16 v[0:15], v[88:91], v[24:27], v[0:15]
    s_waitcnt lgkmcnt(2)
    v_mfma_f32_32x32x16_bf16 v[0:15], v[92:95], v[28:31], v[0:15]
    s_waitcnt lgkmcnt(1)
    v_mfma_f32_32x32x16_bf16 v[0:15], v[88:91], v[32:35], v[0:15]
    s_waitcnt lgkmcnt(0)
    v_mfma_f32_32x32x16_bf16 v[0:15], v[92:95], v[36:39], v[0:15]
    s_nop 11
    v_cvt_pk_bf16_f32 v72, v0, v1
    v_cvt_pk_bf16_f32 v73, v2, v3
    v_cvt_pk_bf16_f32 v74, v4, v5
    v_cvt_pk_bf16_f32 v75, v6, v7
    s_nop 0
    v_permlane32_swap_b32 v72, v74
    v_permlane32_swap_b32 v73, v75
    v_cvt_pk_bf16_f32 v76, v8, v9
    v_cvt_pk_bf16_f32 v77, v10, v11
    v_cvt_pk_bf16_f32 v78, v12, v13
    v_cvt_pk_bf16_f32 v79, v14, v15
    s_nop 0
    v_permlane32_swap_b32 v76, v78
    v_permlane32_swap_b32 v77, v79
    s_nop 0
    v_permlane16_swap_b32 v72, v76
    v_permlane16_swap_b32 v73, v77
    v_permlane16_swap_b32 v74, v78
    v_permlane16_swap_b32 v75, v79
    buffer_store_dwordx4 v[72:75], v70, s[52:55], s21 offen offset:0 sc1
    buffer_store_dwordx4 v[76:79], v70, s[52:55], s21 offen offset:1024 sc1
    s_mov_b64 exec, 0xff
    buffer_store_dwordx4 v[80:83], v84, s[52:55], 0 offen sc1
    s_mov_b64 exec, -1
    v_pk_mul_f32 v[20:21], v[0:1], v[0:1]
    v_pk_mul_f32 v[22:23], v[2:3], v[2:3]
    v_pk_mul_f32 v[24:25], v[4:5], v[4:5]
    v_pk_mul_f32 v[26:27], v[6:7], v[6:7]
    v_pk_mul_f32 v[28:29], v[8:9], v[8:9]
    v_pk_mul_f32 v[30:31], v[10:11], v[10:11]
    v_pk_mul_f32 v[32:33], v[12:13], v[12:13]
    v_pk_mul_f32 v[34:35], v[14:15], v[14:15]
    v_permlane16_swap_b32 v0, v20
    v_permlane16_swap_b32 v1, v21
    v_permlane16_swap_b32 v2, v22
    v_permlane16_swap_b32 v3, v23
    v_permlane16_swap_b32 v4, v24
    v_permlane16_swap_b32 v5, v25
    v_permlane16_swap_b32 v6, v26
    v_permlane16_swap_b32 v7, v27
    v_permlane16_swap_b32 v8, v28
    v_permlane16_swap_b32 v9, v29
    v_permlane16_swap_b32 v10, v30
    v_permlane16_swap_b32 v11, v31
    v_permlane16_swap_b32 v12, v32
    v_permlane16_swap_b32 v13, v33
    v_permlane16_swap_b32 v14, v34
    v_permlane16_swap_b32 v15, v35
    v_add_f32 v0, v0, v20
    v_add_f32 v1, v1, v21
    v_add_f32 v2, v2, v22
    v_add_f32 v3, v3, v23
    v_add_f32 v4, v4, v24
    v_add_f32 v5, v5, v25
    v_add_f32 v6, v6, v26
    v_add_f32 v7, v7, v27
    v_add_f32 v8, v8, v28
    v_add_f32 v9, v9, v29
    v_add_f32 v10, v10, v30
    v_add_f32 v11, v11, v31
    v_add_f32 v12, v12, v32
    v_add_f32 v13, v13, v33
    v_add_f32 v14, v14, v34
    v_add_f32_e64 v15, v15, v35
    v_add_f32_dpp v40, v0, v0 row_ror:8 row_mask:0xf bank_mask:0x3
    v_add_f32_dpp v41, v1, v1 row_ror:8 row_mask:0xf bank_mask:0x3
    v_add_f32_dpp v42, v2, v2 row_ror:8 row_mask:0xf bank_mask:0x3
    v_add_f32_dpp v43, v3, v3 row_ror:8 row_mask:0xf bank_mask:0x3
    v_add_f32_dpp v44, v4, v4 row_ror:8 row_mask:0xf bank_mask:0x3
    v_add_f32_dpp v45, v5, v5 row_ror:8 row_mask:0xf bank_mask:0x3
    v_add_f32_dpp v46, v6, v6 row_ror:8 row_mask:0xf bank_mask:0x3
    v_add_f32_dpp v47, v7, v7 row_ror:8 row_mask:0xf bank_mask:0x3
    v_add_f32_dpp v40, v8, v8 row_ror:8 row_mask:0xf bank_mask:0xc
    v_add_f32_dpp v41, v9, v9 row_ror:8 row_mask:0xf bank_mask:0xc
    v_add_f32_dpp v42, v10, v10 row_ror:8 row_mask:0xf bank_mask:0xc
    v_add_f32_dpp v43, v11, v11 row_ror:8 row_mask:0xf bank_mask:0xc
    v_add_f32_dpp v44, v12, v12 row_ror:8 row_mask:0xf bank_mask:0xc
    v_add_f32_dpp v45, v13, v13 row_ror:8 row_mask:0xf bank_mask:0xc
    v_add_f32_dpp v46, v14, v14 row_ror:8 row_mask:0xf bank_mask:0xc
    v_add_f32_dpp v47, v15, v15 row_ror:8 row_mask:0xf bank_mask:0xc
    v_add_f32_dpp v0, v40, v40 row_half_mirror row_mask:0xf bank_mask:0x5
    v_add_f32_dpp v1, v41, v41 row_half_mirror row_mask:0xf bank_mask:0x5
    v_add_f32_dpp v2, v42, v42 row_half_mirror row_mask:0xf bank_mask:0x5
    v_add_f32_dpp v3, v43, v43 row_half_mirror row_mask:0xf bank_mask:0x5
    v_add_f32_dpp v0, v44, v44 row_half_mirror row_mask:0xf bank_mask:0xa
    v_add_f32_dpp v1, v45, v45 row_half_mirror row_mask:0xf bank_mask:0xa
    v_add_f32_dpp v2, v46, v46 row_half_mirror row_mask:0xf bank_mask:0xa
    v_add_f32_dpp v3, v47, v47 row_half_mirror row_mask:0xf bank_mask:0xa
    v_add_f32_dpp v0, v0, v0 quad_perm:[1,0,3,2] row_mask:0xf bank_mask:0xf
    v_add_f32_dpp v1, v1, v1 quad_perm:[1,0,3,2] row_mask:0xf bank_mask:0xf
    v_add_f32_dpp v2, v2, v2 quad_perm:[1,0,3,2] row_mask:0xf bank_mask:0xf
    v_add_f32_dpp v3, v3, v3 quad_perm:[1,0,3,2] row_mask:0xf bank_mask:0xf
    v_add_f32_dpp v0, v0, v0 quad_perm:[2,3,0,1] row_mask:0xf bank_mask:0xf
    v_add_f32_dpp v1, v1, v1 quad_perm:[2,3,0,1] row_mask:0xf bank_mask:0xf
    v_add_f32_dpp v2, v2, v2 quad_perm:[2,3,0,1] row_mask:0xf bank_mask:0xf
    v_add_f32_dpp v3, v3, v3 quad_perm:[2,3,0,1] row_mask:0xf bank_mask:0xf
    v_permlane16_swap_b32 v0, v1
    s_nop 0
    v_permlane16_swap_b32 v2, v3
    v_cndmask_b32 v0, v0, v1, s[90:91]
    v_cndmask_b32 v2, v2, v3, s[90:91]
    v_cndmask_b32 v0, v0, v68, s[92:93]
    v_cndmask_b32 v2, v2, v68, s[92:93]
    buffer_atomic_add_f32 v0, v71, s[52:55], s19 offen sc1
    buffer_atomic_add_f32 v2, v71, s[52:55], s18 offen sc1
    s_barrier
    s_branch L_g2j_161
L_skip_96:
    s_lshl_b32 s16, s5, 2
    s_add_u32 s16, s16, s6
    s_lshl_b32 s81, s16, 12
    s_lshl_b32 s82, s4, 10
    s_add_u32 s81, s81, s82
    s_add_u32 s81, s81, 10485760
    v_mov_b32 v72, -1
    v_mov_b32 v73, -1
    v_mov_b32 v74, -1
    v_mov_b32 v75, -1
    buffer_store_dwordx4 v[72:75], v126, s[52:55], s81 offen sc1
    s_add_u32 s81, s81, 131072
    buffer_store_dwordx4 v[72:75], v126, s[52:55], s81 offen sc1
    s_add_u32 s81, s81, 131072
    buffer_store_dwordx4 v[72:75], v126, s[52:55], s81 offen sc1
    s_add_u32 s81, s81, 131072
    buffer_store_dwordx4 v[72:75], v126, s[52:55], s81 offen sc1
    s_add_u32 s81, s81, 131072
    buffer_store_dwordx4 v[72:75], v126, s[52:55], s81 offen sc1
    s_add_u32 s81, s81, 131072
    buffer_store_dwordx4 v[72:75], v126, s[52:55], s81 offen sc1
    s_add_u32 s81, s81, 131072
    buffer_store_dwordx4 v[72:75], v126, s[52:55], s81 offen sc1
    s_add_u32 s81, s81, 131072
    buffer_store_dwordx4 v[72:75], v126, s[52:55], s81 offen sc1
    s_add_u32 s81, s81, 131072
    buffer_store_dwordx4 v[72:75], v126, s[52:55], s81 offen sc1
    s_add_u32 s81, s81, 131072
    buffer_store_dwordx4 v[72:75], v126, s[52:55], s81 offen sc1
    s_add_u32 s81, s81, 131072
    buffer_store_dwordx4 v[72:75], v126, s[52:55], s81 offen sc1
    s_add_u32 s81, s81, 131072
    buffer_store_dwordx4 v[72:75], v126, s[52:55], s81 offen sc1
    s_add_u32 s81, s81, 131072
    buffer_store_dwordx4 v[72:75], v126, s[52:55], s81 offen sc1
    s_add_u32 s81, s81, 131072
    buffer_store_dwordx4 v[72:75], v126, s[52:55], s81 offen sc1
    s_add_u32 s81, s81, 131072
    buffer_store_dwordx4 v[72:75], v126, s[52:55], s81 offen sc1
    s_lshl_b32 s81, s16, 12
    s_lshl_b32 s82, s4, 10
    s_add_u32 s81, s81, s82
    s_add_u32 s81, s81, 12582912
    v_mov_b32 v72, -1
    v_mov_b32 v73, -1
    v_mov_b32 v74, -1
    v_mov_b32_e64 v75, -1
    buffer_store_dwordx4 v[72:75], v126, s[52:55], s81 offen sc1
    s_add_u32 s81, s81, 131072
    buffer_store_dwordx4 v[72:75], v126, s[52:55], s81 offen sc1
    s_add_u32 s81, s81, 131072
    buffer_store_dwordx4 v[72:75], v126, s[52:55], s81 offen sc1
    s_add_u32 s81, s81, 131072
    buffer_store_dwordx4 v[72:75], v126, s[52:55], s81 offen sc1
    s_add_u32 s81, s81, 131072
    buffer_store_dwordx4 v[72:75], v126, s[52:55], s81 offen sc1
    s_add_u32 s81, s81, 131072
    buffer_store_dwordx4 v[72:75], v126, s[52:55], s81 offen sc1
    s_add_u32 s81, s81, 131072
    buffer_store_dwordx4 v[72:75], v126, s[52:55], s81 offen sc1
    s_add_u32 s81, s81, 131072
    buffer_store_dwordx4 v[72:75], v126, s[52:55], s81 offen sc1
    s_add_u32 s81, s81, 131072
    buffer_store_dwordx4 v[72:75], v126, s[52:55], s81 offen sc1
    s_add_u32 s81, s81, 131072
    buffer_store_dwordx4 v[72:75], v126, s[52:55], s81 offen sc1
    s_add_u32 s81, s81, 131072
    buffer_store_dwordx4 v[72:75], v126, s[52:55], s81 offen sc1
    s_add_u32 s81, s81, 131072
    buffer_store_dwordx4 v[72:75], v126, s[52:55], s81 offen sc1
    s_add_u32 s81, s81, 131072
    buffer_store_dwordx4 v[72:75], v126, s[52:55], s81 offen sc1
    s_add_u32 s81, s81, 131072
    buffer_store_dwordx4 v[72:75], v126, s[52:55], s81 offen sc1
    s_lshl_b32 s81, s16, 12
    s_lshl_b32 s82, s4, 10
    s_add_u32 s81, s81, s82
    s_add_u32 s81, s81, 14680064
    v_mov_b32 v72, -1
    v_mov_b32 v73, -1
    v_mov_b32 v74, -1
    v_mov_b32_e64 v75, -1
    buffer_store_dwordx4 v[72:75], v126, s[52:55], s81 offen sc1
    s_add_u32 s81, s81, 131072
    buffer_store_dwordx4 v[72:75], v126, s[52:55], s81 offen sc1
    s_add_u32 s81, s81, 131072
    buffer_store_dwordx4 v[72:75], v126, s[52:55], s81 offen sc1
    s_add_u32 s81, s81, 131072
    buffer_store_dwordx4 v[72:75], v126, s[52:55], s81 offen sc1
    s_add_u32 s81, s81, 131072
    buffer_store_dwordx4 v[72:75], v126, s[52:55], s81 offen sc1
    s_add_u32 s81, s81, 131072
    buffer_store_dwordx4 v[72:75], v126, s[52:55], s81 offen sc1
    s_add_u32 s81, s81, 131072
    buffer_store_dwordx4 v[72:75], v126, s[52:55], s81 offen sc1
    s_add_u32 s81, s81, 131072
    buffer_store_dwordx4 v[72:75], v126, s[52:55], s81 offen sc1
    s_add_u32 s81, s81, 131072
    buffer_store_dwordx4 v[72:75], v126, s[52:55], s81 offen sc1
    s_add_u32 s81, s81, 131072
    buffer_store_dwordx4 v[72:75], v126, s[52:55], s81 offen sc1
    s_add_u32 s81, s81, 131072
    buffer_store_dwordx4 v[72:75], v126, s[52:55], s81 offen sc1
    s_add_u32 s81, s81, 131072
    buffer_store_dwordx4 v[72:75], v126, s[52:55], s81 offen sc1
    s_add_u32 s81, s81, 131072
    buffer_store_dwordx4 v[72:75], v126, s[52:55], s81 offen sc1
    s_lshl_b32 s81, s16, 6
    s_lshl_b32 s82, s4, 15
    s_add_u32 s81, s81, s82
    s_add_u32 s81, s81, 2228224
    v_lshlrev_b32 v12, 12, v127
    v_and_b32 v12, 0x4000, v12
    v_and_b32 v8, 3, v127
    v_lshl_add_u32 v12, v8, 4, v12
    v_mov_b32 v8, s14
    v_mov_b32 v9, s15
    v_mov_b32 v10, s14
    v_mov_b32 v11, s15
    s_waitcnt vmcnt(0)
    s_waitcnt lgkmcnt(0)
    s_barrier
    s_mov_b64 exec, 0xff
    buffer_store_dwordx4 v[8:11], v12, s[52:55], s81 offen sc1
    s_mov_b64 exec, -1
    v_min_u32_e64 v62, 27, v127
    s_lshl_b32 s84, s5, 14
    s_add_u32 s84, s84, 3538944
    v_lshl_add_u32 v62, v62, 6, s84
    buffer_load_dwordx2 v[60:61], v62, s[52:55], 0 offen sc1
    s_waitcnt vmcnt(0)
    v_cmp_ne_u64 vcc, s[14:15], v[60:61]
    s_nop 0
    s_cbranch_vccz L_pok_162
    s_mov_b32 s85, 0
L_plp_163:
    buffer_load_dwordx2 v[60:61], v62, s[52:55], 0 offen sc1
    s_waitcnt vmcnt(0)
    v_cmp_ne_u64 vcc, s[14:15], v[60:61]
    s_add_u32 s85, s85, 1
    s_cbranch_vccz L_pok_162
    s_cmp_lt_u32 s85, 0x100000
    s_cbranch_scc1 L_plp_163
L_pok_162:
L_g2j_161:
    s_cmp_eq_u32 s86, 0
    s_cbranch_scc1 L_skip_164
    s_mov_b32 s34, 0x3b124925
    s_mov_b32 s100, 0x3727c5ac
    s_lshl_b32 s81, s4, 10
    v_add_u32 v118, s81, v126
    s_lshr_b32 s81, s4, 1
    s_and_b32 s82, s4, 1
    v_and_b32 v8, 15, v127
    v_lshrrev_b32 v9, 4, v127
    v_not_b32 v10, v8
    v_and_b32 v10, 3, v10
    s_cmp_lg_u32 s81, 0
    s_cselect_b32 s83, 1, 0
    s_mul_i32 s83, s83, 4160
    v_mov_b32 v11, s83
    s_cmp_lg_u32 s81, 0
    s_cselect_b32 s83, 6, 5
    s_mul_i32 s83, s83, 4160
    v_mov_b32 v12, s83
    v_cmp_eq_u32 vcc, 1, v10
    s_nop 1
    v_cndmask_b32 v11, v11, v12, vcc
    s_cmp_lg_u32 s81, 0
    s_cselect_b32 s83, 7, 2
    s_mul_i32 s83, s83, 4160
    v_mov_b32 v12, s83
    v_cmp_eq_u32 vcc, 2, v10
    s_nop 1
    v_cndmask_b32 v11, v11, v12, vcc
    s_cmp_lg_u32 s81, 0
    s_cselect_b32 s83, 4, 3
    s_mul_i32 s83, s83, 4160
    v_mov_b32 v12, s83
    v_cmp_eq_u32 vcc, 3, v10
    s_nop 1
    v_cndmask_b32 v11, v11, v12, vcc
    v_add_u32 v10, v10, v8
    v_lshlrev_b32 v12, 3, v9
    v_sub_u32 v12, v12, v10
    v_lshl_add_u32 v11, v12, 1, v11
    s_lshl_b32 s84, s82, 8
    s_sub_u32 s83, 286, s84
    v_add_u32 v112, s83, v11
    s_mul_i32 s83, s81, 5120
    s_sub_u32 s83, s83, s84
    s_add_u32 s83, s83, 34080
    v_lshlrev_b32 v12, 5, v8
    v_lshl_add_u32 v13, v9, 4, v12
    v_add_u32 v113, s83, v13
    s_lshl_b32 s83, s4, 11
    v_lshl_add_u32 v13, v9, 3, v12
    v_add_u32 v114, s83, v13
    s_xor_b32 s83, s4, 1
    s_lshl_b32 s83, s83, 12
    v_add_u32 v115, s83, v126
    s_lshl_b32 s83, s4, 12
    v_add_u32 v116, s83, v126
    v_and_b32 v10, 1, v9
    v_lshlrev_b32 v10, 3, v10
    v_lshrrev_b32 v11, 1, v8
    v_add_u32 v10, v10, v11
    v_mul_u32_u24 v10, 28800, v10
    v_and_b32 v11, 1, v8
    v_lshl_add_u32 v10, v11, 5, v10
    v_lshrrev_b32 v11, 1, v9
    v_lshl_add_u32 v117, v11, 4, v10
    s_mul_i32 s82, s82, 921600
    s_lshl_b32 s83, s7, 1
    s_add_u32 s81, s81, s83
    s_lshl_b32 s81, s81, 6
    s_add_u32 s81, s81, s82
    s_add_u32 s13, s81, 10485760
    s_add_u32 s21, s13, 460800
    s_lshl_b32 s16, s4, 10
    s_add_u32 s16, s16, 32768
    s_add_u32 s17, s16, 4096
    s_add_u32 s18, s16, 8192
    s_add_u32 s19, s16, 12288
    s_mul_i32 s20, s4, 460800
    s_lshl_b32 s83, s7, 7
    s_add_u32 s20, s20, s83
    s_add_u32 s20, s20, 16777216
    v_lshrrev_b32 v10, 2, v127
    v_mul_u32_u24 v10, 28800, v10
    v_and_b32 v11, 3, v127
    v_lshl_add_u32 v119, v11, 4, v10
    s_add_u32 s22, s16, 0
    s_add_u32 s23, s16, 4096
    s_add_u32 s24, s16, 8192
    s_add_u32 s25, s16, 12288
    s_add_u32 s26, s16, 16384
    s_add_u32 s27, s16, 20480
    s_add_u32 s28, s16, 24576
    s_add_u32 s29, s16, 28672
    v_lshrrev_b32 v108, 3, v127
    v_min_u32 v108, 6, v108
    v_and_b32 v109, 7, v127
    v_lshl_add_u32 v110, v108, 5, v109
    s_lshl_b32 s81, s4, 3
    v_add_u32 v110, s81, v110
    v_and_b32 v109, 7, v127
    v_min_u32 v108, 6, v109
    v_lshl_add_u32 v111, v108, 5, v109
    v_add_u32 v111, s81, v111
    v_mov_b32 v32, 0
    v_mov_b32 v33, 0
    v_mov_b32 v34, 0
    v_mov_b32 v35, 0
    s_and_b32 s81, s4, 1
    s_mul_i32 s81, s81, 5120
    v_add_u32_e64 v36, s81, v126
    ds_write_b128 v36, v[32:35] offset:33280
    s_lshl_b32 s84, s5, 14
    s_add_u32 s84, s84, 2883584
    v_lshl_add_u32 v111, v111, 6, s84
    buffer_load_dwordx2 v[108:109], v111, s[52:55], 0 offen sc1
    s_waitcnt vmcnt(0)
    v_cmp_ne_u64 vcc, s[14:15], v[108:109]
    s_nop 0
    s_cbranch_vccz L_pok_165
    s_mov_b32 s85, 0
L_plp_166:
    buffer_load_dwordx2 v[108:109], v111, s[52:55], 0 offen sc1
    s_waitcnt vmcnt(0)
    v_cmp_ne_u64_e64 vcc, s[14:15], v[108:109]
    s_add_u32 s85, s85, 1
    s_cbranch_vccz L_pok_165
    s_cmp_lt_u32 s85, 0x100000
    s_cbranch_scc1 L_plp_166
L_pok_165:
    s_mov_b32 s85, 0
L_cca_167:
    buffer_load_dwordx4 v[64:67], v126, s[52:55], s22 offen sc1
    buffer_load_dwordx4 v[68:71], v126, s[52:55], s23 offen sc1
    buffer_load_dwordx4 v[96:99], v119, s[52:55], s20 offen sc1
    buffer_load_dwordx4 v[100:103], v119, s[52:55], s20 offen offset:64 sc1
    buffer_load_dwordx4 v[72:75], v126, s[52:55], s24 offen sc1
    buffer_load_dwordx4 v[76:79], v126, s[52:55], s25 offen sc1
    buffer_load_dwordx4 v[80:83], v126, s[52:55], s26 offen sc1
    buffer_load_dwordx4 v[84:87], v126, s[52:55], s27 offen sc1
    buffer_load_dwordx4 v[88:91], v126, s[52:55], s28 offen sc1
    buffer_load_dwordx4 v[92:95], v126, s[52:55], s29 offen sc1
    s_waitcnt vmcnt(9)
    v_pk_mul_f32 v[64:65], v[64:65], s[34:35] op_sel_hi:[1,0]
    v_fma_f32 v67, -v64, v64, s100
    v_add_f32 v65, v65, v67
    v_max_f32 v65, s100, v65
    v_rsq_f32 v32, v65
    s_waitcnt vmcnt(8)
    v_pk_mul_f32 v[68:69], v[68:69], s[34:35] op_sel_hi:[1,0]
    v_fma_f32 v71, -v68, v68, s100
    v_add_f32 v69, v69, v71
    v_max_f32 v69, s100, v69
    v_rsq_f32 v33, v69
    s_waitcnt vmcnt(7)
    v_lshlrev_b32 v0, 16, v96
    v_and_b32 v1, s0, v96
    v_lshlrev_b32 v2, 16, v97
    v_and_b32 v3, s0, v97
    v_lshlrev_b32 v4, 16, v98
    v_and_b32 v5, s0, v98
    v_lshlrev_b32 v6, 16, v99
    v_and_b32 v7, s0, v99
    s_waitcnt vmcnt(6)
    v_lshlrev_b32 v8, 16, v100
    v_and_b32 v9, s0, v100
    v_lshlrev_b32 v10, 16, v101
    v_and_b32 v11, s0, v101
    v_lshlrev_b32 v12, 16, v102
    v_and_b32 v13, s0, v102
    v_lshlrev_b32 v14, 16, v103
    v_and_b32 v15, s0, v103
    v_max_u32 v63, v99, v103
    v_cmp_eq_u32 s[16:17], -1, v63
    v_min_f32 v62, v66, v70
    v_cvt_pk_bf16_f32 v68, v64, v68
    v_lshlrev_b32 v64, 16, v68
    v_and_b32 v68, s0, v68
    v_mul_f32 v40, -v64, v32
    v_mul_f32 v41, -v68, v33
    v_pk_fma_f32 v[16:17], v[0:1], v[32:33], v[40:41]
    v_pk_fma_f32 v[24:25], v[8:9], v[32:33], v[40:41]
    v_cvt_pk_bf16_f32 v48, v16, v17
    v_cvt_pk_bf16_f32 v52, v24, v25
    s_waitcnt vmcnt(5)
    v_pk_mul_f32 v[72:73], v[72:73], s[34:35] op_sel_hi:[1,0]
    v_fma_f32 v75, -v72, v72, s100
    v_add_f32 v73, v73, v75
    v_max_f32 v73, s100, v73
    v_rsq_f32 v34, v73
    s_waitcnt vmcnt(4)
    v_pk_mul_f32 v[76:77], v[76:77], s[34:35] op_sel_hi:[1,0]
    v_fma_f32 v79, -v76, v76, s100
    v_add_f32 v77, v77, v79
    v_max_f32 v77, s100, v77
    v_rsq_f32 v35, v77
    v_min3_f32 v62, v62, v74, v78
    v_cvt_pk_bf16_f32 v76, v72, v76
    v_lshlrev_b32 v72, 16, v76
    v_and_b32 v76, s0, v76
    v_mul_f32 v42, -v72, v34
    v_mul_f32 v43, -v76, v35
    v_pk_fma_f32 v[18:19], v[2:3], v[34:35], v[42:43]
    v_pk_fma_f32 v[26:27], v[10:11], v[34:35], v[42:43]
    v_cvt_pk_bf16_f32 v49, v18, v19
    v_cvt_pk_bf16_f32 v53, v26, v27
    s_waitcnt vmcnt(3)
    v_pk_mul_f32 v[80:81], v[80:81], s[34:35] op_sel_hi:[1,0]
    v_fma_f32 v83, -v80, v80, s100
    v_add_f32 v81, v81, v83
    v_max_f32 v81, s100, v81
    v_rsq_f32 v36, v81
    s_waitcnt vmcnt(2)
    v_pk_mul_f32 v[84:85], v[84:85], s[34:35] op_sel_hi:[1,0]
    v_fma_f32 v87, -v84, v84, s100
    v_add_f32 v85, v85, v87
    v_max_f32 v85, s100, v85
    v_rsq_f32 v37, v85
    v_min3_f32 v62, v62, v82, v86
    v_cvt_pk_bf16_f32 v84, v80, v84
    v_lshlrev_b32 v80, 16, v84
    v_and_b32 v84, s0, v84
    v_mul_f32 v44, -v80, v36
    v_mul_f32 v45, -v84, v37
    v_pk_fma_f32 v[20:21], v[4:5], v[36:37], v[44:45]
    v_pk_fma_f32 v[28:29], v[12:13], v[36:37], v[44:45]
    v_cvt_pk_bf16_f32 v50, v20, v21
    v_cvt_pk_bf16_f32 v54, v28, v29
    s_waitcnt vmcnt(1)
    v_pk_mul_f32 v[88:89], v[88:89], s[34:35] op_sel_hi:[1,0]
    v_fma_f32 v91, -v88, v88, s100
    v_add_f32 v89, v89, v91
    v_max_f32 v89, s100, v89
    v_rsq_f32 v38, v89
    s_waitcnt vmcnt(0)
    v_pk_mul_f32 v[92:93], v[92:93], s[34:35] op_sel_hi:[1,0]
    v_fma_f32 v95, -v92, v92, s100
    v_add_f32 v93, v93, v95
    v_max_f32 v93, s100, v93
    v_rsq_f32 v39, v93
    v_min3_f32 v62, v62, v90, v94
    v_cmp_neq_f32 vcc, 0x41600000, v62
    v_cvt_pk_bf16_f32 v92, v88, v92
    v_lshlrev_b32 v88, 16, v92
    v_and_b32 v92, s0, v92
    v_mul_f32 v46, -v88, v38
    v_mul_f32 v47, -v92, v39
    v_pk_fma_f32 v[22:23], v[6:7], v[38:39], v[46:47]
    v_pk_fma_f32 v[30:31], v[14:15], v[38:39], v[46:47]
    v_cvt_pk_bf16_f32 v51, v22, v23
    v_cvt_pk_bf16_f32 v55, v30, v31
    s_or_b64 vcc, vcc, s[16:17]
    s_cbranch_vccnz L_ccs_169
L_ccb_168:
    ds_write_b128 v118, v[48:51] offset:34304
    ds_write_b128 v118, v[52:55] offset:39424
    v_pk_fma_f32 v[16:17], v[16:17], s[72:73], v[0:1] op_sel_hi:[1,0,1]
    v_pk_fma_f32 v[18:19], v[18:19], s[72:73], v[2:3] op_sel_hi:[1,0,1]
    v_pk_fma_f32 v[20:21], v[20:21], s[72:73], v[4:5] op_sel_hi:[1,0,1]
    v_pk_fma_f32 v[22:23], v[22:23], s[72:73], v[6:7] op_sel_hi:[1,0,1]
    v_cvt_pk_bf16_f32 v88, v16, v17
    v_cvt_pk_bf16_f32 v89, v18, v19
    v_cvt_pk_bf16_f32 v90, v20, v21
    v_cvt_pk_bf16_f32 v91, v22, v23
    v_pk_fma_f32 v[24:25], v[24:25], s[74:75], v[8:9] op_sel_hi:[1,0,1]
    v_pk_fma_f32 v[26:27], v[26:27], s[74:75], v[10:11] op_sel_hi:[1,0,1]
    v_pk_fma_f32 v[28:29], v[28:29], s[74:75], v[12:13] op_sel_hi:[1,0,1]
    v_pk_fma_f32 v[30:31], v[30:31], s[74:75], v[14:15] op_sel_hi:[1,0,1]
    v_cvt_pk_bf16_f32 v92, v24, v25
    v_cvt_pk_bf16_f32 v93, v26, v27
    v_cvt_pk_bf16_f32 v94, v28, v29
    v_cvt_pk_bf16_f32 v95, v30, v31
    v_and_b32 v110, 31, v127
    s_lshl_b32 s84, s5, 14
    s_add_u32 s84, s84, 2228224
    v_lshl_add_u32 v110, v110, 6, s84
    buffer_load_dwordx2 v[108:109], v110, s[52:55], 0 offen sc1
    s_waitcnt lgkmcnt(0)
    s_barrier
    ds_read_b64 v[64:65], v112 offset:192
    ds_read_b64 v[66:67], v112 offset:200
    ds_read_b128 v[32:35], v113 offset:192
    ds_read_b64 v[68:69], v112 offset:704
    ds_read_b64 v[70:71], v112 offset:712
    ds_read_b128 v[36:39], v113 offset:704
    ds_read_b64 v[72:73], v112 offset:1216
    ds_read_b64 v[74:75], v112 offset:1224
    ds_read_b128 v[40:43], v113 offset:1216
    ds_read_b64 v[76:77], v112 offset:1728
    ds_read_b64 v[78:79], v112 offset:1736
    ds_read_b128 v[44:47], v113 offset:1728
    ds_read_b64 v[80:81], v112 offset:2240
    ds_read_b64 v[82:83], v112 offset:2248
    ds_read_b128 v[48:51], v113 offset:2240
    ds_read_b128 v[52:55], v113 offset:2752
    ds_read_b128 v[56:59], v113 offset:3264
    ds_read_b128 v[60:63], v113 offset:3776
    s_waitcnt lgkmcnt(15)
    v_mfma_f32_16x16x32_bf16 v[28:31], v[64:67], v[32:35], 0
    ds_read_b64 v[84:85], v112 offset:2752
    ds_read_b64 v[86:87], v112 offset:2760
    s_waitcnt lgkmcnt(14)
    v_mfma_f32_16x16x32_bf16 v[24:27], v[68:71], v[32:35], 0
    ds_read_b64 v[64:65], v112 offset:3264
    ds_read_b64 v[66:67], v112 offset:3272
    v_mfma_f32_16x16x32_bf16 v[28:31], v[68:71], v[36:39], v[28:31]
    s_waitcnt lgkmcnt(12)
    v_mfma_f32_16x16x32_bf16 v[20:23], v[72:75], v[32:35], 0
    ds_read_b64 v[68:69], v112 offset:3776
    ds_read_b64 v[70:71], v112 offset:3784
    v_mfma_f32_16x16x32_bf16 v[24:27], v[72:75], v[36:39], v[24:27]
    v_mfma_f32_16x16x32_bf16 v[28:31], v[72:75], v[40:43], v[28:31]
    s_waitcnt lgkmcnt(9)
    v_mfma_f32_16x16x32_bf16 v[16:19], v[76:79], v[32:35], 0
    ds_read_b64 v[72:73], v112 offset:128
    ds_read_b64 v[74:75], v112 offset:136
    v_mfma_f32_16x16x32_bf16 v[20:23], v[76:79], v[36:39], v[20:23]
    ds_write_b128 v118, v[88:91] offset:43520
    v_mfma_f32_16x16x32_bf16 v[24:27], v[76:79], v[40:43], v[24:27]
    ds_write_b128 v118, v[92:95] offset:47616
    v_mfma_f32_16x16x32_bf16 v[28:31], v[76:79], v[44:47], v[28:31]
    v_mfma_f32_16x16x32_bf16 v[12:15], v[80:83], v[32:35], 0
    ds_read_b64 v[76:77], v112 offset:640
    ds_read_b64 v[78:79], v112 offset:648
    v_mfma_f32_16x16x32_bf16 v[16:19], v[80:83], v[36:39], v[16:19]
    v_mfma_f32_16x16x32_bf16 v[20:23], v[80:83], v[40:43], v[20:23]
    v_mfma_f32_16x16x32_bf16 v[24:27], v[80:83], v[44:47], v[24:27]
    v_mfma_f32_16x16x32_bf16 v[28:31], v[80:83], v[48:51], v[28:31]
    s_waitcnt lgkmcnt(6)
    v_mfma_f32_16x16x32_bf16 v[8:11], v[84:87], v[32:35], 0
    ds_read_b64 v[80:81], v112 offset:1152
    ds_read_b64 v[82:83], v112 offset:1160
    v_mfma_f32_16x16x32_bf16 v[12:15], v[84:87], v[36:39], v[12:15]
    v_mfma_f32_16x16x32_bf16 v[16:19], v[84:87], v[40:43], v[16:19]
    v_mfma_f32_16x16x32_bf16 v[20:23], v[84:87], v[44:47], v[20:23]
    v_mfma_f32_16x16x32_bf16 v[24:27], v[84:87], v[48:51], v[24:27]
    v_mfma_f32_16x16x32_bf16 v[28:31], v[84:87], v[52:55], v[28:31]
    v_mfma_f32_16x16x32_bf16 v[4:7], v[64:67], v[32:35], 0
    ds_read_b64 v[84:85], v112 offset:1664
    ds_read_b64 v[86:87], v112 offset:1672
    v_mfma_f32_16x16x32_bf16 v[8:11], v[64:67], v[36:39], v[8:11]
    v_mfma_f32_16x16x32_bf16 v[12:15], v[64:67], v[40:43], v[12:15]
    v_mfma_f32_16x16x32_bf16 v[16:19], v[64:67], v[44:47], v[16:19]
    v_mfma_f32_16x16x32_bf16 v[20:23], v[64:67], v[48:51], v[20:23]
    v_mfma_f32_16x16x32_bf16 v[24:27], v[64:67], v[52:55], v[24:27]
    v_mfma_f32_16x16x32_bf16 v[28:31], v[64:67], v[56:59], v[28:31]
    v_mfma_f32_16x16x32_bf16 v[0:3], v[68:71], v[32:35], 0
    ds_read_b64 v[64:65], v112 offset:2176
    ds_read_b64 v[66:67], v112 offset:2184
    ds_read_b128 v[32:35], v113 offset:128
    v_mfma_f32_16x16x32_bf16 v[4:7], v[68:71], v[36:39], v[4:7]
    ds_read_b128 v[36:39], v113 offset:640
    v_mfma_f32_16x16x32_bf16 v[8:11], v[68:71], v[40:43], v[8:11]
    ds_read_b128 v[40:43], v113 offset:1152
    v_mfma_f32_16x16x32_bf16 v[12:15], v[68:71], v[44:47], v[12:15]
    ds_read_b128 v[44:47], v113 offset:1664
    v_mfma_f32_16x16x32_bf16 v[16:19], v[68:71], v[48:51], v[16:19]
    ds_read_b128 v[48:51], v113 offset:2176
    v_mfma_f32_16x16x32_bf16 v[20:23], v[68:71], v[52:55], v[20:23]
    ds_read_b128 v[52:55], v113 offset:2688
    v_mfma_f32_16x16x32_bf16 v[24:27], v[68:71], v[56:59], v[24:27]
    ds_read_b128 v[56:59], v113 offset:3200
    v_mfma_f32_16x16x32_bf16 v[28:31], v[68:71], v[60:63], v[28:31]
    ds_read_b128 v[60:63], v113 offset:3712
    s_waitcnt lgkmcnt(7)
    v_mfma_f32_16x16x32_bf16 v[28:31], v[72:75], v[32:35], v[28:31]
    ds_read_b64 v[68:69], v112 offset:2688
    ds_read_b64 v[70:71], v112 offset:2696
    v_mfma_f32_16x16x32_bf16 v[24:27], v[76:79], v[32:35], v[24:27]
    ds_read_b64 v[72:73], v112 offset:3200
    ds_read_b64 v[74:75], v112 offset:3208
    s_waitcnt lgkmcnt(9)
    v_mfma_f32_16x16x32_bf16 v[28:31], v[76:79], v[36:39], v[28:31]
    v_mfma_f32_16x16x32_bf16 v[20:23], v[80:83], v[32:35], v[20:23]
    ds_read_b64 v[76:77], v112 offset:3712
    ds_read_b64 v[78:79], v112 offset:3720
    v_mfma_f32_16x16x32_bf16 v[24:27], v[80:83], v[36:39], v[24:27]
    v_mfma_f32_16x16x32_bf16 v[28:31], v[80:83], v[40:43], v[28:31]
    v_mfma_f32_16x16x32_bf16 v[16:19], v[84:87], v[32:35], v[16:19]
    ds_read_b64 v[80:81], v112 offset:64
    ds_read_b64 v[82:83], v112 offset:72
    v_mfma_f32_16x16x32_bf16 v[20:23], v[84:87], v[36:39], v[20:23]
    v_mfma_f32_16x16x32_bf16 v[24:27], v[84:87], v[40:43], v[24:27]
    s_waitcnt lgkmcnt(7)
    v_mfma_f32_16x16x32_bf16 v[28:31], v[84:87], v[44:47], v[28:31]
    v_mfma_f32_16x16x32_bf16 v[12:15], v[64:67], v[32:35], v[12:15]
    ds_read_b64 v[84:85], v112 offset:576
    ds_read_b64 v[86:87], v112 offset:584
    v_mfma_f32_16x16x32_bf16 v[16:19], v[64:67], v[36:39], v[16:19]
    v_mfma_f32_16x16x32_bf16 v[20:23], v[64:67], v[40:43], v[20:23]
    v_mfma_f32_16x16x32_bf16 v[24:27], v[64:67], v[44:47], v[24:27]
    v_mfma_f32_16x16x32_bf16 v[28:31], v[64:67], v[48:51], v[28:31]
    s_waitcnt lgkmcnt(4)
    v_mfma_f32_16x16x32_bf16 v[8:11], v[68:71], v[32:35], v[8:11]
    ds_read_b64 v[64:65], v112 offset:1088
    ds_read_b64 v[66:67], v112 offset:1096
    v_mfma_f32_16x16x32_bf16 v[12:15], v[68:71], v[36:39], v[12:15]
    v_mfma_f32_16x16x32_bf16 v[16:19], v[68:71], v[40:43], v[16:19]
    v_mfma_f32_16x16x32_bf16 v[20:23], v[68:71], v[44:47], v[20:23]
    v_mfma_f32_16x16x32_bf16 v[24:27], v[68:71], v[48:51], v[24:27]
    v_mfma_f32_16x16x32_bf16 v[28:31], v[68:71], v[52:55], v[28:31]
    v_mfma_f32_16x16x32_bf16 v[4:7], v[72:75], v[32:35], v[4:7]
    ds_read_b64 v[68:69], v112 offset:1600
    ds_read_b64 v[70:71], v112 offset:1608
    v_mfma_f32_16x16x32_bf16 v[8:11], v[72:75], v[36:39], v[8:11]
    v_mfma_f32_16x16x32_bf16 v[12:15], v[72:75], v[40:43], v[12:15]
    v_mfma_f32_16x16x32_bf16 v[16:19], v[72:75], v[44:47], v[16:19]
    v_mfma_f32_16x16x32_bf16 v[20:23], v[72:75], v[48:51], v[20:23]
    v_mfma_f32_16x16x32_bf16 v[24:27], v[72:75], v[52:55], v[24:27]
    v_mfma_f32_16x16x32_bf16 v[28:31], v[72:75], v[56:59], v[28:31]
    v_mfma_f32_16x16x32_bf16 v[0:3], v[76:79], v[32:35], v[0:3]
    ds_read_b64 v[72:73], v112 offset:2112
    ds_read_b64 v[74:75], v112 offset:2120
    ds_read_b128 v[32:35], v113 offset:64
    v_mfma_f32_16x16x32_bf16 v[4:7], v[76:79], v[36:39], v[4:7]
    ds_read_b128 v[36:39], v113 offset:576
    v_mfma_f32_16x16x32_bf16 v[8:11], v[76:79], v[40:43], v[8:11]
    ds_read_b128 v[40:43], v113 offset:1088
    v_mfma_f32_16x16x32_bf16 v[12:15], v[76:79], v[44:47], v[12:15]
    ds_read_b128 v[44:47], v113 offset:1600
    v_mfma_f32_16x16x32_bf16 v[16:19], v[76:79], v[48:51], v[16:19]
    ds_read_b128 v[48:51], v113 offset:2112
    v_mfma_f32_16x16x32_bf16 v[20:23], v[76:79], v[52:55], v[20:23]
    ds_read_b128 v[52:55], v113 offset:2624
    v_mfma_f32_16x16x32_bf16 v[24:27], v[76:79], v[56:59], v[24:27]
    ds_read_b128 v[56:59], v113 offset:3136
    v_mfma_f32_16x16x32_bf16 v[28:31], v[76:79], v[60:63], v[28:31]
    ds_read_b128 v[60:63], v113 offset:3648
    s_waitcnt lgkmcnt(7)
    v_mfma_f32_16x16x32_bf16 v[28:31], v[80:83], v[32:35], v[28:31]
    ds_read_b64 v[76:77], v112 offset:2624
    ds_read_b64 v[78:79], v112 offset:2632
    v_mfma_f32_16x16x32_bf16 v[24:27], v[84:87], v[32:35], v[24:27]
    ds_read_b64 v[80:81], v112 offset:3136
    ds_read_b64 v[82:83], v112 offset:3144
    s_waitcnt lgkmcnt(9)
    v_mfma_f32_16x16x32_bf16 v[28:31], v[84:87], v[36:39], v[28:31]
    v_mfma_f32_16x16x32_bf16 v[20:23], v[64:67], v[32:35], v[20:23]
    ds_read_b64 v[84:85], v112 offset:3648
    ds_read_b64 v[86:87], v112 offset:3656
    v_mfma_f32_16x16x32_bf16 v[24:27], v[64:67], v[36:39], v[24:27]
    v_mfma_f32_16x16x32_bf16 v[28:31], v[64:67], v[40:43], v[28:31]
    v_mfma_f32_16x16x32_bf16 v[16:19], v[68:71], v[32:35], v[16:19]
    ds_read_b64 v[64:65], v112 offset:0
    ds_read_b64 v[66:67], v112 offset:8
    v_mfma_f32_16x16x32_bf16 v[20:23], v[68:71], v[36:39], v[20:23]
    s_barrier
    v_mfma_f32_16x16x32_bf16 v[24:27], v[68:71], v[40:43], v[24:27]
    ds_read_b64 v[88:89], v114 offset:43520
    s_waitcnt lgkmcnt(7)
    v_mfma_f32_16x16x32_bf16 v[28:31], v[68:71], v[44:47], v[28:31]
    ds_read_b64 v[90:91], v114 offset:44032
    v_mfma_f32_16x16x32_bf16 v[12:15], v[72:75], v[32:35], v[12:15]
    ds_read_b64 v[68:69], v112 offset:512
    ds_read_b64 v[70:71], v112 offset:520
    v_mfma_f32_16x16x32_bf16 v[16:19], v[72:75], v[36:39], v[16:19]
    ds_read_b64 v[92:93], v114 offset:44544
    v_mfma_f32_16x16x32_bf16 v[20:23], v[72:75], v[40:43], v[20:23]
    ds_read_b64 v[94:95], v114 offset:45056
    v_mfma_f32_16x16x32_bf16 v[24:27], v[72:75], v[44:47], v[24:27]
    v_mfma_f32_16x16x32_bf16 v[28:31], v[72:75], v[48:51], v[28:31]
    v_mfma_f32_16x16x32_bf16 v[8:11], v[76:79], v[32:35], v[8:11]
    ds_read_b64 v[72:73], v112 offset:1024
    ds_read_b64 v[74:75], v112 offset:1032
    v_mfma_f32_16x16x32_bf16 v[12:15], v[76:79], v[36:39], v[12:15]
    v_mfma_f32_16x16x32_bf16 v[16:19], v[76:79], v[40:43], v[16:19]
    v_mfma_f32_16x16x32_bf16 v[20:23], v[76:79], v[44:47], v[20:23]
    v_mfma_f32_16x16x32_bf16 v[24:27], v[76:79], v[48:51], v[24:27]
    v_mfma_f32_16x16x32_bf16 v[28:31], v[76:79], v[52:55], v[28:31]
    s_waitcnt lgkmcnt(5)
    v_mfma_f32_16x16x32_bf16 v[4:7], v[80:83], v[32:35], v[4:7]
    ds_read_b64 v[76:77], v112 offset:1536
    ds_read_b64 v[78:79], v112 offset:1544
    v_mfma_f32_16x16x32_bf16 v[8:11], v[80:83], v[36:39], v[8:11]
    v_mfma_f32_16x16x32_bf16 v[12:15], v[80:83], v[40:43], v[12:15]
    v_mfma_f32_16x16x32_bf16 v[16:19], v[80:83], v[44:47], v[16:19]
    v_mfma_f32_16x16x32_bf16 v[20:23], v[80:83], v[48:51], v[20:23]
    v_mfma_f32_16x16x32_bf16 v[24:27], v[80:83], v[52:55], v[24:27]
    v_mfma_f32_16x16x32_bf16 v[28:31], v[80:83], v[56:59], v[28:31]
    v_mfma_f32_16x16x32_bf16 v[0:3], v[84:87], v[32:35], v[0:3]
    ds_read_b64 v[80:81], v112 offset:2048
    ds_read_b64 v[82:83], v112 offset:2056
    ds_read_b128 v[32:35], v113 offset:0
    v_mfma_f32_16x16x32_bf16 v[4:7], v[84:87], v[36:39], v[4:7]
    ds_read_b128 v[36:39], v113 offset:512
    v_mfma_f32_16x16x32_bf16 v[8:11], v[84:87], v[40:43], v[8:11]
    ds_read_b128 v[40:43], v113 offset:1024
    v_mfma_f32_16x16x32_bf16 v[12:15], v[84:87], v[44:47], v[12:15]
    ds_read_b128 v[44:47], v113 offset:1536
    v_mfma_f32_16x16x32_bf16 v[16:19], v[84:87], v[48:51], v[16:19]
    ds_read_b128 v[48:51], v113 offset:2048
    v_mfma_f32_16x16x32_bf16 v[20:23], v[84:87], v[52:55], v[20:23]
    ds_read_b128 v[52:55], v113 offset:2560
    v_mfma_f32_16x16x32_bf16 v[24:27], v[84:87], v[56:59], v[24:27]
    ds_read_b128 v[56:59], v113 offset:3072
    v_mfma_f32_16x16x32_bf16 v[28:31], v[84:87], v[60:63], v[28:31]
    ds_read_b128 v[60:63], v113 offset:3584
    s_waitcnt lgkmcnt(7)
    v_mfma_f32_16x16x32_bf16 v[28:31], v[64:67], v[32:35], v[28:31]
    ds_read_b64 v[84:85], v112 offset:2560
    ds_read_b64 v[86:87], v112 offset:2568
    v_mfma_f32_16x16x32_bf16 v[24:27], v[68:71], v[32:35], v[24:27]
    ds_read_b64 v[64:65], v112 offset:3072
    ds_read_b64 v[66:67], v112 offset:3080
    s_waitcnt lgkmcnt(9)
    v_mfma_f32_16x16x32_bf16 v[28:31], v[68:71], v[36:39], v[28:31]
    v_mfma_f32_16x16x32_bf16 v[20:23], v[72:75], v[32:35], v[20:23]
    ds_read_b64 v[68:69], v112 offset:3584
    ds_read_b64 v[70:71], v112 offset:3592
    v_mfma_f32_16x16x32_bf16 v[24:27], v[72:75], v[36:39], v[24:27]
    v_mfma_f32_16x16x32_bf16 v[28:31], v[72:75], v[40:43], v[28:31]
    v_mfma_f32_16x16x32_bf16 v[16:19], v[76:79], v[32:35], v[16:19]
    v_mfma_f32_16x16x32_bf16 v[20:23], v[76:79], v[36:39], v[20:23]
    s_barrier
    v_mfma_f32_16x16x32_bf16 v[24:27], v[76:79], v[40:43], v[24:27]
    s_waitcnt lgkmcnt(6)
    v_mfma_f32_16x16x32_bf16 v[28:31], v[76:79], v[44:47], v[28:31]
    v_mfma_f32_16x16x32_bf16 v[12:15], v[80:83], v[32:35], v[12:15]
    v_mfma_f32_16x16x32_bf16 v[16:19], v[80:83], v[36:39], v[16:19]
    v_mfma_f32_16x16x32_bf16 v[20:23], v[80:83], v[40:43], v[20:23]
    v_mfma_f32_16x16x32_bf16 v[24:27], v[80:83], v[44:47], v[24:27]
    v_mfma_f32_16x16x32_bf16 v[28:31], v[80:83], v[48:51], v[28:31]
    s_waitcnt lgkmcnt(2)
    v_mfma_f32_16x16x32_bf16 v[8:11], v[84:87], v[32:35], v[8:11]
    v_mfma_f32_16x16x32_bf16 v[12:15], v[84:87], v[36:39], v[12:15]
    v_mfma_f32_16x16x32_bf16 v[16:19], v[84:87], v[40:43], v[16:19]
    v_mfma_f32_16x16x32_bf16 v[20:23], v[84:87], v[44:47], v[20:23]
    v_mfma_f32_16x16x32_bf16 v[24:27], v[84:87], v[48:51], v[24:27]
    v_mfma_f32_16x16x32_bf16 v[28:31], v[84:87], v[52:55], v[28:31]
    v_mfma_f32_16x16x32_bf16 v[4:7], v[64:67], v[32:35], v[4:7]
    v_mfma_f32_16x16x32_bf16 v[8:11], v[64:67], v[36:39], v[8:11]
    v_mfma_f32_16x16x32_bf16 v[12:15], v[64:67], v[40:43], v[12:15]
    v_mfma_f32_16x16x32_bf16 v[16:19], v[64:67], v[44:47], v[16:19]
    v_mfma_f32_16x16x32_bf16 v[20:23], v[64:67], v[48:51], v[20:23]
    v_mfma_f32_16x16x32_bf16 v[24:27], v[64:67], v[52:55], v[24:27]
    v_mfma_f32_16x16x32_bf16 v[28:31], v[64:67], v[56:59], v[28:31]
    s_waitcnt lgkmcnt(0)
    v_mfma_f32_16x16x32_bf16 v[0:3], v[68:71], v[32:35], v[0:3]
    v_mfma_f32_16x16x32_bf16 v[4:7], v[68:71], v[36:39], v[4:7]
    v_mfma_f32_16x16x32_bf16 v[8:11], v[68:71], v[40:43], v[8:11]
    v_mfma_f32_16x16x32_bf16 v[12:15], v[68:71], v[44:47], v[12:15]
    v_mfma_f32_16x16x32_bf16 v[16:19], v[68:71], v[48:51], v[16:19]
    v_mfma_f32_16x16x32_bf16 v[20:23], v[68:71], v[52:55], v[20:23]
    v_mfma_f32_16x16x32_bf16 v[24:27], v[68:71], v[56:59], v[24:27]
    v_mfma_f32_16x16x32_bf16 v[28:31], v[68:71], v[60:63], v[28:31]
    v_lshlrev_b32 v64, 16, v88
    v_and_b32 v65, s0, v88
    v_lshlrev_b32 v66, 16, v89
    v_and_b32 v67, s0, v89
    v_lshlrev_b32 v68, 16, v90
    v_and_b32 v69, s0, v90
    v_lshlrev_b32 v70, 16, v91
    v_and_b32 v71, s0, v91
    v_lshlrev_b32 v72, 16, v92
    v_and_b32 v73, s0, v92
    v_lshlrev_b32 v74, 16, v93
    v_and_b32 v75, s0, v93
    v_lshlrev_b32 v76, 16, v94
    v_and_b32 v77, s0, v94
    v_lshlrev_b32 v78, 16, v95
    v_and_b32 v79, s0, v95
    s_bitcmp1_b32 s4, 0
    s_cbranch_scc1 L_cx_170
    ds_write_b128 v115, v[16:19] offset:43520
    v_pk_add_f32 v[64:65], v[64:65], v[0:1]
    v_pk_add_f32 v[66:67], v[66:67], v[2:3]
    ds_write_b128 v115, v[20:23] offset:44544
    v_pk_add_f32 v[68:69], v[68:69], v[4:5]
    v_pk_add_f32 v[70:71], v[70:71], v[6:7]
    ds_write_b128 v115, v[24:27] offset:45568
    v_pk_add_f32 v[72:73], v[72:73], v[8:9]
    v_pk_add_f32 v[74:75], v[74:75], v[10:11]
    ds_write_b128 v115, v[28:31] offset:46592
    v_pk_add_f32 v[76:77], v[76:77], v[12:13]
    v_pk_add_f32 v[78:79], v[78:79], v[14:15]
    s_branch L_cy_171
L_cx_170:
    ds_write_b128 v115, v[0:3] offset:43520
    v_pk_add_f32 v[64:65], v[64:65], v[16:17]
    v_pk_add_f32 v[66:67], v[66:67], v[18:19]
    ds_write_b128 v115, v[4:7] offset:44544
    v_pk_add_f32 v[68:69], v[68:69], v[20:21]
    v_pk_add_f32 v[70:71], v[70:71], v[22:23]
    ds_write_b128 v115, v[8:11] offset:45568
    v_pk_add_f32 v[72:73], v[72:73], v[24:25]
    v_pk_add_f32 v[74:75], v[74:75], v[26:27]
    ds_write_b128 v115, v[12:15] offset:46592
    v_pk_add_f32 v[76:77], v[76:77], v[28:29]
    v_pk_add_f32 v[78:79], v[78:79], v[30:31]
L_cy_171:
    s_waitcnt vmcnt(0)
    v_cmp_ne_u64 vcc, s[14:15], v[108:109]
    s_nop 0
    s_cbranch_vccz L_pok_172
    s_mov_b32 s85, 0
L_plp_173:
    buffer_load_dwordx2 v[108:109], v110, s[52:55], 0 offen sc1
    s_waitcnt vmcnt(0)
    v_cmp_ne_u64_e64 vcc, s[14:15], v[108:109]
    s_add_u32 s85, s85, 1
    s_cbranch_vccz L_pok_172
    s_cmp_lt_u32 s85, 0x100000
    s_cbranch_scc1 L_plp_173
L_pok_172:
    s_waitcnt lgkmcnt(0)
    s_barrier
    ds_read_b128 v[32:35], v116 offset:43520
    ds_read_b128 v[36:39], v116 offset:44544
    ds_read_b128 v[40:43], v116 offset:45568
    ds_read_b128 v[44:47], v116 offset:46592
    s_waitcnt lgkmcnt(3)
    v_pk_add_f32 v[64:65], v[64:65], v[32:33]
    v_pk_add_f32 v[66:67], v[66:67], v[34:35]
    v_cvt_pk_bf16_f32 v56, v64, v65
    v_cvt_pk_bf16_f32 v57, v66, v67
    s_waitcnt lgkmcnt(2)
    v_pk_add_f32 v[68:69], v[68:69], v[36:37]
    v_pk_add_f32 v[70:71], v[70:71], v[38:39]
    v_cvt_pk_bf16_f32 v58, v68, v69
    v_cvt_pk_bf16_f32 v59, v70, v71
    s_nop 0
    v_permlane16_swap_b32 v56, v58
    v_permlane16_swap_b32 v57, v59
    buffer_store_dwordx4 v[56:59], v117, s[52:55], s13 offen sc1
    s_waitcnt lgkmcnt(1)
    v_pk_add_f32 v[72:73], v[72:73], v[40:41]
    v_pk_add_f32 v[74:75], v[74:75], v[42:43]
    v_cvt_pk_bf16_f32 v60, v72, v73
    v_cvt_pk_bf16_f32 v61, v74, v75
    s_waitcnt lgkmcnt(0)
    v_pk_add_f32 v[76:77], v[76:77], v[44:45]
    v_pk_add_f32 v[78:79], v[78:79], v[46:47]
    v_cvt_pk_bf16_f32 v62, v76, v77
    v_cvt_pk_bf16_f32 v63, v78, v79
    s_nop 0
    v_permlane16_swap_b32 v60, v62
    v_permlane16_swap_b32 v61, v63
    buffer_store_dwordx4 v[60:63], v117, s[52:55], s21 offen sc1
    s_barrier
    s_branch L_cvj_174
L_skip_164:
    v_and_b32 v62, 31, v127
    s_lshl_b32 s84, s5, 14
    s_add_u32 s84, s84, 2228224
    v_lshl_add_u32 v62, v62, 6, s84
    buffer_load_dwordx2 v[60:61], v62, s[52:55], 0 offen sc1
    s_waitcnt vmcnt(0)
    v_cmp_ne_u64 vcc, s[14:15], v[60:61]
    s_nop 0
    s_cbranch_vccz L_pok_175
    s_mov_b32 s85, 0
L_plp_176:
    buffer_load_dwordx2 v[60:61], v62, s[52:55], 0 offen sc1
    s_waitcnt vmcnt(0)
    v_cmp_ne_u64 vcc, s[14:15], v[60:61]
    s_add_u32 s85, s85, 1
    s_cbranch_vccz L_pok_175
    s_cmp_lt_u32 s85, 0x100000
    s_cbranch_scc1 L_plp_176
L_pok_175:
L_cvj_174:
    s_cmp_eq_u32 s89, 0
    s_cbranch_scc1 L_skip_177
    s_mul_i32 s81, s4, 56
    v_min_u32 v116, 55, v127
    v_add_u32 v116, s81, v116
    v_and_b32 v118, 7, v127
    v_mul_u32_u24 v118, 7, v118
    v_add_u32_e64 v118, s81, v118
    s_waitcnt vmcnt(0)
    s_lshr_b32 s16, s12, 1
    s_mul_i32 s16, s16, 28800
    s_and_b32 s81, s12, 1
    s_lshl_b32 s81, s81, 5
    s_add_u32 s16, s16, s81
    s_lshl_b32 s83, s12, 11
    s_mul_i32 s81, s4, 7168
    s_add_u32 s16, s16, s81
    s_add_u32 s16, s16, 10485760
    s_add_u32 s17, s16, 4096
    s_add_u32 s83, s83, 12582912
    s_mul_i32 s30, s4, 7
    v_lshrrev_b32 v1, 1, v127
    v_and_b32 v2, 1, v127
    v_lshlrev_b32 v64, 6, v1
    v_lshl_add_u32 v64, v2, 4, v64
    v_mov_b32 v3, 1073741824
    v_cmp_gt_u32 vcc, 32, v127
    s_nop 1
    v_cndmask_b32 v65, v3, v64, vcc
    s_lshl_b32 s30, s30, 4
    s_mov_b32 s23, s83
    v_add_u32 v4, s30, v1
    v_lshrrev_b32 v5, 6, v4
    v_lshlrev_b32 v5, 18, v5
    v_bfe_u32 v6, v4, 5, 1
    v_lshl_add_u32 v5, v6, 10, v5
    v_and_b32 v6, 31, v4
    v_lshl_add_u32 v5, v6, 4, v5
    v_lshl_add_u32 v68, v2, 9, v5
    s_add_u32 s30, s30, 32
    v_add_u32 v4, s30, v1
    v_lshrrev_b32 v5, 6, v4
    v_lshlrev_b32 v5, 18, v5
    v_bfe_u32 v6, v4, 5, 1
    v_lshl_add_u32 v5, v6, 10, v5
    v_and_b32 v6, 31, v4
    v_lshl_add_u32 v5, v6, 4, v5
    v_lshl_add_u32 v69, v2, 9, v5
    s_add_u32 s30, s30, 32
    v_add_u32 v4, s30, v1
    v_lshrrev_b32 v5, 6, v4
    v_lshlrev_b32 v5, 18, v5
    v_bfe_u32 v6, v4, 5, 1
    v_lshl_add_u32 v5, v6, 10, v5
    v_and_b32 v6, 31, v4
    v_lshl_add_u32 v5, v6, 4, v5
    v_lshl_add_u32 v70, v2, 9, v5
    s_add_u32 s30, s30, 32
    v_add_u32 v4, s30, v1
    v_lshrrev_b32 v5, 6, v4
    v_lshlrev_b32 v5, 18, v5
    v_bfe_u32 v6, v4, 5, 1
    v_lshl_add_u32 v5, v6, 10, v5
    v_and_b32 v6, 31, v4
    v_lshl_add_u32 v5, v6, 4, v5
    v_lshl_add_u32 v71, v2, 9, v5
    v_cndmask_b32 v71, v3, v71, vcc
    v_bfe_u32 v1, v127, 2, 3
    v_lshl_add_u32 v1, v2, 3, v1
    v_lshrrev_b32 v3, 5, v127
    v_lshl_add_u32 v1, v3, 5, v1
    s_lshl_b32 s82, s4, 8
    s_add_u32 s82, s82, 57856
    v_lshl_add_u32 v110, v1, 2, s82
    v_and_b32 v1, 31, v127
    v_lshlrev_b32 v111, 2, v1
    v_add_u32 v111, 57856, v111
    s_add_u32 s82, s82, 1024
    v_lshl_add_u32 v112, v127, 2, s82
    v_lshl_add_u32 v117, v2, 5, s82
    s_mov_b32 s18, 0
    s_mov_b32 s19, -1
    s_lshl_b32 s81, s12, 6
    s_lshl_b32 s82, s4, 15
    s_add_u32 s81, s81, s82
    s_add_u32 s81, s81, 3145728
    v_lshlrev_b32 v108, 12, v127
    v_and_b32 v108, 0x4000, v108
    v_and_b32 v104, 3, v127
    v_lshl_add_u32 v108, v104, 4, v108
    v_add_u32 v108, s81, v108
    v_mov_b32 v104, s14
    v_mov_b32 v105, s15
    v_mov_b32 v106, s14
    v_mov_b32_e64 v107, s15
    s_mov_b32 s85, 0
L_lna_178:
    buffer_load_dwordx4 v[0:3], v64, s[52:55], s16 offen offset:0 sc1
    buffer_load_dwordx4 v[4:7], v64, s[52:55], s16 offen offset:2048 sc1
    buffer_load_dwordx4 v[8:11], v64, s[52:55], s17 offen offset:0 sc1
    buffer_load_dwordx4 v[12:15], v65, s[52:55], s17 offen offset:2048 sc1
    s_waitcnt vmcnt(3)
    v_lshlrev_b32 v28, 16, v0
    v_and_b32 v29, s0, v0
    v_lshlrev_b32 v30, 16, v1
    v_and_b32 v31, s0, v1
    v_lshlrev_b32 v32, 16, v2
    v_and_b32 v33, s0, v2
    v_lshlrev_b32 v34, 16, v3
    v_and_b32_e64 v35, s0, v3
    v_pk_mul_f32 v[92:93], v[28:29], v[28:29]
    v_pk_mul_f32 v[94:95], v[30:31], v[30:31]
    v_pk_mul_f32 v[96:97], v[32:33], v[32:33]
    v_pk_mul_f32 v[98:99], v[34:35], v[34:35]
    s_waitcnt vmcnt(2)
    v_lshlrev_b32 v36, 16, v4
    v_and_b32 v37, s0, v4
    v_lshlrev_b32 v38, 16, v5
    v_and_b32 v39, s0, v5
    v_lshlrev_b32 v40, 16, v6
    v_and_b32 v41, s0, v6
    v_lshlrev_b32 v42, 16, v7
    v_and_b32_e64 v43, s0, v7
    v_pk_fma_f32 v[92:93], v[36:37], v[36:37], v[92:93]
    v_pk_add_f32 v[84:85], v[28:29], v[36:37]
    v_pk_fma_f32 v[94:95], v[38:39], v[38:39], v[94:95]
    v_pk_add_f32 v[86:87], v[30:31], v[38:39]
    v_pk_fma_f32 v[96:97], v[40:41], v[40:41], v[96:97]
    v_pk_add_f32 v[88:89], v[32:33], v[40:41]
    v_pk_fma_f32 v[98:99], v[42:43], v[42:43], v[98:99]
    v_pk_add_f32 v[90:91], v[34:35], v[42:43]
    s_waitcnt vmcnt(1)
    v_lshlrev_b32 v44, 16, v8
    v_and_b32 v45, s0, v8
    v_lshlrev_b32 v46, 16, v9
    v_and_b32 v47, s0, v9
    v_lshlrev_b32 v48, 16, v10
    v_and_b32 v49, s0, v10
    v_lshlrev_b32 v50, 16, v11
    v_and_b32_e64 v51, s0, v11
    v_pk_fma_f32 v[92:93], v[44:45], v[44:45], v[92:93]
    v_pk_add_f32 v[84:85], v[84:85], v[44:45]
    v_pk_fma_f32 v[94:95], v[46:47], v[46:47], v[94:95]
    v_pk_add_f32 v[86:87], v[86:87], v[46:47]
    v_pk_fma_f32 v[96:97], v[48:49], v[48:49], v[96:97]
    v_pk_add_f32 v[88:89], v[88:89], v[48:49]
    v_pk_fma_f32 v[98:99], v[50:51], v[50:51], v[98:99]
    v_pk_add_f32 v[90:91], v[90:91], v[50:51]
    s_waitcnt vmcnt(0)
    v_lshlrev_b32 v52, 16, v12
    v_and_b32 v53, s0, v12
    v_lshlrev_b32 v54, 16, v13
    v_and_b32 v55, s0, v13
    v_lshlrev_b32 v56, 16, v14
    v_and_b32 v57, s0, v14
    v_lshlrev_b32 v58, 16, v15
    v_and_b32_e64 v59, s0, v15
    v_pk_fma_f32 v[92:93], v[52:53], v[52:53], v[92:93]
    v_pk_add_f32 v[84:85], v[84:85], v[52:53]
    v_pk_fma_f32 v[94:95], v[54:55], v[54:55], v[94:95]
    v_pk_add_f32 v[86:87], v[86:87], v[54:55]
    v_pk_fma_f32 v[96:97], v[56:57], v[56:57], v[96:97]
    v_pk_add_f32 v[88:89], v[88:89], v[56:57]
    v_pk_fma_f32 v[98:99], v[58:59], v[58:59], v[98:99]
    v_pk_add_f32 v[90:91], v[90:91], v[58:59]
    v_max3_u32 v113, v3, v7, v11
    v_max_u32 v113, v113, v15
    v_cmp_eq_u32_e64 vcc, -1, v113
    v_permlane32_swap_b32 v84, v92
    v_permlane32_swap_b32 v85, v93
    s_cbranch_vccnz L_lns_180
L_lnb_179:
    v_permlane32_swap_b32 v86, v94
    v_permlane32_swap_b32 v87, v95
    v_permlane32_swap_b32 v88, v96
    v_permlane32_swap_b32 v89, v97
    v_permlane32_swap_b32 v90, v98
    v_permlane32_swap_b32 v91, v99
    v_pk_add_f32 v[84:85], v[84:85], v[92:93]
    v_pk_add_f32 v[86:87], v[86:87], v[94:95]
    v_pk_add_f32 v[88:89], v[88:89], v[96:97]
    v_pk_add_f32 v[90:91], v[90:91], v[98:99]
    s_nop 0
    v_permlane16_swap_b32 v84, v88
    v_permlane16_swap_b32 v85, v89
    v_permlane16_swap_b32 v86, v90
    v_permlane16_swap_b32 v87, v91
    v_pk_add_f32 v[84:85], v[84:85], v[88:89]
    v_pk_add_f32 v[86:87], v[86:87], v[90:91]
    s_nop 0
    v_add_f32_dpp v100, v84, v84 row_ror:8 row_mask:0xf bank_mask:0x3
    v_add_f32_dpp v101, v85, v85 row_ror:8 row_mask:0xf bank_mask:0x3
    s_nop 0
    v_add_f32_dpp v100, v86, v86 row_ror:8 row_mask:0xf bank_mask:0xc
    v_add_f32_dpp v101, v87, v87 row_ror:8 row_mask:0xf bank_mask:0xc
    s_nop 0
    v_add_f32_dpp v84, v100, v100 row_shl:4 row_mask:0xf bank_mask:0x5
    s_nop 1
    v_add_f32_dpp v84, v101, v101 row_shr:4 row_mask:0xf bank_mask:0xa
    s_nop 1
    v_add_f32_dpp v84, v84, v84 quad_perm:[2,3,0,1] row_mask:0xf bank_mask:0xf
    ds_write_b32 v110, v84
    s_waitcnt lgkmcnt(0)
    s_barrier
    s_mov_b64 exec, 0xff
    buffer_store_dwordx4 v[104:107], v108, s[52:55], 0 offen sc1
    s_mov_b64 exec, -1
    ds_read2_b32 v[0:1], v111 offset0:0 offset1:32
    ds_read2_b32 v[2:3], v111 offset0:64 offset1:96
    ds_read2_b32 v[4:5], v111 offset0:128 offset1:160
    ds_read2_b32 v[6:7], v111 offset0:192 offset1:224
    s_waitcnt lgkmcnt(2)
    v_pk_add_f32 v[0:1], v[0:1], v[2:3]
    s_waitcnt lgkmcnt(0)
    v_pk_add_f32 v[4:5], v[4:5], v[6:7]
    v_pk_add_f32 v[0:1], v[0:1], v[4:5]
    v_mul_f32 v0, 0x3b124925, v0
    v_mul_f32 v1, 0x3b124925, v1
    v_fma_f32 v1, -v0, v0, v1
    v_max_f32 v1, 0, v1
    v_add_f32 v2, 0x3727c5ac, v1
    v_fmamk_f32 v2, v2, 0x3727c5ac, v1
    v_rsq_f32 v2, v2
    s_nop 0
    v_mul_f32 v3, -v0, v2
    v_cndmask_b32 v2, v2, v3, s[18:19]
    ds_write_b32 v112, v2
    ds_read_b128 v[84:87], v117
    ds_read_b128 v[92:95], v117 offset:128
    ds_read_b128 v[88:91], v117 offset:16
    ds_read_b128 v[96:99], v117 offset:144
    s_waitcnt lgkmcnt(2)
    v_pk_fma_f32 v[28:29], v[28:29], v[84:85], v[92:93]
    v_pk_fma_f32 v[30:31], v[30:31], v[86:87], v[94:95]
    s_waitcnt lgkmcnt(0)
    v_pk_fma_f32 v[32:33], v[32:33], v[88:89], v[96:97]
    v_pk_fma_f32 v[34:35], v[34:35], v[90:91], v[98:99]
    v_cvt_pk_bf16_f32 v0, v28, v29
    v_cvt_pk_bf16_f32 v1, v30, v31
    v_cvt_pk_bf16_f32 v2, v32, v33
    v_cvt_pk_bf16_f32 v3, v34, v35
    buffer_store_dwordx4 v[0:3], v68, s[52:55], s23 offen sc1
    v_pk_fma_f32 v[36:37], v[36:37], v[84:85], v[92:93]
    v_pk_fma_f32 v[38:39], v[38:39], v[86:87], v[94:95]
    v_pk_fma_f32 v[40:41], v[40:41], v[88:89], v[96:97]
    v_pk_fma_f32 v[42:43], v[42:43], v[90:91], v[98:99]
    v_cvt_pk_bf16_f32 v4, v36, v37
    v_cvt_pk_bf16_f32 v5, v38, v39
    v_cvt_pk_bf16_f32 v6, v40, v41
    v_cvt_pk_bf16_f32 v7, v42, v43
    buffer_store_dwordx4 v[4:7], v69, s[52:55], s23 offen sc1
    v_pk_fma_f32 v[44:45], v[44:45], v[84:85], v[92:93]
    v_pk_fma_f32 v[46:47], v[46:47], v[86:87], v[94:95]
    v_pk_fma_f32 v[48:49], v[48:49], v[88:89], v[96:97]
    v_pk_fma_f32 v[50:51], v[50:51], v[90:91], v[98:99]
    v_cvt_pk_bf16_f32 v8, v44, v45
    v_cvt_pk_bf16_f32 v9, v46, v47
    v_cvt_pk_bf16_f32 v10, v48, v49
    v_cvt_pk_bf16_f32 v11, v50, v51
    buffer_store_dwordx4 v[8:11], v70, s[52:55], s23 offen sc1
    v_pk_fma_f32 v[52:53], v[52:53], v[84:85], v[92:93]
    v_pk_fma_f32 v[54:55], v[54:55], v[86:87], v[94:95]
    v_pk_fma_f32 v[56:57], v[56:57], v[88:89], v[96:97]
    v_pk_fma_f32 v[58:59], v[58:59], v[90:91], v[98:99]
    v_cvt_pk_bf16_f32 v12, v52, v53
    v_cvt_pk_bf16_f32 v13, v54, v55
    v_cvt_pk_bf16_f32 v14, v56, v57
    v_cvt_pk_bf16_f32 v15, v58, v59
    buffer_store_dwordx4 v[12:15], v71, s[52:55], s23 offen sc1
L_skip_177:
    s_cmp_eq_u32 s87, 0
    s_cbranch_scc1 L_skip_181
    s_and_b32 s81, s4, 1
    s_lshl_b32 s81, s81, 10
    v_add_u32 v123, s81, v126
    v_xor_b32 v122, 0x400, v123
    s_lshr_b32 s81, s4, 1
    s_lshl_b32 s81, s81, 6
    s_lshl_b32 s82, s9, 7
    s_add_u32 s81, s81, s82
    v_lshrrev_b32 v16, 5, v127
    v_lshl_add_u32 v16, v16, 3, s81
    global_load_dwordx2 v[20:21], v16, s[38:39] offset:0
    global_load_dwordx2 v[22:23], v16, s[38:39] offset:16
    global_load_dwordx2 v[24:25], v16, s[38:39] offset:32
    global_load_dwordx2 v[26:27], v16, s[38:39] offset:48
    s_lshl_b32 s81, s4, 5
    v_and_b32 v34, 31, v127
    v_add_u32 v34, s81, v34
    v_and_b32 v35, 28, v127
    v_add_u32 v35, s81, v35
    s_lshl_b32 s13, s8, 7
    s_add_u32 s13, s13, s81
    s_lshl_b32 s13, s13, 11
    s_add_u32 s13, s13, 12582912
    s_mov_b32 s34, 0xbdd2d3e8
    s_mul_i32 s21, s8, 112
    s_lshl_b32 s81, s9, 2
    s_add_u32 s21, s21, s81
    s_and_b32 s81, s4, 2
    s_add_u32 s21, s21, s81
    s_lshl_b32 s21, s21, 11
    s_add_u32 s21, s21, 14680064
    s_xor_b32 s24, s4, 1
    s_mul_i32 s24, s24, 6144
    s_xor_b32 s25, s4, 2
    s_mul_i32 s25, s25, 6144
    s_xor_b32 s26, s4, 3
    s_mul_i32 s26, s26, 6144
    s_mul_i32 s23, s4, 6144
    s_mov_b32 s27, s13
    s_add_u32 s28, s13, 65536
    s_lshl_b32 s81, s33, 13
    s_add_u32 s13, s13, s81
    s_mov_b32 s22, s13
    s_waitcnt vmcnt(3)
    v_lshlrev_b32 v0, 16, v20
    v_and_b32 v1, s0, v20
    v_lshlrev_b32 v2, 16, v21
    v_and_b32 v3, s0, v21
    s_waitcnt vmcnt(2)
    v_lshlrev_b32 v4, 16, v22
    v_and_b32 v5, s0, v22
    v_lshlrev_b32 v6, 16, v23
    v_and_b32 v7, s0, v23
    s_waitcnt vmcnt(1)
    v_lshlrev_b32 v8, 16, v24
    v_and_b32 v9, s0, v24
    v_lshlrev_b32 v10, 16, v25
    v_and_b32 v11, s0, v25
    s_waitcnt vmcnt(0)
    v_lshlrev_b32 v12, 16, v26
    v_and_b32 v13, s0, v26
    v_lshlrev_b32 v14, 16, v27
    v_and_b32_e64 v15, s0, v27
    s_lshl_b32 s84, s5, 14
    s_add_u32 s84, s84, 3145728
    v_lshl_add_u32 v35, v35, 6, s84
    buffer_load_dwordx2 v[32:33], v35, s[52:55], 0 offen sc1
    s_waitcnt vmcnt(0)
    v_cmp_ne_u64 vcc, s[14:15], v[32:33]
    s_nop 0
    s_cbranch_vccz L_pok_182
    s_mov_b32 s85, 0
L_plp_183:
    buffer_load_dwordx2 v[32:33], v35, s[52:55], 0 offen sc1
    s_waitcnt vmcnt(0)
    v_cmp_ne_u64_e64 vcc, s[14:15], v[32:33]
    s_add_u32 s85, s85, 1
    s_cbranch_vccz L_pok_182
    s_cmp_lt_u32 s85, 0x100000
    s_cbranch_scc1 L_plp_183
L_pok_182:
    s_mov_b32 s85, 0
    buffer_load_dwordx4 v[64:67], v123, s[52:55], s13 offen offset:0 sc1
    buffer_load_dwordx4 v[68:71], v122, s[52:55], s13 offen offset:0 sc1
    buffer_load_dwordx4 v[72:75], v123, s[52:55], s13 offen offset:2048 sc1
    buffer_load_dwordx4 v[76:79], v122, s[52:55], s13 offen offset:2048 sc1
    s_add_u32 s13, s13, 4096
    buffer_load_dwordx4 v[80:83], v123, s[52:55], s13 offen offset:0 sc1
    buffer_load_dwordx4 v[84:87], v122, s[52:55], s13 offen offset:0 sc1
    buffer_load_dwordx4 v[88:91], v123, s[52:55], s13 offen offset:2048 sc1
    buffer_load_dwordx4 v[92:95], v122, s[52:55], s13 offen offset:2048 sc1
    s_add_u32 s13, s13, 4096
    s_cmp_eq_u32 s13, s28
    s_cmov_b32 s13, s27
    buffer_load_dwordx4 v[96:99], v123, s[52:55], s13 offen offset:0 sc1
    buffer_load_dwordx4 v[100:103], v122, s[52:55], s13 offen offset:0 sc1
    buffer_load_dwordx4 v[104:107], v123, s[52:55], s13 offen offset:2048 sc1
    buffer_load_dwordx4 v[108:111], v122, s[52:55], s13 offen offset:2048 sc1
    s_add_u32 s13, s13, 4096
    buffer_load_dwordx4 v[112:115], v123, s[52:55], s13 offen offset:0 sc1
    buffer_load_dwordx4 v[116:119], v122, s[52:55], s13 offen offset:0 sc1
    s_waitcnt vmcnt(12)
    v_max_u32 v121, v67, v71
    v_cmp_eq_u32_e64 vcc, -1, v121
    s_nop 0
    s_cbranch_vccnz L_gs_185
L_gb_184:
    v_mfma_f32_32x32x16_bf16 v[0:15], a[0:3], v[64:67], v[0:15]
    v_mfma_f32_32x32x16_bf16 v[16:31], a[0:3], v[68:71], 0
    v_mfma_f32_32x32x16_bf16 v[32:47], a[4:7], v[64:67], 0
    buffer_load_dwordx4 v[64:67], v123, s[52:55], s13 offen offset:2048 sc1
    s_waitcnt vmcnt(11)
    v_max_u32 v121, v75, v79
    v_cmp_eq_u32 vcc, -1, v121
    v_mfma_f32_32x32x16_bf16 v[48:63], a[4:7], v[68:71], 0
    buffer_load_dwordx4 v[68:71], v122, s[52:55], s13 offen offset:2048 sc1
    s_cbranch_vccnz L_gs_187
L_gb_186:
    v_mfma_f32_32x32x16_bf16 v[0:15], a[8:11], v[72:75], v[0:15]
    v_mfma_f32_32x32x16_bf16 v[16:31], a[8:11], v[76:79], v[16:31]
    v_mfma_f32_32x32x16_bf16 v[32:47], a[12:15], v[72:75], v[32:47]
    s_add_u32 s13, s13, 4096
    s_cmp_eq_u32 s13, s28
    s_cmov_b32 s13, s27
    buffer_load_dwordx4 v[72:75], v123, s[52:55], s13 offen offset:0 sc1
    s_waitcnt vmcnt(11)
    v_max_u32 v121, v83, v87
    v_cmp_eq_u32 vcc, -1, v121
    v_mfma_f32_32x32x16_bf16 v[48:63], a[12:15], v[76:79], v[48:63]
    buffer_load_dwordx4 v[76:79], v122, s[52:55], s13 offen offset:0 sc1
    s_cbranch_vccnz L_gs_189
L_gb_188:
    v_mfma_f32_32x32x16_bf16 v[0:15], a[16:19], v[80:83], v[0:15]
    v_mfma_f32_32x32x16_bf16 v[16:31], a[16:19], v[84:87], v[16:31]
    v_mfma_f32_32x32x16_bf16 v[32:47], a[20:23], v[80:83], v[32:47]
    buffer_load_dwordx4 v[80:83], v123, s[52:55], s13 offen offset:2048 sc1
    s_waitcnt vmcnt(11)
    v_max_u32 v121, v91, v95
    v_cmp_eq_u32 vcc, -1, v121
    v_mfma_f32_32x32x16_bf16 v[48:63], a[20:23], v[84:87], v[48:63]
    buffer_load_dwordx4 v[84:87], v122, s[52:55], s13 offen offset:2048 sc1
    s_cbranch_vccnz L_gs_191
L_gb_190:
    v_mfma_f32_32x32x16_bf16 v[0:15], a[24:27], v[88:91], v[0:15]
    v_mfma_f32_32x32x16_bf16 v[16:31], a[24:27], v[92:95], v[16:31]
    v_mfma_f32_32x32x16_bf16 v[32:47], a[28:31], v[88:91], v[32:47]
    s_add_u32 s13, s13, 4096
    buffer_load_dwordx4 v[88:91], v123, s[52:55], s13 offen offset:0 sc1
    s_waitcnt vmcnt(11)
    v_max_u32 v121, v99, v103
    v_cmp_eq_u32 vcc, -1, v121
    v_mfma_f32_32x32x16_bf16 v[48:63], a[28:31], v[92:95], v[48:63]
    buffer_load_dwordx4 v[92:95], v122, s[52:55], s13 offen offset:0 sc1
    s_cbranch_vccnz L_gs_193
L_gb_192:
    v_mfma_f32_32x32x16_bf16 v[0:15], a[32:35], v[96:99], v[0:15]
    v_mfma_f32_32x32x16_bf16 v[16:31], a[32:35], v[100:103], v[16:31]
    v_mfma_f32_32x32x16_bf16 v[32:47], a[36:39], v[96:99], v[32:47]
    buffer_load_dwordx4 v[96:99], v123, s[52:55], s13 offen offset:2048 sc1
    s_waitcnt vmcnt(11)
    v_max_u32 v121, v107, v111
    v_cmp_eq_u32 vcc, -1, v121
    v_mfma_f32_32x32x16_bf16 v[48:63], a[36:39], v[100:103], v[48:63]
    buffer_load_dwordx4 v[100:103], v122, s[52:55], s13 offen offset:2048 sc1
    s_cbranch_vccnz L_gs_195
L_gb_194:
    v_mfma_f32_32x32x16_bf16 v[0:15], a[40:43], v[104:107], v[0:15]
    v_mfma_f32_32x32x16_bf16 v[16:31], a[40:43], v[108:111], v[16:31]
    v_mfma_f32_32x32x16_bf16 v[32:47], a[44:47], v[104:107], v[32:47]
    s_add_u32 s13, s13, 4096
    s_cmp_eq_u32 s13, s28
    s_cmov_b32 s13, s27
    buffer_load_dwordx4 v[104:107], v123, s[52:55], s13 offen offset:0 sc1
    s_waitcnt vmcnt(11)
    v_max_u32 v121, v115, v119
    v_cmp_eq_u32 vcc, -1, v121
    v_mfma_f32_32x32x16_bf16 v[48:63], a[44:47], v[108:111], v[48:63]
    buffer_load_dwordx4 v[108:111], v122, s[52:55], s13 offen offset:0 sc1
    s_cbranch_vccnz L_gs_197
L_gb_196:
    v_mfma_f32_32x32x16_bf16 v[0:15], a[48:51], v[112:115], v[0:15]
    v_mfma_f32_32x32x16_bf16 v[16:31], a[48:51], v[116:119], v[16:31]
    v_mfma_f32_32x32x16_bf16 v[32:47], a[52:55], v[112:115], v[32:47]
    buffer_load_dwordx4 v[112:115], v123, s[52:55], s13 offen offset:2048 sc1
    s_waitcnt vmcnt(11)
    v_max_u32 v121, v67, v71
    v_cmp_eq_u32 vcc, -1, v121
    v_mfma_f32_32x32x16_bf16 v[48:63], a[52:55], v[116:119], v[48:63]
    buffer_load_dwordx4 v[116:119], v122, s[52:55], s13 offen offset:2048 sc1
    s_cbranch_vccnz L_gs_199
L_gb_198:
    v_mfma_f32_32x32x16_bf16 v[0:15], a[56:59], v[64:67], v[0:15]
    v_mfma_f32_32x32x16_bf16 v[16:31], a[56:59], v[68:71], v[16:31]
    v_mfma_f32_32x32x16_bf16 v[32:47], a[60:63], v[64:67], v[32:47]
    s_add_u32 s13, s13, 4096
    buffer_load_dwordx4 v[64:67], v123, s[52:55], s13 offen offset:0 sc1
    s_waitcnt vmcnt(11)
    v_max_u32 v121, v75, v79
    v_cmp_eq_u32 vcc, -1, v121
    v_mfma_f32_32x32x16_bf16 v[48:63], a[60:63], v[68:71], v[48:63]
    buffer_load_dwordx4 v[68:71], v122, s[52:55], s13 offen offset:0 sc1
    s_cbranch_vccnz L_gs_201
L_gb_200:
    v_mfma_f32_32x32x16_bf16 v[0:15], a[64:67], v[72:75], v[0:15]
    v_mfma_f32_32x32x16_bf16 v[16:31], a[64:67], v[76:79], v[16:31]
    v_mfma_f32_32x32x16_bf16 v[32:47], a[68:71], v[72:75], v[32:47]
    buffer_load_dwordx4 v[72:75], v123, s[52:55], s13 offen offset:2048 sc1
    s_waitcnt vmcnt(11)
    v_max_u32 v121, v83, v87
    v_cmp_eq_u32 vcc, -1, v121
    v_mfma_f32_32x32x16_bf16 v[48:63], a[68:71], v[76:79], v[48:63]
    buffer_load_dwordx4 v[76:79], v122, s[52:55], s13 offen offset:2048 sc1
    s_cbranch_vccnz L_gs_203
L_gb_202:
    v_mfma_f32_32x32x16_bf16 v[0:15], a[72:75], v[80:83], v[0:15]
    v_mfma_f32_32x32x16_bf16 v[16:31], a[72:75], v[84:87], v[16:31]
    v_mfma_f32_32x32x16_bf16 v[32:47], a[76:79], v[80:83], v[32:47]
    s_add_u32 s13, s13, 4096
    s_cmp_eq_u32 s13, s28
    s_cmov_b32 s13, s27
    buffer_load_dwordx4 v[80:83], v123, s[52:55], s13 offen offset:0 sc1
    s_waitcnt vmcnt(11)
    v_max_u32 v121, v91, v95
    v_cmp_eq_u32 vcc, -1, v121
    v_mfma_f32_32x32x16_bf16 v[48:63], a[76:79], v[84:87], v[48:63]
    buffer_load_dwordx4 v[84:87], v122, s[52:55], s13 offen offset:0 sc1
    s_cbranch_vccnz L_gs_205
L_gb_204:
    v_mfma_f32_32x32x16_bf16 v[0:15], a[80:83], v[88:91], v[0:15]
    v_mfma_f32_32x32x16_bf16 v[16:31], a[80:83], v[92:95], v[16:31]
    v_mfma_f32_32x32x16_bf16 v[32:47], a[84:87], v[88:91], v[32:47]
    buffer_load_dwordx4 v[88:91], v123, s[52:55], s13 offen offset:2048 sc1
    s_waitcnt vmcnt(11)
    v_max_u32 v121, v99, v103
    v_cmp_eq_u32 vcc, -1, v121
    v_mfma_f32_32x32x16_bf16 v[48:63], a[84:87], v[92:95], v[48:63]
    buffer_load_dwordx4 v[92:95], v122, s[52:55], s13 offen offset:2048 sc1
    s_cbranch_vccnz L_gs_207
L_gb_206:
    v_mfma_f32_32x32x16_bf16 v[0:15], a[88:91], v[96:99], v[0:15]
    v_mfma_f32_32x32x16_bf16 v[16:31], a[88:91], v[100:103], v[16:31]
    v_mfma_f32_32x32x16_bf16 v[32:47], a[92:95], v[96:99], v[32:47]
    s_add_u32 s13, s13, 4096
    buffer_load_dwordx4 v[96:99], v123, s[52:55], s13 offen offset:0 sc1
    s_waitcnt vmcnt(11)
    v_max_u32 v121, v107, v111
    v_cmp_eq_u32 vcc, -1, v121
    v_mfma_f32_32x32x16_bf16 v[48:63], a[92:95], v[100:103], v[48:63]
    buffer_load_dwordx4 v[100:103], v122, s[52:55], s13 offen offset:0 sc1
    s_cbranch_vccnz L_gs_209
L_gb_208:
    v_mfma_f32_32x32x16_bf16 v[0:15], a[96:99], v[104:107], v[0:15]
    v_mfma_f32_32x32x16_bf16 v[16:31], a[96:99], v[108:111], v[16:31]
    v_mfma_f32_32x32x16_bf16 v[32:47], a[100:103], v[104:107], v[32:47]
    buffer_load_dwordx4 v[104:107], v123, s[52:55], s13 offen offset:2048 sc1
    s_waitcnt vmcnt(11)
    v_max_u32 v121, v115, v119
    v_cmp_eq_u32 vcc, -1, v121
    v_mfma_f32_32x32x16_bf16 v[48:63], a[100:103], v[108:111], v[48:63]
    buffer_load_dwordx4 v[108:111], v122, s[52:55], s13 offen offset:2048 sc1
    s_cbranch_vccnz L_gs_211
L_gb_210:
    v_mfma_f32_32x32x16_bf16 v[0:15], a[104:107], v[112:115], v[0:15]
    v_mfma_f32_32x32x16_bf16 v[16:31], a[104:107], v[116:119], v[16:31]
    v_mfma_f32_32x32x16_bf16 v[32:47], a[108:111], v[112:115], v[32:47]
    s_add_u32 s13, s13, 4096
    s_cmp_eq_u32 s13, s28
    s_cmov_b32 s13, s27
    buffer_load_dwordx4 v[112:115], v123, s[52:55], s13 offen offset:0 sc1
    s_waitcnt vmcnt(11)
    v_max_u32 v121, v67, v71
    v_cmp_eq_u32 vcc, -1, v121
    v_mfma_f32_32x32x16_bf16 v[48:63], a[108:111], v[116:119], v[48:63]
    buffer_load_dwordx4 v[116:119], v122, s[52:55], s13 offen offset:0 sc1
    s_cbranch_vccnz L_gs_213
L_gb_212:
    v_mfma_f32_32x32x16_bf16 v[0:15], a[112:115], v[64:67], v[0:15]
    v_mfma_f32_32x32x16_bf16 v[16:31], a[112:115], v[68:71], v[16:31]
    v_mfma_f32_32x32x16_bf16 v[32:47], a[116:119], v[64:67], v[32:47]
    buffer_load_dwordx4 v[64:67], v123, s[52:55], s13 offen offset:2048 sc1
    s_waitcnt vmcnt(11)
    v_max_u32 v121, v75, v79
    v_cmp_eq_u32 vcc, -1, v121
    v_mfma_f32_32x32x16_bf16 v[48:63], a[116:119], v[68:71], v[48:63]
    buffer_load_dwordx4 v[68:71], v122, s[52:55], s13 offen offset:2048 sc1
    s_cbranch_vccnz L_gs_215
L_gb_214:
    v_mfma_f32_32x32x16_bf16 v[0:15], a[120:123], v[72:75], v[0:15]
    v_mfma_f32_32x32x16_bf16 v[16:31], a[120:123], v[76:79], v[16:31]
    v_mfma_f32_32x32x16_bf16 v[32:47], a[124:127], v[72:75], v[32:47]
    s_add_u32 s13, s13, 4096
    buffer_load_dwordx4 v[72:75], v123, s[52:55], s13 offen offset:0 sc1
    s_waitcnt vmcnt(11)
    v_max_u32 v121, v83, v87
    v_cmp_eq_u32 vcc, -1, v121
    v_mfma_f32_32x32x16_bf16 v[48:63], a[124:127], v[76:79], v[48:63]
    buffer_load_dwordx4 v[76:79], v122, s[52:55], s13 offen offset:0 sc1
    s_cbranch_vccnz L_gs_217
L_gb_216:
    v_mfma_f32_32x32x16_bf16 v[0:15], a[128:131], v[80:83], v[0:15]
    v_mfma_f32_32x32x16_bf16 v[16:31], a[128:131], v[84:87], v[16:31]
    v_mfma_f32_32x32x16_bf16 v[32:47], a[132:135], v[80:83], v[32:47]
    buffer_load_dwordx4 v[80:83], v123, s[52:55], s13 offen offset:2048 sc1
    s_waitcnt vmcnt(11)
    v_max_u32 v121, v91, v95
    v_cmp_eq_u32 vcc, -1, v121
    v_mfma_f32_32x32x16_bf16 v[48:63], a[132:135], v[84:87], v[48:63]
    buffer_load_dwordx4 v[84:87], v122, s[52:55], s13 offen offset:2048 sc1
    s_cbranch_vccnz L_gs_219
L_gb_218:
    v_mfma_f32_32x32x16_bf16 v[0:15], a[136:139], v[88:91], v[0:15]
    v_mfma_f32_32x32x16_bf16 v[16:31], a[136:139], v[92:95], v[16:31]
    v_mfma_f32_32x32x16_bf16 v[32:47], a[140:143], v[88:91], v[32:47]
    s_add_u32 s13, s13, 4096
    s_cmp_eq_u32 s13, s28
    s_cmov_b32 s13, s27
    buffer_load_dwordx4 v[88:91], v123, s[52:55], s13 offen offset:0 sc1
    s_waitcnt vmcnt(11)
    v_max_u32 v121, v99, v103
    v_cmp_eq_u32 vcc, -1, v121
    v_mfma_f32_32x32x16_bf16 v[48:63], a[140:143], v[92:95], v[48:63]
    buffer_load_dwordx4 v[92:95], v122, s[52:55], s13 offen offset:0 sc1
    s_cbranch_vccnz L_gs_221
L_gb_220:
    v_mfma_f32_32x32x16_bf16 v[0:15], a[144:147], v[96:99], v[0:15]
    v_mfma_f32_32x32x16_bf16 v[16:31], a[144:147], v[100:103], v[16:31]
    v_mfma_f32_32x32x16_bf16 v[32:47], a[148:151], v[96:99], v[32:47]
    buffer_load_dwordx4 v[96:99], v123, s[52:55], s13 offen offset:2048 sc1
    s_waitcnt vmcnt(11)
    v_max_u32 v121, v107, v111
    v_cmp_eq_u32 vcc, -1, v121
    v_mfma_f32_32x32x16_bf16 v[48:63], a[148:151], v[100:103], v[48:63]
    buffer_load_dwordx4 v[100:103], v122, s[52:55], s13 offen offset:2048 sc1
    s_cbranch_vccnz L_gs_223
L_gb_222:
    v_mfma_f32_32x32x16_bf16 v[0:15], a[152:155], v[104:107], v[0:15]
    v_mfma_f32_32x32x16_bf16 v[16:31], a[152:155], v[108:111], v[16:31]
    v_mfma_f32_32x32x16_bf16 v[32:47], a[156:159], v[104:107], v[32:47]
    s_add_u32 s13, s13, 4096
    buffer_load_dwordx4 v[104:107], v123, s[52:55], s13 offen offset:0 sc1
    s_waitcnt vmcnt(11)
    v_max_u32 v121, v115, v119
    v_cmp_eq_u32 vcc, -1, v121
    v_mfma_f32_32x32x16_bf16 v[48:63], a[156:159], v[108:111], v[48:63]
    buffer_load_dwordx4 v[108:111], v122, s[52:55], s13 offen offset:0 sc1
    s_cbranch_vccnz L_gs_225
L_gb_224:
    v_mfma_f32_32x32x16_bf16 v[0:15], a[160:163], v[112:115], v[0:15]
    v_mfma_f32_32x32x16_bf16 v[16:31], a[160:163], v[116:119], v[16:31]
    v_mfma_f32_32x32x16_bf16 v[32:47], a[164:167], v[112:115], v[32:47]
    buffer_load_dwordx4 v[112:115], v123, s[52:55], s13 offen offset:2048 sc1
    s_waitcnt vmcnt(11)
    v_max_u32 v121, v67, v71
    v_cmp_eq_u32 vcc, -1, v121
    v_mfma_f32_32x32x16_bf16 v[48:63], a[164:167], v[116:119], v[48:63]
    buffer_load_dwordx4 v[116:119], v122, s[52:55], s13 offen offset:2048 sc1
    s_cbranch_vccnz L_gs_227
L_gb_226:
    v_mfma_f32_32x32x16_bf16 v[0:15], a[168:171], v[64:67], v[0:15]
    v_mfma_f32_32x32x16_bf16 v[16:31], a[168:171], v[68:71], v[16:31]
    v_mfma_f32_32x32x16_bf16 v[32:47], a[172:175], v[64:67], v[32:47]
    s_add_u32 s13, s13, 4096
    s_cmp_eq_u32 s13, s28
    s_cmov_b32 s13, s27
    buffer_load_dwordx4 v[64:67], v123, s[52:55], s13 offen offset:0 sc1
    s_waitcnt vmcnt(11)
    v_max_u32 v121, v75, v79
    v_cmp_eq_u32 vcc, -1, v121
    v_mfma_f32_32x32x16_bf16 v[48:63], a[172:175], v[68:71], v[48:63]
    buffer_load_dwordx4 v[68:71], v122, s[52:55], s13 offen offset:0 sc1
    s_cbranch_vccnz L_gs_229
L_gb_228:
    v_mfma_f32_32x32x16_bf16 v[0:15], a[176:179], v[72:75], v[0:15]
    v_mfma_f32_32x32x16_bf16 v[16:31], a[176:179], v[76:79], v[16:31]
    v_mfma_f32_32x32x16_bf16 v[32:47], a[180:183], v[72:75], v[32:47]
    buffer_load_dwordx4 v[72:75], v123, s[52:55], s13 offen offset:2048 sc1
    s_waitcnt vmcnt(11)
    v_max_u32 v121, v83, v87
    v_cmp_eq_u32 vcc, -1, v121
    v_mfma_f32_32x32x16_bf16 v[48:63], a[180:183], v[76:79], v[48:63]
    buffer_load_dwordx4 v[76:79], v122, s[52:55], s13 offen offset:2048 sc1
    s_cbranch_vccnz L_gs_231
L_gb_230:
    v_mfma_f32_32x32x16_bf16 v[0:15], a[184:187], v[80:83], v[0:15]
    v_mfma_f32_32x32x16_bf16 v[16:31], a[184:187], v[84:87], v[16:31]
    v_mfma_f32_32x32x16_bf16 v[32:47], a[188:191], v[80:83], v[32:47]
    s_add_u32 s13, s13, 4096
    buffer_load_dwordx4 v[80:83], v123, s[52:55], s13 offen offset:0 sc1
    s_waitcnt vmcnt(11)
    v_max_u32 v121, v91, v95
    v_cmp_eq_u32 vcc, -1, v121
    v_mfma_f32_32x32x16_bf16 v[48:63], a[188:191], v[84:87], v[48:63]
    buffer_load_dwordx4 v[84:87], v122, s[52:55], s13 offen offset:0 sc1
    s_cbranch_vccnz L_gs_233
L_gb_232:
    v_mfma_f32_32x32x16_bf16 v[0:15], a[192:195], v[88:91], v[0:15]
    v_mfma_f32_32x32x16_bf16 v[16:31], a[192:195], v[92:95], v[16:31]
    v_mfma_f32_32x32x16_bf16 v[32:47], a[196:199], v[88:91], v[32:47]
    buffer_load_dwordx4 v[88:91], v123, s[52:55], s13 offen offset:2048 sc1
    s_waitcnt vmcnt(11)
    v_max_u32 v121, v99, v103
    v_cmp_eq_u32 vcc, -1, v121
    v_mfma_f32_32x32x16_bf16 v[48:63], a[196:199], v[92:95], v[48:63]
    buffer_load_dwordx4 v[92:95], v122, s[52:55], s13 offen offset:2048 sc1
    s_cbranch_vccnz L_gs_235
L_gb_234:
    v_mfma_f32_32x32x16_bf16 v[0:15], a[200:203], v[96:99], v[0:15]
    v_mfma_f32_32x32x16_bf16 v[16:31], a[200:203], v[100:103], v[16:31]
    v_mfma_f32_32x32x16_bf16 v[32:47], a[204:207], v[96:99], v[32:47]
    s_waitcnt vmcnt(10)
    v_max_u32 v121, v107, v111
    v_cmp_eq_u32 vcc, -1, v121
    v_mfma_f32_32x32x16_bf16 v[48:63], a[204:207], v[100:103], v[48:63]
    s_cbranch_vccnz L_gs_237
L_gb_236:
    v_mfma_f32_32x32x16_bf16 v[0:15], a[208:211], v[104:107], v[0:15]
    v_mfma_f32_32x32x16_bf16 v[16:31], a[208:211], v[108:111], v[16:31]
    v_mfma_f32_32x32x16_bf16 v[32:47], a[212:215], v[104:107], v[32:47]
    s_waitcnt vmcnt(8)
    v_max_u32 v121, v115, v119
    v_cmp_eq_u32 vcc, -1, v121
    v_mfma_f32_32x32x16_bf16 v[48:63], a[212:215], v[108:111], v[48:63]
    s_cbranch_vccnz L_gs_239
L_gb_238:
    v_mfma_f32_32x32x16_bf16 v[0:15], a[216:219], v[112:115], v[0:15]
    v_mfma_f32_32x32x16_bf16 v[16:31], a[216:219], v[116:119], v[16:31]
    v_mfma_f32_32x32x16_bf16 v[32:47], a[220:223], v[112:115], v[32:47]
    s_waitcnt vmcnt(6)
    v_max_u32 v121, v67, v71
    v_cmp_eq_u32 vcc, -1, v121
    v_mfma_f32_32x32x16_bf16 v[48:63], a[220:223], v[116:119], v[48:63]
    s_cbranch_vccnz L_gs_241
L_gb_240:
    v_mfma_f32_32x32x16_bf16 v[0:15], a[224:227], v[64:67], v[0:15]
    ds_read_b128 v[96:99], v126 offset:61440
    ds_read_b128 v[100:103], v126 offset:62464
    v_mfma_f32_32x32x16_bf16 v[16:31], a[224:227], v[68:71], v[16:31]
    v_mfma_f32_32x32x16_bf16 v[32:47], a[228:231], v[64:67], v[32:47]
    s_waitcnt vmcnt(4)
    v_max_u32 v121, v75, v79
    v_cmp_eq_u32 vcc, -1, v121
    v_mfma_f32_32x32x16_bf16 v[48:63], a[228:231], v[68:71], v[48:63]
    s_cbranch_vccnz L_gs_243
L_gb_242:
    v_mfma_f32_32x32x16_bf16 v[0:15], a[232:235], v[72:75], v[0:15]
    v_mfma_f32_32x32x16_bf16 v[16:31], a[232:235], v[76:79], v[16:31]
    v_mfma_f32_32x32x16_bf16 v[32:47], a[236:239], v[72:75], v[32:47]
    s_waitcnt vmcnt(2)
    v_max_u32 v121, v83, v87
    v_cmp_eq_u32 vcc, -1, v121
    v_mfma_f32_32x32x16_bf16 v[48:63], a[236:239], v[76:79], v[48:63]
    s_cbranch_vccnz L_gs_245
L_gb_244:
    v_mfma_f32_32x32x16_bf16 v[0:15], a[240:243], v[80:83], v[0:15]
    v_add_u32 v64, s23, v126
    v_add_u32 v65, s24, v126
    v_add_u32 v66, s25, v126
    v_add_u32 v67, s26, v126
    v_mfma_f32_32x32x16_bf16 v[16:31], a[240:243], v[84:87], v[16:31]
    v_mfma_f32_32x32x16_bf16 v[32:47], a[244:247], v[80:83], v[32:47]
    s_waitcnt vmcnt(0)
    v_max_u32 v121, v91, v95
    v_cmp_eq_u32 vcc, -1, v121
    v_mfma_f32_32x32x16_bf16 v[48:63], a[244:247], v[84:87], v[48:63]
    s_cbranch_vccnz L_gs_247
L_gb_246:
    v_mfma_f32_32x32x16_bf16 v[16:31], a[248:251], v[92:95], v[16:31]
    v_mfma_f32_32x32x16_bf16 v[32:47], a[252:255], v[88:91], v[32:47]
    v_mfma_f32_32x32x16_bf16 v[48:63], a[252:255], v[92:95], v[48:63]
    v_mfma_f32_32x32x16_bf16 v[0:15], a[248:251], v[88:91], v[0:15]
    v_mov_b32 v80, 0xc0135761
    s_mul_i32 s81, s8, 28
    s_add_u32 s81, s81, s9
    s_lshl_b32 s81, s81, 6
    s_lshl_b32 s82, s4, 15
    s_add_u32 s81, s81, s82
    s_add_u32 s81, s81, 3276800
    v_lshlrev_b32 v76, 12, v127
    v_and_b32 v76, 0x4000, v76
    v_cvt_pk_bf16_f32 v104, v16, v17
    v_cvt_pk_bf16_f32 v105, v18, v19
    v_cvt_pk_bf16_f32 v106, v20, v21
    v_cvt_pk_bf16_f32 v107, v22, v23
    ds_write_b128 v65, v[104:107] offset:33280
    v_and_b32 v72, 3, v127
    v_lshl_add_u32 v76, v72, 4, v76
    v_add_u32 v76, s81, v76
    v_cvt_pk_bf16_f32 v108, v24, v25
    v_cvt_pk_bf16_f32 v109, v26, v27
    v_cvt_pk_bf16_f32 v110, v28, v29
    v_cvt_pk_bf16_f32 v111, v30, v31
    ds_write_b128 v65, v[108:111] offset:34304
    v_mov_b32 v72, s14
    v_mov_b32 v73, s15
    v_mov_b32_e64 v74, s14
    v_cvt_pk_bf16_f32 v112, v32, v33
    v_cvt_pk_bf16_f32 v113, v34, v35
    v_cvt_pk_bf16_f32 v114, v36, v37
    v_cvt_pk_bf16_f32 v115, v38, v39
    ds_write_b128 v66, v[112:115] offset:35328
    v_mov_b32_e64 v75, s15
    v_cvt_pk_bf16_f32 v116, v40, v41
    v_cvt_pk_bf16_f32 v117, v42, v43
    v_cvt_pk_bf16_f32 v118, v44, v45
    v_cvt_pk_bf16_f32 v119, v46, v47
    ds_write_b128 v66, v[116:119] offset:36352
    v_cvt_pk_bf16_f32 v104, v48, v49
    v_cvt_pk_bf16_f32 v105, v50, v51
    v_cvt_pk_bf16_f32 v106, v52, v53
    v_cvt_pk_bf16_f32 v107, v54, v55
    ds_write_b128 v67, v[104:107] offset:37376
    v_cvt_pk_bf16_f32 v108, v56, v57
    v_cvt_pk_bf16_f32 v109, v58, v59
    v_cvt_pk_bf16_f32 v110, v60, v61
    v_cvt_pk_bf16_f32 v111, v62, v63
    ds_write_b128 v67, v[108:111] offset:38400
    s_waitcnt lgkmcnt(0)
    s_barrier
    ds_read_b128 v[16:19], v64 offset:33280
    ds_read_b128 v[24:27], v64 offset:35328
    ds_read_b128 v[32:35], v64 offset:37376
    ds_read_b128 v[20:23], v64 offset:34304
    ds_read_b128 v[28:31], v64 offset:36352
    ds_read_b128 v[36:39], v64 offset:38400
    s_mov_b64 exec, 0xff
    buffer_store_dwordx4 v[72:75], v76, s[52:55], 0 offen sc1
    s_mov_b64 exec, -1
    s_waitcnt lgkmcnt(5)
    s_nop 2
    v_mfma_f32_32x32x16_bf16 v[0:15], v[96:99], v[16:19], v[0:15]
    s_waitcnt lgkmcnt(4)
    v_mfma_f32_32x32x16_bf16 v[0:15], v[96:99], v[24:27], v[0:15]
    s_waitcnt lgkmcnt(3)
    v_mfma_f32_32x32x16_bf16 v[0:15], v[96:99], v[32:35], v[0:15]
    s_waitcnt lgkmcnt(2)
    v_mfma_f32_32x32x16_bf16 v[48:63], v[100:103], v[20:23], 0
    s_waitcnt lgkmcnt(1)
    v_mfma_f32_32x32x16_bf16 v[48:63], v[100:103], v[28:31], v[48:63]
    s_nop 7
    v_pk_mul_f32 v[16:17], v[0:1], v[0:1]
    v_pk_mul_f32 v[18:19], v[2:3], v[2:3]
    v_pk_mul_f32 v[20:21], v[4:5], v[4:5]
    s_waitcnt lgkmcnt(0)
    v_mfma_f32_32x32x16_bf16 v[48:63], v[100:103], v[36:39], v[48:63]
    v_pk_mul_f32 v[22:23], v[6:7], v[6:7]
    v_pk_fma_f32 v[16:17], v[16:17], s[34:35], v[80:81] op_sel_hi:[1,0,0]
    v_pk_fma_f32 v[18:19], v[18:19], s[34:35], v[80:81] op_sel_hi:[1,0,0]
    v_pk_fma_f32 v[20:21], v[20:21], s[34:35], v[80:81] op_sel_hi:[1,0,0]
    v_pk_fma_f32 v[22:23], v[22:23], s[34:35], v[80:81] op_sel_hi:[1,0,0]
    v_pk_mul_f32 v[16:17], v[16:17], v[0:1]
    v_pk_mul_f32 v[18:19], v[18:19], v[2:3]
    v_pk_mul_f32 v[20:21], v[20:21], v[4:5]
    v_pk_mul_f32 v[22:23], v[22:23], v[6:7]
    v_exp_f32 v16, v16
    v_exp_f32 v17, v17
    v_exp_f32 v18, v18
    v_exp_f32 v19, v19
    v_exp_f32 v20, v20
    v_exp_f32 v21, v21
    v_exp_f32 v22, v22
    v_exp_f32_e64 v23, v23
    v_pk_add_f32 v[16:17], v[16:17], 1.0 op_sel_hi:[1,0]
    v_pk_add_f32 v[18:19], v[18:19], 1.0 op_sel_hi:[1,0]
    v_pk_add_f32 v[20:21], v[20:21], 1.0 op_sel_hi:[1,0]
    v_pk_add_f32 v[22:23], v[22:23], 1.0 op_sel_hi:[1,0]
    v_rcp_f32 v16, v16
    v_rcp_f32 v17, v17
    v_rcp_f32 v18, v18
    v_rcp_f32 v19, v19
    v_rcp_f32 v20, v20
    v_rcp_f32 v21, v21
    v_rcp_f32 v22, v22
    v_rcp_f32 v23, v23
    v_pk_mul_f32 v[0:1], v[0:1], v[16:17]
    v_pk_mul_f32 v[2:3], v[2:3], v[18:19]
    v_pk_mul_f32 v[4:5], v[4:5], v[20:21]
    v_pk_mul_f32 v[6:7], v[6:7], v[22:23]
    v_cvt_pk_bf16_f32 v84, v0, v1
    v_cvt_pk_bf16_f32 v85, v2, v3
    v_cvt_pk_bf16_f32 v86, v4, v5
    v_cvt_pk_bf16_f32 v87, v6, v7
    buffer_store_dwordx4 v[84:87], v123, s[52:55], s21 offen offset:0 sc1
    v_pk_add_f32 v[8:9], v[8:9], v[56:57]
    v_pk_add_f32 v[10:11], v[10:11], v[58:59]
    v_pk_add_f32 v[12:13], v[12:13], v[60:61]
    v_pk_add_f32 v[14:15], v[14:15], v[62:63]
    v_pk_mul_f32 v[24:25], v[8:9], v[8:9]
    v_pk_mul_f32 v[26:27], v[10:11], v[10:11]
    v_pk_mul_f32 v[28:29], v[12:13], v[12:13]
    v_pk_mul_f32 v[30:31], v[14:15], v[14:15]
    v_pk_fma_f32 v[24:25], v[24:25], s[34:35], v[80:81] op_sel_hi:[1,0,0]
    v_pk_fma_f32 v[26:27], v[26:27], s[34:35], v[80:81] op_sel_hi:[1,0,0]
    v_pk_fma_f32 v[28:29], v[28:29], s[34:35], v[80:81] op_sel_hi:[1,0,0]
    v_pk_fma_f32 v[30:31], v[30:31], s[34:35], v[80:81] op_sel_hi:[1,0,0]
    v_pk_mul_f32 v[24:25], v[24:25], v[8:9]
    v_pk_mul_f32 v[26:27], v[26:27], v[10:11]
    v_pk_mul_f32 v[28:29], v[28:29], v[12:13]
    v_pk_mul_f32 v[30:31], v[30:31], v[14:15]
    v_exp_f32 v24, v24
    v_exp_f32 v25, v25
    v_exp_f32 v26, v26
    v_exp_f32 v27, v27
    v_exp_f32 v28, v28
    v_exp_f32 v29, v29
    v_exp_f32 v30, v30
    v_exp_f32 v31, v31
    v_pk_add_f32 v[24:25], v[24:25], 1.0 op_sel_hi:[1,0]
    v_pk_add_f32 v[26:27], v[26:27], 1.0 op_sel_hi:[1,0]
    v_pk_add_f32 v[28:29], v[28:29], 1.0 op_sel_hi:[1,0]
    v_pk_add_f32 v[30:31], v[30:31], 1.0 op_sel_hi:[1,0]
    v_rcp_f32 v24, v24
    v_rcp_f32 v25, v25
    v_rcp_f32 v26, v26
    v_rcp_f32 v27, v27
    v_rcp_f32 v28, v28
    v_rcp_f32 v29, v29
    v_rcp_f32 v30, v30
    v_rcp_f32 v31, v31
    v_pk_mul_f32 v[8:9], v[8:9], v[24:25]
    v_pk_mul_f32 v[10:11], v[10:11], v[26:27]
    v_pk_mul_f32 v[12:13], v[12:13], v[28:29]
    v_pk_mul_f32 v[14:15], v[14:15], v[30:31]
    v_cvt_pk_bf16_f32 v88, v8, v9
    v_cvt_pk_bf16_f32 v89, v10, v11
    v_cvt_pk_bf16_f32 v90, v12, v13
    v_cvt_pk_bf16_f32 v91, v14, v15
    buffer_store_dwordx4 v[88:91], v123, s[52:55], s21 offen offset:2048 sc1
    s_barrier
L_skip_181:
    s_cmp_eq_u32 s88, 0
    s_cbranch_scc1 L_skip_248
    s_and_b32 s81, s4, 1
    s_lshl_b32 s81, s81, 10
    v_add_u32 v123, s81, v126
    v_xor_b32 v122, 0x400, v123
    s_lshr_b32 s81, s4, 1
    s_lshl_b32 s81, s81, 5
    s_lshl_b32 s82, s11, 6
    s_add_u32 s50, s81, s82
    s_and_b32 s82, s4, 1
    s_lshl_b32 s82, s82, 5
    s_lshl_b32 s83, s10, 6
    s_add_u32 s51, s82, s83
    s_lshr_b32 s83, s50, 5
    s_mul_i32 s83, s83, 28800
    s_lshl_b32 s82, s51, 6
    s_add_u32 s20, s83, s82
    s_add_u32 s30, s20, 10485760
    v_and_b32 v16, 31, v127
    v_lshrrev_b32 v17, 5, v127
    s_lshl_b32 s81, s50, 1
    v_and_b32 v19, 3, v127
    s_lshl_b32 s31, s4, 11
    v_lshl_add_u32 v28, v16, 1, s81
    global_load_ushort v29, v28, s[42:43]
    v_bfe_u32 v31, v127, 2, 2
    v_lshl_add_u32 v31, v17, 2, v31
    v_lshlrev_b32_e64 v31, 6, v31
    v_bfe_u32 v30, v127, 4, 1
    v_lshl_add_u32 v31, v30, 5, v31
    v_lshl_add_u32 v31, v19, 3, v31
    v_add_u32 v31, s31, v31
    s_mul_i32 s81, s10, 28
    s_mul_i32 s82, s4, 7
    s_add_u32 s81, s81, s82
    v_min_u32 v44, 6, v127
    v_add_u32 v44, s81, v44
    v_mov_b32 v45, v44
    s_lshl_b32 s13, s81, 13
    s_add_u32 s13, s13, 14680064
    s_mul_i32 s81, s50, 896
    s_lshl_b32 s82, s51, 1
    s_add_u32 s21, s81, s82
    s_xor_b32 s24, s4, 1
    s_mul_i32 s24, s24, 6144
    s_xor_b32 s25, s4, 2
    s_mul_i32 s25, s25, 6144
    s_xor_b32 s26, s4, 3
    s_mul_i32 s26, s26, 6144
    s_mul_i32 s23, s4, 6144
    s_mov_b32 s27, s13
    s_add_u32 s28, s13, 57344
    s_lshl_b32 s81, s35, 13
    s_add_u32 s13, s13, s81
    s_mov_b32 s22, s13
    s_cmp_eq_u32 s87, 0
    s_cbranch_scc1 L_res_249
    s_mov_b32 m0, s31
    s_nop 0
    buffer_load_dwordx4 v126, s[52:55], s30 offen sc1 lds
    buffer_load_dwordx4 v126, s[52:55], s30 offen offset:1024 sc1 lds
    s_waitcnt vmcnt(0)
    ds_read_b64_tr_b16 v[20:21], v31 offset:0
    ds_read_b64_tr_b16 v[22:23], v31 offset:512
    ds_read_b64_tr_b16 v[24:25], v31 offset:1024
    ds_read_b64_tr_b16 v[26:27], v31 offset:1536
    v_lshlrev_b32 v40, 16, v29
    s_waitcnt lgkmcnt(3)
    v_lshlrev_b32 v0, 16, v20
    v_and_b32 v1, s0, v20
    v_pk_add_f32 v[0:1], v[0:1], v[40:41] op_sel_hi:[1,0]
    v_lshlrev_b32 v2, 16, v21
    v_and_b32 v3, s0, v21
    v_pk_add_f32 v[2:3], v[2:3], v[40:41] op_sel_hi:[1,0]
    s_waitcnt lgkmcnt(2)
    v_lshlrev_b32 v4, 16, v22
    v_and_b32 v5, s0, v22
    v_pk_add_f32 v[4:5], v[4:5], v[40:41] op_sel_hi:[1,0]
    v_lshlrev_b32 v6, 16, v23
    v_and_b32 v7, s0, v23
    v_pk_add_f32 v[6:7], v[6:7], v[40:41] op_sel_hi:[1,0]
    s_waitcnt lgkmcnt(1)
    v_lshlrev_b32 v8, 16, v24
    v_and_b32 v9, s0, v24
    v_pk_add_f32 v[8:9], v[8:9], v[40:41] op_sel_hi:[1,0]
    v_lshlrev_b32 v10, 16, v25
    v_and_b32 v11, s0, v25
    v_pk_add_f32 v[10:11], v[10:11], v[40:41] op_sel_hi:[1,0]
    s_waitcnt lgkmcnt(0)
    v_lshlrev_b32 v12, 16, v26
    v_and_b32 v13, s0, v26
    v_pk_add_f32 v[12:13], v[12:13], v[40:41] op_sel_hi:[1,0]
    v_lshlrev_b32 v14, 16, v27
    v_and_b32 v15, s0, v27
    v_pk_add_f32 v[14:15], v[14:15], v[40:41] op_sel_hi:[1,0]
    s_lshl_b32 s84, s5, 14
    s_add_u32 s84, s84, 3276800
    v_lshl_add_u32 v45, v45, 6, s84
    buffer_load_dwordx2 v[42:43], v45, s[52:55], 0 offen sc1
    s_waitcnt vmcnt(0)
    v_cmp_ne_u64 vcc, s[14:15], v[42:43]
    s_nop 0
    s_cbranch_vccz L_pok_251
    s_mov_b32 s85, 0
L_plp_252:
    buffer_load_dwordx2 v[42:43], v45, s[52:55], 0 offen sc1
    s_waitcnt vmcnt(0)
    v_cmp_ne_u64 vcc, s[14:15], v[42:43]
    s_add_u32 s85, s85, 1
    s_cbranch_vccz L_pok_251
    s_cmp_lt_u32 s85, 0x100000
    s_cbranch_scc1 L_plp_252
L_pok_251:
    s_branch L_resj_250
L_res_249:
    s_lshl_b32 s84, s5, 14
    s_add_u32 s84, s84, 3276800
    v_lshl_add_u32 v45, v45, 6, s84
    buffer_load_dwordx2 v[42:43], v45, s[52:55], 0 offen sc1
    s_waitcnt vmcnt(0)
    v_cmp_ne_u64 vcc, s[14:15], v[42:43]
    s_nop 0
    s_cbranch_vccz L_pok_253
    s_mov_b32 s85, 0
L_plp_254:
    buffer_load_dwordx2 v[42:43], v45, s[52:55], 0 offen sc1
    s_waitcnt vmcnt(0)
    v_cmp_ne_u64 vcc, s[14:15], v[42:43]
    s_add_u32 s85, s85, 1
    s_cbranch_vccz L_pok_253
    s_cmp_lt_u32 s85, 0x100000
    s_cbranch_scc1 L_plp_254
L_pok_253:
    s_mov_b32 m0, s31
    s_nop 0
    buffer_load_dwordx4 v126, s[52:55], s30 offen sc1 lds
    buffer_load_dwordx4 v126, s[52:55], s30 offen offset:1024 sc1 lds
    s_waitcnt vmcnt(0)
    ds_read_b64_tr_b16 v[20:21], v31 offset:0
    ds_read_b64_tr_b16 v[22:23], v31 offset:512
    ds_read_b64_tr_b16 v[24:25], v31 offset:1024
    ds_read_b64_tr_b16 v[26:27], v31 offset:1536
    v_lshlrev_b32 v40, 16, v29
    s_waitcnt lgkmcnt(3)
    v_lshlrev_b32 v0, 16, v20
    v_and_b32 v1, s0, v20
    v_pk_add_f32 v[0:1], v[0:1], v[40:41] op_sel_hi:[1,0]
    v_lshlrev_b32 v2, 16, v21
    v_and_b32 v3, s0, v21
    v_pk_add_f32 v[2:3], v[2:3], v[40:41] op_sel_hi:[1,0]
    s_waitcnt lgkmcnt(2)
    v_lshlrev_b32 v4, 16, v22
    v_and_b32 v5, s0, v22
    v_pk_add_f32 v[4:5], v[4:5], v[40:41] op_sel_hi:[1,0]
    v_lshlrev_b32 v6, 16, v23
    v_and_b32 v7, s0, v23
    v_pk_add_f32 v[6:7], v[6:7], v[40:41] op_sel_hi:[1,0]
    s_waitcnt lgkmcnt(1)
    v_lshlrev_b32 v8, 16, v24
    v_and_b32 v9, s0, v24
    v_pk_add_f32 v[8:9], v[8:9], v[40:41] op_sel_hi:[1,0]
    v_lshlrev_b32 v10, 16, v25
    v_and_b32 v11, s0, v25
    v_pk_add_f32 v[10:11], v[10:11], v[40:41] op_sel_hi:[1,0]
    s_waitcnt lgkmcnt(0)
    v_lshlrev_b32 v12, 16, v26
    v_and_b32 v13, s0, v26
    v_pk_add_f32 v[12:13], v[12:13], v[40:41] op_sel_hi:[1,0]
    v_lshlrev_b32 v14, 16, v27
    v_and_b32_e64 v15, s0, v27
    v_pk_add_f32 v[14:15], v[14:15], v[40:41] op_sel_hi:[1,0]
L_resj_250:
    s_mov_b32 s85, 0
    buffer_load_dwordx4 v[64:67], v123, s[52:55], s13 offen offset:0 sc1
    buffer_load_dwordx4 v[68:71], v122, s[52:55], s13 offen offset:0 sc1
    buffer_load_dwordx4 v[72:75], v123, s[52:55], s13 offen offset:2048 sc1
    buffer_load_dwordx4 v[76:79], v122, s[52:55], s13 offen offset:2048 sc1
    s_add_u32 s13, s13, 4096
    buffer_load_dwordx4 v[80:83], v123, s[52:55], s13 offen offset:0 sc1
    buffer_load_dwordx4 v[84:87], v122, s[52:55], s13 offen offset:0 sc1
    buffer_load_dwordx4 v[88:91], v123, s[52:55], s13 offen offset:2048 sc1
    buffer_load_dwordx4 v[92:95], v122, s[52:55], s13 offen offset:2048 sc1
    s_add_u32 s13, s13, 4096
    s_cmp_eq_u32 s13, s28
    s_cmov_b32 s13, s27
    buffer_load_dwordx4 v[96:99], v123, s[52:55], s13 offen offset:0 sc1
    buffer_load_dwordx4 v[100:103], v122, s[52:55], s13 offen offset:0 sc1
    s_waitcnt vmcnt(8)
    v_max_u32 v121, v67, v71
    v_cmp_eq_u32_e64 vcc, -1, v121
    s_nop 0
    s_cbranch_vccnz L_gs_256
L_gb_255:
    v_mfma_f32_32x32x16_bf16 v[0:15], v[64:67], v[128:131], v[0:15]
    v_mfma_f32_32x32x16_bf16 v[16:31], v[68:71], v[128:131], 0
    v_mfma_f32_32x32x16_bf16 v[32:47], v[64:67], v[132:135], 0
    buffer_load_dwordx4 v[64:67], v123, s[52:55], s13 offen offset:2048 sc1
    s_waitcnt vmcnt(7)
    v_max_u32 v121, v75, v79
    v_cmp_eq_u32 vcc, -1, v121
    v_mfma_f32_32x32x16_bf16 v[48:63], v[68:71], v[132:135], 0
    buffer_load_dwordx4 v[68:71], v122, s[52:55], s13 offen offset:2048 sc1
    s_cbranch_vccnz L_gs_258
L_gb_257:
    v_mfma_f32_32x32x16_bf16 v[0:15], v[72:75], v[136:139], v[0:15]
    v_mfma_f32_32x32x16_bf16 v[16:31], v[76:79], v[136:139], v[16:31]
    v_mfma_f32_32x32x16_bf16 v[32:47], v[72:75], v[140:143], v[32:47]
    s_add_u32 s13, s13, 4096
    buffer_load_dwordx4 v[72:75], v123, s[52:55], s13 offen offset:0 sc1
    s_waitcnt vmcnt(7)
    v_max_u32 v121, v83, v87
    v_cmp_eq_u32 vcc, -1, v121
    v_mfma_f32_32x32x16_bf16 v[48:63], v[76:79], v[140:143], v[48:63]
    buffer_load_dwordx4 v[76:79], v122, s[52:55], s13 offen offset:0 sc1
    s_cbranch_vccnz L_gs_260
L_gb_259:
    v_mfma_f32_32x32x16_bf16 v[0:15], v[80:83], v[144:147], v[0:15]
    v_mfma_f32_32x32x16_bf16 v[16:31], v[84:87], v[144:147], v[16:31]
    v_mfma_f32_32x32x16_bf16 v[32:47], v[80:83], v[148:151], v[32:47]
    buffer_load_dwordx4 v[80:83], v123, s[52:55], s13 offen offset:2048 sc1
    s_waitcnt vmcnt(7)
    v_max_u32 v121, v91, v95
    v_cmp_eq_u32 vcc, -1, v121
    v_mfma_f32_32x32x16_bf16 v[48:63], v[84:87], v[148:151], v[48:63]
    buffer_load_dwordx4 v[84:87], v122, s[52:55], s13 offen offset:2048 sc1
    s_cbranch_vccnz L_gs_262
L_gb_261:
    v_mfma_f32_32x32x16_bf16 v[0:15], v[88:91], v[152:155], v[0:15]
    v_mfma_f32_32x32x16_bf16 v[16:31], v[92:95], v[152:155], v[16:31]
    v_mfma_f32_32x32x16_bf16 v[32:47], v[88:91], v[156:159], v[32:47]
    s_add_u32 s13, s13, 4096
    s_cmp_eq_u32 s13, s28
    s_cmov_b32 s13, s27
    buffer_load_dwordx4 v[88:91], v123, s[52:55], s13 offen offset:0 sc1
    s_waitcnt vmcnt(7)
    v_max_u32 v121, v99, v103
    v_cmp_eq_u32 vcc, -1, v121
    v_mfma_f32_32x32x16_bf16 v[48:63], v[92:95], v[156:159], v[48:63]
    buffer_load_dwordx4 v[92:95], v122, s[52:55], s13 offen offset:0 sc1
    s_cbranch_vccnz L_gs_264
L_gb_263:
    v_mfma_f32_32x32x16_bf16 v[0:15], v[96:99], v[160:163], v[0:15]
    v_mfma_f32_32x32x16_bf16 v[16:31], v[100:103], v[160:163], v[16:31]
    v_mfma_f32_32x32x16_bf16 v[32:47], v[96:99], v[164:167], v[32:47]
    buffer_load_dwordx4 v[96:99], v123, s[52:55], s13 offen offset:2048 sc1
    s_waitcnt vmcnt(7)
    v_max_u32 v121, v67, v71
    v_cmp_eq_u32 vcc, -1, v121
    v_mfma_f32_32x32x16_bf16 v[48:63], v[100:103], v[164:167], v[48:63]
    buffer_load_dwordx4 v[100:103], v122, s[52:55], s13 offen offset:2048 sc1
    s_cbranch_vccnz L_gs_266
L_gb_265:
    v_mfma_f32_32x32x16_bf16 v[0:15], v[64:67], v[168:171], v[0:15]
    v_mfma_f32_32x32x16_bf16 v[16:31], v[68:71], v[168:171], v[16:31]
    v_mfma_f32_32x32x16_bf16 v[32:47], v[64:67], v[172:175], v[32:47]
    s_add_u32 s13, s13, 4096
    buffer_load_dwordx4 v[64:67], v123, s[52:55], s13 offen offset:0 sc1
    s_waitcnt vmcnt(7)
    v_max_u32 v121, v75, v79
    v_cmp_eq_u32 vcc, -1, v121
    v_mfma_f32_32x32x16_bf16 v[48:63], v[68:71], v[172:175], v[48:63]
    buffer_load_dwordx4 v[68:71], v122, s[52:55], s13 offen offset:0 sc1
    s_cbranch_vccnz L_gs_268
L_gb_267:
    v_mfma_f32_32x32x16_bf16 v[0:15], v[72:75], v[176:179], v[0:15]
    v_mfma_f32_32x32x16_bf16 v[16:31], v[76:79], v[176:179], v[16:31]
    v_mfma_f32_32x32x16_bf16 v[32:47], v[72:75], v[180:183], v[32:47]
    buffer_load_dwordx4 v[72:75], v123, s[52:55], s13 offen offset:2048 sc1
    s_waitcnt vmcnt(7)
    v_max_u32 v121, v83, v87
    v_cmp_eq_u32 vcc, -1, v121
    v_mfma_f32_32x32x16_bf16 v[48:63], v[76:79], v[180:183], v[48:63]
    buffer_load_dwordx4 v[76:79], v122, s[52:55], s13 offen offset:2048 sc1
    s_cbranch_vccnz L_gs_270
L_gb_269:
    v_mfma_f32_32x32x16_bf16 v[0:15], v[80:83], v[184:187], v[0:15]
    v_mfma_f32_32x32x16_bf16 v[16:31], v[84:87], v[184:187], v[16:31]
    v_mfma_f32_32x32x16_bf16 v[32:47], v[80:83], v[188:191], v[32:47]
    s_add_u32 s13, s13, 4096
    s_cmp_eq_u32 s13, s28
    s_cmov_b32 s13, s27
    buffer_load_dwordx4 v[80:83], v123, s[52:55], s13 offen offset:0 sc1
    s_waitcnt vmcnt(7)
    v_max_u32 v121, v91, v95
    v_cmp_eq_u32 vcc, -1, v121
    v_mfma_f32_32x32x16_bf16 v[48:63], v[84:87], v[188:191], v[48:63]
    buffer_load_dwordx4 v[84:87], v122, s[52:55], s13 offen offset:0 sc1
    s_cbranch_vccnz L_gs_272
L_gb_271:
    v_mfma_f32_32x32x16_bf16 v[0:15], v[88:91], v[192:195], v[0:15]
    v_mfma_f32_32x32x16_bf16 v[16:31], v[92:95], v[192:195], v[16:31]
    v_mfma_f32_32x32x16_bf16 v[32:47], v[88:91], v[196:199], v[32:47]
    buffer_load_dwordx4 v[88:91], v123, s[52:55], s13 offen offset:2048 sc1
    s_waitcnt vmcnt(7)
    v_max_u32 v121, v99, v103
    v_cmp_eq_u32 vcc, -1, v121
    v_mfma_f32_32x32x16_bf16 v[48:63], v[92:95], v[196:199], v[48:63]
    buffer_load_dwordx4 v[92:95], v122, s[52:55], s13 offen offset:2048 sc1
    s_cbranch_vccnz L_gs_274
L_gb_273:
    v_mfma_f32_32x32x16_bf16 v[0:15], v[96:99], v[200:203], v[0:15]
    v_mfma_f32_32x32x16_bf16 v[16:31], v[100:103], v[200:203], v[16:31]
    v_mfma_f32_32x32x16_bf16 v[32:47], v[96:99], v[204:207], v[32:47]
    s_add_u32 s13, s13, 4096
    buffer_load_dwordx4 v[96:99], v123, s[52:55], s13 offen offset:0 sc1
    s_waitcnt vmcnt(7)
    v_max_u32 v121, v67, v71
    v_cmp_eq_u32 vcc, -1, v121
    v_mfma_f32_32x32x16_bf16 v[48:63], v[100:103], v[204:207], v[48:63]
    buffer_load_dwordx4 v[100:103], v122, s[52:55], s13 offen offset:0 sc1
    s_cbranch_vccnz L_gs_276
L_gb_275:
    v_mfma_f32_32x32x16_bf16 v[0:15], v[64:67], v[208:211], v[0:15]
    v_mfma_f32_32x32x16_bf16 v[16:31], v[68:71], v[208:211], v[16:31]
    v_mfma_f32_32x32x16_bf16 v[32:47], v[64:67], v[212:215], v[32:47]
    buffer_load_dwordx4 v[64:67], v123, s[52:55], s13 offen offset:2048 sc1
    s_waitcnt vmcnt(7)
    v_max_u32 v121, v75, v79
    v_cmp_eq_u32 vcc, -1, v121
    v_mfma_f32_32x32x16_bf16 v[48:63], v[68:71], v[212:215], v[48:63]
    buffer_load_dwordx4 v[68:71], v122, s[52:55], s13 offen offset:2048 sc1
    s_cbranch_vccnz L_gs_278
L_gb_277:
    v_mfma_f32_32x32x16_bf16 v[0:15], v[72:75], v[216:219], v[0:15]
    v_mfma_f32_32x32x16_bf16 v[16:31], v[76:79], v[216:219], v[16:31]
    v_mfma_f32_32x32x16_bf16 v[32:47], v[72:75], v[220:223], v[32:47]
    s_add_u32 s13, s13, 4096
    s_cmp_eq_u32 s13, s28
    s_cmov_b32 s13, s27
    buffer_load_dwordx4 v[72:75], v123, s[52:55], s13 offen offset:0 sc1
    s_waitcnt vmcnt(7)
    v_max_u32 v121, v83, v87
    v_cmp_eq_u32 vcc, -1, v121
    v_mfma_f32_32x32x16_bf16 v[48:63], v[76:79], v[220:223], v[48:63]
    buffer_load_dwordx4 v[76:79], v122, s[52:55], s13 offen offset:0 sc1
    s_cbranch_vccnz L_gs_280
L_gb_279:
    v_mfma_f32_32x32x16_bf16 v[0:15], v[80:83], v[224:227], v[0:15]
    v_mfma_f32_32x32x16_bf16 v[16:31], v[84:87], v[224:227], v[16:31]
    v_mfma_f32_32x32x16_bf16 v[32:47], v[80:83], v[228:231], v[32:47]
    buffer_load_dwordx4 v[80:83], v123, s[52:55], s13 offen offset:2048 sc1
    s_waitcnt vmcnt(7)
    v_max_u32 v121, v91, v95
    v_cmp_eq_u32 vcc, -1, v121
    v_mfma_f32_32x32x16_bf16 v[48:63], v[84:87], v[228:231], v[48:63]
    buffer_load_dwordx4 v[84:87], v122, s[52:55], s13 offen offset:2048 sc1
    s_cbranch_vccnz L_gs_282
L_gb_281:
    v_mfma_f32_32x32x16_bf16 v[0:15], v[88:91], v[232:235], v[0:15]
    v_mfma_f32_32x32x16_bf16 v[16:31], v[92:95], v[232:235], v[16:31]
    v_mfma_f32_32x32x16_bf16 v[32:47], v[88:91], v[236:239], v[32:47]
    s_add_u32 s13, s13, 4096
    buffer_load_dwordx4 v[88:91], v123, s[52:55], s13 offen offset:0 sc1
    s_waitcnt vmcnt(7)
    v_max_u32 v121, v99, v103
    v_cmp_eq_u32 vcc, -1, v121
    v_mfma_f32_32x32x16_bf16 v[48:63], v[92:95], v[236:239], v[48:63]
    buffer_load_dwordx4 v[92:95], v122, s[52:55], s13 offen offset:0 sc1
    s_cbranch_vccnz L_gs_284
L_gb_283:
    v_mfma_f32_32x32x16_bf16 v[0:15], v[96:99], v[240:243], v[0:15]
    v_mfma_f32_32x32x16_bf16 v[16:31], v[100:103], v[240:243], v[16:31]
    v_mfma_f32_32x32x16_bf16 v[32:47], v[96:99], v[244:247], v[32:47]
    buffer_load_dwordx4 v[96:99], v123, s[52:55], s13 offen offset:2048 sc1
    s_waitcnt vmcnt(7)
    v_max_u32 v121, v67, v71
    v_cmp_eq_u32 vcc, -1, v121
    v_mfma_f32_32x32x16_bf16 v[48:63], v[100:103], v[244:247], v[48:63]
    buffer_load_dwordx4 v[100:103], v122, s[52:55], s13 offen offset:2048 sc1
    s_cbranch_vccnz L_gs_286
L_gb_285:
    v_mfma_f32_32x32x16_bf16 v[0:15], v[64:67], v[248:251], v[0:15]
    ds_read_b64_tr_b16 v[104:105], v125 offset:0
    v_mfma_f32_32x32x16_bf16 v[16:31], v[68:71], v[248:251], v[16:31]
    ds_read_b64_tr_b16 v[106:107], v125 offset:1024
    v_mfma_f32_32x32x16_bf16 v[32:47], v[64:67], v[252:255], v[32:47]
    ds_read_b64_tr_b16 v[108:109], v124 offset:0
    s_add_u32 s13, s13, 4096
    s_cmp_eq_u32 s13, s28
    s_cmov_b32 s13, s27
    buffer_load_dwordx4 v[64:67], v123, s[52:55], s13 offen offset:0 sc1
    s_waitcnt vmcnt(7)
    v_max_u32 v121, v75, v79
    v_cmp_eq_u32_e64 vcc, -1, v121
    v_mfma_f32_32x32x16_bf16 v[48:63], v[68:71], v[252:255], v[48:63]
    ds_read_b64_tr_b16 v[110:111], v124 offset:1024
    buffer_load_dwordx4 v[68:71], v122, s[52:55], s13 offen offset:0 sc1
    s_cbranch_vccnz L_gs_288
L_gb_287:
    s_waitcnt lgkmcnt(2)
    v_mfma_f32_32x32x16_bf16 v[0:15], v[72:75], v[104:107], v[0:15]
    ds_read_b64_tr_b16 v[112:113], v125 offset:2048
    v_mfma_f32_32x32x16_bf16 v[16:31], v[76:79], v[104:107], v[16:31]
    ds_read_b64_tr_b16 v[114:115], v125 offset:3072
    s_waitcnt lgkmcnt(2)
    v_mfma_f32_32x32x16_bf16 v[32:47], v[72:75], v[108:111], v[32:47]
    ds_read_b64_tr_b16 v[116:117], v124 offset:2048
    buffer_load_dwordx4 v[72:75], v123, s[52:55], s13 offen offset:2048 sc1
    s_waitcnt vmcnt(7)
    v_max_u32 v121, v83, v87
    v_cmp_eq_u32 vcc, -1, v121
    v_mfma_f32_32x32x16_bf16 v[48:63], v[76:79], v[108:111], v[48:63]
    ds_read_b64_tr_b16 v[118:119], v124 offset:3072
    buffer_load_dwordx4 v[76:79], v122, s[52:55], s13 offen offset:2048 sc1
    s_cbranch_vccnz L_gs_290
L_gb_289:
    s_waitcnt lgkmcnt(2)
    v_mfma_f32_32x32x16_bf16 v[0:15], v[80:83], v[112:115], v[0:15]
    ds_read_b64_tr_b16 v[104:105], v125 offset:4096
    v_mfma_f32_32x32x16_bf16 v[16:31], v[84:87], v[112:115], v[16:31]
    ds_read_b64_tr_b16 v[106:107], v125 offset:5120
    s_waitcnt lgkmcnt(2)
    v_mfma_f32_32x32x16_bf16 v[32:47], v[80:83], v[116:119], v[32:47]
    ds_read_b64_tr_b16 v[108:109], v124 offset:4096
    s_add_u32 s13, s13, 4096
    buffer_load_dwordx4 v[80:83], v123, s[52:55], s13 offen offset:0 sc1
    s_waitcnt vmcnt(7)
    v_max_u32 v121, v91, v95
    v_cmp_eq_u32 vcc, -1, v121
    v_mfma_f32_32x32x16_bf16 v[48:63], v[84:87], v[116:119], v[48:63]
    ds_read_b64_tr_b16 v[110:111], v124 offset:5120
    buffer_load_dwordx4 v[84:87], v122, s[52:55], s13 offen offset:0 sc1
    s_cbranch_vccnz L_gs_292
L_gb_291:
    s_waitcnt lgkmcnt(2)
    v_mfma_f32_32x32x16_bf16 v[0:15], v[88:91], v[104:107], v[0:15]
    ds_read_b64_tr_b16 v[112:113], v125 offset:6144
    v_mfma_f32_32x32x16_bf16 v[16:31], v[92:95], v[104:107], v[16:31]
    ds_read_b64_tr_b16 v[114:115], v125 offset:7168
    s_waitcnt lgkmcnt(2)
    v_mfma_f32_32x32x16_bf16 v[32:47], v[88:91], v[108:111], v[32:47]
    ds_read_b64_tr_b16 v[116:117], v124 offset:6144
    buffer_load_dwordx4 v[88:91], v123, s[52:55], s13 offen offset:2048 sc1
    s_waitcnt vmcnt(7)
    v_max_u32 v121, v99, v103
    v_cmp_eq_u32 vcc, -1, v121
    v_mfma_f32_32x32x16_bf16 v[48:63], v[92:95], v[108:111], v[48:63]
    ds_read_b64_tr_b16 v[118:119], v124 offset:7168
    buffer_load_dwordx4 v[92:95], v122, s[52:55], s13 offen offset:2048 sc1
    s_cbranch_vccnz L_gs_294
L_gb_293:
    s_waitcnt lgkmcnt(2)
    v_mfma_f32_32x32x16_bf16 v[0:15], v[96:99], v[112:115], v[0:15]
    ds_read_b64_tr_b16 v[104:105], v125 offset:8192
    v_mfma_f32_32x32x16_bf16 v[16:31], v[100:103], v[112:115], v[16:31]
    ds_read_b64_tr_b16 v[106:107], v125 offset:9216
    s_waitcnt lgkmcnt(2)
    v_mfma_f32_32x32x16_bf16 v[32:47], v[96:99], v[116:119], v[32:47]
    ds_read_b64_tr_b16 v[108:109], v124 offset:8192
    s_add_u32 s13, s13, 4096
    s_cmp_eq_u32 s13, s28
    s_cmov_b32 s13, s27
    buffer_load_dwordx4 v[96:99], v123, s[52:55], s13 offen offset:0 sc1
    s_waitcnt vmcnt(7)
    v_max_u32 v121, v67, v71
    v_cmp_eq_u32 vcc, -1, v121
    v_mfma_f32_32x32x16_bf16 v[48:63], v[100:103], v[116:119], v[48:63]
    ds_read_b64_tr_b16 v[110:111], v124 offset:9216
    buffer_load_dwordx4 v[100:103], v122, s[52:55], s13 offen offset:0 sc1
    s_cbranch_vccnz L_gs_296
L_gb_295:
    s_waitcnt lgkmcnt(2)
    v_mfma_f32_32x32x16_bf16 v[0:15], v[64:67], v[104:107], v[0:15]
    ds_read_b64_tr_b16 v[112:113], v125 offset:10240
    v_mfma_f32_32x32x16_bf16 v[16:31], v[68:71], v[104:107], v[16:31]
    ds_read_b64_tr_b16 v[114:115], v125 offset:11264
    s_waitcnt lgkmcnt(2)
    v_mfma_f32_32x32x16_bf16 v[32:47], v[64:67], v[108:111], v[32:47]
    ds_read_b64_tr_b16 v[116:117], v124 offset:10240
    buffer_load_dwordx4 v[64:67], v123, s[52:55], s13 offen offset:2048 sc1
    s_waitcnt vmcnt(7)
    v_max_u32 v121, v75, v79
    v_cmp_eq_u32 vcc, -1, v121
    v_mfma_f32_32x32x16_bf16 v[48:63], v[68:71], v[108:111], v[48:63]
    ds_read_b64_tr_b16 v[118:119], v124 offset:11264
    buffer_load_dwordx4 v[68:71], v122, s[52:55], s13 offen offset:2048 sc1
    s_cbranch_vccnz L_gs_298
L_gb_297:
    s_waitcnt lgkmcnt(2)
    v_mfma_f32_32x32x16_bf16 v[0:15], v[72:75], v[112:115], v[0:15]
    ds_read_b64_tr_b16 v[104:105], v125 offset:12288
    v_mfma_f32_32x32x16_bf16 v[16:31], v[76:79], v[112:115], v[16:31]
    ds_read_b64_tr_b16 v[106:107], v125 offset:13312
    s_waitcnt lgkmcnt(2)
    v_mfma_f32_32x32x16_bf16 v[32:47], v[72:75], v[116:119], v[32:47]
    ds_read_b64_tr_b16 v[108:109], v124 offset:12288
    s_add_u32 s13, s13, 4096
    buffer_load_dwordx4 v[72:75], v123, s[52:55], s13 offen offset:0 sc1
    s_waitcnt vmcnt(7)
    v_max_u32 v121, v83, v87
    v_cmp_eq_u32 vcc, -1, v121
    v_mfma_f32_32x32x16_bf16 v[48:63], v[76:79], v[116:119], v[48:63]
    ds_read_b64_tr_b16 v[110:111], v124 offset:13312
    buffer_load_dwordx4 v[76:79], v122, s[52:55], s13 offen offset:0 sc1
    s_cbranch_vccnz L_gs_300
L_gb_299:
    s_waitcnt lgkmcnt(2)
    v_mfma_f32_32x32x16_bf16 v[0:15], v[80:83], v[104:107], v[0:15]
    ds_read_b64_tr_b16 v[112:113], v125 offset:14336
    v_mfma_f32_32x32x16_bf16 v[16:31], v[84:87], v[104:107], v[16:31]
    ds_read_b64_tr_b16 v[114:115], v125 offset:15360
    s_waitcnt lgkmcnt(2)
    v_mfma_f32_32x32x16_bf16 v[32:47], v[80:83], v[108:111], v[32:47]
    ds_read_b64_tr_b16 v[116:117], v124 offset:14336
    buffer_load_dwordx4 v[80:83], v123, s[52:55], s13 offen offset:2048 sc1
    s_waitcnt vmcnt(7)
    v_max_u32 v121, v91, v95
    v_cmp_eq_u32 vcc, -1, v121
    v_mfma_f32_32x32x16_bf16 v[48:63], v[84:87], v[108:111], v[48:63]
    ds_read_b64_tr_b16 v[118:119], v124 offset:15360
    buffer_load_dwordx4 v[84:87], v122, s[52:55], s13 offen offset:2048 sc1
    s_cbranch_vccnz L_gs_302
L_gb_301:
    s_waitcnt lgkmcnt(2)
    v_mfma_f32_32x32x16_bf16 v[0:15], v[88:91], v[112:115], v[0:15]
    ds_read_b64_tr_b16 v[104:105], v125 offset:16384
    v_mfma_f32_32x32x16_bf16 v[16:31], v[92:95], v[112:115], v[16:31]
    ds_read_b64_tr_b16 v[106:107], v125 offset:17408
    s_waitcnt lgkmcnt(2)
    v_mfma_f32_32x32x16_bf16 v[32:47], v[88:91], v[116:119], v[32:47]
    ds_read_b64_tr_b16 v[108:109], v124 offset:16384
    s_waitcnt vmcnt(6)
    v_max_u32 v121, v99, v103
    v_cmp_eq_u32 vcc, -1, v121
    v_mfma_f32_32x32x16_bf16 v[48:63], v[92:95], v[116:119], v[48:63]
    ds_read_b64_tr_b16 v[110:111], v124 offset:17408
    s_cbranch_vccnz L_gs_304
L_gb_303:
    s_waitcnt lgkmcnt(2)
    v_mfma_f32_32x32x16_bf16 v[0:15], v[96:99], v[104:107], v[0:15]
    ds_read_b64_tr_b16 v[112:113], v125 offset:18432
    v_mfma_f32_32x32x16_bf16 v[16:31], v[100:103], v[104:107], v[16:31]
    ds_read_b64_tr_b16 v[114:115], v125 offset:19456
    s_waitcnt lgkmcnt(2)
    v_mfma_f32_32x32x16_bf16 v[32:47], v[96:99], v[108:111], v[32:47]
    ds_read_b64_tr_b16 v[116:117], v124 offset:18432
    s_waitcnt vmcnt(4)
    v_max_u32 v121, v67, v71
    v_cmp_eq_u32 vcc, -1, v121
    v_mfma_f32_32x32x16_bf16 v[48:63], v[100:103], v[108:111], v[48:63]
    ds_read_b64_tr_b16 v[118:119], v124 offset:19456
    s_cbranch_vccnz L_gs_306
L_gb_305:
    s_waitcnt lgkmcnt(2)
    v_mfma_f32_32x32x16_bf16 v[0:15], v[64:67], v[112:115], v[0:15]
    ds_read_b64_tr_b16 v[104:105], v125 offset:20480
    ds_read_b128 v[88:91], v126 offset:61440
    ds_read_b128 v[92:95], v126 offset:62464
    v_mfma_f32_32x32x16_bf16 v[16:31], v[68:71], v[112:115], v[16:31]
    ds_read_b64_tr_b16 v[106:107], v125 offset:21504
    s_waitcnt lgkmcnt(4)
    v_mfma_f32_32x32x16_bf16 v[32:47], v[64:67], v[116:119], v[32:47]
    ds_read_b64_tr_b16 v[108:109], v124 offset:20480
    s_waitcnt vmcnt(2)
    v_max_u32 v121, v75, v79
    v_cmp_eq_u32 vcc, -1, v121
    v_mfma_f32_32x32x16_bf16 v[48:63], v[68:71], v[116:119], v[48:63]
    ds_read_b64_tr_b16 v[110:111], v124 offset:21504
    s_cbranch_vccnz L_gs_308
L_gb_307:
    s_waitcnt lgkmcnt(2)
    v_mfma_f32_32x32x16_bf16 v[0:15], v[72:75], v[104:107], v[0:15]
    ds_read_b64_tr_b16 v[112:113], v125 offset:22528
    v_add_u32 v64, s23, v126
    v_add_u32 v65, s24, v126
    v_add_u32 v66, s25, v126
    v_add_u32 v67, s26, v126
    v_mfma_f32_32x32x16_bf16 v[16:31], v[76:79], v[104:107], v[16:31]
    ds_read_b64_tr_b16 v[114:115], v125 offset:23552
    s_waitcnt lgkmcnt(2)
    v_mfma_f32_32x32x16_bf16 v[32:47], v[72:75], v[108:111], v[32:47]
    ds_read_b64_tr_b16 v[116:117], v124 offset:22528
    s_waitcnt vmcnt(0)
    v_max_u32 v121, v83, v87
    v_cmp_eq_u32 vcc, -1, v121
    v_mfma_f32_32x32x16_bf16 v[48:63], v[76:79], v[108:111], v[48:63]
    ds_read_b64_tr_b16 v[118:119], v124 offset:23552
    s_cbranch_vccnz L_gs_310
L_gb_309:
    s_waitcnt lgkmcnt(2)
    v_mfma_f32_32x32x16_bf16 v[16:31], v[84:87], v[112:115], v[16:31]
    s_waitcnt lgkmcnt(0)
    v_mfma_f32_32x32x16_bf16 v[32:47], v[80:83], v[116:119], v[32:47]
    v_mfma_f32_32x32x16_bf16 v[48:63], v[84:87], v[116:119], v[48:63]
    v_mfma_f32_32x32x16_bf16 v[0:15], v[80:83], v[112:115], v[0:15]
    v_and_b32 v68, 31, v127
    v_lshrrev_b32 v69, 5, v127
    v_mul_u32_u24 v70, 896, v68
    v_lshl_add_u32 v70, v69, 4, v70
    s_nop 3
    v_cvt_pk_bf16_f32 v104, v16, v17
    v_cvt_pk_bf16_f32 v105, v18, v19
    v_cvt_pk_bf16_f32 v106, v20, v21
    v_cvt_pk_bf16_f32 v107, v22, v23
    ds_write_b128 v65, v[104:107] offset:33280
    v_cvt_pk_bf16_f32 v108, v24, v25
    v_cvt_pk_bf16_f32 v109, v26, v27
    v_cvt_pk_bf16_f32 v110, v28, v29
    v_cvt_pk_bf16_f32 v111, v30, v31
    ds_write_b128 v65, v[108:111] offset:34304
    v_cvt_pk_bf16_f32 v112, v32, v33
    v_cvt_pk_bf16_f32 v113, v34, v35
    v_cvt_pk_bf16_f32 v114, v36, v37
    v_cvt_pk_bf16_f32 v115, v38, v39
    ds_write_b128 v66, v[112:115] offset:35328
    v_cvt_pk_bf16_f32 v116, v40, v41
    v_cvt_pk_bf16_f32 v117, v42, v43
    v_cvt_pk_bf16_f32 v118, v44, v45
    v_cvt_pk_bf16_f32 v119, v46, v47
    ds_write_b128 v66, v[116:119] offset:36352
    v_cvt_pk_bf16_f32 v104, v48, v49
    v_cvt_pk_bf16_f32 v105, v50, v51
    v_cvt_pk_bf16_f32 v106, v52, v53
    v_cvt_pk_bf16_f32 v107, v54, v55
    ds_write_b128 v67, v[104:107] offset:37376
    v_cvt_pk_bf16_f32 v108, v56, v57
    v_cvt_pk_bf16_f32 v109, v58, v59
    v_cvt_pk_bf16_f32 v110, v60, v61
    v_cvt_pk_bf16_f32 v111, v62, v63
    ds_write_b128 v67, v[108:111] offset:38400
    s_waitcnt lgkmcnt(0)
    s_barrier
    ds_read_b128 v[16:19], v64 offset:33280
    ds_read_b128 v[20:23], v64 offset:34304
    ds_read_b128 v[24:27], v64 offset:35328
    ds_read_b128 v[28:31], v64 offset:36352
    ds_read_b128 v[32:35], v64 offset:37376
    ds_read_b128 v[36:39], v64 offset:38400
    s_waitcnt lgkmcnt(5)
    v_mfma_f32_32x32x16_bf16 v[0:15], v[88:91], v[16:19], v[0:15]
    s_waitcnt lgkmcnt(4)
    v_mfma_f32_32x32x16_bf16 v[0:15], v[92:95], v[20:23], v[0:15]
    s_waitcnt lgkmcnt(3)
    v_mfma_f32_32x32x16_bf16 v[0:15], v[88:91], v[24:27], v[0:15]
    s_waitcnt lgkmcnt(2)
    v_mfma_f32_32x32x16_bf16 v[0:15], v[92:95], v[28:31], v[0:15]
    s_waitcnt lgkmcnt(1)
    v_mfma_f32_32x32x16_bf16 v[0:15], v[88:91], v[32:35], v[0:15]
    s_waitcnt lgkmcnt(0)
    v_mfma_f32_32x32x16_bf16 v[0:15], v[92:95], v[36:39], v[0:15]
    s_nop 11
    v_cvt_pk_bf16_f32 v72, v0, v1
    v_cvt_pk_bf16_f32 v73, v2, v3
    v_cvt_pk_bf16_f32 v74, v4, v5
    v_cvt_pk_bf16_f32 v75, v6, v7
    s_nop 0
    v_permlane32_swap_b32 v72, v74
    v_permlane32_swap_b32 v73, v75
    buffer_store_dwordx4 v[72:75], v70, s[68:71], s21 offen offset:0
    v_cvt_pk_bf16_f32 v76, v8, v9
    v_cvt_pk_bf16_f32 v77, v10, v11
    v_cvt_pk_bf16_f32 v78, v12, v13
    v_cvt_pk_bf16_f32 v79, v14, v15
    s_nop 0
    v_permlane32_swap_b32 v76, v78
    v_permlane32_swap_b32 v77, v79
    buffer_store_dwordx4 v[76:79], v70, s[68:71], s21 offen offset:32
L_skip_248:
    s_endpgm
L_lns_21:
    s_add_u32 s85, s85, 1
    s_cmp_lt_u32 s85, 65536
    s_cbranch_scc1 L_lna_19
    s_branch L_lnb_20
L_gs_32:
    s_add_u32 s3, s22, 0
    s_cmp_ge_u32 s3, s28
    s_cselect_b32 s18, 65536, 0
    s_sub_u32 s3, s3, s18
    buffer_load_dwordx4 v[64:67], v123, s[52:55], s3 offen sc1
    buffer_load_dwordx4 v[68:71], v122, s[52:55], s3 offen sc1
    s_add_u32 s3, s22, 2048
    s_cmp_ge_u32 s3, s28
    s_cselect_b32 s18, 65536, 0
    s_sub_u32 s3, s3, s18
    buffer_load_dwordx4 v[72:75], v123, s[52:55], s3 offen sc1
    buffer_load_dwordx4 v[76:79], v122, s[52:55], s3 offen sc1
    s_add_u32 s3, s22, 4096
    s_cmp_ge_u32 s3, s28
    s_cselect_b32 s18, 65536, 0
    s_sub_u32 s3, s3, s18
    buffer_load_dwordx4 v[80:83], v123, s[52:55], s3 offen sc1
    buffer_load_dwordx4 v[84:87], v122, s[52:55], s3 offen sc1
    s_add_u32 s3, s22, 6144
    s_cmp_ge_u32 s3, s28
    s_cselect_b32 s18, 65536, 0
    s_sub_u32 s3, s3, s18
    buffer_load_dwordx4 v[88:91], v123, s[52:55], s3 offen sc1
    buffer_load_dwordx4 v[92:95], v122, s[52:55], s3 offen sc1
    s_waitcnt vmcnt(0)
    v_max_u32 v121, v67, v71
    v_cmp_eq_u32 vcc, -1, v121
    s_add_u32 s85, s85, 1
    s_cbranch_vccz L_gb_31
    s_cmp_lt_u32 s85, 65536
    s_cbranch_scc1 L_gs_32
    s_branch L_gb_31
L_gs_34:
    s_add_u32 s3, s22, 2048
    s_cmp_ge_u32 s3, s28
    s_cselect_b32 s18, 65536, 0
    s_sub_u32 s3, s3, s18
    buffer_load_dwordx4 v[72:75], v123, s[52:55], s3 offen sc1
    buffer_load_dwordx4 v[76:79], v122, s[52:55], s3 offen sc1
    s_add_u32 s3, s22, 4096
    s_cmp_ge_u32 s3, s28
    s_cselect_b32 s18, 65536, 0
    s_sub_u32 s3, s3, s18
    buffer_load_dwordx4 v[80:83], v123, s[52:55], s3 offen sc1
    buffer_load_dwordx4 v[84:87], v122, s[52:55], s3 offen sc1
    s_add_u32 s3, s22, 6144
    s_cmp_ge_u32 s3, s28
    s_cselect_b32 s18, 65536, 0
    s_sub_u32 s3, s3, s18
    buffer_load_dwordx4 v[88:91], v123, s[52:55], s3 offen sc1
    buffer_load_dwordx4 v[92:95], v122, s[52:55], s3 offen sc1
    s_add_u32 s3, s22, 8192
    s_cmp_ge_u32 s3, s28
    s_cselect_b32 s18, 65536, 0
    s_sub_u32 s3, s3, s18
    buffer_load_dwordx4 v[96:99], v123, s[52:55], s3 offen sc1
    buffer_load_dwordx4 v[100:103], v122, s[52:55], s3 offen sc1
    s_waitcnt vmcnt(0)
    v_max_u32 v121, v75, v79
    v_cmp_eq_u32 vcc, -1, v121
    s_add_u32 s85, s85, 1
    s_cbranch_vccz L_gb_33
    s_cmp_lt_u32 s85, 65536
    s_cbranch_scc1 L_gs_34
    s_branch L_gb_33
L_gs_36:
    s_add_u32 s3, s22, 4096
    s_cmp_ge_u32 s3, s28
    s_cselect_b32 s18, 65536, 0
    s_sub_u32 s3, s3, s18
    buffer_load_dwordx4 v[80:83], v123, s[52:55], s3 offen sc1
    buffer_load_dwordx4 v[84:87], v122, s[52:55], s3 offen sc1
    s_add_u32 s3, s22, 6144
    s_cmp_ge_u32 s3, s28
    s_cselect_b32 s18, 65536, 0
    s_sub_u32 s3, s3, s18
    buffer_load_dwordx4 v[88:91], v123, s[52:55], s3 offen sc1
    buffer_load_dwordx4 v[92:95], v122, s[52:55], s3 offen sc1
    s_add_u32 s3, s22, 8192
    s_cmp_ge_u32 s3, s28
    s_cselect_b32 s18, 65536, 0
    s_sub_u32 s3, s3, s18
    buffer_load_dwordx4 v[96:99], v123, s[52:55], s3 offen sc1
    buffer_load_dwordx4 v[100:103], v122, s[52:55], s3 offen sc1
    s_add_u32 s3, s22, 10240
    s_cmp_ge_u32 s3, s28
    s_cselect_b32 s18, 65536, 0
    s_sub_u32 s3, s3, s18
    buffer_load_dwordx4 v[104:107], v123, s[52:55], s3 offen sc1
    buffer_load_dwordx4 v[108:111], v122, s[52:55], s3 offen sc1
    s_waitcnt vmcnt(0)
    v_max_u32 v121, v83, v87
    v_cmp_eq_u32 vcc, -1, v121
    s_add_u32 s85, s85, 1
    s_cbranch_vccz L_gb_35
    s_cmp_lt_u32 s85, 65536
    s_cbranch_scc1 L_gs_36
    s_branch L_gb_35
L_gs_38:
    s_add_u32 s3, s22, 6144
    s_cmp_ge_u32 s3, s28
    s_cselect_b32 s18, 65536, 0
    s_sub_u32 s3, s3, s18
    buffer_load_dwordx4 v[88:91], v123, s[52:55], s3 offen sc1
    buffer_load_dwordx4 v[92:95], v122, s[52:55], s3 offen sc1
    s_add_u32 s3, s22, 8192
    s_cmp_ge_u32 s3, s28
    s_cselect_b32 s18, 65536, 0
    s_sub_u32 s3, s3, s18
    buffer_load_dwordx4 v[96:99], v123, s[52:55], s3 offen sc1
    buffer_load_dwordx4 v[100:103], v122, s[52:55], s3 offen sc1
    s_add_u32 s3, s22, 10240
    s_cmp_ge_u32 s3, s28
    s_cselect_b32 s18, 65536, 0
    s_sub_u32 s3, s3, s18
    buffer_load_dwordx4 v[104:107], v123, s[52:55], s3 offen sc1
    buffer_load_dwordx4 v[108:111], v122, s[52:55], s3 offen sc1
    s_add_u32 s3, s22, 12288
    s_cmp_ge_u32 s3, s28
    s_cselect_b32 s18, 65536, 0
    s_sub_u32 s3, s3, s18
    buffer_load_dwordx4 v[112:115], v123, s[52:55], s3 offen sc1
    buffer_load_dwordx4 v[116:119], v122, s[52:55], s3 offen sc1
    s_waitcnt vmcnt(0)
    v_max_u32 v121, v91, v95
    v_cmp_eq_u32 vcc, -1, v121
    s_add_u32 s85, s85, 1
    s_cbranch_vccz L_gb_37
    s_cmp_lt_u32 s85, 65536
    s_cbranch_scc1 L_gs_38
    s_branch L_gb_37
L_gs_40:
    s_add_u32 s3, s22, 8192
    s_cmp_ge_u32 s3, s28
    s_cselect_b32 s18, 65536, 0
    s_sub_u32 s3, s3, s18
    buffer_load_dwordx4 v[96:99], v123, s[52:55], s3 offen sc1
    buffer_load_dwordx4 v[100:103], v122, s[52:55], s3 offen sc1
    s_add_u32 s3, s22, 10240
    s_cmp_ge_u32 s3, s28
    s_cselect_b32 s18, 65536, 0
    s_sub_u32 s3, s3, s18
    buffer_load_dwordx4 v[104:107], v123, s[52:55], s3 offen sc1
    buffer_load_dwordx4 v[108:111], v122, s[52:55], s3 offen sc1
    s_add_u32 s3, s22, 12288
    s_cmp_ge_u32 s3, s28
    s_cselect_b32 s18, 65536, 0
    s_sub_u32 s3, s3, s18
    buffer_load_dwordx4 v[112:115], v123, s[52:55], s3 offen sc1
    buffer_load_dwordx4 v[116:119], v122, s[52:55], s3 offen sc1
    s_add_u32 s3, s22, 14336
    s_cmp_ge_u32 s3, s28
    s_cselect_b32 s18, 65536, 0
    s_sub_u32 s3, s3, s18
    buffer_load_dwordx4 v[64:67], v123, s[52:55], s3 offen sc1
    buffer_load_dwordx4 v[68:71], v122, s[52:55], s3 offen sc1
    s_waitcnt vmcnt(0)
    v_max_u32 v121, v99, v103
    v_cmp_eq_u32 vcc, -1, v121
    s_add_u32 s85, s85, 1
    s_cbranch_vccz L_gb_39
    s_cmp_lt_u32 s85, 65536
    s_cbranch_scc1 L_gs_40
    s_branch L_gb_39
L_gs_42:
    s_add_u32 s3, s22, 10240
    s_cmp_ge_u32 s3, s28
    s_cselect_b32 s18, 65536, 0
    s_sub_u32 s3, s3, s18
    buffer_load_dwordx4 v[104:107], v123, s[52:55], s3 offen sc1
    buffer_load_dwordx4 v[108:111], v122, s[52:55], s3 offen sc1
    s_add_u32 s3, s22, 12288
    s_cmp_ge_u32 s3, s28
    s_cselect_b32 s18, 65536, 0
    s_sub_u32 s3, s3, s18
    buffer_load_dwordx4 v[112:115], v123, s[52:55], s3 offen sc1
    buffer_load_dwordx4 v[116:119], v122, s[52:55], s3 offen sc1
    s_add_u32 s3, s22, 14336
    s_cmp_ge_u32 s3, s28
    s_cselect_b32 s18, 65536, 0
    s_sub_u32 s3, s3, s18
    buffer_load_dwordx4 v[64:67], v123, s[52:55], s3 offen sc1
    buffer_load_dwordx4 v[68:71], v122, s[52:55], s3 offen sc1
    s_add_u32 s3, s22, 16384
    s_cmp_ge_u32 s3, s28
    s_cselect_b32 s18, 65536, 0
    s_sub_u32 s3, s3, s18
    buffer_load_dwordx4 v[72:75], v123, s[52:55], s3 offen sc1
    buffer_load_dwordx4 v[76:79], v122, s[52:55], s3 offen sc1
    s_waitcnt vmcnt(0)
    v_max_u32 v121, v107, v111
    v_cmp_eq_u32 vcc, -1, v121
    s_add_u32 s85, s85, 1
    s_cbranch_vccz L_gb_41
    s_cmp_lt_u32 s85, 65536
    s_cbranch_scc1 L_gs_42
    s_branch L_gb_41
L_gs_44:
    s_add_u32 s3, s22, 12288
    s_cmp_ge_u32 s3, s28
    s_cselect_b32 s18, 65536, 0
    s_sub_u32 s3, s3, s18
    buffer_load_dwordx4 v[112:115], v123, s[52:55], s3 offen sc1
    buffer_load_dwordx4 v[116:119], v122, s[52:55], s3 offen sc1
    s_add_u32 s3, s22, 14336
    s_cmp_ge_u32 s3, s28
    s_cselect_b32 s18, 65536, 0
    s_sub_u32 s3, s3, s18
    buffer_load_dwordx4 v[64:67], v123, s[52:55], s3 offen sc1
    buffer_load_dwordx4 v[68:71], v122, s[52:55], s3 offen sc1
    s_add_u32 s3, s22, 16384
    s_cmp_ge_u32 s3, s28
    s_cselect_b32 s18, 65536, 0
    s_sub_u32 s3, s3, s18
    buffer_load_dwordx4 v[72:75], v123, s[52:55], s3 offen sc1
    buffer_load_dwordx4 v[76:79], v122, s[52:55], s3 offen sc1
    s_add_u32 s3, s22, 18432
    s_cmp_ge_u32 s3, s28
    s_cselect_b32 s18, 65536, 0
    s_sub_u32 s3, s3, s18
    buffer_load_dwordx4 v[80:83], v123, s[52:55], s3 offen sc1
    buffer_load_dwordx4 v[84:87], v122, s[52:55], s3 offen sc1
    s_waitcnt vmcnt(0)
    v_max_u32 v121, v115, v119
    v_cmp_eq_u32 vcc, -1, v121
    s_add_u32 s85, s85, 1
    s_cbranch_vccz L_gb_43
    s_cmp_lt_u32 s85, 65536
    s_cbranch_scc1 L_gs_44
    s_branch L_gb_43
L_gs_46:
    s_add_u32 s3, s22, 14336
    s_cmp_ge_u32 s3, s28
    s_cselect_b32 s18, 65536, 0
    s_sub_u32 s3, s3, s18
    buffer_load_dwordx4 v[64:67], v123, s[52:55], s3 offen sc1
    buffer_load_dwordx4 v[68:71], v122, s[52:55], s3 offen sc1
    s_add_u32 s3, s22, 16384
    s_cmp_ge_u32 s3, s28
    s_cselect_b32 s18, 65536, 0
    s_sub_u32 s3, s3, s18
    buffer_load_dwordx4 v[72:75], v123, s[52:55], s3 offen sc1
    buffer_load_dwordx4 v[76:79], v122, s[52:55], s3 offen sc1
    s_add_u32 s3, s22, 18432
    s_cmp_ge_u32 s3, s28
    s_cselect_b32 s18, 65536, 0
    s_sub_u32 s3, s3, s18
    buffer_load_dwordx4 v[80:83], v123, s[52:55], s3 offen sc1
    buffer_load_dwordx4 v[84:87], v122, s[52:55], s3 offen sc1
    s_add_u32 s3, s22, 20480
    s_cmp_ge_u32 s3, s28
    s_cselect_b32 s18, 65536, 0
    s_sub_u32 s3, s3, s18
    buffer_load_dwordx4 v[88:91], v123, s[52:55], s3 offen sc1
    buffer_load_dwordx4 v[92:95], v122, s[52:55], s3 offen sc1
    s_waitcnt vmcnt(0)
    v_max_u32 v121, v67, v71
    v_cmp_eq_u32 vcc, -1, v121
    s_add_u32 s85, s85, 1
    s_cbranch_vccz L_gb_45
    s_cmp_lt_u32 s85, 65536
    s_cbranch_scc1 L_gs_46
    s_branch L_gb_45
L_gs_48:
    s_add_u32 s3, s22, 16384
    s_cmp_ge_u32 s3, s28
    s_cselect_b32 s18, 65536, 0
    s_sub_u32 s3, s3, s18
    buffer_load_dwordx4 v[72:75], v123, s[52:55], s3 offen sc1
    buffer_load_dwordx4 v[76:79], v122, s[52:55], s3 offen sc1
    s_add_u32 s3, s22, 18432
    s_cmp_ge_u32 s3, s28
    s_cselect_b32 s18, 65536, 0
    s_sub_u32 s3, s3, s18
    buffer_load_dwordx4 v[80:83], v123, s[52:55], s3 offen sc1
    buffer_load_dwordx4 v[84:87], v122, s[52:55], s3 offen sc1
    s_add_u32 s3, s22, 20480
    s_cmp_ge_u32 s3, s28
    s_cselect_b32 s18, 65536, 0
    s_sub_u32 s3, s3, s18
    buffer_load_dwordx4 v[88:91], v123, s[52:55], s3 offen sc1
    buffer_load_dwordx4 v[92:95], v122, s[52:55], s3 offen sc1
    s_add_u32 s3, s22, 22528
    s_cmp_ge_u32 s3, s28
    s_cselect_b32 s18, 65536, 0
    s_sub_u32 s3, s3, s18
    buffer_load_dwordx4 v[96:99], v123, s[52:55], s3 offen sc1
    buffer_load_dwordx4 v[100:103], v122, s[52:55], s3 offen sc1
    s_waitcnt vmcnt(0)
    v_max_u32 v121, v75, v79
    v_cmp_eq_u32 vcc, -1, v121
    s_add_u32 s85, s85, 1
    s_cbranch_vccz L_gb_47
    s_cmp_lt_u32 s85, 65536
    s_cbranch_scc1 L_gs_48
    s_branch L_gb_47
L_gs_50:
    s_add_u32 s3, s22, 18432
    s_cmp_ge_u32 s3, s28
    s_cselect_b32 s18, 65536, 0
    s_sub_u32 s3, s3, s18
    buffer_load_dwordx4 v[80:83], v123, s[52:55], s3 offen sc1
    buffer_load_dwordx4 v[84:87], v122, s[52:55], s3 offen sc1
    s_add_u32 s3, s22, 20480
    s_cmp_ge_u32 s3, s28
    s_cselect_b32 s18, 65536, 0
    s_sub_u32 s3, s3, s18
    buffer_load_dwordx4 v[88:91], v123, s[52:55], s3 offen sc1
    buffer_load_dwordx4 v[92:95], v122, s[52:55], s3 offen sc1
    s_add_u32 s3, s22, 22528
    s_cmp_ge_u32 s3, s28
    s_cselect_b32 s18, 65536, 0
    s_sub_u32 s3, s3, s18
    buffer_load_dwordx4 v[96:99], v123, s[52:55], s3 offen sc1
    buffer_load_dwordx4 v[100:103], v122, s[52:55], s3 offen sc1
    s_add_u32 s3, s22, 24576
    s_cmp_ge_u32 s3, s28
    s_cselect_b32 s18, 65536, 0
    s_sub_u32 s3, s3, s18
    buffer_load_dwordx4 v[104:107], v123, s[52:55], s3 offen sc1
    buffer_load_dwordx4 v[108:111], v122, s[52:55], s3 offen sc1
    s_waitcnt vmcnt(0)
    v_max_u32 v121, v83, v87
    v_cmp_eq_u32 vcc, -1, v121
    s_add_u32 s85, s85, 1
    s_cbranch_vccz L_gb_49
    s_cmp_lt_u32 s85, 65536
    s_cbranch_scc1 L_gs_50
    s_branch L_gb_49
L_gs_52:
    s_add_u32 s3, s22, 20480
    s_cmp_ge_u32 s3, s28
    s_cselect_b32 s18, 65536, 0
    s_sub_u32 s3, s3, s18
    buffer_load_dwordx4 v[88:91], v123, s[52:55], s3 offen sc1
    buffer_load_dwordx4 v[92:95], v122, s[52:55], s3 offen sc1
    s_add_u32 s3, s22, 22528
    s_cmp_ge_u32 s3, s28
    s_cselect_b32 s18, 65536, 0
    s_sub_u32 s3, s3, s18
    buffer_load_dwordx4 v[96:99], v123, s[52:55], s3 offen sc1
    buffer_load_dwordx4 v[100:103], v122, s[52:55], s3 offen sc1
    s_add_u32 s3, s22, 24576
    s_cmp_ge_u32 s3, s28
    s_cselect_b32 s18, 65536, 0
    s_sub_u32 s3, s3, s18
    buffer_load_dwordx4 v[104:107], v123, s[52:55], s3 offen sc1
    buffer_load_dwordx4 v[108:111], v122, s[52:55], s3 offen sc1
    s_add_u32 s3, s22, 26624
    s_cmp_ge_u32 s3, s28
    s_cselect_b32 s18, 65536, 0
    s_sub_u32 s3, s3, s18
    buffer_load_dwordx4 v[112:115], v123, s[52:55], s3 offen sc1
    buffer_load_dwordx4 v[116:119], v122, s[52:55], s3 offen sc1
    s_waitcnt vmcnt(0)
    v_max_u32 v121, v91, v95
    v_cmp_eq_u32 vcc, -1, v121
    s_add_u32 s85, s85, 1
    s_cbranch_vccz L_gb_51
    s_cmp_lt_u32 s85, 65536
    s_cbranch_scc1 L_gs_52
    s_branch L_gb_51
L_gs_54:
    s_add_u32 s3, s22, 22528
    s_cmp_ge_u32 s3, s28
    s_cselect_b32 s18, 65536, 0
    s_sub_u32 s3, s3, s18
    buffer_load_dwordx4 v[96:99], v123, s[52:55], s3 offen sc1
    buffer_load_dwordx4 v[100:103], v122, s[52:55], s3 offen sc1
    s_add_u32 s3, s22, 24576
    s_cmp_ge_u32 s3, s28
    s_cselect_b32 s18, 65536, 0
    s_sub_u32 s3, s3, s18
    buffer_load_dwordx4 v[104:107], v123, s[52:55], s3 offen sc1
    buffer_load_dwordx4 v[108:111], v122, s[52:55], s3 offen sc1
    s_add_u32 s3, s22, 26624
    s_cmp_ge_u32 s3, s28
    s_cselect_b32 s18, 65536, 0
    s_sub_u32 s3, s3, s18
    buffer_load_dwordx4 v[112:115], v123, s[52:55], s3 offen sc1
    buffer_load_dwordx4 v[116:119], v122, s[52:55], s3 offen sc1
    s_add_u32 s3, s22, 28672
    s_cmp_ge_u32 s3, s28
    s_cselect_b32 s18, 65536, 0
    s_sub_u32 s3, s3, s18
    buffer_load_dwordx4 v[64:67], v123, s[52:55], s3 offen sc1
    buffer_load_dwordx4 v[68:71], v122, s[52:55], s3 offen sc1
    s_waitcnt vmcnt(0)
    v_max_u32 v121, v99, v103
    v_cmp_eq_u32 vcc, -1, v121
    s_add_u32 s85, s85, 1
    s_cbranch_vccz L_gb_53
    s_cmp_lt_u32 s85, 65536
    s_cbranch_scc1 L_gs_54
    s_branch L_gb_53
L_gs_56:
    s_add_u32 s3, s22, 24576
    s_cmp_ge_u32 s3, s28
    s_cselect_b32 s18, 65536, 0
    s_sub_u32 s3, s3, s18
    buffer_load_dwordx4 v[104:107], v123, s[52:55], s3 offen sc1
    buffer_load_dwordx4 v[108:111], v122, s[52:55], s3 offen sc1
    s_add_u32 s3, s22, 26624
    s_cmp_ge_u32 s3, s28
    s_cselect_b32 s18, 65536, 0
    s_sub_u32 s3, s3, s18
    buffer_load_dwordx4 v[112:115], v123, s[52:55], s3 offen sc1
    buffer_load_dwordx4 v[116:119], v122, s[52:55], s3 offen sc1
    s_add_u32 s3, s22, 28672
    s_cmp_ge_u32 s3, s28
    s_cselect_b32 s18, 65536, 0
    s_sub_u32 s3, s3, s18
    buffer_load_dwordx4 v[64:67], v123, s[52:55], s3 offen sc1
    buffer_load_dwordx4 v[68:71], v122, s[52:55], s3 offen sc1
    s_add_u32 s3, s22, 30720
    s_cmp_ge_u32 s3, s28
    s_cselect_b32 s18, 65536, 0
    s_sub_u32 s3, s3, s18
    buffer_load_dwordx4 v[72:75], v123, s[52:55], s3 offen sc1
    buffer_load_dwordx4 v[76:79], v122, s[52:55], s3 offen sc1
    s_waitcnt vmcnt(0)
    v_max_u32 v121, v107, v111
    v_cmp_eq_u32 vcc, -1, v121
    s_add_u32 s85, s85, 1
    s_cbranch_vccz L_gb_55
    s_cmp_lt_u32 s85, 65536
    s_cbranch_scc1 L_gs_56
    s_branch L_gb_55
L_gs_58:
    s_add_u32 s3, s22, 26624
    s_cmp_ge_u32 s3, s28
    s_cselect_b32 s18, 65536, 0
    s_sub_u32 s3, s3, s18
    buffer_load_dwordx4 v[112:115], v123, s[52:55], s3 offen sc1
    buffer_load_dwordx4 v[116:119], v122, s[52:55], s3 offen sc1
    s_add_u32 s3, s22, 28672
    s_cmp_ge_u32 s3, s28
    s_cselect_b32 s18, 65536, 0
    s_sub_u32 s3, s3, s18
    buffer_load_dwordx4 v[64:67], v123, s[52:55], s3 offen sc1
    buffer_load_dwordx4 v[68:71], v122, s[52:55], s3 offen sc1
    s_add_u32 s3, s22, 30720
    s_cmp_ge_u32 s3, s28
    s_cselect_b32 s18, 65536, 0
    s_sub_u32 s3, s3, s18
    buffer_load_dwordx4 v[72:75], v123, s[52:55], s3 offen sc1
    buffer_load_dwordx4 v[76:79], v122, s[52:55], s3 offen sc1
    s_add_u32 s3, s22, 32768
    s_cmp_ge_u32 s3, s28
    s_cselect_b32 s18, 65536, 0
    s_sub_u32 s3, s3, s18
    buffer_load_dwordx4 v[80:83], v123, s[52:55], s3 offen sc1
    buffer_load_dwordx4 v[84:87], v122, s[52:55], s3 offen sc1
    s_waitcnt vmcnt(0)
    v_max_u32 v121, v115, v119
    v_cmp_eq_u32 vcc, -1, v121
    s_add_u32 s85, s85, 1
    s_cbranch_vccz L_gb_57
    s_cmp_lt_u32 s85, 65536
    s_cbranch_scc1 L_gs_58
    s_branch L_gb_57
L_gs_60:
    s_add_u32 s3, s22, 28672
    s_cmp_ge_u32 s3, s28
    s_cselect_b32 s18, 65536, 0
    s_sub_u32 s3, s3, s18
    buffer_load_dwordx4 v[64:67], v123, s[52:55], s3 offen sc1
    buffer_load_dwordx4 v[68:71], v122, s[52:55], s3 offen sc1
    s_add_u32 s3, s22, 30720
    s_cmp_ge_u32 s3, s28
    s_cselect_b32 s18, 65536, 0
    s_sub_u32 s3, s3, s18
    buffer_load_dwordx4 v[72:75], v123, s[52:55], s3 offen sc1
    buffer_load_dwordx4 v[76:79], v122, s[52:55], s3 offen sc1
    s_add_u32 s3, s22, 32768
    s_cmp_ge_u32 s3, s28
    s_cselect_b32 s18, 65536, 0
    s_sub_u32 s3, s3, s18
    buffer_load_dwordx4 v[80:83], v123, s[52:55], s3 offen sc1
    buffer_load_dwordx4 v[84:87], v122, s[52:55], s3 offen sc1
    s_add_u32 s3, s22, 34816
    s_cmp_ge_u32 s3, s28
    s_cselect_b32 s18, 65536, 0
    s_sub_u32 s3, s3, s18
    buffer_load_dwordx4 v[88:91], v123, s[52:55], s3 offen sc1
    buffer_load_dwordx4 v[92:95], v122, s[52:55], s3 offen sc1
    s_waitcnt vmcnt(0)
    v_max_u32 v121, v67, v71
    v_cmp_eq_u32 vcc, -1, v121
    s_add_u32 s85, s85, 1
    s_cbranch_vccz L_gb_59
    s_cmp_lt_u32 s85, 65536
    s_cbranch_scc1 L_gs_60
    s_branch L_gb_59
L_gs_62:
    s_add_u32 s3, s22, 30720
    s_cmp_ge_u32 s3, s28
    s_cselect_b32 s18, 65536, 0
    s_sub_u32 s3, s3, s18
    buffer_load_dwordx4 v[72:75], v123, s[52:55], s3 offen sc1
    buffer_load_dwordx4 v[76:79], v122, s[52:55], s3 offen sc1
    s_add_u32 s3, s22, 32768
    s_cmp_ge_u32 s3, s28
    s_cselect_b32 s18, 65536, 0
    s_sub_u32 s3, s3, s18
    buffer_load_dwordx4 v[80:83], v123, s[52:55], s3 offen sc1
    buffer_load_dwordx4 v[84:87], v122, s[52:55], s3 offen sc1
    s_add_u32 s3, s22, 34816
    s_cmp_ge_u32 s3, s28
    s_cselect_b32 s18, 65536, 0
    s_sub_u32 s3, s3, s18
    buffer_load_dwordx4 v[88:91], v123, s[52:55], s3 offen sc1
    buffer_load_dwordx4 v[92:95], v122, s[52:55], s3 offen sc1
    s_add_u32 s3, s22, 36864
    s_cmp_ge_u32 s3, s28
    s_cselect_b32 s18, 65536, 0
    s_sub_u32 s3, s3, s18
    buffer_load_dwordx4 v[96:99], v123, s[52:55], s3 offen sc1
    buffer_load_dwordx4 v[100:103], v122, s[52:55], s3 offen sc1
    s_waitcnt vmcnt(0)
    v_max_u32 v121, v75, v79
    v_cmp_eq_u32 vcc, -1, v121
    s_add_u32 s85, s85, 1
    s_cbranch_vccz L_gb_61
    s_cmp_lt_u32 s85, 65536
    s_cbranch_scc1 L_gs_62
    s_branch L_gb_61
L_gs_64:
    s_add_u32 s3, s22, 32768
    s_cmp_ge_u32 s3, s28
    s_cselect_b32 s18, 65536, 0
    s_sub_u32 s3, s3, s18
    buffer_load_dwordx4 v[80:83], v123, s[52:55], s3 offen sc1
    buffer_load_dwordx4 v[84:87], v122, s[52:55], s3 offen sc1
    s_add_u32 s3, s22, 34816
    s_cmp_ge_u32 s3, s28
    s_cselect_b32 s18, 65536, 0
    s_sub_u32 s3, s3, s18
    buffer_load_dwordx4 v[88:91], v123, s[52:55], s3 offen sc1
    buffer_load_dwordx4 v[92:95], v122, s[52:55], s3 offen sc1
    s_add_u32 s3, s22, 36864
    s_cmp_ge_u32 s3, s28
    s_cselect_b32 s18, 65536, 0
    s_sub_u32 s3, s3, s18
    buffer_load_dwordx4 v[96:99], v123, s[52:55], s3 offen sc1
    buffer_load_dwordx4 v[100:103], v122, s[52:55], s3 offen sc1
    s_add_u32 s3, s22, 38912
    s_cmp_ge_u32 s3, s28
    s_cselect_b32 s18, 65536, 0
    s_sub_u32 s3, s3, s18
    buffer_load_dwordx4 v[104:107], v123, s[52:55], s3 offen sc1
    buffer_load_dwordx4 v[108:111], v122, s[52:55], s3 offen sc1
    s_waitcnt vmcnt(0)
    v_max_u32 v121, v83, v87
    v_cmp_eq_u32 vcc, -1, v121
    s_add_u32 s85, s85, 1
    s_cbranch_vccz L_gb_63
    s_cmp_lt_u32 s85, 65536
    s_cbranch_scc1 L_gs_64
    s_branch L_gb_63
L_gs_66:
    s_add_u32 s3, s22, 34816
    s_cmp_ge_u32 s3, s28
    s_cselect_b32 s18, 65536, 0
    s_sub_u32 s3, s3, s18
    buffer_load_dwordx4 v[88:91], v123, s[52:55], s3 offen sc1
    buffer_load_dwordx4 v[92:95], v122, s[52:55], s3 offen sc1
    s_add_u32 s3, s22, 36864
    s_cmp_ge_u32 s3, s28
    s_cselect_b32 s18, 65536, 0
    s_sub_u32 s3, s3, s18
    buffer_load_dwordx4 v[96:99], v123, s[52:55], s3 offen sc1
    buffer_load_dwordx4 v[100:103], v122, s[52:55], s3 offen sc1
    s_add_u32 s3, s22, 38912
    s_cmp_ge_u32 s3, s28
    s_cselect_b32 s18, 65536, 0
    s_sub_u32 s3, s3, s18
    buffer_load_dwordx4 v[104:107], v123, s[52:55], s3 offen sc1
    buffer_load_dwordx4 v[108:111], v122, s[52:55], s3 offen sc1
    s_add_u32 s3, s22, 40960
    s_cmp_ge_u32 s3, s28
    s_cselect_b32 s18, 65536, 0
    s_sub_u32 s3, s3, s18
    buffer_load_dwordx4 v[112:115], v123, s[52:55], s3 offen sc1
    buffer_load_dwordx4 v[116:119], v122, s[52:55], s3 offen sc1
    s_waitcnt vmcnt(0)
    v_max_u32 v121, v91, v95
    v_cmp_eq_u32 vcc, -1, v121
    s_add_u32 s85, s85, 1
    s_cbranch_vccz L_gb_65
    s_cmp_lt_u32 s85, 65536
    s_cbranch_scc1 L_gs_66
    s_branch L_gb_65
L_gs_68:
    s_add_u32 s3, s22, 36864
    s_cmp_ge_u32 s3, s28
    s_cselect_b32 s18, 65536, 0
    s_sub_u32 s3, s3, s18
    buffer_load_dwordx4 v[96:99], v123, s[52:55], s3 offen sc1
    buffer_load_dwordx4 v[100:103], v122, s[52:55], s3 offen sc1
    s_add_u32 s3, s22, 38912
    s_cmp_ge_u32 s3, s28
    s_cselect_b32 s18, 65536, 0
    s_sub_u32 s3, s3, s18
    buffer_load_dwordx4 v[104:107], v123, s[52:55], s3 offen sc1
    buffer_load_dwordx4 v[108:111], v122, s[52:55], s3 offen sc1
    s_add_u32 s3, s22, 40960
    s_cmp_ge_u32 s3, s28
    s_cselect_b32 s18, 65536, 0
    s_sub_u32 s3, s3, s18
    buffer_load_dwordx4 v[112:115], v123, s[52:55], s3 offen sc1
    buffer_load_dwordx4 v[116:119], v122, s[52:55], s3 offen sc1
    s_add_u32 s3, s22, 43008
    s_cmp_ge_u32 s3, s28
    s_cselect_b32 s18, 65536, 0
    s_sub_u32 s3, s3, s18
    buffer_load_dwordx4 v[64:67], v123, s[52:55], s3 offen sc1
    buffer_load_dwordx4 v[68:71], v122, s[52:55], s3 offen sc1
    s_waitcnt vmcnt(0)
    v_max_u32 v121, v99, v103
    v_cmp_eq_u32 vcc, -1, v121
    s_add_u32 s85, s85, 1
    s_cbranch_vccz L_gb_67
    s_cmp_lt_u32 s85, 65536
    s_cbranch_scc1 L_gs_68
    s_branch L_gb_67
L_gs_70:
    s_add_u32 s3, s22, 38912
    s_cmp_ge_u32 s3, s28
    s_cselect_b32 s18, 65536, 0
    s_sub_u32 s3, s3, s18
    buffer_load_dwordx4 v[104:107], v123, s[52:55], s3 offen sc1
    buffer_load_dwordx4 v[108:111], v122, s[52:55], s3 offen sc1
    s_add_u32 s3, s22, 40960
    s_cmp_ge_u32 s3, s28
    s_cselect_b32 s18, 65536, 0
    s_sub_u32 s3, s3, s18
    buffer_load_dwordx4 v[112:115], v123, s[52:55], s3 offen sc1
    buffer_load_dwordx4 v[116:119], v122, s[52:55], s3 offen sc1
    s_add_u32 s3, s22, 43008
    s_cmp_ge_u32 s3, s28
    s_cselect_b32 s18, 65536, 0
    s_sub_u32 s3, s3, s18
    buffer_load_dwordx4 v[64:67], v123, s[52:55], s3 offen sc1
    buffer_load_dwordx4 v[68:71], v122, s[52:55], s3 offen sc1
    s_add_u32 s3, s22, 45056
    s_cmp_ge_u32 s3, s28
    s_cselect_b32 s18, 65536, 0
    s_sub_u32 s3, s3, s18
    buffer_load_dwordx4 v[72:75], v123, s[52:55], s3 offen sc1
    buffer_load_dwordx4 v[76:79], v122, s[52:55], s3 offen sc1
    s_waitcnt vmcnt(0)
    v_max_u32 v121, v107, v111
    v_cmp_eq_u32 vcc, -1, v121
    s_add_u32 s85, s85, 1
    s_cbranch_vccz L_gb_69
    s_cmp_lt_u32 s85, 65536
    s_cbranch_scc1 L_gs_70
    s_branch L_gb_69
L_gs_72:
    s_add_u32 s3, s22, 40960
    s_cmp_ge_u32 s3, s28
    s_cselect_b32 s18, 65536, 0
    s_sub_u32 s3, s3, s18
    buffer_load_dwordx4 v[112:115], v123, s[52:55], s3 offen sc1
    buffer_load_dwordx4 v[116:119], v122, s[52:55], s3 offen sc1
    s_add_u32 s3, s22, 43008
    s_cmp_ge_u32 s3, s28
    s_cselect_b32 s18, 65536, 0
    s_sub_u32 s3, s3, s18
    buffer_load_dwordx4 v[64:67], v123, s[52:55], s3 offen sc1
    buffer_load_dwordx4 v[68:71], v122, s[52:55], s3 offen sc1
    s_add_u32 s3, s22, 45056
    s_cmp_ge_u32 s3, s28
    s_cselect_b32 s18, 65536, 0
    s_sub_u32 s3, s3, s18
    buffer_load_dwordx4 v[72:75], v123, s[52:55], s3 offen sc1
    buffer_load_dwordx4 v[76:79], v122, s[52:55], s3 offen sc1
    s_add_u32 s3, s22, 47104
    s_cmp_ge_u32 s3, s28
    s_cselect_b32 s18, 65536, 0
    s_sub_u32 s3, s3, s18
    buffer_load_dwordx4 v[80:83], v123, s[52:55], s3 offen sc1
    buffer_load_dwordx4 v[84:87], v122, s[52:55], s3 offen sc1
    s_waitcnt vmcnt(0)
    v_max_u32 v121, v115, v119
    v_cmp_eq_u32 vcc, -1, v121
    s_add_u32 s85, s85, 1
    s_cbranch_vccz L_gb_71
    s_cmp_lt_u32 s85, 65536
    s_cbranch_scc1 L_gs_72
    s_branch L_gb_71
L_gs_74:
    s_add_u32 s3, s22, 43008
    s_cmp_ge_u32 s3, s28
    s_cselect_b32 s18, 65536, 0
    s_sub_u32 s3, s3, s18
    buffer_load_dwordx4 v[64:67], v123, s[52:55], s3 offen sc1
    buffer_load_dwordx4 v[68:71], v122, s[52:55], s3 offen sc1
    s_add_u32 s3, s22, 45056
    s_cmp_ge_u32 s3, s28
    s_cselect_b32 s18, 65536, 0
    s_sub_u32 s3, s3, s18
    buffer_load_dwordx4 v[72:75], v123, s[52:55], s3 offen sc1
    buffer_load_dwordx4 v[76:79], v122, s[52:55], s3 offen sc1
    s_add_u32 s3, s22, 47104
    s_cmp_ge_u32 s3, s28
    s_cselect_b32 s18, 65536, 0
    s_sub_u32 s3, s3, s18
    buffer_load_dwordx4 v[80:83], v123, s[52:55], s3 offen sc1
    buffer_load_dwordx4 v[84:87], v122, s[52:55], s3 offen sc1
    s_add_u32 s3, s22, 49152
    s_cmp_ge_u32 s3, s28
    s_cselect_b32 s18, 65536, 0
    s_sub_u32 s3, s3, s18
    buffer_load_dwordx4 v[88:91], v123, s[52:55], s3 offen sc1
    buffer_load_dwordx4 v[92:95], v122, s[52:55], s3 offen sc1
    s_waitcnt vmcnt(0)
    v_max_u32 v121, v67, v71
    v_cmp_eq_u32 vcc, -1, v121
    s_add_u32 s85, s85, 1
    s_cbranch_vccz L_gb_73
    s_cmp_lt_u32 s85, 65536
    s_cbranch_scc1 L_gs_74
    s_branch L_gb_73
L_gs_76:
    s_add_u32 s3, s22, 45056
    s_cmp_ge_u32 s3, s28
    s_cselect_b32 s18, 65536, 0
    s_sub_u32 s3, s3, s18
    buffer_load_dwordx4 v[72:75], v123, s[52:55], s3 offen sc1
    buffer_load_dwordx4 v[76:79], v122, s[52:55], s3 offen sc1
    s_add_u32 s3, s22, 47104
    s_cmp_ge_u32 s3, s28
    s_cselect_b32 s18, 65536, 0
    s_sub_u32 s3, s3, s18
    buffer_load_dwordx4 v[80:83], v123, s[52:55], s3 offen sc1
    buffer_load_dwordx4 v[84:87], v122, s[52:55], s3 offen sc1
    s_add_u32 s3, s22, 49152
    s_cmp_ge_u32 s3, s28
    s_cselect_b32 s18, 65536, 0
    s_sub_u32 s3, s3, s18
    buffer_load_dwordx4 v[88:91], v123, s[52:55], s3 offen sc1
    buffer_load_dwordx4 v[92:95], v122, s[52:55], s3 offen sc1
    s_add_u32 s3, s22, 51200
    s_cmp_ge_u32 s3, s28
    s_cselect_b32 s18, 65536, 0
    s_sub_u32 s3, s3, s18
    buffer_load_dwordx4 v[96:99], v123, s[52:55], s3 offen sc1
    buffer_load_dwordx4 v[100:103], v122, s[52:55], s3 offen sc1
    s_waitcnt vmcnt(0)
    v_max_u32 v121, v75, v79
    v_cmp_eq_u32 vcc, -1, v121
    s_add_u32 s85, s85, 1
    s_cbranch_vccz L_gb_75
    s_cmp_lt_u32 s85, 65536
    s_cbranch_scc1 L_gs_76
    s_branch L_gb_75
L_gs_78:
    s_add_u32 s3, s22, 47104
    s_cmp_ge_u32 s3, s28
    s_cselect_b32 s18, 65536, 0
    s_sub_u32 s3, s3, s18
    buffer_load_dwordx4 v[80:83], v123, s[52:55], s3 offen sc1
    buffer_load_dwordx4 v[84:87], v122, s[52:55], s3 offen sc1
    s_add_u32 s3, s22, 49152
    s_cmp_ge_u32 s3, s28
    s_cselect_b32 s18, 65536, 0
    s_sub_u32 s3, s3, s18
    buffer_load_dwordx4 v[88:91], v123, s[52:55], s3 offen sc1
    buffer_load_dwordx4 v[92:95], v122, s[52:55], s3 offen sc1
    s_add_u32 s3, s22, 51200
    s_cmp_ge_u32 s3, s28
    s_cselect_b32 s18, 65536, 0
    s_sub_u32 s3, s3, s18
    buffer_load_dwordx4 v[96:99], v123, s[52:55], s3 offen sc1
    buffer_load_dwordx4 v[100:103], v122, s[52:55], s3 offen sc1
    s_add_u32 s3, s22, 53248
    s_cmp_ge_u32 s3, s28
    s_cselect_b32 s18, 65536, 0
    s_sub_u32 s3, s3, s18
    buffer_load_dwordx4 v[104:107], v123, s[52:55], s3 offen sc1
    buffer_load_dwordx4 v[108:111], v122, s[52:55], s3 offen sc1
    s_waitcnt vmcnt(0)
    v_max_u32 v121, v83, v87
    v_cmp_eq_u32 vcc, -1, v121
    s_add_u32 s85, s85, 1
    s_cbranch_vccz L_gb_77
    s_cmp_lt_u32 s85, 65536
    s_cbranch_scc1 L_gs_78
    s_branch L_gb_77
L_gs_80:
    s_add_u32 s3, s22, 49152
    s_cmp_ge_u32 s3, s28
    s_cselect_b32 s18, 65536, 0
    s_sub_u32 s3, s3, s18
    buffer_load_dwordx4 v[88:91], v123, s[52:55], s3 offen sc1
    buffer_load_dwordx4 v[92:95], v122, s[52:55], s3 offen sc1
    s_add_u32 s3, s22, 51200
    s_cmp_ge_u32 s3, s28
    s_cselect_b32 s18, 65536, 0
    s_sub_u32 s3, s3, s18
    buffer_load_dwordx4 v[96:99], v123, s[52:55], s3 offen sc1
    buffer_load_dwordx4 v[100:103], v122, s[52:55], s3 offen sc1
    s_add_u32 s3, s22, 53248
    s_cmp_ge_u32 s3, s28
    s_cselect_b32 s18, 65536, 0
    s_sub_u32 s3, s3, s18
    buffer_load_dwordx4 v[104:107], v123, s[52:55], s3 offen sc1
    buffer_load_dwordx4 v[108:111], v122, s[52:55], s3 offen sc1
    s_add_u32 s3, s22, 55296
    s_cmp_ge_u32 s3, s28
    s_cselect_b32 s18, 65536, 0
    s_sub_u32 s3, s3, s18
    buffer_load_dwordx4 v[112:115], v123, s[52:55], s3 offen sc1
    buffer_load_dwordx4 v[116:119], v122, s[52:55], s3 offen sc1
    s_waitcnt vmcnt(0)
    v_max_u32 v121, v91, v95
    v_cmp_eq_u32 vcc, -1, v121
    s_add_u32 s85, s85, 1
    s_cbranch_vccz L_gb_79
    s_cmp_lt_u32 s85, 65536
    s_cbranch_scc1 L_gs_80
    s_branch L_gb_79
L_gs_82:
    s_add_u32 s3, s22, 51200
    s_cmp_ge_u32 s3, s28
    s_cselect_b32 s18, 65536, 0
    s_sub_u32 s3, s3, s18
    buffer_load_dwordx4 v[96:99], v123, s[52:55], s3 offen sc1
    buffer_load_dwordx4 v[100:103], v122, s[52:55], s3 offen sc1
    s_add_u32 s3, s22, 53248
    s_cmp_ge_u32 s3, s28
    s_cselect_b32 s18, 65536, 0
    s_sub_u32 s3, s3, s18
    buffer_load_dwordx4 v[104:107], v123, s[52:55], s3 offen sc1
    buffer_load_dwordx4 v[108:111], v122, s[52:55], s3 offen sc1
    s_add_u32 s3, s22, 55296
    s_cmp_ge_u32 s3, s28
    s_cselect_b32 s18, 65536, 0
    s_sub_u32 s3, s3, s18
    buffer_load_dwordx4 v[112:115], v123, s[52:55], s3 offen sc1
    buffer_load_dwordx4 v[116:119], v122, s[52:55], s3 offen sc1
    s_add_u32 s3, s22, 57344
    s_cmp_ge_u32 s3, s28
    s_cselect_b32 s18, 65536, 0
    s_sub_u32 s3, s3, s18
    buffer_load_dwordx4 v[64:67], v123, s[52:55], s3 offen sc1
    buffer_load_dwordx4 v[68:71], v122, s[52:55], s3 offen sc1
    s_waitcnt vmcnt(0)
    v_max_u32 v121, v99, v103
    v_cmp_eq_u32 vcc, -1, v121
    s_add_u32 s85, s85, 1
    s_cbranch_vccz L_gb_81
    s_cmp_lt_u32 s85, 65536
    s_cbranch_scc1 L_gs_82
    s_branch L_gb_81
L_gs_84:
    s_add_u32 s3, s22, 53248
    s_cmp_ge_u32 s3, s28
    s_cselect_b32 s18, 65536, 0
    s_sub_u32 s3, s3, s18
    buffer_load_dwordx4 v[104:107], v123, s[52:55], s3 offen sc1
    buffer_load_dwordx4 v[108:111], v122, s[52:55], s3 offen sc1
    s_add_u32 s3, s22, 55296
    s_cmp_ge_u32 s3, s28
    s_cselect_b32 s18, 65536, 0
    s_sub_u32 s3, s3, s18
    buffer_load_dwordx4 v[112:115], v123, s[52:55], s3 offen sc1
    buffer_load_dwordx4 v[116:119], v122, s[52:55], s3 offen sc1
    s_add_u32 s3, s22, 57344
    s_cmp_ge_u32 s3, s28
    s_cselect_b32 s18, 65536, 0
    s_sub_u32 s3, s3, s18
    buffer_load_dwordx4 v[64:67], v123, s[52:55], s3 offen sc1
    buffer_load_dwordx4 v[68:71], v122, s[52:55], s3 offen sc1
    s_add_u32 s3, s22, 59392
    s_cmp_ge_u32 s3, s28
    s_cselect_b32 s18, 65536, 0
    s_sub_u32 s3, s3, s18
    buffer_load_dwordx4 v[72:75], v123, s[52:55], s3 offen sc1
    buffer_load_dwordx4 v[76:79], v122, s[52:55], s3 offen sc1
    s_waitcnt vmcnt(0)
    v_max_u32 v121, v107, v111
    v_cmp_eq_u32 vcc, -1, v121
    s_add_u32 s85, s85, 1
    s_cbranch_vccz L_gb_83
    s_cmp_lt_u32 s85, 65536
    s_cbranch_scc1 L_gs_84
    s_branch L_gb_83
L_gs_86:
    s_add_u32 s3, s22, 55296
    s_cmp_ge_u32 s3, s28
    s_cselect_b32 s18, 65536, 0
    s_sub_u32 s3, s3, s18
    buffer_load_dwordx4 v[112:115], v123, s[52:55], s3 offen sc1
    buffer_load_dwordx4 v[116:119], v122, s[52:55], s3 offen sc1
    s_add_u32 s3, s22, 57344
    s_cmp_ge_u32 s3, s28
    s_cselect_b32 s18, 65536, 0
    s_sub_u32 s3, s3, s18
    buffer_load_dwordx4 v[64:67], v123, s[52:55], s3 offen sc1
    buffer_load_dwordx4 v[68:71], v122, s[52:55], s3 offen sc1
    s_add_u32 s3, s22, 59392
    s_cmp_ge_u32 s3, s28
    s_cselect_b32 s18, 65536, 0
    s_sub_u32 s3, s3, s18
    buffer_load_dwordx4 v[72:75], v123, s[52:55], s3 offen sc1
    buffer_load_dwordx4 v[76:79], v122, s[52:55], s3 offen sc1
    s_add_u32 s3, s22, 61440
    s_cmp_ge_u32 s3, s28
    s_cselect_b32 s18, 65536, 0
    s_sub_u32 s3, s3, s18
    buffer_load_dwordx4 v[80:83], v123, s[52:55], s3 offen sc1
    buffer_load_dwordx4 v[84:87], v122, s[52:55], s3 offen sc1
    s_waitcnt vmcnt(0)
    v_max_u32 v121, v115, v119
    v_cmp_eq_u32 vcc, -1, v121
    s_add_u32 s85, s85, 1
    s_cbranch_vccz L_gb_85
    s_cmp_lt_u32 s85, 65536
    s_cbranch_scc1 L_gs_86
    s_branch L_gb_85
L_gs_88:
    s_add_u32 s3, s22, 57344
    s_cmp_ge_u32 s3, s28
    s_cselect_b32 s18, 65536, 0
    s_sub_u32 s3, s3, s18
    buffer_load_dwordx4 v[64:67], v123, s[52:55], s3 offen sc1
    buffer_load_dwordx4 v[68:71], v122, s[52:55], s3 offen sc1
    s_add_u32 s3, s22, 59392
    s_cmp_ge_u32 s3, s28
    s_cselect_b32 s18, 65536, 0
    s_sub_u32 s3, s3, s18
    buffer_load_dwordx4 v[72:75], v123, s[52:55], s3 offen sc1
    buffer_load_dwordx4 v[76:79], v122, s[52:55], s3 offen sc1
    s_add_u32 s3, s22, 61440
    s_cmp_ge_u32 s3, s28
    s_cselect_b32 s18, 65536, 0
    s_sub_u32 s3, s3, s18
    buffer_load_dwordx4 v[80:83], v123, s[52:55], s3 offen sc1
    buffer_load_dwordx4 v[84:87], v122, s[52:55], s3 offen sc1
    s_add_u32 s3, s22, 63488
    s_cmp_ge_u32 s3, s28
    s_cselect_b32 s18, 65536, 0
    s_sub_u32 s3, s3, s18
    buffer_load_dwordx4 v[88:91], v123, s[52:55], s3 offen sc1
    buffer_load_dwordx4 v[92:95], v122, s[52:55], s3 offen sc1
    s_waitcnt vmcnt(0)
    v_max_u32 v121, v67, v71
    v_cmp_eq_u32 vcc, -1, v121
    s_add_u32 s85, s85, 1
    s_cbranch_vccz L_gb_87
    s_cmp_lt_u32 s85, 65536
    s_cbranch_scc1 L_gs_88
    s_branch L_gb_87
L_gs_90:
    s_add_u32 s3, s22, 59392
    s_cmp_ge_u32 s3, s28
    s_cselect_b32 s18, 65536, 0
    s_sub_u32 s3, s3, s18
    buffer_load_dwordx4 v[72:75], v123, s[52:55], s3 offen sc1
    buffer_load_dwordx4 v[76:79], v122, s[52:55], s3 offen sc1
    s_add_u32 s3, s22, 61440
    s_cmp_ge_u32 s3, s28
    s_cselect_b32 s18, 65536, 0
    s_sub_u32 s3, s3, s18
    buffer_load_dwordx4 v[80:83], v123, s[52:55], s3 offen sc1
    buffer_load_dwordx4 v[84:87], v122, s[52:55], s3 offen sc1
    s_add_u32 s3, s22, 63488
    s_cmp_ge_u32 s3, s28
    s_cselect_b32 s18, 65536, 0
    s_sub_u32 s3, s3, s18
    buffer_load_dwordx4 v[88:91], v123, s[52:55], s3 offen sc1
    buffer_load_dwordx4 v[92:95], v122, s[52:55], s3 offen sc1
    s_waitcnt vmcnt(0)
    v_max_u32 v121, v75, v79
    v_cmp_eq_u32 vcc, -1, v121
    s_add_u32 s85, s85, 1
    s_cbranch_vccz L_gb_89
    s_cmp_lt_u32 s85, 65536
    s_cbranch_scc1 L_gs_90
    s_branch L_gb_89
L_gs_92:
    s_add_u32 s3, s22, 61440
    s_cmp_ge_u32 s3, s28
    s_cselect_b32 s18, 65536, 0
    s_sub_u32 s3, s3, s18
    buffer_load_dwordx4 v[80:83], v123, s[52:55], s3 offen sc1
    buffer_load_dwordx4 v[84:87], v122, s[52:55], s3 offen sc1
    s_add_u32 s3, s22, 63488
    s_cmp_ge_u32 s3, s28
    s_cselect_b32 s18, 65536, 0
    s_sub_u32 s3, s3, s18
    buffer_load_dwordx4 v[88:91], v123, s[52:55], s3 offen sc1
    buffer_load_dwordx4 v[92:95], v122, s[52:55], s3 offen sc1
    s_waitcnt vmcnt(0)
    v_max_u32 v121, v83, v87
    v_cmp_eq_u32 vcc, -1, v121
    s_add_u32 s85, s85, 1
    s_cbranch_vccz L_gb_91
    s_cmp_lt_u32 s85, 65536
    s_cbranch_scc1 L_gs_92
    s_branch L_gb_91
L_gs_94:
    s_add_u32 s3, s22, 63488
    s_cmp_ge_u32 s3, s28
    s_cselect_b32 s18, 65536, 0
    s_sub_u32 s3, s3, s18
    buffer_load_dwordx4 v[88:91], v123, s[52:55], s3 offen sc1
    buffer_load_dwordx4 v[92:95], v122, s[52:55], s3 offen sc1
    s_waitcnt vmcnt(0)
    v_max_u32 v121, v91, v95
    v_cmp_eq_u32 vcc, -1, v121
    s_add_u32 s85, s85, 1
    s_cbranch_vccz L_gb_93
    s_cmp_lt_u32 s85, 65536
    s_cbranch_scc1 L_gs_94
    s_branch L_gb_93
L_gs_106:
    s_add_u32 s3, s22, 0
    s_cmp_ge_u32 s3, s28
    s_cselect_b32 s18, 57344, 0
    s_sub_u32 s3, s3, s18
    buffer_load_dwordx4 v[64:67], v123, s[52:55], s3 offen sc1
    buffer_load_dwordx4 v[68:71], v122, s[52:55], s3 offen sc1
    s_add_u32 s3, s22, 2048
    s_cmp_ge_u32 s3, s28
    s_cselect_b32 s18, 57344, 0
    s_sub_u32 s3, s3, s18
    buffer_load_dwordx4 v[72:75], v123, s[52:55], s3 offen sc1
    buffer_load_dwordx4 v[76:79], v122, s[52:55], s3 offen sc1
    s_add_u32 s3, s22, 4096
    s_cmp_ge_u32 s3, s28
    s_cselect_b32 s18, 57344, 0
    s_sub_u32 s3, s3, s18
    buffer_load_dwordx4 v[80:83], v123, s[52:55], s3 offen sc1
    buffer_load_dwordx4 v[84:87], v122, s[52:55], s3 offen sc1
    s_add_u32 s3, s22, 6144
    s_cmp_ge_u32 s3, s28
    s_cselect_b32 s18, 57344, 0
    s_sub_u32 s3, s3, s18
    buffer_load_dwordx4 v[88:91], v123, s[52:55], s3 offen sc1
    buffer_load_dwordx4 v[92:95], v122, s[52:55], s3 offen sc1
    s_waitcnt vmcnt(0)
    v_max_u32 v121, v67, v71
    v_cmp_eq_u32 vcc, -1, v121
    s_add_u32 s85, s85, 1
    s_cbranch_vccz L_gb_105
    s_cmp_lt_u32 s85, 65536
    s_cbranch_scc1 L_gs_106
    s_branch L_gb_105
L_gs_108:
    s_add_u32 s3, s22, 2048
    s_cmp_ge_u32 s3, s28
    s_cselect_b32 s18, 57344, 0
    s_sub_u32 s3, s3, s18
    buffer_load_dwordx4 v[72:75], v123, s[52:55], s3 offen sc1
    buffer_load_dwordx4 v[76:79], v122, s[52:55], s3 offen sc1
    s_add_u32 s3, s22, 4096
    s_cmp_ge_u32 s3, s28
    s_cselect_b32 s18, 57344, 0
    s_sub_u32 s3, s3, s18
    buffer_load_dwordx4 v[80:83], v123, s[52:55], s3 offen sc1
    buffer_load_dwordx4 v[84:87], v122, s[52:55], s3 offen sc1
    s_add_u32 s3, s22, 6144
    s_cmp_ge_u32 s3, s28
    s_cselect_b32 s18, 57344, 0
    s_sub_u32 s3, s3, s18
    buffer_load_dwordx4 v[88:91], v123, s[52:55], s3 offen sc1
    buffer_load_dwordx4 v[92:95], v122, s[52:55], s3 offen sc1
    s_add_u32 s3, s22, 8192
    s_cmp_ge_u32 s3, s28
    s_cselect_b32 s18, 57344, 0
    s_sub_u32 s3, s3, s18
    buffer_load_dwordx4 v[96:99], v123, s[52:55], s3 offen sc1
    buffer_load_dwordx4 v[100:103], v122, s[52:55], s3 offen sc1
    s_waitcnt vmcnt(0)
    v_max_u32 v121, v75, v79
    v_cmp_eq_u32 vcc, -1, v121
    s_add_u32 s85, s85, 1
    s_cbranch_vccz L_gb_107
    s_cmp_lt_u32 s85, 65536
    s_cbranch_scc1 L_gs_108
    s_branch L_gb_107
L_gs_110:
    s_add_u32 s3, s22, 4096
    s_cmp_ge_u32 s3, s28
    s_cselect_b32 s18, 57344, 0
    s_sub_u32 s3, s3, s18
    buffer_load_dwordx4 v[80:83], v123, s[52:55], s3 offen sc1
    buffer_load_dwordx4 v[84:87], v122, s[52:55], s3 offen sc1
    s_add_u32 s3, s22, 6144
    s_cmp_ge_u32 s3, s28
    s_cselect_b32 s18, 57344, 0
    s_sub_u32 s3, s3, s18
    buffer_load_dwordx4 v[88:91], v123, s[52:55], s3 offen sc1
    buffer_load_dwordx4 v[92:95], v122, s[52:55], s3 offen sc1
    s_add_u32 s3, s22, 8192
    s_cmp_ge_u32 s3, s28
    s_cselect_b32 s18, 57344, 0
    s_sub_u32 s3, s3, s18
    buffer_load_dwordx4 v[96:99], v123, s[52:55], s3 offen sc1
    buffer_load_dwordx4 v[100:103], v122, s[52:55], s3 offen sc1
    s_add_u32 s3, s22, 10240
    s_cmp_ge_u32 s3, s28
    s_cselect_b32 s18, 57344, 0
    s_sub_u32 s3, s3, s18
    buffer_load_dwordx4 v[64:67], v123, s[52:55], s3 offen sc1
    buffer_load_dwordx4 v[68:71], v122, s[52:55], s3 offen sc1
    s_waitcnt vmcnt(0)
    v_max_u32 v121, v83, v87
    v_cmp_eq_u32 vcc, -1, v121
    s_add_u32 s85, s85, 1
    s_cbranch_vccz L_gb_109
    s_cmp_lt_u32 s85, 65536
    s_cbranch_scc1 L_gs_110
    s_branch L_gb_109
L_gs_112:
    s_add_u32 s3, s22, 6144
    s_cmp_ge_u32 s3, s28
    s_cselect_b32 s18, 57344, 0
    s_sub_u32 s3, s3, s18
    buffer_load_dwordx4 v[88:91], v123, s[52:55], s3 offen sc1
    buffer_load_dwordx4 v[92:95], v122, s[52:55], s3 offen sc1
    s_add_u32 s3, s22, 8192
    s_cmp_ge_u32 s3, s28
    s_cselect_b32 s18, 57344, 0
    s_sub_u32 s3, s3, s18
    buffer_load_dwordx4 v[96:99], v123, s[52:55], s3 offen sc1
    buffer_load_dwordx4 v[100:103], v122, s[52:55], s3 offen sc1
    s_add_u32 s3, s22, 10240
    s_cmp_ge_u32 s3, s28
    s_cselect_b32 s18, 57344, 0
    s_sub_u32 s3, s3, s18
    buffer_load_dwordx4 v[64:67], v123, s[52:55], s3 offen sc1
    buffer_load_dwordx4 v[68:71], v122, s[52:55], s3 offen sc1
    s_add_u32 s3, s22, 12288
    s_cmp_ge_u32 s3, s28
    s_cselect_b32 s18, 57344, 0
    s_sub_u32 s3, s3, s18
    buffer_load_dwordx4 v[72:75], v123, s[52:55], s3 offen sc1
    buffer_load_dwordx4 v[76:79], v122, s[52:55], s3 offen sc1
    s_waitcnt vmcnt(0)
    v_max_u32 v121, v91, v95
    v_cmp_eq_u32 vcc, -1, v121
    s_add_u32 s85, s85, 1
    s_cbranch_vccz L_gb_111
    s_cmp_lt_u32 s85, 65536
    s_cbranch_scc1 L_gs_112
    s_branch L_gb_111
L_gs_114:
    s_add_u32 s3, s22, 8192
    s_cmp_ge_u32 s3, s28
    s_cselect_b32 s18, 57344, 0
    s_sub_u32 s3, s3, s18
    buffer_load_dwordx4 v[96:99], v123, s[52:55], s3 offen sc1
    buffer_load_dwordx4 v[100:103], v122, s[52:55], s3 offen sc1
    s_add_u32 s3, s22, 10240
    s_cmp_ge_u32 s3, s28
    s_cselect_b32 s18, 57344, 0
    s_sub_u32 s3, s3, s18
    buffer_load_dwordx4 v[64:67], v123, s[52:55], s3 offen sc1
    buffer_load_dwordx4 v[68:71], v122, s[52:55], s3 offen sc1
    s_add_u32 s3, s22, 12288
    s_cmp_ge_u32 s3, s28
    s_cselect_b32 s18, 57344, 0
    s_sub_u32 s3, s3, s18
    buffer_load_dwordx4 v[72:75], v123, s[52:55], s3 offen sc1
    buffer_load_dwordx4 v[76:79], v122, s[52:55], s3 offen sc1
    s_add_u32 s3, s22, 14336
    s_cmp_ge_u32 s3, s28
    s_cselect_b32 s18, 57344, 0
    s_sub_u32 s3, s3, s18
    buffer_load_dwordx4 v[80:83], v123, s[52:55], s3 offen sc1
    buffer_load_dwordx4 v[84:87], v122, s[52:55], s3 offen sc1
    s_waitcnt vmcnt(0)
    v_max_u32 v121, v99, v103
    v_cmp_eq_u32 vcc, -1, v121
    s_add_u32 s85, s85, 1
    s_cbranch_vccz L_gb_113
    s_cmp_lt_u32 s85, 65536
    s_cbranch_scc1 L_gs_114
    s_branch L_gb_113
L_gs_116:
    s_add_u32 s3, s22, 10240
    s_cmp_ge_u32 s3, s28
    s_cselect_b32 s18, 57344, 0
    s_sub_u32 s3, s3, s18
    buffer_load_dwordx4 v[64:67], v123, s[52:55], s3 offen sc1
    buffer_load_dwordx4 v[68:71], v122, s[52:55], s3 offen sc1
    s_add_u32 s3, s22, 12288
    s_cmp_ge_u32 s3, s28
    s_cselect_b32 s18, 57344, 0
    s_sub_u32 s3, s3, s18
    buffer_load_dwordx4 v[72:75], v123, s[52:55], s3 offen sc1
    buffer_load_dwordx4 v[76:79], v122, s[52:55], s3 offen sc1
    s_add_u32 s3, s22, 14336
    s_cmp_ge_u32 s3, s28
    s_cselect_b32 s18, 57344, 0
    s_sub_u32 s3, s3, s18
    buffer_load_dwordx4 v[80:83], v123, s[52:55], s3 offen sc1
    buffer_load_dwordx4 v[84:87], v122, s[52:55], s3 offen sc1
    s_add_u32 s3, s22, 16384
    s_cmp_ge_u32 s3, s28
    s_cselect_b32 s18, 57344, 0
    s_sub_u32 s3, s3, s18
    buffer_load_dwordx4 v[88:91], v123, s[52:55], s3 offen sc1
    buffer_load_dwordx4 v[92:95], v122, s[52:55], s3 offen sc1
    s_waitcnt vmcnt(0)
    v_max_u32 v121, v67, v71
    v_cmp_eq_u32 vcc, -1, v121
    s_add_u32 s85, s85, 1
    s_cbranch_vccz L_gb_115
    s_cmp_lt_u32 s85, 65536
    s_cbranch_scc1 L_gs_116
    s_branch L_gb_115
L_gs_118:
    s_add_u32 s3, s22, 12288
    s_cmp_ge_u32 s3, s28
    s_cselect_b32 s18, 57344, 0
    s_sub_u32 s3, s3, s18
    buffer_load_dwordx4 v[72:75], v123, s[52:55], s3 offen sc1
    buffer_load_dwordx4 v[76:79], v122, s[52:55], s3 offen sc1
    s_add_u32 s3, s22, 14336
    s_cmp_ge_u32 s3, s28
    s_cselect_b32 s18, 57344, 0
    s_sub_u32 s3, s3, s18
    buffer_load_dwordx4 v[80:83], v123, s[52:55], s3 offen sc1
    buffer_load_dwordx4 v[84:87], v122, s[52:55], s3 offen sc1
    s_add_u32 s3, s22, 16384
    s_cmp_ge_u32 s3, s28
    s_cselect_b32 s18, 57344, 0
    s_sub_u32 s3, s3, s18
    buffer_load_dwordx4 v[88:91], v123, s[52:55], s3 offen sc1
    buffer_load_dwordx4 v[92:95], v122, s[52:55], s3 offen sc1
    s_add_u32 s3, s22, 18432
    s_cmp_ge_u32 s3, s28
    s_cselect_b32 s18, 57344, 0
    s_sub_u32 s3, s3, s18
    buffer_load_dwordx4 v[96:99], v123, s[52:55], s3 offen sc1
    buffer_load_dwordx4 v[100:103], v122, s[52:55], s3 offen sc1
    s_waitcnt vmcnt(0)
    v_max_u32 v121, v75, v79
    v_cmp_eq_u32 vcc, -1, v121
    s_add_u32 s85, s85, 1
    s_cbranch_vccz L_gb_117
    s_cmp_lt_u32 s85, 65536
    s_cbranch_scc1 L_gs_118
    s_branch L_gb_117
L_gs_120:
    s_add_u32 s3, s22, 14336
    s_cmp_ge_u32 s3, s28
    s_cselect_b32 s18, 57344, 0
    s_sub_u32 s3, s3, s18
    buffer_load_dwordx4 v[80:83], v123, s[52:55], s3 offen sc1
    buffer_load_dwordx4 v[84:87], v122, s[52:55], s3 offen sc1
    s_add_u32 s3, s22, 16384
    s_cmp_ge_u32 s3, s28
    s_cselect_b32 s18, 57344, 0
    s_sub_u32 s3, s3, s18
    buffer_load_dwordx4 v[88:91], v123, s[52:55], s3 offen sc1
    buffer_load_dwordx4 v[92:95], v122, s[52:55], s3 offen sc1
    s_add_u32 s3, s22, 18432
    s_cmp_ge_u32 s3, s28
    s_cselect_b32 s18, 57344, 0
    s_sub_u32 s3, s3, s18
    buffer_load_dwordx4 v[96:99], v123, s[52:55], s3 offen sc1
    buffer_load_dwordx4 v[100:103], v122, s[52:55], s3 offen sc1
    s_add_u32 s3, s22, 20480
    s_cmp_ge_u32 s3, s28
    s_cselect_b32 s18, 57344, 0
    s_sub_u32 s3, s3, s18
    buffer_load_dwordx4 v[64:67], v123, s[52:55], s3 offen sc1
    buffer_load_dwordx4 v[68:71], v122, s[52:55], s3 offen sc1
    s_waitcnt vmcnt(0)
    v_max_u32 v121, v83, v87
    v_cmp_eq_u32 vcc, -1, v121
    s_add_u32 s85, s85, 1
    s_cbranch_vccz L_gb_119
    s_cmp_lt_u32 s85, 65536
    s_cbranch_scc1 L_gs_120
    s_branch L_gb_119
L_gs_122:
    s_add_u32 s3, s22, 16384
    s_cmp_ge_u32 s3, s28
    s_cselect_b32 s18, 57344, 0
    s_sub_u32 s3, s3, s18
    buffer_load_dwordx4 v[88:91], v123, s[52:55], s3 offen sc1
    buffer_load_dwordx4 v[92:95], v122, s[52:55], s3 offen sc1
    s_add_u32 s3, s22, 18432
    s_cmp_ge_u32 s3, s28
    s_cselect_b32 s18, 57344, 0
    s_sub_u32 s3, s3, s18
    buffer_load_dwordx4 v[96:99], v123, s[52:55], s3 offen sc1
    buffer_load_dwordx4 v[100:103], v122, s[52:55], s3 offen sc1
    s_add_u32 s3, s22, 20480
    s_cmp_ge_u32 s3, s28
    s_cselect_b32 s18, 57344, 0
    s_sub_u32 s3, s3, s18
    buffer_load_dwordx4 v[64:67], v123, s[52:55], s3 offen sc1
    buffer_load_dwordx4 v[68:71], v122, s[52:55], s3 offen sc1
    s_add_u32 s3, s22, 22528
    s_cmp_ge_u32 s3, s28
    s_cselect_b32 s18, 57344, 0
    s_sub_u32 s3, s3, s18
    buffer_load_dwordx4 v[72:75], v123, s[52:55], s3 offen sc1
    buffer_load_dwordx4 v[76:79], v122, s[52:55], s3 offen sc1
    s_waitcnt vmcnt(0)
    v_max_u32 v121, v91, v95
    v_cmp_eq_u32 vcc, -1, v121
    s_add_u32 s85, s85, 1
    s_cbranch_vccz L_gb_121
    s_cmp_lt_u32 s85, 65536
    s_cbranch_scc1 L_gs_122
    s_branch L_gb_121
L_gs_124:
    s_add_u32 s3, s22, 18432
    s_cmp_ge_u32 s3, s28
    s_cselect_b32 s18, 57344, 0
    s_sub_u32 s3, s3, s18
    buffer_load_dwordx4 v[96:99], v123, s[52:55], s3 offen sc1
    buffer_load_dwordx4 v[100:103], v122, s[52:55], s3 offen sc1
    s_add_u32 s3, s22, 20480
    s_cmp_ge_u32 s3, s28
    s_cselect_b32 s18, 57344, 0
    s_sub_u32 s3, s3, s18
    buffer_load_dwordx4 v[64:67], v123, s[52:55], s3 offen sc1
    buffer_load_dwordx4 v[68:71], v122, s[52:55], s3 offen sc1
    s_add_u32 s3, s22, 22528
    s_cmp_ge_u32 s3, s28
    s_cselect_b32 s18, 57344, 0
    s_sub_u32 s3, s3, s18
    buffer_load_dwordx4 v[72:75], v123, s[52:55], s3 offen sc1
    buffer_load_dwordx4 v[76:79], v122, s[52:55], s3 offen sc1
    s_add_u32 s3, s22, 24576
    s_cmp_ge_u32 s3, s28
    s_cselect_b32 s18, 57344, 0
    s_sub_u32 s3, s3, s18
    buffer_load_dwordx4 v[80:83], v123, s[52:55], s3 offen sc1
    buffer_load_dwordx4 v[84:87], v122, s[52:55], s3 offen sc1
    s_waitcnt vmcnt(0)
    v_max_u32 v121, v99, v103
    v_cmp_eq_u32 vcc, -1, v121
    s_add_u32 s85, s85, 1
    s_cbranch_vccz L_gb_123
    s_cmp_lt_u32 s85, 65536
    s_cbranch_scc1 L_gs_124
    s_branch L_gb_123
L_gs_126:
    s_add_u32 s3, s22, 20480
    s_cmp_ge_u32 s3, s28
    s_cselect_b32 s18, 57344, 0
    s_sub_u32 s3, s3, s18
    buffer_load_dwordx4 v[64:67], v123, s[52:55], s3 offen sc1
    buffer_load_dwordx4 v[68:71], v122, s[52:55], s3 offen sc1
    s_add_u32 s3, s22, 22528
    s_cmp_ge_u32 s3, s28
    s_cselect_b32 s18, 57344, 0
    s_sub_u32 s3, s3, s18
    buffer_load_dwordx4 v[72:75], v123, s[52:55], s3 offen sc1
    buffer_load_dwordx4 v[76:79], v122, s[52:55], s3 offen sc1
    s_add_u32 s3, s22, 24576
    s_cmp_ge_u32 s3, s28
    s_cselect_b32 s18, 57344, 0
    s_sub_u32 s3, s3, s18
    buffer_load_dwordx4 v[80:83], v123, s[52:55], s3 offen sc1
    buffer_load_dwordx4 v[84:87], v122, s[52:55], s3 offen sc1
    s_add_u32 s3, s22, 26624
    s_cmp_ge_u32 s3, s28
    s_cselect_b32 s18, 57344, 0
    s_sub_u32 s3, s3, s18
    buffer_load_dwordx4 v[88:91], v123, s[52:55], s3 offen sc1
    buffer_load_dwordx4 v[92:95], v122, s[52:55], s3 offen sc1
    s_waitcnt vmcnt(0)
    v_max_u32 v121, v67, v71
    v_cmp_eq_u32 vcc, -1, v121
    s_add_u32 s85, s85, 1
    s_cbranch_vccz L_gb_125
    s_cmp_lt_u32 s85, 65536
    s_cbranch_scc1 L_gs_126
    s_branch L_gb_125
L_gs_128:
    s_add_u32 s3, s22, 22528
    s_cmp_ge_u32 s3, s28
    s_cselect_b32 s18, 57344, 0
    s_sub_u32 s3, s3, s18
    buffer_load_dwordx4 v[72:75], v123, s[52:55], s3 offen sc1
    buffer_load_dwordx4 v[76:79], v122, s[52:55], s3 offen sc1
    s_add_u32 s3, s22, 24576
    s_cmp_ge_u32 s3, s28
    s_cselect_b32 s18, 57344, 0
    s_sub_u32 s3, s3, s18
    buffer_load_dwordx4 v[80:83], v123, s[52:55], s3 offen sc1
    buffer_load_dwordx4 v[84:87], v122, s[52:55], s3 offen sc1
    s_add_u32 s3, s22, 26624
    s_cmp_ge_u32 s3, s28
    s_cselect_b32 s18, 57344, 0
    s_sub_u32 s3, s3, s18
    buffer_load_dwordx4 v[88:91], v123, s[52:55], s3 offen sc1
    buffer_load_dwordx4 v[92:95], v122, s[52:55], s3 offen sc1
    s_add_u32 s3, s22, 28672
    s_cmp_ge_u32 s3, s28
    s_cselect_b32 s18, 57344, 0
    s_sub_u32 s3, s3, s18
    buffer_load_dwordx4 v[96:99], v123, s[52:55], s3 offen sc1
    buffer_load_dwordx4 v[100:103], v122, s[52:55], s3 offen sc1
    s_waitcnt vmcnt(0)
    v_max_u32 v121, v75, v79
    v_cmp_eq_u32 vcc, -1, v121
    s_add_u32 s85, s85, 1
    s_cbranch_vccz L_gb_127
    s_cmp_lt_u32 s85, 65536
    s_cbranch_scc1 L_gs_128
    s_branch L_gb_127
L_gs_130:
    s_add_u32 s3, s22, 24576
    s_cmp_ge_u32 s3, s28
    s_cselect_b32 s18, 57344, 0
    s_sub_u32 s3, s3, s18
    buffer_load_dwordx4 v[80:83], v123, s[52:55], s3 offen sc1
    buffer_load_dwordx4 v[84:87], v122, s[52:55], s3 offen sc1
    s_add_u32 s3, s22, 26624
    s_cmp_ge_u32 s3, s28
    s_cselect_b32 s18, 57344, 0
    s_sub_u32 s3, s3, s18
    buffer_load_dwordx4 v[88:91], v123, s[52:55], s3 offen sc1
    buffer_load_dwordx4 v[92:95], v122, s[52:55], s3 offen sc1
    s_add_u32 s3, s22, 28672
    s_cmp_ge_u32 s3, s28
    s_cselect_b32 s18, 57344, 0
    s_sub_u32 s3, s3, s18
    buffer_load_dwordx4 v[96:99], v123, s[52:55], s3 offen sc1
    buffer_load_dwordx4 v[100:103], v122, s[52:55], s3 offen sc1
    s_add_u32 s3, s22, 30720
    s_cmp_ge_u32 s3, s28
    s_cselect_b32 s18, 57344, 0
    s_sub_u32 s3, s3, s18
    buffer_load_dwordx4 v[64:67], v123, s[52:55], s3 offen sc1
    buffer_load_dwordx4 v[68:71], v122, s[52:55], s3 offen sc1
    s_waitcnt vmcnt(0)
    v_max_u32 v121, v83, v87
    v_cmp_eq_u32 vcc, -1, v121
    s_add_u32 s85, s85, 1
    s_cbranch_vccz L_gb_129
    s_cmp_lt_u32 s85, 65536
    s_cbranch_scc1 L_gs_130
    s_branch L_gb_129
L_gs_132:
    s_add_u32 s3, s22, 26624
    s_cmp_ge_u32 s3, s28
    s_cselect_b32 s18, 57344, 0
    s_sub_u32 s3, s3, s18
    buffer_load_dwordx4 v[88:91], v123, s[52:55], s3 offen sc1
    buffer_load_dwordx4 v[92:95], v122, s[52:55], s3 offen sc1
    s_add_u32 s3, s22, 28672
    s_cmp_ge_u32 s3, s28
    s_cselect_b32 s18, 57344, 0
    s_sub_u32 s3, s3, s18
    buffer_load_dwordx4 v[96:99], v123, s[52:55], s3 offen sc1
    buffer_load_dwordx4 v[100:103], v122, s[52:55], s3 offen sc1
    s_add_u32 s3, s22, 30720
    s_cmp_ge_u32 s3, s28
    s_cselect_b32 s18, 57344, 0
    s_sub_u32 s3, s3, s18
    buffer_load_dwordx4 v[64:67], v123, s[52:55], s3 offen sc1
    buffer_load_dwordx4 v[68:71], v122, s[52:55], s3 offen sc1
    s_add_u32 s3, s22, 32768
    s_cmp_ge_u32 s3, s28
    s_cselect_b32 s18, 57344, 0
    s_sub_u32 s3, s3, s18
    buffer_load_dwordx4 v[72:75], v123, s[52:55], s3 offen sc1
    buffer_load_dwordx4 v[76:79], v122, s[52:55], s3 offen sc1
    s_waitcnt vmcnt(0)
    v_max_u32 v121, v91, v95
    v_cmp_eq_u32 vcc, -1, v121
    s_add_u32 s85, s85, 1
    s_cbranch_vccz L_gb_131
    s_cmp_lt_u32 s85, 65536
    s_cbranch_scc1 L_gs_132
    s_branch L_gb_131
L_gs_134:
    s_add_u32 s3, s22, 28672
    s_cmp_ge_u32 s3, s28
    s_cselect_b32 s18, 57344, 0
    s_sub_u32 s3, s3, s18
    buffer_load_dwordx4 v[96:99], v123, s[52:55], s3 offen sc1
    buffer_load_dwordx4 v[100:103], v122, s[52:55], s3 offen sc1
    s_add_u32 s3, s22, 30720
    s_cmp_ge_u32 s3, s28
    s_cselect_b32 s18, 57344, 0
    s_sub_u32 s3, s3, s18
    buffer_load_dwordx4 v[64:67], v123, s[52:55], s3 offen sc1
    buffer_load_dwordx4 v[68:71], v122, s[52:55], s3 offen sc1
    s_add_u32 s3, s22, 32768
    s_cmp_ge_u32 s3, s28
    s_cselect_b32 s18, 57344, 0
    s_sub_u32 s3, s3, s18
    buffer_load_dwordx4 v[72:75], v123, s[52:55], s3 offen sc1
    buffer_load_dwordx4 v[76:79], v122, s[52:55], s3 offen sc1
    s_add_u32 s3, s22, 34816
    s_cmp_ge_u32 s3, s28
    s_cselect_b32 s18, 57344, 0
    s_sub_u32 s3, s3, s18
    buffer_load_dwordx4 v[80:83], v123, s[52:55], s3 offen sc1
    buffer_load_dwordx4 v[84:87], v122, s[52:55], s3 offen sc1
    s_waitcnt vmcnt(0)
    v_max_u32 v121, v99, v103
    v_cmp_eq_u32 vcc, -1, v121
    s_add_u32 s85, s85, 1
    s_cbranch_vccz L_gb_133
    s_cmp_lt_u32 s85, 65536
    s_cbranch_scc1 L_gs_134
    s_branch L_gb_133
L_gs_136:
    s_add_u32 s3, s22, 30720
    s_cmp_ge_u32 s3, s28
    s_cselect_b32 s18, 57344, 0
    s_sub_u32 s3, s3, s18
    buffer_load_dwordx4 v[64:67], v123, s[52:55], s3 offen sc1
    buffer_load_dwordx4 v[68:71], v122, s[52:55], s3 offen sc1
    s_add_u32 s3, s22, 32768
    s_cmp_ge_u32 s3, s28
    s_cselect_b32 s18, 57344, 0
    s_sub_u32 s3, s3, s18
    buffer_load_dwordx4 v[72:75], v123, s[52:55], s3 offen sc1
    buffer_load_dwordx4 v[76:79], v122, s[52:55], s3 offen sc1
    s_add_u32 s3, s22, 34816
    s_cmp_ge_u32 s3, s28
    s_cselect_b32 s18, 57344, 0
    s_sub_u32 s3, s3, s18
    buffer_load_dwordx4 v[80:83], v123, s[52:55], s3 offen sc1
    buffer_load_dwordx4 v[84:87], v122, s[52:55], s3 offen sc1
    s_add_u32 s3, s22, 36864
    s_cmp_ge_u32 s3, s28
    s_cselect_b32 s18, 57344, 0
    s_sub_u32 s3, s3, s18
    buffer_load_dwordx4 v[88:91], v123, s[52:55], s3 offen sc1
    buffer_load_dwordx4 v[92:95], v122, s[52:55], s3 offen sc1
    s_waitcnt vmcnt(0)
    v_max_u32 v121, v67, v71
    v_cmp_eq_u32 vcc, -1, v121
    s_add_u32 s85, s85, 1
    s_cbranch_vccz L_gb_135
    s_cmp_lt_u32 s85, 65536
    s_cbranch_scc1 L_gs_136
    s_branch L_gb_135
L_gs_138:
    s_add_u32 s3, s22, 32768
    s_cmp_ge_u32 s3, s28
    s_cselect_b32 s18, 57344, 0
    s_sub_u32 s3, s3, s18
    buffer_load_dwordx4 v[72:75], v123, s[52:55], s3 offen sc1
    buffer_load_dwordx4 v[76:79], v122, s[52:55], s3 offen sc1
    s_add_u32 s3, s22, 34816
    s_cmp_ge_u32 s3, s28
    s_cselect_b32 s18, 57344, 0
    s_sub_u32 s3, s3, s18
    buffer_load_dwordx4 v[80:83], v123, s[52:55], s3 offen sc1
    buffer_load_dwordx4 v[84:87], v122, s[52:55], s3 offen sc1
    s_add_u32 s3, s22, 36864
    s_cmp_ge_u32 s3, s28
    s_cselect_b32 s18, 57344, 0
    s_sub_u32 s3, s3, s18
    buffer_load_dwordx4 v[88:91], v123, s[52:55], s3 offen sc1
    buffer_load_dwordx4 v[92:95], v122, s[52:55], s3 offen sc1
    s_add_u32 s3, s22, 38912
    s_cmp_ge_u32 s3, s28
    s_cselect_b32 s18, 57344, 0
    s_sub_u32 s3, s3, s18
    buffer_load_dwordx4 v[96:99], v123, s[52:55], s3 offen sc1
    buffer_load_dwordx4 v[100:103], v122, s[52:55], s3 offen sc1
    s_waitcnt vmcnt(0)
    v_max_u32 v121, v75, v79
    v_cmp_eq_u32 vcc, -1, v121
    s_add_u32 s85, s85, 1
    s_cbranch_vccz L_gb_137
    s_cmp_lt_u32 s85, 65536
    s_cbranch_scc1 L_gs_138
    s_branch L_gb_137
L_gs_140:
    s_add_u32 s3, s22, 34816
    s_cmp_ge_u32 s3, s28
    s_cselect_b32 s18, 57344, 0
    s_sub_u32 s3, s3, s18
    buffer_load_dwordx4 v[80:83], v123, s[52:55], s3 offen sc1
    buffer_load_dwordx4 v[84:87], v122, s[52:55], s3 offen sc1
    s_add_u32 s3, s22, 36864
    s_cmp_ge_u32 s3, s28
    s_cselect_b32 s18, 57344, 0
    s_sub_u32 s3, s3, s18
    buffer_load_dwordx4 v[88:91], v123, s[52:55], s3 offen sc1
    buffer_load_dwordx4 v[92:95], v122, s[52:55], s3 offen sc1
    s_add_u32 s3, s22, 38912
    s_cmp_ge_u32 s3, s28
    s_cselect_b32 s18, 57344, 0
    s_sub_u32 s3, s3, s18
    buffer_load_dwordx4 v[96:99], v123, s[52:55], s3 offen sc1
    buffer_load_dwordx4 v[100:103], v122, s[52:55], s3 offen sc1
    s_add_u32 s3, s22, 40960
    s_cmp_ge_u32 s3, s28
    s_cselect_b32 s18, 57344, 0
    s_sub_u32 s3, s3, s18
    buffer_load_dwordx4 v[64:67], v123, s[52:55], s3 offen sc1
    buffer_load_dwordx4 v[68:71], v122, s[52:55], s3 offen sc1
    s_waitcnt vmcnt(0)
    v_max_u32 v121, v83, v87
    v_cmp_eq_u32 vcc, -1, v121
    s_add_u32 s85, s85, 1
    s_cbranch_vccz L_gb_139
    s_cmp_lt_u32 s85, 65536
    s_cbranch_scc1 L_gs_140
    s_branch L_gb_139
L_gs_142:
    s_add_u32 s3, s22, 36864
    s_cmp_ge_u32 s3, s28
    s_cselect_b32 s18, 57344, 0
    s_sub_u32 s3, s3, s18
    buffer_load_dwordx4 v[88:91], v123, s[52:55], s3 offen sc1
    buffer_load_dwordx4 v[92:95], v122, s[52:55], s3 offen sc1
    s_add_u32 s3, s22, 38912
    s_cmp_ge_u32 s3, s28
    s_cselect_b32 s18, 57344, 0
    s_sub_u32 s3, s3, s18
    buffer_load_dwordx4 v[96:99], v123, s[52:55], s3 offen sc1
    buffer_load_dwordx4 v[100:103], v122, s[52:55], s3 offen sc1
    s_add_u32 s3, s22, 40960
    s_cmp_ge_u32 s3, s28
    s_cselect_b32 s18, 57344, 0
    s_sub_u32 s3, s3, s18
    buffer_load_dwordx4 v[64:67], v123, s[52:55], s3 offen sc1
    buffer_load_dwordx4 v[68:71], v122, s[52:55], s3 offen sc1
    s_add_u32 s3, s22, 43008
    s_cmp_ge_u32 s3, s28
    s_cselect_b32 s18, 57344, 0
    s_sub_u32 s3, s3, s18
    buffer_load_dwordx4 v[72:75], v123, s[52:55], s3 offen sc1
    buffer_load_dwordx4 v[76:79], v122, s[52:55], s3 offen sc1
    s_waitcnt vmcnt(0)
    v_max_u32 v121, v91, v95
    v_cmp_eq_u32 vcc, -1, v121
    s_add_u32 s85, s85, 1
    s_cbranch_vccz L_gb_141
    s_cmp_lt_u32 s85, 65536
    s_cbranch_scc1 L_gs_142
    s_branch L_gb_141
L_gs_144:
    s_add_u32 s3, s22, 38912
    s_cmp_ge_u32 s3, s28
    s_cselect_b32 s18, 57344, 0
    s_sub_u32 s3, s3, s18
    buffer_load_dwordx4 v[96:99], v123, s[52:55], s3 offen sc1
    buffer_load_dwordx4 v[100:103], v122, s[52:55], s3 offen sc1
    s_add_u32 s3, s22, 40960
    s_cmp_ge_u32 s3, s28
    s_cselect_b32 s18, 57344, 0
    s_sub_u32 s3, s3, s18
    buffer_load_dwordx4 v[64:67], v123, s[52:55], s3 offen sc1
    buffer_load_dwordx4 v[68:71], v122, s[52:55], s3 offen sc1
    s_add_u32 s3, s22, 43008
    s_cmp_ge_u32 s3, s28
    s_cselect_b32 s18, 57344, 0
    s_sub_u32 s3, s3, s18
    buffer_load_dwordx4 v[72:75], v123, s[52:55], s3 offen sc1
    buffer_load_dwordx4 v[76:79], v122, s[52:55], s3 offen sc1
    s_add_u32 s3, s22, 45056
    s_cmp_ge_u32 s3, s28
    s_cselect_b32 s18, 57344, 0
    s_sub_u32 s3, s3, s18
    buffer_load_dwordx4 v[80:83], v123, s[52:55], s3 offen sc1
    buffer_load_dwordx4 v[84:87], v122, s[52:55], s3 offen sc1
    s_waitcnt vmcnt(0)
    v_max_u32 v121, v99, v103
    v_cmp_eq_u32 vcc, -1, v121
    s_add_u32 s85, s85, 1
    s_cbranch_vccz L_gb_143
    s_cmp_lt_u32 s85, 65536
    s_cbranch_scc1 L_gs_144
    s_branch L_gb_143
L_gs_146:
    s_add_u32 s3, s22, 40960
    s_cmp_ge_u32 s3, s28
    s_cselect_b32 s18, 57344, 0
    s_sub_u32 s3, s3, s18
    buffer_load_dwordx4 v[64:67], v123, s[52:55], s3 offen sc1
    buffer_load_dwordx4 v[68:71], v122, s[52:55], s3 offen sc1
    s_add_u32 s3, s22, 43008
    s_cmp_ge_u32 s3, s28
    s_cselect_b32 s18, 57344, 0
    s_sub_u32 s3, s3, s18
    buffer_load_dwordx4 v[72:75], v123, s[52:55], s3 offen sc1
    buffer_load_dwordx4 v[76:79], v122, s[52:55], s3 offen sc1
    s_add_u32 s3, s22, 45056
    s_cmp_ge_u32 s3, s28
    s_cselect_b32 s18, 57344, 0
    s_sub_u32 s3, s3, s18
    buffer_load_dwordx4 v[80:83], v123, s[52:55], s3 offen sc1
    buffer_load_dwordx4 v[84:87], v122, s[52:55], s3 offen sc1
    s_add_u32 s3, s22, 47104
    s_cmp_ge_u32 s3, s28
    s_cselect_b32 s18, 57344, 0
    s_sub_u32 s3, s3, s18
    buffer_load_dwordx4 v[88:91], v123, s[52:55], s3 offen sc1
    buffer_load_dwordx4 v[92:95], v122, s[52:55], s3 offen sc1
    s_waitcnt vmcnt(0)
    v_max_u32 v121, v67, v71
    v_cmp_eq_u32 vcc, -1, v121
    s_add_u32 s85, s85, 1
    s_cbranch_vccz L_gb_145
    s_cmp_lt_u32 s85, 65536
    s_cbranch_scc1 L_gs_146
    s_branch L_gb_145
L_gs_148:
    s_add_u32 s3, s22, 43008
    s_cmp_ge_u32 s3, s28
    s_cselect_b32 s18, 57344, 0
    s_sub_u32 s3, s3, s18
    buffer_load_dwordx4 v[72:75], v123, s[52:55], s3 offen sc1
    buffer_load_dwordx4 v[76:79], v122, s[52:55], s3 offen sc1
    s_add_u32 s3, s22, 45056
    s_cmp_ge_u32 s3, s28
    s_cselect_b32 s18, 57344, 0
    s_sub_u32 s3, s3, s18
    buffer_load_dwordx4 v[80:83], v123, s[52:55], s3 offen sc1
    buffer_load_dwordx4 v[84:87], v122, s[52:55], s3 offen sc1
    s_add_u32 s3, s22, 47104
    s_cmp_ge_u32 s3, s28
    s_cselect_b32 s18, 57344, 0
    s_sub_u32 s3, s3, s18
    buffer_load_dwordx4 v[88:91], v123, s[52:55], s3 offen sc1
    buffer_load_dwordx4 v[92:95], v122, s[52:55], s3 offen sc1
    s_add_u32 s3, s22, 49152
    s_cmp_ge_u32 s3, s28
    s_cselect_b32 s18, 57344, 0
    s_sub_u32 s3, s3, s18
    buffer_load_dwordx4 v[96:99], v123, s[52:55], s3 offen sc1
    buffer_load_dwordx4 v[100:103], v122, s[52:55], s3 offen sc1
    s_waitcnt vmcnt(0)
    v_max_u32 v121, v75, v79
    v_cmp_eq_u32 vcc, -1, v121
    s_add_u32 s85, s85, 1
    s_cbranch_vccz L_gb_147
    s_cmp_lt_u32 s85, 65536
    s_cbranch_scc1 L_gs_148
    s_branch L_gb_147
L_gs_150:
    s_add_u32 s3, s22, 45056
    s_cmp_ge_u32 s3, s28
    s_cselect_b32 s18, 57344, 0
    s_sub_u32 s3, s3, s18
    buffer_load_dwordx4 v[80:83], v123, s[52:55], s3 offen sc1
    buffer_load_dwordx4 v[84:87], v122, s[52:55], s3 offen sc1
    s_add_u32 s3, s22, 47104
    s_cmp_ge_u32 s3, s28
    s_cselect_b32 s18, 57344, 0
    s_sub_u32 s3, s3, s18
    buffer_load_dwordx4 v[88:91], v123, s[52:55], s3 offen sc1
    buffer_load_dwordx4 v[92:95], v122, s[52:55], s3 offen sc1
    s_add_u32 s3, s22, 49152
    s_cmp_ge_u32 s3, s28
    s_cselect_b32 s18, 57344, 0
    s_sub_u32 s3, s3, s18
    buffer_load_dwordx4 v[96:99], v123, s[52:55], s3 offen sc1
    buffer_load_dwordx4 v[100:103], v122, s[52:55], s3 offen sc1
    s_add_u32 s3, s22, 51200
    s_cmp_ge_u32 s3, s28
    s_cselect_b32 s18, 57344, 0
    s_sub_u32 s3, s3, s18
    buffer_load_dwordx4 v[64:67], v123, s[52:55], s3 offen sc1
    buffer_load_dwordx4 v[68:71], v122, s[52:55], s3 offen sc1
    s_waitcnt vmcnt(0)
    v_max_u32 v121, v83, v87
    v_cmp_eq_u32 vcc, -1, v121
    s_add_u32 s85, s85, 1
    s_cbranch_vccz L_gb_149
    s_cmp_lt_u32 s85, 65536
    s_cbranch_scc1 L_gs_150
    s_branch L_gb_149
L_gs_152:
    s_add_u32 s3, s22, 47104
    s_cmp_ge_u32 s3, s28
    s_cselect_b32 s18, 57344, 0
    s_sub_u32 s3, s3, s18
    buffer_load_dwordx4 v[88:91], v123, s[52:55], s3 offen sc1
    buffer_load_dwordx4 v[92:95], v122, s[52:55], s3 offen sc1
    s_add_u32 s3, s22, 49152
    s_cmp_ge_u32 s3, s28
    s_cselect_b32 s18, 57344, 0
    s_sub_u32 s3, s3, s18
    buffer_load_dwordx4 v[96:99], v123, s[52:55], s3 offen sc1
    buffer_load_dwordx4 v[100:103], v122, s[52:55], s3 offen sc1
    s_add_u32 s3, s22, 51200
    s_cmp_ge_u32 s3, s28
    s_cselect_b32 s18, 57344, 0
    s_sub_u32 s3, s3, s18
    buffer_load_dwordx4 v[64:67], v123, s[52:55], s3 offen sc1
    buffer_load_dwordx4 v[68:71], v122, s[52:55], s3 offen sc1
    s_add_u32 s3, s22, 53248
    s_cmp_ge_u32 s3, s28
    s_cselect_b32 s18, 57344, 0
    s_sub_u32 s3, s3, s18
    buffer_load_dwordx4 v[72:75], v123, s[52:55], s3 offen sc1
    buffer_load_dwordx4 v[76:79], v122, s[52:55], s3 offen sc1
    s_waitcnt vmcnt(0)
    v_max_u32 v121, v91, v95
    v_cmp_eq_u32 vcc, -1, v121
    s_add_u32 s85, s85, 1
    s_cbranch_vccz L_gb_151
    s_cmp_lt_u32 s85, 65536
    s_cbranch_scc1 L_gs_152
    s_branch L_gb_151
L_gs_154:
    s_add_u32 s3, s22, 49152
    s_cmp_ge_u32 s3, s28
    s_cselect_b32 s18, 57344, 0
    s_sub_u32 s3, s3, s18
    buffer_load_dwordx4 v[96:99], v123, s[52:55], s3 offen sc1
    buffer_load_dwordx4 v[100:103], v122, s[52:55], s3 offen sc1
    s_add_u32 s3, s22, 51200
    s_cmp_ge_u32 s3, s28
    s_cselect_b32 s18, 57344, 0
    s_sub_u32 s3, s3, s18
    buffer_load_dwordx4 v[64:67], v123, s[52:55], s3 offen sc1
    buffer_load_dwordx4 v[68:71], v122, s[52:55], s3 offen sc1
    s_add_u32 s3, s22, 53248
    s_cmp_ge_u32 s3, s28
    s_cselect_b32 s18, 57344, 0
    s_sub_u32 s3, s3, s18
    buffer_load_dwordx4 v[72:75], v123, s[52:55], s3 offen sc1
    buffer_load_dwordx4 v[76:79], v122, s[52:55], s3 offen sc1
    s_add_u32 s3, s22, 55296
    s_cmp_ge_u32 s3, s28
    s_cselect_b32 s18, 57344, 0
    s_sub_u32 s3, s3, s18
    buffer_load_dwordx4 v[80:83], v123, s[52:55], s3 offen sc1
    buffer_load_dwordx4 v[84:87], v122, s[52:55], s3 offen sc1
    s_waitcnt vmcnt(0)
    v_max_u32 v121, v99, v103
    v_cmp_eq_u32 vcc, -1, v121
    s_add_u32 s85, s85, 1
    s_cbranch_vccz L_gb_153
    s_cmp_lt_u32 s85, 65536
    s_cbranch_scc1 L_gs_154
    s_branch L_gb_153
L_gs_156:
    s_add_u32 s3, s22, 51200
    s_cmp_ge_u32 s3, s28
    s_cselect_b32 s18, 57344, 0
    s_sub_u32 s3, s3, s18
    buffer_load_dwordx4 v[64:67], v123, s[52:55], s3 offen sc1
    buffer_load_dwordx4 v[68:71], v122, s[52:55], s3 offen sc1
    s_add_u32 s3, s22, 53248
    s_cmp_ge_u32 s3, s28
    s_cselect_b32 s18, 57344, 0
    s_sub_u32 s3, s3, s18
    buffer_load_dwordx4 v[72:75], v123, s[52:55], s3 offen sc1
    buffer_load_dwordx4 v[76:79], v122, s[52:55], s3 offen sc1
    s_add_u32 s3, s22, 55296
    s_cmp_ge_u32 s3, s28
    s_cselect_b32 s18, 57344, 0
    s_sub_u32 s3, s3, s18
    buffer_load_dwordx4 v[80:83], v123, s[52:55], s3 offen sc1
    buffer_load_dwordx4 v[84:87], v122, s[52:55], s3 offen sc1
    s_waitcnt vmcnt(0)
    v_max_u32 v121, v67, v71
    v_cmp_eq_u32 vcc, -1, v121
    s_add_u32 s85, s85, 1
    s_cbranch_vccz L_gb_155
    s_cmp_lt_u32 s85, 65536
    s_cbranch_scc1 L_gs_156
    s_branch L_gb_155
L_gs_158:
    s_add_u32 s3, s22, 53248
    s_cmp_ge_u32 s3, s28
    s_cselect_b32 s18, 57344, 0
    s_sub_u32 s3, s3, s18
    buffer_load_dwordx4 v[72:75], v123, s[52:55], s3 offen sc1
    buffer_load_dwordx4 v[76:79], v122, s[52:55], s3 offen sc1
    s_add_u32 s3, s22, 55296
    s_cmp_ge_u32 s3, s28
    s_cselect_b32 s18, 57344, 0
    s_sub_u32 s3, s3, s18
    buffer_load_dwordx4 v[80:83], v123, s[52:55], s3 offen sc1
    buffer_load_dwordx4 v[84:87], v122, s[52:55], s3 offen sc1
    s_waitcnt vmcnt(0)
    v_max_u32 v121, v75, v79
    v_cmp_eq_u32 vcc, -1, v121
    s_add_u32 s85, s85, 1
    s_cbranch_vccz L_gb_157
    s_cmp_lt_u32 s85, 65536
    s_cbranch_scc1 L_gs_158
    s_branch L_gb_157
L_gs_160:
    s_add_u32 s3, s22, 55296
    s_cmp_ge_u32 s3, s28
    s_cselect_b32 s18, 57344, 0
    s_sub_u32 s3, s3, s18
    buffer_load_dwordx4 v[80:83], v123, s[52:55], s3 offen sc1
    buffer_load_dwordx4 v[84:87], v122, s[52:55], s3 offen sc1
    s_waitcnt vmcnt(0)
    v_max_u32 v121, v83, v87
    v_cmp_eq_u32 vcc, -1, v121
    s_add_u32 s85, s85, 1
    s_cbranch_vccz L_gb_159
    s_cmp_lt_u32 s85, 65536
    s_cbranch_scc1 L_gs_160
    s_branch L_gb_159
L_ccs_169:
    s_add_u32 s85, s85, 1
    s_cmp_lt_u32 s85, 65536
    s_cbranch_scc0 L_ccb_168
    s_branch L_cca_167
L_lns_180:
    s_add_u32 s85, s85, 1
    s_cmp_lt_u32 s85, 65536
    s_cbranch_scc1 L_lna_178
    s_branch L_lnb_179
L_gs_185:
    s_add_u32 s3, s22, 0
    s_cmp_ge_u32 s3, s28
    s_cselect_b32 s18, 65536, 0
    s_sub_u32 s3, s3, s18
    buffer_load_dwordx4 v[64:67], v123, s[52:55], s3 offen sc1
    buffer_load_dwordx4 v[68:71], v122, s[52:55], s3 offen sc1
    s_add_u32 s3, s22, 2048
    s_cmp_ge_u32 s3, s28
    s_cselect_b32 s18, 65536, 0
    s_sub_u32 s3, s3, s18
    buffer_load_dwordx4 v[72:75], v123, s[52:55], s3 offen sc1
    buffer_load_dwordx4 v[76:79], v122, s[52:55], s3 offen sc1
    s_add_u32 s3, s22, 4096
    s_cmp_ge_u32 s3, s28
    s_cselect_b32 s18, 65536, 0
    s_sub_u32 s3, s3, s18
    buffer_load_dwordx4 v[80:83], v123, s[52:55], s3 offen sc1
    buffer_load_dwordx4 v[84:87], v122, s[52:55], s3 offen sc1
    s_add_u32 s3, s22, 6144
    s_cmp_ge_u32 s3, s28
    s_cselect_b32 s18, 65536, 0
    s_sub_u32 s3, s3, s18
    buffer_load_dwordx4 v[88:91], v123, s[52:55], s3 offen sc1
    buffer_load_dwordx4 v[92:95], v122, s[52:55], s3 offen sc1
    s_waitcnt vmcnt(0)
    v_max_u32 v121, v67, v71
    v_cmp_eq_u32 vcc, -1, v121
    s_add_u32 s85, s85, 1
    s_cbranch_vccz L_gb_184
    s_cmp_lt_u32 s85, 65536
    s_cbranch_scc1 L_gs_185
    s_branch L_gb_184
L_gs_187:
    s_add_u32 s3, s22, 2048
    s_cmp_ge_u32 s3, s28
    s_cselect_b32 s18, 65536, 0
    s_sub_u32 s3, s3, s18
    buffer_load_dwordx4 v[72:75], v123, s[52:55], s3 offen sc1
    buffer_load_dwordx4 v[76:79], v122, s[52:55], s3 offen sc1
    s_add_u32 s3, s22, 4096
    s_cmp_ge_u32 s3, s28
    s_cselect_b32 s18, 65536, 0
    s_sub_u32 s3, s3, s18
    buffer_load_dwordx4 v[80:83], v123, s[52:55], s3 offen sc1
    buffer_load_dwordx4 v[84:87], v122, s[52:55], s3 offen sc1
    s_add_u32 s3, s22, 6144
    s_cmp_ge_u32 s3, s28
    s_cselect_b32 s18, 65536, 0
    s_sub_u32 s3, s3, s18
    buffer_load_dwordx4 v[88:91], v123, s[52:55], s3 offen sc1
    buffer_load_dwordx4 v[92:95], v122, s[52:55], s3 offen sc1
    s_add_u32 s3, s22, 8192
    s_cmp_ge_u32 s3, s28
    s_cselect_b32 s18, 65536, 0
    s_sub_u32 s3, s3, s18
    buffer_load_dwordx4 v[96:99], v123, s[52:55], s3 offen sc1
    buffer_load_dwordx4 v[100:103], v122, s[52:55], s3 offen sc1
    s_waitcnt vmcnt(0)
    v_max_u32 v121, v75, v79
    v_cmp_eq_u32 vcc, -1, v121
    s_add_u32 s85, s85, 1
    s_cbranch_vccz L_gb_186
    s_cmp_lt_u32 s85, 65536
    s_cbranch_scc1 L_gs_187
    s_branch L_gb_186
L_gs_189:
    s_add_u32 s3, s22, 4096
    s_cmp_ge_u32 s3, s28
    s_cselect_b32 s18, 65536, 0
    s_sub_u32 s3, s3, s18
    buffer_load_dwordx4 v[80:83], v123, s[52:55], s3 offen sc1
    buffer_load_dwordx4 v[84:87], v122, s[52:55], s3 offen sc1
    s_add_u32 s3, s22, 6144
    s_cmp_ge_u32 s3, s28
    s_cselect_b32 s18, 65536, 0
    s_sub_u32 s3, s3, s18
    buffer_load_dwordx4 v[88:91], v123, s[52:55], s3 offen sc1
    buffer_load_dwordx4 v[92:95], v122, s[52:55], s3 offen sc1
    s_add_u32 s3, s22, 8192
    s_cmp_ge_u32 s3, s28
    s_cselect_b32 s18, 65536, 0
    s_sub_u32 s3, s3, s18
    buffer_load_dwordx4 v[96:99], v123, s[52:55], s3 offen sc1
    buffer_load_dwordx4 v[100:103], v122, s[52:55], s3 offen sc1
    s_add_u32 s3, s22, 10240
    s_cmp_ge_u32 s3, s28
    s_cselect_b32 s18, 65536, 0
    s_sub_u32 s3, s3, s18
    buffer_load_dwordx4 v[104:107], v123, s[52:55], s3 offen sc1
    buffer_load_dwordx4 v[108:111], v122, s[52:55], s3 offen sc1
    s_waitcnt vmcnt(0)
    v_max_u32 v121, v83, v87
    v_cmp_eq_u32 vcc, -1, v121
    s_add_u32 s85, s85, 1
    s_cbranch_vccz L_gb_188
    s_cmp_lt_u32 s85, 65536
    s_cbranch_scc1 L_gs_189
    s_branch L_gb_188
L_gs_191:
    s_add_u32 s3, s22, 6144
    s_cmp_ge_u32 s3, s28
    s_cselect_b32 s18, 65536, 0
    s_sub_u32 s3, s3, s18
    buffer_load_dwordx4 v[88:91], v123, s[52:55], s3 offen sc1
    buffer_load_dwordx4 v[92:95], v122, s[52:55], s3 offen sc1
    s_add_u32 s3, s22, 8192
    s_cmp_ge_u32 s3, s28
    s_cselect_b32 s18, 65536, 0
    s_sub_u32 s3, s3, s18
    buffer_load_dwordx4 v[96:99], v123, s[52:55], s3 offen sc1
    buffer_load_dwordx4 v[100:103], v122, s[52:55], s3 offen sc1
    s_add_u32 s3, s22, 10240
    s_cmp_ge_u32 s3, s28
    s_cselect_b32 s18, 65536, 0
    s_sub_u32 s3, s3, s18
    buffer_load_dwordx4 v[104:107], v123, s[52:55], s3 offen sc1
    buffer_load_dwordx4 v[108:111], v122, s[52:55], s3 offen sc1
    s_add_u32 s3, s22, 12288
    s_cmp_ge_u32 s3, s28
    s_cselect_b32 s18, 65536, 0
    s_sub_u32 s3, s3, s18
    buffer_load_dwordx4 v[112:115], v123, s[52:55], s3 offen sc1
    buffer_load_dwordx4 v[116:119], v122, s[52:55], s3 offen sc1
    s_waitcnt vmcnt(0)
    v_max_u32 v121, v91, v95
    v_cmp_eq_u32 vcc, -1, v121
    s_add_u32 s85, s85, 1
    s_cbranch_vccz L_gb_190
    s_cmp_lt_u32 s85, 65536
    s_cbranch_scc1 L_gs_191
    s_branch L_gb_190
L_gs_193:
    s_add_u32 s3, s22, 8192
    s_cmp_ge_u32 s3, s28
    s_cselect_b32 s18, 65536, 0
    s_sub_u32 s3, s3, s18
    buffer_load_dwordx4 v[96:99], v123, s[52:55], s3 offen sc1
    buffer_load_dwordx4 v[100:103], v122, s[52:55], s3 offen sc1
    s_add_u32 s3, s22, 10240
    s_cmp_ge_u32 s3, s28
    s_cselect_b32 s18, 65536, 0
    s_sub_u32 s3, s3, s18
    buffer_load_dwordx4 v[104:107], v123, s[52:55], s3 offen sc1
    buffer_load_dwordx4 v[108:111], v122, s[52:55], s3 offen sc1
    s_add_u32 s3, s22, 12288
    s_cmp_ge_u32 s3, s28
    s_cselect_b32 s18, 65536, 0
    s_sub_u32 s3, s3, s18
    buffer_load_dwordx4 v[112:115], v123, s[52:55], s3 offen sc1
    buffer_load_dwordx4 v[116:119], v122, s[52:55], s3 offen sc1
    s_add_u32 s3, s22, 14336
    s_cmp_ge_u32 s3, s28
    s_cselect_b32 s18, 65536, 0
    s_sub_u32 s3, s3, s18
    buffer_load_dwordx4 v[64:67], v123, s[52:55], s3 offen sc1
    buffer_load_dwordx4 v[68:71], v122, s[52:55], s3 offen sc1
    s_waitcnt vmcnt(0)
    v_max_u32 v121, v99, v103
    v_cmp_eq_u32 vcc, -1, v121
    s_add_u32 s85, s85, 1
    s_cbranch_vccz L_gb_192
    s_cmp_lt_u32 s85, 65536
    s_cbranch_scc1 L_gs_193
    s_branch L_gb_192
L_gs_195:
    s_add_u32 s3, s22, 10240
    s_cmp_ge_u32 s3, s28
    s_cselect_b32 s18, 65536, 0
    s_sub_u32 s3, s3, s18
    buffer_load_dwordx4 v[104:107], v123, s[52:55], s3 offen sc1
    buffer_load_dwordx4 v[108:111], v122, s[52:55], s3 offen sc1
    s_add_u32 s3, s22, 12288
    s_cmp_ge_u32 s3, s28
    s_cselect_b32 s18, 65536, 0
    s_sub_u32 s3, s3, s18
    buffer_load_dwordx4 v[112:115], v123, s[52:55], s3 offen sc1
    buffer_load_dwordx4 v[116:119], v122, s[52:55], s3 offen sc1
    s_add_u32 s3, s22, 14336
    s_cmp_ge_u32 s3, s28
    s_cselect_b32 s18, 65536, 0
    s_sub_u32 s3, s3, s18
    buffer_load_dwordx4 v[64:67], v123, s[52:55], s3 offen sc1
    buffer_load_dwordx4 v[68:71], v122, s[52:55], s3 offen sc1
    s_add_u32 s3, s22, 16384
    s_cmp_ge_u32 s3, s28
    s_cselect_b32 s18, 65536, 0
    s_sub_u32 s3, s3, s18
    buffer_load_dwordx4 v[72:75], v123, s[52:55], s3 offen sc1
    buffer_load_dwordx4 v[76:79], v122, s[52:55], s3 offen sc1
    s_waitcnt vmcnt(0)
    v_max_u32 v121, v107, v111
    v_cmp_eq_u32 vcc, -1, v121
    s_add_u32 s85, s85, 1
    s_cbranch_vccz L_gb_194
    s_cmp_lt_u32 s85, 65536
    s_cbranch_scc1 L_gs_195
    s_branch L_gb_194
L_gs_197:
    s_add_u32 s3, s22, 12288
    s_cmp_ge_u32 s3, s28
    s_cselect_b32 s18, 65536, 0
    s_sub_u32 s3, s3, s18
    buffer_load_dwordx4 v[112:115], v123, s[52:55], s3 offen sc1
    buffer_load_dwordx4 v[116:119], v122, s[52:55], s3 offen sc1
    s_add_u32 s3, s22, 14336
    s_cmp_ge_u32 s3, s28
    s_cselect_b32 s18, 65536, 0
    s_sub_u32 s3, s3, s18
    buffer_load_dwordx4 v[64:67], v123, s[52:55], s3 offen sc1
    buffer_load_dwordx4 v[68:71], v122, s[52:55], s3 offen sc1
    s_add_u32 s3, s22, 16384
    s_cmp_ge_u32 s3, s28
    s_cselect_b32 s18, 65536, 0
    s_sub_u32 s3, s3, s18
    buffer_load_dwordx4 v[72:75], v123, s[52:55], s3 offen sc1
    buffer_load_dwordx4 v[76:79], v122, s[52:55], s3 offen sc1
    s_add_u32 s3, s22, 18432
    s_cmp_ge_u32 s3, s28
    s_cselect_b32 s18, 65536, 0
    s_sub_u32 s3, s3, s18
    buffer_load_dwordx4 v[80:83], v123, s[52:55], s3 offen sc1
    buffer_load_dwordx4 v[84:87], v122, s[52:55], s3 offen sc1
    s_waitcnt vmcnt(0)
    v_max_u32 v121, v115, v119
    v_cmp_eq_u32 vcc, -1, v121
    s_add_u32 s85, s85, 1
    s_cbranch_vccz L_gb_196
    s_cmp_lt_u32 s85, 65536
    s_cbranch_scc1 L_gs_197
    s_branch L_gb_196
L_gs_199:
    s_add_u32 s3, s22, 14336
    s_cmp_ge_u32 s3, s28
    s_cselect_b32 s18, 65536, 0
    s_sub_u32 s3, s3, s18
    buffer_load_dwordx4 v[64:67], v123, s[52:55], s3 offen sc1
    buffer_load_dwordx4 v[68:71], v122, s[52:55], s3 offen sc1
    s_add_u32 s3, s22, 16384
    s_cmp_ge_u32 s3, s28
    s_cselect_b32 s18, 65536, 0
    s_sub_u32 s3, s3, s18
    buffer_load_dwordx4 v[72:75], v123, s[52:55], s3 offen sc1
    buffer_load_dwordx4 v[76:79], v122, s[52:55], s3 offen sc1
    s_add_u32 s3, s22, 18432
    s_cmp_ge_u32 s3, s28
    s_cselect_b32 s18, 65536, 0
    s_sub_u32 s3, s3, s18
    buffer_load_dwordx4 v[80:83], v123, s[52:55], s3 offen sc1
    buffer_load_dwordx4 v[84:87], v122, s[52:55], s3 offen sc1
    s_add_u32 s3, s22, 20480
    s_cmp_ge_u32 s3, s28
    s_cselect_b32 s18, 65536, 0
    s_sub_u32 s3, s3, s18
    buffer_load_dwordx4 v[88:91], v123, s[52:55], s3 offen sc1
    buffer_load_dwordx4 v[92:95], v122, s[52:55], s3 offen sc1
    s_waitcnt vmcnt(0)
    v_max_u32 v121, v67, v71
    v_cmp_eq_u32 vcc, -1, v121
    s_add_u32 s85, s85, 1
    s_cbranch_vccz L_gb_198
    s_cmp_lt_u32 s85, 65536
    s_cbranch_scc1 L_gs_199
    s_branch L_gb_198
L_gs_201:
    s_add_u32 s3, s22, 16384
    s_cmp_ge_u32 s3, s28
    s_cselect_b32 s18, 65536, 0
    s_sub_u32 s3, s3, s18
    buffer_load_dwordx4 v[72:75], v123, s[52:55], s3 offen sc1
    buffer_load_dwordx4 v[76:79], v122, s[52:55], s3 offen sc1
    s_add_u32 s3, s22, 18432
    s_cmp_ge_u32 s3, s28
    s_cselect_b32 s18, 65536, 0
    s_sub_u32 s3, s3, s18
    buffer_load_dwordx4 v[80:83], v123, s[52:55], s3 offen sc1
    buffer_load_dwordx4 v[84:87], v122, s[52:55], s3 offen sc1
    s_add_u32 s3, s22, 20480
    s_cmp_ge_u32 s3, s28
    s_cselect_b32 s18, 65536, 0
    s_sub_u32 s3, s3, s18
    buffer_load_dwordx4 v[88:91], v123, s[52:55], s3 offen sc1
    buffer_load_dwordx4 v[92:95], v122, s[52:55], s3 offen sc1
    s_add_u32 s3, s22, 22528
    s_cmp_ge_u32 s3, s28
    s_cselect_b32 s18, 65536, 0
    s_sub_u32 s3, s3, s18
    buffer_load_dwordx4 v[96:99], v123, s[52:55], s3 offen sc1
    buffer_load_dwordx4 v[100:103], v122, s[52:55], s3 offen sc1
    s_waitcnt vmcnt(0)
    v_max_u32 v121, v75, v79
    v_cmp_eq_u32 vcc, -1, v121
    s_add_u32 s85, s85, 1
    s_cbranch_vccz L_gb_200
    s_cmp_lt_u32 s85, 65536
    s_cbranch_scc1 L_gs_201
    s_branch L_gb_200
L_gs_203:
    s_add_u32 s3, s22, 18432
    s_cmp_ge_u32 s3, s28
    s_cselect_b32 s18, 65536, 0
    s_sub_u32 s3, s3, s18
    buffer_load_dwordx4 v[80:83], v123, s[52:55], s3 offen sc1
    buffer_load_dwordx4 v[84:87], v122, s[52:55], s3 offen sc1
    s_add_u32 s3, s22, 20480
    s_cmp_ge_u32 s3, s28
    s_cselect_b32 s18, 65536, 0
    s_sub_u32 s3, s3, s18
    buffer_load_dwordx4 v[88:91], v123, s[52:55], s3 offen sc1
    buffer_load_dwordx4 v[92:95], v122, s[52:55], s3 offen sc1
    s_add_u32 s3, s22, 22528
    s_cmp_ge_u32 s3, s28
    s_cselect_b32 s18, 65536, 0
    s_sub_u32 s3, s3, s18
    buffer_load_dwordx4 v[96:99], v123, s[52:55], s3 offen sc1
    buffer_load_dwordx4 v[100:103], v122, s[52:55], s3 offen sc1
    s_add_u32 s3, s22, 24576
    s_cmp_ge_u32 s3, s28
    s_cselect_b32 s18, 65536, 0
    s_sub_u32 s3, s3, s18
    buffer_load_dwordx4 v[104:107], v123, s[52:55], s3 offen sc1
    buffer_load_dwordx4 v[108:111], v122, s[52:55], s3 offen sc1
    s_waitcnt vmcnt(0)
    v_max_u32 v121, v83, v87
    v_cmp_eq_u32 vcc, -1, v121
    s_add_u32 s85, s85, 1
    s_cbranch_vccz L_gb_202
    s_cmp_lt_u32 s85, 65536
    s_cbranch_scc1 L_gs_203
    s_branch L_gb_202
L_gs_205:
    s_add_u32 s3, s22, 20480
    s_cmp_ge_u32 s3, s28
    s_cselect_b32 s18, 65536, 0
    s_sub_u32 s3, s3, s18
    buffer_load_dwordx4 v[88:91], v123, s[52:55], s3 offen sc1
    buffer_load_dwordx4 v[92:95], v122, s[52:55], s3 offen sc1
    s_add_u32 s3, s22, 22528
    s_cmp_ge_u32 s3, s28
    s_cselect_b32 s18, 65536, 0
    s_sub_u32 s3, s3, s18
    buffer_load_dwordx4 v[96:99], v123, s[52:55], s3 offen sc1
    buffer_load_dwordx4 v[100:103], v122, s[52:55], s3 offen sc1
    s_add_u32 s3, s22, 24576
    s_cmp_ge_u32 s3, s28
    s_cselect_b32 s18, 65536, 0
    s_sub_u32 s3, s3, s18
    buffer_load_dwordx4 v[104:107], v123, s[52:55], s3 offen sc1
    buffer_load_dwordx4 v[108:111], v122, s[52:55], s3 offen sc1
    s_add_u32 s3, s22, 26624
    s_cmp_ge_u32 s3, s28
    s_cselect_b32 s18, 65536, 0
    s_sub_u32 s3, s3, s18
    buffer_load_dwordx4 v[112:115], v123, s[52:55], s3 offen sc1
    buffer_load_dwordx4 v[116:119], v122, s[52:55], s3 offen sc1
    s_waitcnt vmcnt(0)
    v_max_u32 v121, v91, v95
    v_cmp_eq_u32 vcc, -1, v121
    s_add_u32 s85, s85, 1
    s_cbranch_vccz L_gb_204
    s_cmp_lt_u32 s85, 65536
    s_cbranch_scc1 L_gs_205
    s_branch L_gb_204
L_gs_207:
    s_add_u32 s3, s22, 22528
    s_cmp_ge_u32 s3, s28
    s_cselect_b32 s18, 65536, 0
    s_sub_u32 s3, s3, s18
    buffer_load_dwordx4 v[96:99], v123, s[52:55], s3 offen sc1
    buffer_load_dwordx4 v[100:103], v122, s[52:55], s3 offen sc1
    s_add_u32 s3, s22, 24576
    s_cmp_ge_u32 s3, s28
    s_cselect_b32 s18, 65536, 0
    s_sub_u32 s3, s3, s18
    buffer_load_dwordx4 v[104:107], v123, s[52:55], s3 offen sc1
    buffer_load_dwordx4 v[108:111], v122, s[52:55], s3 offen sc1
    s_add_u32 s3, s22, 26624
    s_cmp_ge_u32 s3, s28
    s_cselect_b32 s18, 65536, 0
    s_sub_u32 s3, s3, s18
    buffer_load_dwordx4 v[112:115], v123, s[52:55], s3 offen sc1
    buffer_load_dwordx4 v[116:119], v122, s[52:55], s3 offen sc1
    s_add_u32 s3, s22, 28672
    s_cmp_ge_u32 s3, s28
    s_cselect_b32 s18, 65536, 0
    s_sub_u32 s3, s3, s18
    buffer_load_dwordx4 v[64:67], v123, s[52:55], s3 offen sc1
    buffer_load_dwordx4 v[68:71], v122, s[52:55], s3 offen sc1
    s_waitcnt vmcnt(0)
    v_max_u32 v121, v99, v103
    v_cmp_eq_u32 vcc, -1, v121
    s_add_u32 s85, s85, 1
    s_cbranch_vccz L_gb_206
    s_cmp_lt_u32 s85, 65536
    s_cbranch_scc1 L_gs_207
    s_branch L_gb_206
L_gs_209:
    s_add_u32 s3, s22, 24576
    s_cmp_ge_u32 s3, s28
    s_cselect_b32 s18, 65536, 0
    s_sub_u32 s3, s3, s18
    buffer_load_dwordx4 v[104:107], v123, s[52:55], s3 offen sc1
    buffer_load_dwordx4 v[108:111], v122, s[52:55], s3 offen sc1
    s_add_u32 s3, s22, 26624
    s_cmp_ge_u32 s3, s28
    s_cselect_b32 s18, 65536, 0
    s_sub_u32 s3, s3, s18
    buffer_load_dwordx4 v[112:115], v123, s[52:55], s3 offen sc1
    buffer_load_dwordx4 v[116:119], v122, s[52:55], s3 offen sc1
    s_add_u32 s3, s22, 28672
    s_cmp_ge_u32 s3, s28
    s_cselect_b32 s18, 65536, 0
    s_sub_u32 s3, s3, s18
    buffer_load_dwordx4 v[64:67], v123, s[52:55], s3 offen sc1
    buffer_load_dwordx4 v[68:71], v122, s[52:55], s3 offen sc1
    s_add_u32 s3, s22, 30720
    s_cmp_ge_u32 s3, s28
    s_cselect_b32 s18, 65536, 0
    s_sub_u32 s3, s3, s18
    buffer_load_dwordx4 v[72:75], v123, s[52:55], s3 offen sc1
    buffer_load_dwordx4 v[76:79], v122, s[52:55], s3 offen sc1
    s_waitcnt vmcnt(0)
    v_max_u32 v121, v107, v111
    v_cmp_eq_u32 vcc, -1, v121
    s_add_u32 s85, s85, 1
    s_cbranch_vccz L_gb_208
    s_cmp_lt_u32 s85, 65536
    s_cbranch_scc1 L_gs_209
    s_branch L_gb_208
L_gs_211:
    s_add_u32 s3, s22, 26624
    s_cmp_ge_u32 s3, s28
    s_cselect_b32 s18, 65536, 0
    s_sub_u32 s3, s3, s18
    buffer_load_dwordx4 v[112:115], v123, s[52:55], s3 offen sc1
    buffer_load_dwordx4 v[116:119], v122, s[52:55], s3 offen sc1
    s_add_u32 s3, s22, 28672
    s_cmp_ge_u32 s3, s28
    s_cselect_b32 s18, 65536, 0
    s_sub_u32 s3, s3, s18
    buffer_load_dwordx4 v[64:67], v123, s[52:55], s3 offen sc1
    buffer_load_dwordx4 v[68:71], v122, s[52:55], s3 offen sc1
    s_add_u32 s3, s22, 30720
    s_cmp_ge_u32 s3, s28
    s_cselect_b32 s18, 65536, 0
    s_sub_u32 s3, s3, s18
    buffer_load_dwordx4 v[72:75], v123, s[52:55], s3 offen sc1
    buffer_load_dwordx4 v[76:79], v122, s[52:55], s3 offen sc1
    s_add_u32 s3, s22, 32768
    s_cmp_ge_u32 s3, s28
    s_cselect_b32 s18, 65536, 0
    s_sub_u32 s3, s3, s18
    buffer_load_dwordx4 v[80:83], v123, s[52:55], s3 offen sc1
    buffer_load_dwordx4 v[84:87], v122, s[52:55], s3 offen sc1
    s_waitcnt vmcnt(0)
    v_max_u32 v121, v115, v119
    v_cmp_eq_u32 vcc, -1, v121
    s_add_u32 s85, s85, 1
    s_cbranch_vccz L_gb_210
    s_cmp_lt_u32 s85, 65536
    s_cbranch_scc1 L_gs_211
    s_branch L_gb_210
L_gs_213:
    s_add_u32 s3, s22, 28672
    s_cmp_ge_u32 s3, s28
    s_cselect_b32 s18, 65536, 0
    s_sub_u32 s3, s3, s18
    buffer_load_dwordx4 v[64:67], v123, s[52:55], s3 offen sc1
    buffer_load_dwordx4 v[68:71], v122, s[52:55], s3 offen sc1
    s_add_u32 s3, s22, 30720
    s_cmp_ge_u32 s3, s28
    s_cselect_b32 s18, 65536, 0
    s_sub_u32 s3, s3, s18
    buffer_load_dwordx4 v[72:75], v123, s[52:55], s3 offen sc1
    buffer_load_dwordx4 v[76:79], v122, s[52:55], s3 offen sc1
    s_add_u32 s3, s22, 32768
    s_cmp_ge_u32 s3, s28
    s_cselect_b32 s18, 65536, 0
    s_sub_u32 s3, s3, s18
    buffer_load_dwordx4 v[80:83], v123, s[52:55], s3 offen sc1
    buffer_load_dwordx4 v[84:87], v122, s[52:55], s3 offen sc1
    s_add_u32 s3, s22, 34816
    s_cmp_ge_u32 s3, s28
    s_cselect_b32 s18, 65536, 0
    s_sub_u32 s3, s3, s18
    buffer_load_dwordx4 v[88:91], v123, s[52:55], s3 offen sc1
    buffer_load_dwordx4 v[92:95], v122, s[52:55], s3 offen sc1
    s_waitcnt vmcnt(0)
    v_max_u32 v121, v67, v71
    v_cmp_eq_u32 vcc, -1, v121
    s_add_u32 s85, s85, 1
    s_cbranch_vccz L_gb_212
    s_cmp_lt_u32 s85, 65536
    s_cbranch_scc1 L_gs_213
    s_branch L_gb_212
L_gs_215:
    s_add_u32 s3, s22, 30720
    s_cmp_ge_u32 s3, s28
    s_cselect_b32 s18, 65536, 0
    s_sub_u32 s3, s3, s18
    buffer_load_dwordx4 v[72:75], v123, s[52:55], s3 offen sc1
    buffer_load_dwordx4 v[76:79], v122, s[52:55], s3 offen sc1
    s_add_u32 s3, s22, 32768
    s_cmp_ge_u32 s3, s28
    s_cselect_b32 s18, 65536, 0
    s_sub_u32 s3, s3, s18
    buffer_load_dwordx4 v[80:83], v123, s[52:55], s3 offen sc1
    buffer_load_dwordx4 v[84:87], v122, s[52:55], s3 offen sc1
    s_add_u32 s3, s22, 34816
    s_cmp_ge_u32 s3, s28
    s_cselect_b32 s18, 65536, 0
    s_sub_u32 s3, s3, s18
    buffer_load_dwordx4 v[88:91], v123, s[52:55], s3 offen sc1
    buffer_load_dwordx4 v[92:95], v122, s[52:55], s3 offen sc1
    s_add_u32 s3, s22, 36864
    s_cmp_ge_u32 s3, s28
    s_cselect_b32 s18, 65536, 0
    s_sub_u32 s3, s3, s18
    buffer_load_dwordx4 v[96:99], v123, s[52:55], s3 offen sc1
    buffer_load_dwordx4 v[100:103], v122, s[52:55], s3 offen sc1
    s_waitcnt vmcnt(0)
    v_max_u32 v121, v75, v79
    v_cmp_eq_u32 vcc, -1, v121
    s_add_u32 s85, s85, 1
    s_cbranch_vccz L_gb_214
    s_cmp_lt_u32 s85, 65536
    s_cbranch_scc1 L_gs_215
    s_branch L_gb_214
L_gs_217:
    s_add_u32 s3, s22, 32768
    s_cmp_ge_u32 s3, s28
    s_cselect_b32 s18, 65536, 0
    s_sub_u32 s3, s3, s18
    buffer_load_dwordx4 v[80:83], v123, s[52:55], s3 offen sc1
    buffer_load_dwordx4 v[84:87], v122, s[52:55], s3 offen sc1
    s_add_u32 s3, s22, 34816
    s_cmp_ge_u32 s3, s28
    s_cselect_b32 s18, 65536, 0
    s_sub_u32 s3, s3, s18
    buffer_load_dwordx4 v[88:91], v123, s[52:55], s3 offen sc1
    buffer_load_dwordx4 v[92:95], v122, s[52:55], s3 offen sc1
    s_add_u32 s3, s22, 36864
    s_cmp_ge_u32 s3, s28
    s_cselect_b32 s18, 65536, 0
    s_sub_u32 s3, s3, s18
    buffer_load_dwordx4 v[96:99], v123, s[52:55], s3 offen sc1
    buffer_load_dwordx4 v[100:103], v122, s[52:55], s3 offen sc1
    s_add_u32 s3, s22, 38912
    s_cmp_ge_u32 s3, s28
    s_cselect_b32 s18, 65536, 0
    s_sub_u32 s3, s3, s18
    buffer_load_dwordx4 v[104:107], v123, s[52:55], s3 offen sc1
    buffer_load_dwordx4 v[108:111], v122, s[52:55], s3 offen sc1
    s_waitcnt vmcnt(0)
    v_max_u32 v121, v83, v87
    v_cmp_eq_u32 vcc, -1, v121
    s_add_u32 s85, s85, 1
    s_cbranch_vccz L_gb_216
    s_cmp_lt_u32 s85, 65536
    s_cbranch_scc1 L_gs_217
    s_branch L_gb_216
L_gs_219:
    s_add_u32 s3, s22, 34816
    s_cmp_ge_u32 s3, s28
    s_cselect_b32 s18, 65536, 0
    s_sub_u32 s3, s3, s18
    buffer_load_dwordx4 v[88:91], v123, s[52:55], s3 offen sc1
    buffer_load_dwordx4 v[92:95], v122, s[52:55], s3 offen sc1
    s_add_u32 s3, s22, 36864
    s_cmp_ge_u32 s3, s28
    s_cselect_b32 s18, 65536, 0
    s_sub_u32 s3, s3, s18
    buffer_load_dwordx4 v[96:99], v123, s[52:55], s3 offen sc1
    buffer_load_dwordx4 v[100:103], v122, s[52:55], s3 offen sc1
    s_add_u32 s3, s22, 38912
    s_cmp_ge_u32 s3, s28
    s_cselect_b32 s18, 65536, 0
    s_sub_u32 s3, s3, s18
    buffer_load_dwordx4 v[104:107], v123, s[52:55], s3 offen sc1
    buffer_load_dwordx4 v[108:111], v122, s[52:55], s3 offen sc1
    s_add_u32 s3, s22, 40960
    s_cmp_ge_u32 s3, s28
    s_cselect_b32 s18, 65536, 0
    s_sub_u32 s3, s3, s18
    buffer_load_dwordx4 v[112:115], v123, s[52:55], s3 offen sc1
    buffer_load_dwordx4 v[116:119], v122, s[52:55], s3 offen sc1
    s_waitcnt vmcnt(0)
    v_max_u32 v121, v91, v95
    v_cmp_eq_u32 vcc, -1, v121
    s_add_u32 s85, s85, 1
    s_cbranch_vccz L_gb_218
    s_cmp_lt_u32 s85, 65536
    s_cbranch_scc1 L_gs_219
    s_branch L_gb_218
L_gs_221:
    s_add_u32 s3, s22, 36864
    s_cmp_ge_u32 s3, s28
    s_cselect_b32 s18, 65536, 0
    s_sub_u32 s3, s3, s18
    buffer_load_dwordx4 v[96:99], v123, s[52:55], s3 offen sc1
    buffer_load_dwordx4 v[100:103], v122, s[52:55], s3 offen sc1
    s_add_u32 s3, s22, 38912
    s_cmp_ge_u32 s3, s28
    s_cselect_b32 s18, 65536, 0
    s_sub_u32 s3, s3, s18
    buffer_load_dwordx4 v[104:107], v123, s[52:55], s3 offen sc1
    buffer_load_dwordx4 v[108:111], v122, s[52:55], s3 offen sc1
    s_add_u32 s3, s22, 40960
    s_cmp_ge_u32 s3, s28
    s_cselect_b32 s18, 65536, 0
    s_sub_u32 s3, s3, s18
    buffer_load_dwordx4 v[112:115], v123, s[52:55], s3 offen sc1
    buffer_load_dwordx4 v[116:119], v122, s[52:55], s3 offen sc1
    s_add_u32 s3, s22, 43008
    s_cmp_ge_u32 s3, s28
    s_cselect_b32 s18, 65536, 0
    s_sub_u32 s3, s3, s18
    buffer_load_dwordx4 v[64:67], v123, s[52:55], s3 offen sc1
    buffer_load_dwordx4 v[68:71], v122, s[52:55], s3 offen sc1
    s_waitcnt vmcnt(0)
    v_max_u32 v121, v99, v103
    v_cmp_eq_u32 vcc, -1, v121
    s_add_u32 s85, s85, 1
    s_cbranch_vccz L_gb_220
    s_cmp_lt_u32 s85, 65536
    s_cbranch_scc1 L_gs_221
    s_branch L_gb_220
L_gs_223:
    s_add_u32 s3, s22, 38912
    s_cmp_ge_u32 s3, s28
    s_cselect_b32 s18, 65536, 0
    s_sub_u32 s3, s3, s18
    buffer_load_dwordx4 v[104:107], v123, s[52:55], s3 offen sc1
    buffer_load_dwordx4 v[108:111], v122, s[52:55], s3 offen sc1
    s_add_u32 s3, s22, 40960
    s_cmp_ge_u32 s3, s28
    s_cselect_b32 s18, 65536, 0
    s_sub_u32 s3, s3, s18
    buffer_load_dwordx4 v[112:115], v123, s[52:55], s3 offen sc1
    buffer_load_dwordx4 v[116:119], v122, s[52:55], s3 offen sc1
    s_add_u32 s3, s22, 43008
    s_cmp_ge_u32 s3, s28
    s_cselect_b32 s18, 65536, 0
    s_sub_u32 s3, s3, s18
    buffer_load_dwordx4 v[64:67], v123, s[52:55], s3 offen sc1
    buffer_load_dwordx4 v[68:71], v122, s[52:55], s3 offen sc1
    s_add_u32 s3, s22, 45056
    s_cmp_ge_u32 s3, s28
    s_cselect_b32 s18, 65536, 0
    s_sub_u32 s3, s3, s18
    buffer_load_dwordx4 v[72:75], v123, s[52:55], s3 offen sc1
    buffer_load_dwordx4 v[76:79], v122, s[52:55], s3 offen sc1
    s_waitcnt vmcnt(0)
    v_max_u32 v121, v107, v111
    v_cmp_eq_u32 vcc, -1, v121
    s_add_u32 s85, s85, 1
    s_cbranch_vccz L_gb_222
    s_cmp_lt_u32 s85, 65536
    s_cbranch_scc1 L_gs_223
    s_branch L_gb_222
L_gs_225:
    s_add_u32 s3, s22, 40960
    s_cmp_ge_u32 s3, s28
    s_cselect_b32 s18, 65536, 0
    s_sub_u32 s3, s3, s18
    buffer_load_dwordx4 v[112:115], v123, s[52:55], s3 offen sc1
    buffer_load_dwordx4 v[116:119], v122, s[52:55], s3 offen sc1
    s_add_u32 s3, s22, 43008
    s_cmp_ge_u32 s3, s28
    s_cselect_b32 s18, 65536, 0
    s_sub_u32 s3, s3, s18
    buffer_load_dwordx4 v[64:67], v123, s[52:55], s3 offen sc1
    buffer_load_dwordx4 v[68:71], v122, s[52:55], s3 offen sc1
    s_add_u32 s3, s22, 45056
    s_cmp_ge_u32 s3, s28
    s_cselect_b32 s18, 65536, 0
    s_sub_u32 s3, s3, s18
    buffer_load_dwordx4 v[72:75], v123, s[52:55], s3 offen sc1
    buffer_load_dwordx4 v[76:79], v122, s[52:55], s3 offen sc1
    s_add_u32 s3, s22, 47104
    s_cmp_ge_u32 s3, s28
    s_cselect_b32 s18, 65536, 0
    s_sub_u32 s3, s3, s18
    buffer_load_dwordx4 v[80:83], v123, s[52:55], s3 offen sc1
    buffer_load_dwordx4 v[84:87], v122, s[52:55], s3 offen sc1
    s_waitcnt vmcnt(0)
    v_max_u32 v121, v115, v119
    v_cmp_eq_u32 vcc, -1, v121
    s_add_u32 s85, s85, 1
    s_cbranch_vccz L_gb_224
    s_cmp_lt_u32 s85, 65536
    s_cbranch_scc1 L_gs_225
    s_branch L_gb_224
L_gs_227:
    s_add_u32 s3, s22, 43008
    s_cmp_ge_u32 s3, s28
    s_cselect_b32 s18, 65536, 0
    s_sub_u32 s3, s3, s18
    buffer_load_dwordx4 v[64:67], v123, s[52:55], s3 offen sc1
    buffer_load_dwordx4 v[68:71], v122, s[52:55], s3 offen sc1
    s_add_u32 s3, s22, 45056
    s_cmp_ge_u32 s3, s28
    s_cselect_b32 s18, 65536, 0
    s_sub_u32 s3, s3, s18
    buffer_load_dwordx4 v[72:75], v123, s[52:55], s3 offen sc1
    buffer_load_dwordx4 v[76:79], v122, s[52:55], s3 offen sc1
    s_add_u32 s3, s22, 47104
    s_cmp_ge_u32 s3, s28
    s_cselect_b32 s18, 65536, 0
    s_sub_u32 s3, s3, s18
    buffer_load_dwordx4 v[80:83], v123, s[52:55], s3 offen sc1
    buffer_load_dwordx4 v[84:87], v122, s[52:55], s3 offen sc1
    s_add_u32 s3, s22, 49152
    s_cmp_ge_u32 s3, s28
    s_cselect_b32 s18, 65536, 0
    s_sub_u32 s3, s3, s18
    buffer_load_dwordx4 v[88:91], v123, s[52:55], s3 offen sc1
    buffer_load_dwordx4 v[92:95], v122, s[52:55], s3 offen sc1
    s_waitcnt vmcnt(0)
    v_max_u32 v121, v67, v71
    v_cmp_eq_u32 vcc, -1, v121
    s_add_u32 s85, s85, 1
    s_cbranch_vccz L_gb_226
    s_cmp_lt_u32 s85, 65536
    s_cbranch_scc1 L_gs_227
    s_branch L_gb_226
L_gs_229:
    s_add_u32 s3, s22, 45056
    s_cmp_ge_u32 s3, s28
    s_cselect_b32 s18, 65536, 0
    s_sub_u32 s3, s3, s18
    buffer_load_dwordx4 v[72:75], v123, s[52:55], s3 offen sc1
    buffer_load_dwordx4 v[76:79], v122, s[52:55], s3 offen sc1
    s_add_u32 s3, s22, 47104
    s_cmp_ge_u32 s3, s28
    s_cselect_b32 s18, 65536, 0
    s_sub_u32 s3, s3, s18
    buffer_load_dwordx4 v[80:83], v123, s[52:55], s3 offen sc1
    buffer_load_dwordx4 v[84:87], v122, s[52:55], s3 offen sc1
    s_add_u32 s3, s22, 49152
    s_cmp_ge_u32 s3, s28
    s_cselect_b32 s18, 65536, 0
    s_sub_u32 s3, s3, s18
    buffer_load_dwordx4 v[88:91], v123, s[52:55], s3 offen sc1
    buffer_load_dwordx4 v[92:95], v122, s[52:55], s3 offen sc1
    s_add_u32 s3, s22, 51200
    s_cmp_ge_u32 s3, s28
    s_cselect_b32 s18, 65536, 0
    s_sub_u32 s3, s3, s18
    buffer_load_dwordx4 v[96:99], v123, s[52:55], s3 offen sc1
    buffer_load_dwordx4 v[100:103], v122, s[52:55], s3 offen sc1
    s_waitcnt vmcnt(0)
    v_max_u32 v121, v75, v79
    v_cmp_eq_u32 vcc, -1, v121
    s_add_u32 s85, s85, 1
    s_cbranch_vccz L_gb_228
    s_cmp_lt_u32 s85, 65536
    s_cbranch_scc1 L_gs_229
    s_branch L_gb_228
L_gs_231:
    s_add_u32 s3, s22, 47104
    s_cmp_ge_u32 s3, s28
    s_cselect_b32 s18, 65536, 0
    s_sub_u32 s3, s3, s18
    buffer_load_dwordx4 v[80:83], v123, s[52:55], s3 offen sc1
    buffer_load_dwordx4 v[84:87], v122, s[52:55], s3 offen sc1
    s_add_u32 s3, s22, 49152
    s_cmp_ge_u32 s3, s28
    s_cselect_b32 s18, 65536, 0
    s_sub_u32 s3, s3, s18
    buffer_load_dwordx4 v[88:91], v123, s[52:55], s3 offen sc1
    buffer_load_dwordx4 v[92:95], v122, s[52:55], s3 offen sc1
    s_add_u32 s3, s22, 51200
    s_cmp_ge_u32 s3, s28
    s_cselect_b32 s18, 65536, 0
    s_sub_u32 s3, s3, s18
    buffer_load_dwordx4 v[96:99], v123, s[52:55], s3 offen sc1
    buffer_load_dwordx4 v[100:103], v122, s[52:55], s3 offen sc1
    s_add_u32 s3, s22, 53248
    s_cmp_ge_u32 s3, s28
    s_cselect_b32 s18, 65536, 0
    s_sub_u32 s3, s3, s18
    buffer_load_dwordx4 v[104:107], v123, s[52:55], s3 offen sc1
    buffer_load_dwordx4 v[108:111], v122, s[52:55], s3 offen sc1
    s_waitcnt vmcnt(0)
    v_max_u32 v121, v83, v87
    v_cmp_eq_u32 vcc, -1, v121
    s_add_u32 s85, s85, 1
    s_cbranch_vccz L_gb_230
    s_cmp_lt_u32 s85, 65536
    s_cbranch_scc1 L_gs_231
    s_branch L_gb_230
L_gs_233:
    s_add_u32 s3, s22, 49152
    s_cmp_ge_u32 s3, s28
    s_cselect_b32 s18, 65536, 0
    s_sub_u32 s3, s3, s18
    buffer_load_dwordx4 v[88:91], v123, s[52:55], s3 offen sc1
    buffer_load_dwordx4 v[92:95], v122, s[52:55], s3 offen sc1
    s_add_u32 s3, s22, 51200
    s_cmp_ge_u32 s3, s28
    s_cselect_b32 s18, 65536, 0
    s_sub_u32 s3, s3, s18
    buffer_load_dwordx4 v[96:99], v123, s[52:55], s3 offen sc1
    buffer_load_dwordx4 v[100:103], v122, s[52:55], s3 offen sc1
    s_add_u32 s3, s22, 53248
    s_cmp_ge_u32 s3, s28
    s_cselect_b32 s18, 65536, 0
    s_sub_u32 s3, s3, s18
    buffer_load_dwordx4 v[104:107], v123, s[52:55], s3 offen sc1
    buffer_load_dwordx4 v[108:111], v122, s[52:55], s3 offen sc1
    s_add_u32 s3, s22, 55296
    s_cmp_ge_u32 s3, s28
    s_cselect_b32 s18, 65536, 0
    s_sub_u32 s3, s3, s18
    buffer_load_dwordx4 v[112:115], v123, s[52:55], s3 offen sc1
    buffer_load_dwordx4 v[116:119], v122, s[52:55], s3 offen sc1
    s_waitcnt vmcnt(0)
    v_max_u32 v121, v91, v95
    v_cmp_eq_u32 vcc, -1, v121
    s_add_u32 s85, s85, 1
    s_cbranch_vccz L_gb_232
    s_cmp_lt_u32 s85, 65536
    s_cbranch_scc1 L_gs_233
    s_branch L_gb_232
L_gs_235:
    s_add_u32 s3, s22, 51200
    s_cmp_ge_u32 s3, s28
    s_cselect_b32 s18, 65536, 0
    s_sub_u32 s3, s3, s18
    buffer_load_dwordx4 v[96:99], v123, s[52:55], s3 offen sc1
    buffer_load_dwordx4 v[100:103], v122, s[52:55], s3 offen sc1
    s_add_u32 s3, s22, 53248
    s_cmp_ge_u32 s3, s28
    s_cselect_b32 s18, 65536, 0
    s_sub_u32 s3, s3, s18
    buffer_load_dwordx4 v[104:107], v123, s[52:55], s3 offen sc1
    buffer_load_dwordx4 v[108:111], v122, s[52:55], s3 offen sc1
    s_add_u32 s3, s22, 55296
    s_cmp_ge_u32 s3, s28
    s_cselect_b32 s18, 65536, 0
    s_sub_u32 s3, s3, s18
    buffer_load_dwordx4 v[112:115], v123, s[52:55], s3 offen sc1
    buffer_load_dwordx4 v[116:119], v122, s[52:55], s3 offen sc1
    s_add_u32 s3, s22, 57344
    s_cmp_ge_u32 s3, s28
    s_cselect_b32 s18, 65536, 0
    s_sub_u32 s3, s3, s18
    buffer_load_dwordx4 v[64:67], v123, s[52:55], s3 offen sc1
    buffer_load_dwordx4 v[68:71], v122, s[52:55], s3 offen sc1
    s_waitcnt vmcnt(0)
    v_max_u32 v121, v99, v103
    v_cmp_eq_u32 vcc, -1, v121
    s_add_u32 s85, s85, 1
    s_cbranch_vccz L_gb_234
    s_cmp_lt_u32 s85, 65536
    s_cbranch_scc1 L_gs_235
    s_branch L_gb_234
L_gs_237:
    s_add_u32 s3, s22, 53248
    s_cmp_ge_u32 s3, s28
    s_cselect_b32 s18, 65536, 0
    s_sub_u32 s3, s3, s18
    buffer_load_dwordx4 v[104:107], v123, s[52:55], s3 offen sc1
    buffer_load_dwordx4 v[108:111], v122, s[52:55], s3 offen sc1
    s_add_u32 s3, s22, 55296
    s_cmp_ge_u32 s3, s28
    s_cselect_b32 s18, 65536, 0
    s_sub_u32 s3, s3, s18
    buffer_load_dwordx4 v[112:115], v123, s[52:55], s3 offen sc1
    buffer_load_dwordx4 v[116:119], v122, s[52:55], s3 offen sc1
    s_add_u32 s3, s22, 57344
    s_cmp_ge_u32 s3, s28
    s_cselect_b32 s18, 65536, 0
    s_sub_u32 s3, s3, s18
    buffer_load_dwordx4 v[64:67], v123, s[52:55], s3 offen sc1
    buffer_load_dwordx4 v[68:71], v122, s[52:55], s3 offen sc1
    s_add_u32 s3, s22, 59392
    s_cmp_ge_u32 s3, s28
    s_cselect_b32 s18, 65536, 0
    s_sub_u32 s3, s3, s18
    buffer_load_dwordx4 v[72:75], v123, s[52:55], s3 offen sc1
    buffer_load_dwordx4 v[76:79], v122, s[52:55], s3 offen sc1
    s_waitcnt vmcnt(0)
    v_max_u32 v121, v107, v111
    v_cmp_eq_u32 vcc, -1, v121
    s_add_u32 s85, s85, 1
    s_cbranch_vccz L_gb_236
    s_cmp_lt_u32 s85, 65536
    s_cbranch_scc1 L_gs_237
    s_branch L_gb_236
L_gs_239:
    s_add_u32 s3, s22, 55296
    s_cmp_ge_u32 s3, s28
    s_cselect_b32 s18, 65536, 0
    s_sub_u32 s3, s3, s18
    buffer_load_dwordx4 v[112:115], v123, s[52:55], s3 offen sc1
    buffer_load_dwordx4 v[116:119], v122, s[52:55], s3 offen sc1
    s_add_u32 s3, s22, 57344
    s_cmp_ge_u32 s3, s28
    s_cselect_b32 s18, 65536, 0
    s_sub_u32 s3, s3, s18
    buffer_load_dwordx4 v[64:67], v123, s[52:55], s3 offen sc1
    buffer_load_dwordx4 v[68:71], v122, s[52:55], s3 offen sc1
    s_add_u32 s3, s22, 59392
    s_cmp_ge_u32 s3, s28
    s_cselect_b32 s18, 65536, 0
    s_sub_u32 s3, s3, s18
    buffer_load_dwordx4 v[72:75], v123, s[52:55], s3 offen sc1
    buffer_load_dwordx4 v[76:79], v122, s[52:55], s3 offen sc1
    s_add_u32 s3, s22, 61440
    s_cmp_ge_u32 s3, s28
    s_cselect_b32 s18, 65536, 0
    s_sub_u32 s3, s3, s18
    buffer_load_dwordx4 v[80:83], v123, s[52:55], s3 offen sc1
    buffer_load_dwordx4 v[84:87], v122, s[52:55], s3 offen sc1
    s_waitcnt vmcnt(0)
    v_max_u32 v121, v115, v119
    v_cmp_eq_u32 vcc, -1, v121
    s_add_u32 s85, s85, 1
    s_cbranch_vccz L_gb_238
    s_cmp_lt_u32 s85, 65536
    s_cbranch_scc1 L_gs_239
    s_branch L_gb_238
L_gs_241:
    s_add_u32 s3, s22, 57344
    s_cmp_ge_u32 s3, s28
    s_cselect_b32 s18, 65536, 0
    s_sub_u32 s3, s3, s18
    buffer_load_dwordx4 v[64:67], v123, s[52:55], s3 offen sc1
    buffer_load_dwordx4 v[68:71], v122, s[52:55], s3 offen sc1
    s_add_u32 s3, s22, 59392
    s_cmp_ge_u32 s3, s28
    s_cselect_b32 s18, 65536, 0
    s_sub_u32 s3, s3, s18
    buffer_load_dwordx4 v[72:75], v123, s[52:55], s3 offen sc1
    buffer_load_dwordx4 v[76:79], v122, s[52:55], s3 offen sc1
    s_add_u32 s3, s22, 61440
    s_cmp_ge_u32 s3, s28
    s_cselect_b32 s18, 65536, 0
    s_sub_u32 s3, s3, s18
    buffer_load_dwordx4 v[80:83], v123, s[52:55], s3 offen sc1
    buffer_load_dwordx4 v[84:87], v122, s[52:55], s3 offen sc1
    s_add_u32 s3, s22, 63488
    s_cmp_ge_u32 s3, s28
    s_cselect_b32 s18, 65536, 0
    s_sub_u32 s3, s3, s18
    buffer_load_dwordx4 v[88:91], v123, s[52:55], s3 offen sc1
    buffer_load_dwordx4 v[92:95], v122, s[52:55], s3 offen sc1
    s_waitcnt vmcnt(0)
    v_max_u32 v121, v67, v71
    v_cmp_eq_u32 vcc, -1, v121
    s_add_u32 s85, s85, 1
    s_cbranch_vccz L_gb_240
    s_cmp_lt_u32 s85, 65536
    s_cbranch_scc1 L_gs_241
    s_branch L_gb_240
L_gs_243:
    s_add_u32 s3, s22, 59392
    s_cmp_ge_u32 s3, s28
    s_cselect_b32 s18, 65536, 0
    s_sub_u32 s3, s3, s18
    buffer_load_dwordx4 v[72:75], v123, s[52:55], s3 offen sc1
    buffer_load_dwordx4 v[76:79], v122, s[52:55], s3 offen sc1
    s_add_u32 s3, s22, 61440
    s_cmp_ge_u32 s3, s28
    s_cselect_b32 s18, 65536, 0
    s_sub_u32 s3, s3, s18
    buffer_load_dwordx4 v[80:83], v123, s[52:55], s3 offen sc1
    buffer_load_dwordx4 v[84:87], v122, s[52:55], s3 offen sc1
    s_add_u32 s3, s22, 63488
    s_cmp_ge_u32 s3, s28
    s_cselect_b32 s18, 65536, 0
    s_sub_u32 s3, s3, s18
    buffer_load_dwordx4 v[88:91], v123, s[52:55], s3 offen sc1
    buffer_load_dwordx4 v[92:95], v122, s[52:55], s3 offen sc1
    s_waitcnt vmcnt(0)
    v_max_u32 v121, v75, v79
    v_cmp_eq_u32 vcc, -1, v121
    s_add_u32 s85, s85, 1
    s_cbranch_vccz L_gb_242
    s_cmp_lt_u32 s85, 65536
    s_cbranch_scc1 L_gs_243
    s_branch L_gb_242
L_gs_245:
    s_add_u32 s3, s22, 61440
    s_cmp_ge_u32 s3, s28
    s_cselect_b32 s18, 65536, 0
    s_sub_u32 s3, s3, s18
    buffer_load_dwordx4 v[80:83], v123, s[52:55], s3 offen sc1
    buffer_load_dwordx4 v[84:87], v122, s[52:55], s3 offen sc1
    s_add_u32 s3, s22, 63488
    s_cmp_ge_u32 s3, s28
    s_cselect_b32 s18, 65536, 0
    s_sub_u32 s3, s3, s18
    buffer_load_dwordx4 v[88:91], v123, s[52:55], s3 offen sc1
    buffer_load_dwordx4 v[92:95], v122, s[52:55], s3 offen sc1
    s_waitcnt vmcnt(0)
    v_max_u32 v121, v83, v87
    v_cmp_eq_u32 vcc, -1, v121
    s_add_u32 s85, s85, 1
    s_cbranch_vccz L_gb_244
    s_cmp_lt_u32 s85, 65536
    s_cbranch_scc1 L_gs_245
    s_branch L_gb_244
L_gs_247:
    s_add_u32 s3, s22, 63488
    s_cmp_ge_u32 s3, s28
    s_cselect_b32 s18, 65536, 0
    s_sub_u32 s3, s3, s18
    buffer_load_dwordx4 v[88:91], v123, s[52:55], s3 offen sc1
    buffer_load_dwordx4 v[92:95], v122, s[52:55], s3 offen sc1
    s_waitcnt vmcnt(0)
    v_max_u32 v121, v91, v95
    v_cmp_eq_u32 vcc, -1, v121
    s_add_u32 s85, s85, 1
    s_cbranch_vccz L_gb_246
    s_cmp_lt_u32 s85, 65536
    s_cbranch_scc1 L_gs_247
    s_branch L_gb_246
L_gs_256:
    s_add_u32 s3, s22, 0
    s_cmp_ge_u32 s3, s28
    s_cselect_b32 s18, 57344, 0
    s_sub_u32 s3, s3, s18
    buffer_load_dwordx4 v[64:67], v123, s[52:55], s3 offen sc1
    buffer_load_dwordx4 v[68:71], v122, s[52:55], s3 offen sc1
    s_add_u32 s3, s22, 2048
    s_cmp_ge_u32 s3, s28
    s_cselect_b32 s18, 57344, 0
    s_sub_u32 s3, s3, s18
    buffer_load_dwordx4 v[72:75], v123, s[52:55], s3 offen sc1
    buffer_load_dwordx4 v[76:79], v122, s[52:55], s3 offen sc1
    s_add_u32 s3, s22, 4096
    s_cmp_ge_u32 s3, s28
    s_cselect_b32 s18, 57344, 0
    s_sub_u32 s3, s3, s18
    buffer_load_dwordx4 v[80:83], v123, s[52:55], s3 offen sc1
    buffer_load_dwordx4 v[84:87], v122, s[52:55], s3 offen sc1
    s_add_u32 s3, s22, 6144
    s_cmp_ge_u32 s3, s28
    s_cselect_b32 s18, 57344, 0
    s_sub_u32 s3, s3, s18
    buffer_load_dwordx4 v[88:91], v123, s[52:55], s3 offen sc1
    buffer_load_dwordx4 v[92:95], v122, s[52:55], s3 offen sc1
    s_waitcnt vmcnt(0)
    v_max_u32 v121, v67, v71
    v_cmp_eq_u32 vcc, -1, v121
    s_add_u32 s85, s85, 1
    s_cbranch_vccz L_gb_255
    s_cmp_lt_u32 s85, 65536
    s_cbranch_scc1 L_gs_256
    s_branch L_gb_255
L_gs_258:
    s_add_u32 s3, s22, 2048
    s_cmp_ge_u32 s3, s28
    s_cselect_b32 s18, 57344, 0
    s_sub_u32 s3, s3, s18
    buffer_load_dwordx4 v[72:75], v123, s[52:55], s3 offen sc1
    buffer_load_dwordx4 v[76:79], v122, s[52:55], s3 offen sc1
    s_add_u32 s3, s22, 4096
    s_cmp_ge_u32 s3, s28
    s_cselect_b32 s18, 57344, 0
    s_sub_u32 s3, s3, s18
    buffer_load_dwordx4 v[80:83], v123, s[52:55], s3 offen sc1
    buffer_load_dwordx4 v[84:87], v122, s[52:55], s3 offen sc1
    s_add_u32 s3, s22, 6144
    s_cmp_ge_u32 s3, s28
    s_cselect_b32 s18, 57344, 0
    s_sub_u32 s3, s3, s18
    buffer_load_dwordx4 v[88:91], v123, s[52:55], s3 offen sc1
    buffer_load_dwordx4 v[92:95], v122, s[52:55], s3 offen sc1
    s_add_u32 s3, s22, 8192
    s_cmp_ge_u32 s3, s28
    s_cselect_b32 s18, 57344, 0
    s_sub_u32 s3, s3, s18
    buffer_load_dwordx4 v[96:99], v123, s[52:55], s3 offen sc1
    buffer_load_dwordx4 v[100:103], v122, s[52:55], s3 offen sc1
    s_waitcnt vmcnt(0)
    v_max_u32 v121, v75, v79
    v_cmp_eq_u32 vcc, -1, v121
    s_add_u32 s85, s85, 1
    s_cbranch_vccz L_gb_257
    s_cmp_lt_u32 s85, 65536
    s_cbranch_scc1 L_gs_258
    s_branch L_gb_257
L_gs_260:
    s_add_u32 s3, s22, 4096
    s_cmp_ge_u32 s3, s28
    s_cselect_b32 s18, 57344, 0
    s_sub_u32 s3, s3, s18
    buffer_load_dwordx4 v[80:83], v123, s[52:55], s3 offen sc1
    buffer_load_dwordx4 v[84:87], v122, s[52:55], s3 offen sc1
    s_add_u32 s3, s22, 6144
    s_cmp_ge_u32 s3, s28
    s_cselect_b32 s18, 57344, 0
    s_sub_u32 s3, s3, s18
    buffer_load_dwordx4 v[88:91], v123, s[52:55], s3 offen sc1
    buffer_load_dwordx4 v[92:95], v122, s[52:55], s3 offen sc1
    s_add_u32 s3, s22, 8192
    s_cmp_ge_u32 s3, s28
    s_cselect_b32 s18, 57344, 0
    s_sub_u32 s3, s3, s18
    buffer_load_dwordx4 v[96:99], v123, s[52:55], s3 offen sc1
    buffer_load_dwordx4 v[100:103], v122, s[52:55], s3 offen sc1
    s_add_u32 s3, s22, 10240
    s_cmp_ge_u32 s3, s28
    s_cselect_b32 s18, 57344, 0
    s_sub_u32 s3, s3, s18
    buffer_load_dwordx4 v[64:67], v123, s[52:55], s3 offen sc1
    buffer_load_dwordx4 v[68:71], v122, s[52:55], s3 offen sc1
    s_waitcnt vmcnt(0)
    v_max_u32 v121, v83, v87
    v_cmp_eq_u32 vcc, -1, v121
    s_add_u32 s85, s85, 1
    s_cbranch_vccz L_gb_259
    s_cmp_lt_u32 s85, 65536
    s_cbranch_scc1 L_gs_260
    s_branch L_gb_259
L_gs_262:
    s_add_u32 s3, s22, 6144
    s_cmp_ge_u32 s3, s28
    s_cselect_b32 s18, 57344, 0
    s_sub_u32 s3, s3, s18
    buffer_load_dwordx4 v[88:91], v123, s[52:55], s3 offen sc1
    buffer_load_dwordx4 v[92:95], v122, s[52:55], s3 offen sc1
    s_add_u32 s3, s22, 8192
    s_cmp_ge_u32 s3, s28
    s_cselect_b32 s18, 57344, 0
    s_sub_u32 s3, s3, s18
    buffer_load_dwordx4 v[96:99], v123, s[52:55], s3 offen sc1
    buffer_load_dwordx4 v[100:103], v122, s[52:55], s3 offen sc1
    s_add_u32 s3, s22, 10240
    s_cmp_ge_u32 s3, s28
    s_cselect_b32 s18, 57344, 0
    s_sub_u32 s3, s3, s18
    buffer_load_dwordx4 v[64:67], v123, s[52:55], s3 offen sc1
    buffer_load_dwordx4 v[68:71], v122, s[52:55], s3 offen sc1
    s_add_u32 s3, s22, 12288
    s_cmp_ge_u32 s3, s28
    s_cselect_b32 s18, 57344, 0
    s_sub_u32 s3, s3, s18
    buffer_load_dwordx4 v[72:75], v123, s[52:55], s3 offen sc1
    buffer_load_dwordx4 v[76:79], v122, s[52:55], s3 offen sc1
    s_waitcnt vmcnt(0)
    v_max_u32 v121, v91, v95
    v_cmp_eq_u32 vcc, -1, v121
    s_add_u32 s85, s85, 1
    s_cbranch_vccz L_gb_261
    s_cmp_lt_u32 s85, 65536
    s_cbranch_scc1 L_gs_262
    s_branch L_gb_261
L_gs_264:
    s_add_u32 s3, s22, 8192
    s_cmp_ge_u32 s3, s28
    s_cselect_b32 s18, 57344, 0
    s_sub_u32 s3, s3, s18
    buffer_load_dwordx4 v[96:99], v123, s[52:55], s3 offen sc1
    buffer_load_dwordx4 v[100:103], v122, s[52:55], s3 offen sc1
    s_add_u32 s3, s22, 10240
    s_cmp_ge_u32 s3, s28
    s_cselect_b32 s18, 57344, 0
    s_sub_u32 s3, s3, s18
    buffer_load_dwordx4 v[64:67], v123, s[52:55], s3 offen sc1
    buffer_load_dwordx4 v[68:71], v122, s[52:55], s3 offen sc1
    s_add_u32 s3, s22, 12288
    s_cmp_ge_u32 s3, s28
    s_cselect_b32 s18, 57344, 0
    s_sub_u32 s3, s3, s18
    buffer_load_dwordx4 v[72:75], v123, s[52:55], s3 offen sc1
    buffer_load_dwordx4 v[76:79], v122, s[52:55], s3 offen sc1
    s_add_u32 s3, s22, 14336
    s_cmp_ge_u32 s3, s28
    s_cselect_b32 s18, 57344, 0
    s_sub_u32 s3, s3, s18
    buffer_load_dwordx4 v[80:83], v123, s[52:55], s3 offen sc1
    buffer_load_dwordx4 v[84:87], v122, s[52:55], s3 offen sc1
    s_waitcnt vmcnt(0)
    v_max_u32 v121, v99, v103
    v_cmp_eq_u32 vcc, -1, v121
    s_add_u32 s85, s85, 1
    s_cbranch_vccz L_gb_263
    s_cmp_lt_u32 s85, 65536
    s_cbranch_scc1 L_gs_264
    s_branch L_gb_263
L_gs_266:
    s_add_u32 s3, s22, 10240
    s_cmp_ge_u32 s3, s28
    s_cselect_b32 s18, 57344, 0
    s_sub_u32 s3, s3, s18
    buffer_load_dwordx4 v[64:67], v123, s[52:55], s3 offen sc1
    buffer_load_dwordx4 v[68:71], v122, s[52:55], s3 offen sc1
    s_add_u32 s3, s22, 12288
    s_cmp_ge_u32 s3, s28
    s_cselect_b32 s18, 57344, 0
    s_sub_u32 s3, s3, s18
    buffer_load_dwordx4 v[72:75], v123, s[52:55], s3 offen sc1
    buffer_load_dwordx4 v[76:79], v122, s[52:55], s3 offen sc1
    s_add_u32 s3, s22, 14336
    s_cmp_ge_u32 s3, s28
    s_cselect_b32 s18, 57344, 0
    s_sub_u32 s3, s3, s18
    buffer_load_dwordx4 v[80:83], v123, s[52:55], s3 offen sc1
    buffer_load_dwordx4 v[84:87], v122, s[52:55], s3 offen sc1
    s_add_u32 s3, s22, 16384
    s_cmp_ge_u32 s3, s28
    s_cselect_b32 s18, 57344, 0
    s_sub_u32 s3, s3, s18
    buffer_load_dwordx4 v[88:91], v123, s[52:55], s3 offen sc1
    buffer_load_dwordx4 v[92:95], v122, s[52:55], s3 offen sc1
    s_waitcnt vmcnt(0)
    v_max_u32 v121, v67, v71
    v_cmp_eq_u32 vcc, -1, v121
    s_add_u32 s85, s85, 1
    s_cbranch_vccz L_gb_265
    s_cmp_lt_u32 s85, 65536
    s_cbranch_scc1 L_gs_266
    s_branch L_gb_265
L_gs_268:
    s_add_u32 s3, s22, 12288
    s_cmp_ge_u32 s3, s28
    s_cselect_b32 s18, 57344, 0
    s_sub_u32 s3, s3, s18
    buffer_load_dwordx4 v[72:75], v123, s[52:55], s3 offen sc1
    buffer_load_dwordx4 v[76:79], v122, s[52:55], s3 offen sc1
    s_add_u32 s3, s22, 14336
    s_cmp_ge_u32 s3, s28
    s_cselect_b32 s18, 57344, 0
    s_sub_u32 s3, s3, s18
    buffer_load_dwordx4 v[80:83], v123, s[52:55], s3 offen sc1
    buffer_load_dwordx4 v[84:87], v122, s[52:55], s3 offen sc1
    s_add_u32 s3, s22, 16384
    s_cmp_ge_u32 s3, s28
    s_cselect_b32 s18, 57344, 0
    s_sub_u32 s3, s3, s18
    buffer_load_dwordx4 v[88:91], v123, s[52:55], s3 offen sc1
    buffer_load_dwordx4 v[92:95], v122, s[52:55], s3 offen sc1
    s_add_u32 s3, s22, 18432
    s_cmp_ge_u32 s3, s28
    s_cselect_b32 s18, 57344, 0
    s_sub_u32 s3, s3, s18
    buffer_load_dwordx4 v[96:99], v123, s[52:55], s3 offen sc1
    buffer_load_dwordx4 v[100:103], v122, s[52:55], s3 offen sc1
    s_waitcnt vmcnt(0)
    v_max_u32 v121, v75, v79
    v_cmp_eq_u32 vcc, -1, v121
    s_add_u32 s85, s85, 1
    s_cbranch_vccz L_gb_267
    s_cmp_lt_u32 s85, 65536
    s_cbranch_scc1 L_gs_268
    s_branch L_gb_267
L_gs_270:
    s_add_u32 s3, s22, 14336
    s_cmp_ge_u32 s3, s28
    s_cselect_b32 s18, 57344, 0
    s_sub_u32 s3, s3, s18
    buffer_load_dwordx4 v[80:83], v123, s[52:55], s3 offen sc1
    buffer_load_dwordx4 v[84:87], v122, s[52:55], s3 offen sc1
    s_add_u32 s3, s22, 16384
    s_cmp_ge_u32 s3, s28
    s_cselect_b32 s18, 57344, 0
    s_sub_u32 s3, s3, s18
    buffer_load_dwordx4 v[88:91], v123, s[52:55], s3 offen sc1
    buffer_load_dwordx4 v[92:95], v122, s[52:55], s3 offen sc1
    s_add_u32 s3, s22, 18432
    s_cmp_ge_u32 s3, s28
    s_cselect_b32 s18, 57344, 0
    s_sub_u32 s3, s3, s18
    buffer_load_dwordx4 v[96:99], v123, s[52:55], s3 offen sc1
    buffer_load_dwordx4 v[100:103], v122, s[52:55], s3 offen sc1
    s_add_u32 s3, s22, 20480
    s_cmp_ge_u32 s3, s28
    s_cselect_b32 s18, 57344, 0
    s_sub_u32 s3, s3, s18
    buffer_load_dwordx4 v[64:67], v123, s[52:55], s3 offen sc1
    buffer_load_dwordx4 v[68:71], v122, s[52:55], s3 offen sc1
    s_waitcnt vmcnt(0)
    v_max_u32 v121, v83, v87
    v_cmp_eq_u32 vcc, -1, v121
    s_add_u32 s85, s85, 1
    s_cbranch_vccz L_gb_269
    s_cmp_lt_u32 s85, 65536
    s_cbranch_scc1 L_gs_270
    s_branch L_gb_269
L_gs_272:
    s_add_u32 s3, s22, 16384
    s_cmp_ge_u32 s3, s28
    s_cselect_b32 s18, 57344, 0
    s_sub_u32 s3, s3, s18
    buffer_load_dwordx4 v[88:91], v123, s[52:55], s3 offen sc1
    buffer_load_dwordx4 v[92:95], v122, s[52:55], s3 offen sc1
    s_add_u32 s3, s22, 18432
    s_cmp_ge_u32 s3, s28
    s_cselect_b32 s18, 57344, 0
    s_sub_u32 s3, s3, s18
    buffer_load_dwordx4 v[96:99], v123, s[52:55], s3 offen sc1
    buffer_load_dwordx4 v[100:103], v122, s[52:55], s3 offen sc1
    s_add_u32 s3, s22, 20480
    s_cmp_ge_u32 s3, s28
    s_cselect_b32 s18, 57344, 0
    s_sub_u32 s3, s3, s18
    buffer_load_dwordx4 v[64:67], v123, s[52:55], s3 offen sc1
    buffer_load_dwordx4 v[68:71], v122, s[52:55], s3 offen sc1
    s_add_u32 s3, s22, 22528
    s_cmp_ge_u32 s3, s28
    s_cselect_b32 s18, 57344, 0
    s_sub_u32 s3, s3, s18
    buffer_load_dwordx4 v[72:75], v123, s[52:55], s3 offen sc1
    buffer_load_dwordx4 v[76:79], v122, s[52:55], s3 offen sc1
    s_waitcnt vmcnt(0)
    v_max_u32 v121, v91, v95
    v_cmp_eq_u32 vcc, -1, v121
    s_add_u32 s85, s85, 1
    s_cbranch_vccz L_gb_271
    s_cmp_lt_u32 s85, 65536
    s_cbranch_scc1 L_gs_272
    s_branch L_gb_271
L_gs_274:
    s_add_u32 s3, s22, 18432
    s_cmp_ge_u32 s3, s28
    s_cselect_b32 s18, 57344, 0
    s_sub_u32 s3, s3, s18
    buffer_load_dwordx4 v[96:99], v123, s[52:55], s3 offen sc1
    buffer_load_dwordx4 v[100:103], v122, s[52:55], s3 offen sc1
    s_add_u32 s3, s22, 20480
    s_cmp_ge_u32 s3, s28
    s_cselect_b32 s18, 57344, 0
    s_sub_u32 s3, s3, s18
    buffer_load_dwordx4 v[64:67], v123, s[52:55], s3 offen sc1
    buffer_load_dwordx4 v[68:71], v122, s[52:55], s3 offen sc1
    s_add_u32 s3, s22, 22528
    s_cmp_ge_u32 s3, s28
    s_cselect_b32 s18, 57344, 0
    s_sub_u32 s3, s3, s18
    buffer_load_dwordx4 v[72:75], v123, s[52:55], s3 offen sc1
    buffer_load_dwordx4 v[76:79], v122, s[52:55], s3 offen sc1
    s_add_u32 s3, s22, 24576
    s_cmp_ge_u32 s3, s28
    s_cselect_b32 s18, 57344, 0
    s_sub_u32 s3, s3, s18
    buffer_load_dwordx4 v[80:83], v123, s[52:55], s3 offen sc1
    buffer_load_dwordx4 v[84:87], v122, s[52:55], s3 offen sc1
    s_waitcnt vmcnt(0)
    v_max_u32 v121, v99, v103
    v_cmp_eq_u32 vcc, -1, v121
    s_add_u32 s85, s85, 1
    s_cbranch_vccz L_gb_273
    s_cmp_lt_u32 s85, 65536
    s_cbranch_scc1 L_gs_274
    s_branch L_gb_273
L_gs_276:
    s_add_u32 s3, s22, 20480
    s_cmp_ge_u32 s3, s28
    s_cselect_b32 s18, 57344, 0
    s_sub_u32 s3, s3, s18
    buffer_load_dwordx4 v[64:67], v123, s[52:55], s3 offen sc1
    buffer_load_dwordx4 v[68:71], v122, s[52:55], s3 offen sc1
    s_add_u32 s3, s22, 22528
    s_cmp_ge_u32 s3, s28
    s_cselect_b32 s18, 57344, 0
    s_sub_u32 s3, s3, s18
    buffer_load_dwordx4 v[72:75], v123, s[52:55], s3 offen sc1
    buffer_load_dwordx4 v[76:79], v122, s[52:55], s3 offen sc1
    s_add_u32 s3, s22, 24576
    s_cmp_ge_u32 s3, s28
    s_cselect_b32 s18, 57344, 0
    s_sub_u32 s3, s3, s18
    buffer_load_dwordx4 v[80:83], v123, s[52:55], s3 offen sc1
    buffer_load_dwordx4 v[84:87], v122, s[52:55], s3 offen sc1
    s_add_u32 s3, s22, 26624
    s_cmp_ge_u32 s3, s28
    s_cselect_b32 s18, 57344, 0
    s_sub_u32 s3, s3, s18
    buffer_load_dwordx4 v[88:91], v123, s[52:55], s3 offen sc1
    buffer_load_dwordx4 v[92:95], v122, s[52:55], s3 offen sc1
    s_waitcnt vmcnt(0)
    v_max_u32 v121, v67, v71
    v_cmp_eq_u32 vcc, -1, v121
    s_add_u32 s85, s85, 1
    s_cbranch_vccz L_gb_275
    s_cmp_lt_u32 s85, 65536
    s_cbranch_scc1 L_gs_276
    s_branch L_gb_275
L_gs_278:
    s_add_u32 s3, s22, 22528
    s_cmp_ge_u32 s3, s28
    s_cselect_b32 s18, 57344, 0
    s_sub_u32 s3, s3, s18
    buffer_load_dwordx4 v[72:75], v123, s[52:55], s3 offen sc1
    buffer_load_dwordx4 v[76:79], v122, s[52:55], s3 offen sc1
    s_add_u32 s3, s22, 24576
    s_cmp_ge_u32 s3, s28
    s_cselect_b32 s18, 57344, 0
    s_sub_u32 s3, s3, s18
    buffer_load_dwordx4 v[80:83], v123, s[52:55], s3 offen sc1
    buffer_load_dwordx4 v[84:87], v122, s[52:55], s3 offen sc1
    s_add_u32 s3, s22, 26624
    s_cmp_ge_u32 s3, s28
    s_cselect_b32 s18, 57344, 0
    s_sub_u32 s3, s3, s18
    buffer_load_dwordx4 v[88:91], v123, s[52:55], s3 offen sc1
    buffer_load_dwordx4 v[92:95], v122, s[52:55], s3 offen sc1
    s_add_u32 s3, s22, 28672
    s_cmp_ge_u32 s3, s28
    s_cselect_b32 s18, 57344, 0
    s_sub_u32 s3, s3, s18
    buffer_load_dwordx4 v[96:99], v123, s[52:55], s3 offen sc1
    buffer_load_dwordx4 v[100:103], v122, s[52:55], s3 offen sc1
    s_waitcnt vmcnt(0)
    v_max_u32 v121, v75, v79
    v_cmp_eq_u32 vcc, -1, v121
    s_add_u32 s85, s85, 1
    s_cbranch_vccz L_gb_277
    s_cmp_lt_u32 s85, 65536
    s_cbranch_scc1 L_gs_278
    s_branch L_gb_277
L_gs_280:
    s_add_u32 s3, s22, 24576
    s_cmp_ge_u32 s3, s28
    s_cselect_b32 s18, 57344, 0
    s_sub_u32 s3, s3, s18
    buffer_load_dwordx4 v[80:83], v123, s[52:55], s3 offen sc1
    buffer_load_dwordx4 v[84:87], v122, s[52:55], s3 offen sc1
    s_add_u32 s3, s22, 26624
    s_cmp_ge_u32 s3, s28
    s_cselect_b32 s18, 57344, 0
    s_sub_u32 s3, s3, s18
    buffer_load_dwordx4 v[88:91], v123, s[52:55], s3 offen sc1
    buffer_load_dwordx4 v[92:95], v122, s[52:55], s3 offen sc1
    s_add_u32 s3, s22, 28672
    s_cmp_ge_u32 s3, s28
    s_cselect_b32 s18, 57344, 0
    s_sub_u32 s3, s3, s18
    buffer_load_dwordx4 v[96:99], v123, s[52:55], s3 offen sc1
    buffer_load_dwordx4 v[100:103], v122, s[52:55], s3 offen sc1
    s_add_u32 s3, s22, 30720
    s_cmp_ge_u32 s3, s28
    s_cselect_b32 s18, 57344, 0
    s_sub_u32 s3, s3, s18
    buffer_load_dwordx4 v[64:67], v123, s[52:55], s3 offen sc1
    buffer_load_dwordx4 v[68:71], v122, s[52:55], s3 offen sc1
    s_waitcnt vmcnt(0)
    v_max_u32 v121, v83, v87
    v_cmp_eq_u32 vcc, -1, v121
    s_add_u32 s85, s85, 1
    s_cbranch_vccz L_gb_279
    s_cmp_lt_u32 s85, 65536
    s_cbranch_scc1 L_gs_280
    s_branch L_gb_279
L_gs_282:
    s_add_u32 s3, s22, 26624
    s_cmp_ge_u32 s3, s28
    s_cselect_b32 s18, 57344, 0
    s_sub_u32 s3, s3, s18
    buffer_load_dwordx4 v[88:91], v123, s[52:55], s3 offen sc1
    buffer_load_dwordx4 v[92:95], v122, s[52:55], s3 offen sc1
    s_add_u32 s3, s22, 28672
    s_cmp_ge_u32 s3, s28
    s_cselect_b32 s18, 57344, 0
    s_sub_u32 s3, s3, s18
    buffer_load_dwordx4 v[96:99], v123, s[52:55], s3 offen sc1
    buffer_load_dwordx4 v[100:103], v122, s[52:55], s3 offen sc1
    s_add_u32 s3, s22, 30720
    s_cmp_ge_u32 s3, s28
    s_cselect_b32 s18, 57344, 0
    s_sub_u32 s3, s3, s18
    buffer_load_dwordx4 v[64:67], v123, s[52:55], s3 offen sc1
    buffer_load_dwordx4 v[68:71], v122, s[52:55], s3 offen sc1
    s_add_u32 s3, s22, 32768
    s_cmp_ge_u32 s3, s28
    s_cselect_b32 s18, 57344, 0
    s_sub_u32 s3, s3, s18
    buffer_load_dwordx4 v[72:75], v123, s[52:55], s3 offen sc1
    buffer_load_dwordx4 v[76:79], v122, s[52:55], s3 offen sc1
    s_waitcnt vmcnt(0)
    v_max_u32 v121, v91, v95
    v_cmp_eq_u32 vcc, -1, v121
    s_add_u32 s85, s85, 1
    s_cbranch_vccz L_gb_281
    s_cmp_lt_u32 s85, 65536
    s_cbranch_scc1 L_gs_282
    s_branch L_gb_281
L_gs_284:
    s_add_u32 s3, s22, 28672
    s_cmp_ge_u32 s3, s28
    s_cselect_b32 s18, 57344, 0
    s_sub_u32 s3, s3, s18
    buffer_load_dwordx4 v[96:99], v123, s[52:55], s3 offen sc1
    buffer_load_dwordx4 v[100:103], v122, s[52:55], s3 offen sc1
    s_add_u32 s3, s22, 30720
    s_cmp_ge_u32 s3, s28
    s_cselect_b32 s18, 57344, 0
    s_sub_u32 s3, s3, s18
    buffer_load_dwordx4 v[64:67], v123, s[52:55], s3 offen sc1
    buffer_load_dwordx4 v[68:71], v122, s[52:55], s3 offen sc1
    s_add_u32 s3, s22, 32768
    s_cmp_ge_u32 s3, s28
    s_cselect_b32 s18, 57344, 0
    s_sub_u32 s3, s3, s18
    buffer_load_dwordx4 v[72:75], v123, s[52:55], s3 offen sc1
    buffer_load_dwordx4 v[76:79], v122, s[52:55], s3 offen sc1
    s_add_u32 s3, s22, 34816
    s_cmp_ge_u32 s3, s28
    s_cselect_b32 s18, 57344, 0
    s_sub_u32 s3, s3, s18
    buffer_load_dwordx4 v[80:83], v123, s[52:55], s3 offen sc1
    buffer_load_dwordx4 v[84:87], v122, s[52:55], s3 offen sc1
    s_waitcnt vmcnt(0)
    v_max_u32 v121, v99, v103
    v_cmp_eq_u32 vcc, -1, v121
    s_add_u32 s85, s85, 1
    s_cbranch_vccz L_gb_283
    s_cmp_lt_u32 s85, 65536
    s_cbranch_scc1 L_gs_284
    s_branch L_gb_283
L_gs_286:
    s_add_u32 s3, s22, 30720
    s_cmp_ge_u32 s3, s28
    s_cselect_b32 s18, 57344, 0
    s_sub_u32 s3, s3, s18
    buffer_load_dwordx4 v[64:67], v123, s[52:55], s3 offen sc1
    buffer_load_dwordx4 v[68:71], v122, s[52:55], s3 offen sc1
    s_add_u32 s3, s22, 32768
    s_cmp_ge_u32 s3, s28
    s_cselect_b32 s18, 57344, 0
    s_sub_u32 s3, s3, s18
    buffer_load_dwordx4 v[72:75], v123, s[52:55], s3 offen sc1
    buffer_load_dwordx4 v[76:79], v122, s[52:55], s3 offen sc1
    s_add_u32 s3, s22, 34816
    s_cmp_ge_u32 s3, s28
    s_cselect_b32 s18, 57344, 0
    s_sub_u32 s3, s3, s18
    buffer_load_dwordx4 v[80:83], v123, s[52:55], s3 offen sc1
    buffer_load_dwordx4 v[84:87], v122, s[52:55], s3 offen sc1
    s_add_u32 s3, s22, 36864
    s_cmp_ge_u32 s3, s28
    s_cselect_b32 s18, 57344, 0
    s_sub_u32 s3, s3, s18
    buffer_load_dwordx4 v[88:91], v123, s[52:55], s3 offen sc1
    buffer_load_dwordx4 v[92:95], v122, s[52:55], s3 offen sc1
    s_waitcnt vmcnt(0)
    v_max_u32 v121, v67, v71
    v_cmp_eq_u32 vcc, -1, v121
    s_add_u32 s85, s85, 1
    s_cbranch_vccz L_gb_285
    s_cmp_lt_u32 s85, 65536
    s_cbranch_scc1 L_gs_286
    s_branch L_gb_285
L_gs_288:
    s_add_u32 s3, s22, 32768
    s_cmp_ge_u32 s3, s28
    s_cselect_b32 s18, 57344, 0
    s_sub_u32 s3, s3, s18
    buffer_load_dwordx4 v[72:75], v123, s[52:55], s3 offen sc1
    buffer_load_dwordx4 v[76:79], v122, s[52:55], s3 offen sc1
    s_add_u32 s3, s22, 34816
    s_cmp_ge_u32 s3, s28
    s_cselect_b32 s18, 57344, 0
    s_sub_u32 s3, s3, s18
    buffer_load_dwordx4 v[80:83], v123, s[52:55], s3 offen sc1
    buffer_load_dwordx4 v[84:87], v122, s[52:55], s3 offen sc1
    s_add_u32 s3, s22, 36864
    s_cmp_ge_u32 s3, s28
    s_cselect_b32 s18, 57344, 0
    s_sub_u32 s3, s3, s18
    buffer_load_dwordx4 v[88:91], v123, s[52:55], s3 offen sc1
    buffer_load_dwordx4 v[92:95], v122, s[52:55], s3 offen sc1
    s_add_u32 s3, s22, 38912
    s_cmp_ge_u32 s3, s28
    s_cselect_b32 s18, 57344, 0
    s_sub_u32 s3, s3, s18
    buffer_load_dwordx4 v[96:99], v123, s[52:55], s3 offen sc1
    buffer_load_dwordx4 v[100:103], v122, s[52:55], s3 offen sc1
    s_waitcnt vmcnt(0)
    v_max_u32 v121, v75, v79
    v_cmp_eq_u32 vcc, -1, v121
    s_add_u32 s85, s85, 1
    s_cbranch_vccz L_gb_287
    s_cmp_lt_u32 s85, 65536
    s_cbranch_scc1 L_gs_288
    s_branch L_gb_287
L_gs_290:
    s_add_u32 s3, s22, 34816
    s_cmp_ge_u32 s3, s28
    s_cselect_b32 s18, 57344, 0
    s_sub_u32 s3, s3, s18
    buffer_load_dwordx4 v[80:83], v123, s[52:55], s3 offen sc1
    buffer_load_dwordx4 v[84:87], v122, s[52:55], s3 offen sc1
    s_add_u32 s3, s22, 36864
    s_cmp_ge_u32 s3, s28
    s_cselect_b32 s18, 57344, 0
    s_sub_u32 s3, s3, s18
    buffer_load_dwordx4 v[88:91], v123, s[52:55], s3 offen sc1
    buffer_load_dwordx4 v[92:95], v122, s[52:55], s3 offen sc1
    s_add_u32 s3, s22, 38912
    s_cmp_ge_u32 s3, s28
    s_cselect_b32 s18, 57344, 0
    s_sub_u32 s3, s3, s18
    buffer_load_dwordx4 v[96:99], v123, s[52:55], s3 offen sc1
    buffer_load_dwordx4 v[100:103], v122, s[52:55], s3 offen sc1
    s_add_u32 s3, s22, 40960
    s_cmp_ge_u32 s3, s28
    s_cselect_b32 s18, 57344, 0
    s_sub_u32 s3, s3, s18
    buffer_load_dwordx4 v[64:67], v123, s[52:55], s3 offen sc1
    buffer_load_dwordx4 v[68:71], v122, s[52:55], s3 offen sc1
    s_waitcnt vmcnt(0)
    v_max_u32 v121, v83, v87
    v_cmp_eq_u32 vcc, -1, v121
    s_add_u32 s85, s85, 1
    s_cbranch_vccz L_gb_289
    s_cmp_lt_u32 s85, 65536
    s_cbranch_scc1 L_gs_290
    s_branch L_gb_289
L_gs_292:
    s_add_u32 s3, s22, 36864
    s_cmp_ge_u32 s3, s28
    s_cselect_b32 s18, 57344, 0
    s_sub_u32 s3, s3, s18
    buffer_load_dwordx4 v[88:91], v123, s[52:55], s3 offen sc1
    buffer_load_dwordx4 v[92:95], v122, s[52:55], s3 offen sc1
    s_add_u32 s3, s22, 38912
    s_cmp_ge_u32 s3, s28
    s_cselect_b32 s18, 57344, 0
    s_sub_u32 s3, s3, s18
    buffer_load_dwordx4 v[96:99], v123, s[52:55], s3 offen sc1
    buffer_load_dwordx4 v[100:103], v122, s[52:55], s3 offen sc1
    s_add_u32 s3, s22, 40960
    s_cmp_ge_u32 s3, s28
    s_cselect_b32 s18, 57344, 0
    s_sub_u32 s3, s3, s18
    buffer_load_dwordx4 v[64:67], v123, s[52:55], s3 offen sc1
    buffer_load_dwordx4 v[68:71], v122, s[52:55], s3 offen sc1
    s_add_u32 s3, s22, 43008
    s_cmp_ge_u32 s3, s28
    s_cselect_b32 s18, 57344, 0
    s_sub_u32 s3, s3, s18
    buffer_load_dwordx4 v[72:75], v123, s[52:55], s3 offen sc1
    buffer_load_dwordx4 v[76:79], v122, s[52:55], s3 offen sc1
    s_waitcnt vmcnt(0)
    v_max_u32 v121, v91, v95
    v_cmp_eq_u32 vcc, -1, v121
    s_add_u32 s85, s85, 1
    s_cbranch_vccz L_gb_291
    s_cmp_lt_u32 s85, 65536
    s_cbranch_scc1 L_gs_292
    s_branch L_gb_291
L_gs_294:
    s_add_u32 s3, s22, 38912
    s_cmp_ge_u32 s3, s28
    s_cselect_b32 s18, 57344, 0
    s_sub_u32 s3, s3, s18
    buffer_load_dwordx4 v[96:99], v123, s[52:55], s3 offen sc1
    buffer_load_dwordx4 v[100:103], v122, s[52:55], s3 offen sc1
    s_add_u32 s3, s22, 40960
    s_cmp_ge_u32 s3, s28
    s_cselect_b32 s18, 57344, 0
    s_sub_u32 s3, s3, s18
    buffer_load_dwordx4 v[64:67], v123, s[52:55], s3 offen sc1
    buffer_load_dwordx4 v[68:71], v122, s[52:55], s3 offen sc1
    s_add_u32 s3, s22, 43008
    s_cmp_ge_u32 s3, s28
    s_cselect_b32 s18, 57344, 0
    s_sub_u32 s3, s3, s18
    buffer_load_dwordx4 v[72:75], v123, s[52:55], s3 offen sc1
    buffer_load_dwordx4 v[76:79], v122, s[52:55], s3 offen sc1
    s_add_u32 s3, s22, 45056
    s_cmp_ge_u32 s3, s28
    s_cselect_b32 s18, 57344, 0
    s_sub_u32 s3, s3, s18
    buffer_load_dwordx4 v[80:83], v123, s[52:55], s3 offen sc1
    buffer_load_dwordx4 v[84:87], v122, s[52:55], s3 offen sc1
    s_waitcnt vmcnt(0)
    v_max_u32 v121, v99, v103
    v_cmp_eq_u32 vcc, -1, v121
    s_add_u32 s85, s85, 1
    s_cbranch_vccz L_gb_293
    s_cmp_lt_u32 s85, 65536
    s_cbranch_scc1 L_gs_294
    s_branch L_gb_293
L_gs_296:
    s_add_u32 s3, s22, 40960
    s_cmp_ge_u32 s3, s28
    s_cselect_b32 s18, 57344, 0
    s_sub_u32 s3, s3, s18
    buffer_load_dwordx4 v[64:67], v123, s[52:55], s3 offen sc1
    buffer_load_dwordx4 v[68:71], v122, s[52:55], s3 offen sc1
    s_add_u32 s3, s22, 43008
    s_cmp_ge_u32 s3, s28
    s_cselect_b32 s18, 57344, 0
    s_sub_u32 s3, s3, s18
    buffer_load_dwordx4 v[72:75], v123, s[52:55], s3 offen sc1
    buffer_load_dwordx4 v[76:79], v122, s[52:55], s3 offen sc1
    s_add_u32 s3, s22, 45056
    s_cmp_ge_u32 s3, s28
    s_cselect_b32 s18, 57344, 0
    s_sub_u32 s3, s3, s18
    buffer_load_dwordx4 v[80:83], v123, s[52:55], s3 offen sc1
    buffer_load_dwordx4 v[84:87], v122, s[52:55], s3 offen sc1
    s_add_u32 s3, s22, 47104
    s_cmp_ge_u32 s3, s28
    s_cselect_b32 s18, 57344, 0
    s_sub_u32 s3, s3, s18
    buffer_load_dwordx4 v[88:91], v123, s[52:55], s3 offen sc1
    buffer_load_dwordx4 v[92:95], v122, s[52:55], s3 offen sc1
    s_waitcnt vmcnt(0)
    v_max_u32 v121, v67, v71
    v_cmp_eq_u32 vcc, -1, v121
    s_add_u32 s85, s85, 1
    s_cbranch_vccz L_gb_295
    s_cmp_lt_u32 s85, 65536
    s_cbranch_scc1 L_gs_296
    s_branch L_gb_295
L_gs_298:
    s_add_u32 s3, s22, 43008
    s_cmp_ge_u32 s3, s28
    s_cselect_b32 s18, 57344, 0
    s_sub_u32 s3, s3, s18
    buffer_load_dwordx4 v[72:75], v123, s[52:55], s3 offen sc1
    buffer_load_dwordx4 v[76:79], v122, s[52:55], s3 offen sc1
    s_add_u32 s3, s22, 45056
    s_cmp_ge_u32 s3, s28
    s_cselect_b32 s18, 57344, 0
    s_sub_u32 s3, s3, s18
    buffer_load_dwordx4 v[80:83], v123, s[52:55], s3 offen sc1
    buffer_load_dwordx4 v[84:87], v122, s[52:55], s3 offen sc1
    s_add_u32 s3, s22, 47104
    s_cmp_ge_u32 s3, s28
    s_cselect_b32 s18, 57344, 0
    s_sub_u32 s3, s3, s18
    buffer_load_dwordx4 v[88:91], v123, s[52:55], s3 offen sc1
    buffer_load_dwordx4 v[92:95], v122, s[52:55], s3 offen sc1
    s_add_u32 s3, s22, 49152
    s_cmp_ge_u32 s3, s28
    s_cselect_b32 s18, 57344, 0
    s_sub_u32 s3, s3, s18
    buffer_load_dwordx4 v[96:99], v123, s[52:55], s3 offen sc1
    buffer_load_dwordx4 v[100:103], v122, s[52:55], s3 offen sc1
    s_waitcnt vmcnt(0)
    v_max_u32 v121, v75, v79
    v_cmp_eq_u32 vcc, -1, v121
    s_add_u32 s85, s85, 1
    s_cbranch_vccz L_gb_297
    s_cmp_lt_u32 s85, 65536
    s_cbranch_scc1 L_gs_298
    s_branch L_gb_297
L_gs_300:
    s_add_u32 s3, s22, 45056
    s_cmp_ge_u32 s3, s28
    s_cselect_b32 s18, 57344, 0
    s_sub_u32 s3, s3, s18
    buffer_load_dwordx4 v[80:83], v123, s[52:55], s3 offen sc1
    buffer_load_dwordx4 v[84:87], v122, s[52:55], s3 offen sc1
    s_add_u32 s3, s22, 47104
    s_cmp_ge_u32 s3, s28
    s_cselect_b32 s18, 57344, 0
    s_sub_u32 s3, s3, s18
    buffer_load_dwordx4 v[88:91], v123, s[52:55], s3 offen sc1
    buffer_load_dwordx4 v[92:95], v122, s[52:55], s3 offen sc1
    s_add_u32 s3, s22, 49152
    s_cmp_ge_u32 s3, s28
    s_cselect_b32 s18, 57344, 0
    s_sub_u32 s3, s3, s18
    buffer_load_dwordx4 v[96:99], v123, s[52:55], s3 offen sc1
    buffer_load_dwordx4 v[100:103], v122, s[52:55], s3 offen sc1
    s_add_u32 s3, s22, 51200
    s_cmp_ge_u32 s3, s28
    s_cselect_b32 s18, 57344, 0
    s_sub_u32 s3, s3, s18
    buffer_load_dwordx4 v[64:67], v123, s[52:55], s3 offen sc1
    buffer_load_dwordx4 v[68:71], v122, s[52:55], s3 offen sc1
    s_waitcnt vmcnt(0)
    v_max_u32 v121, v83, v87
    v_cmp_eq_u32 vcc, -1, v121
    s_add_u32 s85, s85, 1
    s_cbranch_vccz L_gb_299
    s_cmp_lt_u32 s85, 65536
    s_cbranch_scc1 L_gs_300
    s_branch L_gb_299
L_gs_302:
    s_add_u32 s3, s22, 47104
    s_cmp_ge_u32 s3, s28
    s_cselect_b32 s18, 57344, 0
    s_sub_u32 s3, s3, s18
    buffer_load_dwordx4 v[88:91], v123, s[52:55], s3 offen sc1
    buffer_load_dwordx4 v[92:95], v122, s[52:55], s3 offen sc1
    s_add_u32 s3, s22, 49152
    s_cmp_ge_u32 s3, s28
    s_cselect_b32 s18, 57344, 0
    s_sub_u32 s3, s3, s18
    buffer_load_dwordx4 v[96:99], v123, s[52:55], s3 offen sc1
    buffer_load_dwordx4 v[100:103], v122, s[52:55], s3 offen sc1
    s_add_u32 s3, s22, 51200
    s_cmp_ge_u32 s3, s28
    s_cselect_b32 s18, 57344, 0
    s_sub_u32 s3, s3, s18
    buffer_load_dwordx4 v[64:67], v123, s[52:55], s3 offen sc1
    buffer_load_dwordx4 v[68:71], v122, s[52:55], s3 offen sc1
    s_add_u32 s3, s22, 53248
    s_cmp_ge_u32 s3, s28
    s_cselect_b32 s18, 57344, 0
    s_sub_u32 s3, s3, s18
    buffer_load_dwordx4 v[72:75], v123, s[52:55], s3 offen sc1
    buffer_load_dwordx4 v[76:79], v122, s[52:55], s3 offen sc1
    s_waitcnt vmcnt(0)
    v_max_u32 v121, v91, v95
    v_cmp_eq_u32 vcc, -1, v121
    s_add_u32 s85, s85, 1
    s_cbranch_vccz L_gb_301
    s_cmp_lt_u32 s85, 65536
    s_cbranch_scc1 L_gs_302
    s_branch L_gb_301
L_gs_304:
    s_add_u32 s3, s22, 49152
    s_cmp_ge_u32 s3, s28
    s_cselect_b32 s18, 57344, 0
    s_sub_u32 s3, s3, s18
    buffer_load_dwordx4 v[96:99], v123, s[52:55], s3 offen sc1
    buffer_load_dwordx4 v[100:103], v122, s[52:55], s3 offen sc1
    s_add_u32 s3, s22, 51200
    s_cmp_ge_u32 s3, s28
    s_cselect_b32 s18, 57344, 0
    s_sub_u32 s3, s3, s18
    buffer_load_dwordx4 v[64:67], v123, s[52:55], s3 offen sc1
    buffer_load_dwordx4 v[68:71], v122, s[52:55], s3 offen sc1
    s_add_u32 s3, s22, 53248
    s_cmp_ge_u32 s3, s28
    s_cselect_b32 s18, 57344, 0
    s_sub_u32 s3, s3, s18
    buffer_load_dwordx4 v[72:75], v123, s[52:55], s3 offen sc1
    buffer_load_dwordx4 v[76:79], v122, s[52:55], s3 offen sc1
    s_add_u32 s3, s22, 55296
    s_cmp_ge_u32 s3, s28
    s_cselect_b32 s18, 57344, 0
    s_sub_u32 s3, s3, s18
    buffer_load_dwordx4 v[80:83], v123, s[52:55], s3 offen sc1
    buffer_load_dwordx4 v[84:87], v122, s[52:55], s3 offen sc1
    s_waitcnt vmcnt(0)
    v_max_u32 v121, v99, v103
    v_cmp_eq_u32 vcc, -1, v121
    s_add_u32 s85, s85, 1
    s_cbranch_vccz L_gb_303
    s_cmp_lt_u32 s85, 65536
    s_cbranch_scc1 L_gs_304
    s_branch L_gb_303
L_gs_306:
    s_add_u32 s3, s22, 51200
    s_cmp_ge_u32 s3, s28
    s_cselect_b32 s18, 57344, 0
    s_sub_u32 s3, s3, s18
    buffer_load_dwordx4 v[64:67], v123, s[52:55], s3 offen sc1
    buffer_load_dwordx4 v[68:71], v122, s[52:55], s3 offen sc1
    s_add_u32 s3, s22, 53248
    s_cmp_ge_u32 s3, s28
    s_cselect_b32 s18, 57344, 0
    s_sub_u32 s3, s3, s18
    buffer_load_dwordx4 v[72:75], v123, s[52:55], s3 offen sc1
    buffer_load_dwordx4 v[76:79], v122, s[52:55], s3 offen sc1
    s_add_u32 s3, s22, 55296
    s_cmp_ge_u32 s3, s28
    s_cselect_b32 s18, 57344, 0
    s_sub_u32 s3, s3, s18
    buffer_load_dwordx4 v[80:83], v123, s[52:55], s3 offen sc1
    buffer_load_dwordx4 v[84:87], v122, s[52:55], s3 offen sc1
    s_waitcnt vmcnt(0)
    v_max_u32 v121, v67, v71
    v_cmp_eq_u32 vcc, -1, v121
    s_add_u32 s85, s85, 1
    s_cbranch_vccz L_gb_305
    s_cmp_lt_u32 s85, 65536
    s_cbranch_scc1 L_gs_306
    s_branch L_gb_305
L_gs_308:
    s_add_u32 s3, s22, 53248
    s_cmp_ge_u32 s3, s28
    s_cselect_b32 s18, 57344, 0
    s_sub_u32 s3, s3, s18
    buffer_load_dwordx4 v[72:75], v123, s[52:55], s3 offen sc1
    buffer_load_dwordx4 v[76:79], v122, s[52:55], s3 offen sc1
    s_add_u32 s3, s22, 55296
    s_cmp_ge_u32 s3, s28
    s_cselect_b32 s18, 57344, 0
    s_sub_u32 s3, s3, s18
    buffer_load_dwordx4 v[80:83], v123, s[52:55], s3 offen sc1
    buffer_load_dwordx4 v[84:87], v122, s[52:55], s3 offen sc1
    s_waitcnt vmcnt(0)
    v_max_u32 v121, v75, v79
    v_cmp_eq_u32 vcc, -1, v121
    s_add_u32 s85, s85, 1
    s_cbranch_vccz L_gb_307
    s_cmp_lt_u32 s85, 65536
    s_cbranch_scc1 L_gs_308
    s_branch L_gb_307
L_gs_310:
    s_add_u32 s3, s22, 55296
    s_cmp_ge_u32 s3, s28
    s_cselect_b32 s18, 57344, 0
    s_sub_u32 s3, s3, s18
    buffer_load_dwordx4 v[80:83], v123, s[52:55], s3 offen sc1
    buffer_load_dwordx4 v[84:87], v122, s[52:55], s3 offen sc1
    s_waitcnt vmcnt(0)
    v_max_u32 v121, v83, v87
    v_cmp_eq_u32 vcc, -1, v121
    s_add_u32 s85, s85, 1
    s_cbranch_vccz L_gb_309
    s_cmp_lt_u32 s85, 65536
    s_cbranch_scc1 L_gs_310
    s_branch L_gb_309
.p2align 6
.type ktab,@object
ktab:
    .short 2560, 2560, 2560, 2560, 2556, 2556, 2556, 2556, 2556, 2556, 2556, 2540, 2540, 2540, 2540, 2540
    .short 2540, 2540, 2540, 2540, 2524, 2524, 2524, 2524, 2524, 2524, 2524, 2508, 2508, 2508, 2508, 2508
    .short 2508, 2508, 2508, 2508, 2492, 2492, 2492, 2492, 2492, 2492, 2492, 2476, 2476, 2476, 2476, 2476
    .short 2476, 2476, 2476, 2476, 2460, 2460, 2460, 2460, 2460, 2460, 2460, 2444, 2444, 2444, 2444, 2444
    .short 2444, 2444, 2444, 2444, 2428, 2428, 2428, 2428, 2428, 2428, 2428, 2412, 2412, 2412, 2412, 2412
    .short 2412, 2412, 2412, 2412, 2396, 2396, 2396, 2396, 2396, 2396, 2396, 2380, 2380, 2380, 2380, 2380
    .short 2380, 2380, 2380, 2380, 2364, 2364, 2364, 2364, 2364, 2364, 2364, 2348, 2348, 2348, 2348, 2348
    .short 2348, 2348, 2348, 2348, 2332, 2332, 2332, 2332, 2332, 2332, 2332, 2316, 2316, 2316, 2316, 2316
    .short 2316, 2316, 2316, 2316, 2552, 2552, 2552, 2552, 2552, 2552, 2552, 2536, 2536, 2536, 2536, 2536
    .short 2536, 2536, 2536, 2536, 2520, 2520, 2520, 2520, 2520, 2520, 2520, 2504, 2504, 2504, 2504, 2504
    .short 2504, 2504, 2504, 2504, 2488, 2488, 2488, 2488, 2488, 2488, 2488, 2472, 2472, 2472, 2472, 2472
    .short 2472, 2472, 2472, 2472, 2456, 2456, 2456, 2456, 2456, 2456, 2456, 2440, 2440, 2440, 2440, 2440
    .short 2440, 2440, 2440, 2440, 2424, 2424, 2424, 2424, 2424, 2424, 2424, 2408, 2408, 2408, 2408, 2408
    .short 2408, 2408, 2408, 2408, 2392, 2392, 2392, 2392, 2392, 2392, 2392, 2376, 2376, 2376, 2376, 2376
    .short 2376, 2376, 2376, 2376, 2360, 2360, 2360, 2360, 2360, 2360, 2360, 2344, 2344, 2344, 2344, 2344
    .short 2344, 2344, 2344, 2344, 2328, 2328, 2328, 2328, 2328, 2328, 2328, 2312, 2312, 2312, 2312, 2312
    .short 2312, 2312, 2312, 2312, 2548, 2548, 2548, 2548, 2548, 2548, 2548, 2532, 2532, 2532, 2532, 2532
    .short 2532, 2532, 2532, 2532, 2516, 2516, 2516, 2516, 2516, 2516, 2516, 2500, 2500, 2500, 2500, 2500
    .short 2500, 2500, 2500, 2500, 2484, 2484, 2484, 2484, 2484, 2484, 2484, 2468, 2468, 2468, 2468, 2468
    .short 2468, 2468, 2468, 2468, 2452, 2452, 2452, 2452, 2452, 2452, 2452, 2436, 2436, 2436, 2436, 2436
    .short 2436, 2436, 2436, 2436, 2420, 2420, 2420, 2420, 2420, 2420, 2420, 2404, 2404, 2404, 2404, 2404
    .short 2404, 2404, 2404, 2404, 2388, 2388, 2388, 2388, 2388, 2388, 2388, 2372, 2372, 2372, 2372, 2372
    .short 2372, 2372, 2372, 2372, 2356, 2356, 2356, 2356, 2356, 2356, 2356, 2340, 2340, 2340, 2340, 2340
    .short 2340, 2340, 2340, 2340, 2324, 2324, 2324, 2324, 2324, 2324, 2324, 2308, 2308, 2308, 2308, 2308
    .short 2308, 2308, 2308, 2308, 2544, 2544, 2544, 2544, 2544, 2544, 2544, 2528, 2528, 2528, 2528, 2528
    .short 2528, 2528, 2528, 2528, 2512, 2512, 2512, 2512, 2512, 2512, 2512, 2496, 2496, 2496, 2496, 2496
    .short 2496, 2496, 2496, 2496, 2480, 2480, 2480, 2480, 2480, 2480, 2480, 2464, 2464, 2464, 2464, 2464
    .short 2464, 2464, 2464, 2464, 2448, 2448, 2448, 2448, 2448, 2448, 2448, 2432, 2432, 2432, 2432, 2432
    .short 2432, 2432, 2432, 2432, 2416, 2416, 2416, 2416, 2416, 2416, 2416, 2400, 2400, 2400, 2400, 2400
    .short 2400, 2400, 2400, 2400, 2384, 2384, 2384, 2384, 2384, 2384, 2384, 2368, 2368, 2368, 2368, 2368
    .short 2368, 2368, 2368, 2368, 2352, 2352, 2352, 2352, 2352, 2352, 2352, 2336, 2336, 2336, 2336, 2336
    .short 2336, 2336, 2336, 2336, 2320, 2320, 2320, 2320, 2320, 2320, 2320, 2304, 2304, 2304, 2304, 2304
    .short 2304, 2304, 2304, 2304, 2300, 2300, 2300, 2300, 2300, 2300, 2300, 2284, 2284, 2284, 2284, 2284
    .short 2284, 2284, 2284, 2284, 2268, 2268, 2268, 2268, 2268, 2268, 2268, 2252, 2252, 2252, 2252, 2252
    .short 2252, 2252, 2252, 2252, 2236, 2236, 2236, 2236, 2236, 2236, 2236, 2220, 2220, 2220, 2220, 2220
    .short 2220, 2220, 2220, 2220, 2204, 2204, 2204, 2204, 2204, 2204, 2204, 2188, 2188, 2188, 2188, 2188
    .short 2188, 2188, 2188, 2188, 2172, 2172, 2172, 2172, 2172, 2172, 2172, 2156, 2156, 2156, 2156, 2156
    .short 2156, 2156, 2156, 2156, 2140, 2140, 2140, 2140, 2140, 2140, 2140, 2124, 2124, 2124, 2124, 2124
    .short 2124, 2124, 2124, 2124, 2108, 2108, 2108, 2108, 2108, 2108, 2108, 2092, 2092, 2092, 2092, 2092
    .short 2092, 2092, 2092, 2092, 2076, 2076, 2076, 2076, 2076, 2076, 2076, 2060, 2060, 2060, 2060, 2060
    .short 2060, 2060, 2060, 2060, 2296, 2296, 2296, 2296, 2296, 2296, 2296, 2280, 2280, 2280, 2280, 2280
    .short 2280, 2280, 2280, 2280, 2264, 2264, 2264, 2264, 2264, 2264, 2264, 2248, 2248, 2248, 2248, 2248
    .short 2248, 2248, 2248, 2248, 2232, 2232, 2232, 2232, 2232, 2232, 2232, 2216, 2216, 2216, 2216, 2216
    .short 2216, 2216, 2216, 2216, 2200, 2200, 2200, 2200, 2200, 2200, 2200, 2184, 2184, 2184, 2184, 2184
    .short 2184, 2184, 2184, 2184, 2168, 2168, 2168, 2168, 2168, 2168, 2168, 2152, 2152, 2152, 2152, 2152
    .short 2152, 2152, 2152, 2152, 2136, 2136, 2136, 2136, 2136, 2136, 2136, 2120, 2120, 2120, 2120, 2120
    .short 2120, 2120, 2120, 2120, 2104, 2104, 2104, 2104, 2104, 2104, 2104, 2088, 2088, 2088, 2088, 2088
    .short 2088, 2088, 2088, 2088, 2072, 2072, 2072, 2072, 2072, 2072, 2072, 2056, 2056, 2056, 2056, 2056
    .short 2056, 2056, 2056, 2056, 2292, 2292, 2292, 2292, 2292, 2292, 2292, 2276, 2276, 2276, 2276, 2276
    .short 2276, 2276, 2276, 2276, 2260, 2260, 2260, 2260, 2260, 2260, 2260, 2244, 2244, 2244, 2244, 2244
    .short 2244, 2244, 2244, 2244, 2228, 2228, 2228, 2228, 2228, 2228, 2228, 2212, 2212, 2212, 2212, 2212
    .short 2212, 2212, 2212, 2212, 2196, 2196, 2196, 2196, 2196, 2196, 2196, 2180, 2180, 2180, 2180, 2180
    .short 2180, 2180, 2180, 2180, 2164, 2164, 2164, 2164, 2164, 2164, 2164, 2148, 2148, 2148, 2148, 2148
    .short 2148, 2148, 2148, 2148, 2132, 2132, 2132, 2132, 2132, 2132, 2132, 2116, 2116, 2116, 2116, 2116
    .short 2116, 2116, 2116, 2116, 2100, 2100, 2100, 2100, 2100, 2100, 2100, 2084, 2084, 2084, 2084, 2084
    .short 2084, 2084, 2084, 2084, 2068, 2068, 2068, 2068, 2068, 2068, 2068, 2052, 2052, 2052, 2052, 2052
    .short 2052, 2052, 2052, 2052, 2288, 2288, 2288, 2288, 2288, 2288, 2288, 2272, 2272, 2272, 2272, 2272
    .short 2272, 2272, 2272, 2272, 2256, 2256, 2256, 2256, 2256, 2256, 2256, 2240, 2240, 2240, 2240, 2240
    .short 2240, 2240, 2240, 2240, 2224, 2224, 2224, 2224, 2224, 2224, 2224, 2208, 2208, 2208, 2208, 2208
    .short 2208, 2208, 2208, 2208, 2192, 2192, 2192, 2192, 2192, 2192, 2192, 2176, 2176, 2176, 2176, 2176
    .short 2176, 2176, 2176, 2176, 2160, 2160, 2160, 2160, 2160, 2160, 2160, 2144, 2144, 2144, 2144, 2144
    .short 2144, 2144, 2144, 2144, 2128, 2128, 2128, 2128, 2128, 2128, 2128, 2112, 2112, 2112, 2112, 2112
    .short 2112, 2112, 2112, 2112, 2096, 2096, 2096, 2096, 2096, 2096, 2096, 2080, 2080, 2080, 2080, 2080
    .short 2080, 2080, 2080, 2080, 2064, 2064, 2064, 2064, 2064, 2064, 2064, 2048, 2048, 2048, 2048, 2048
    .short 2048, 2048, 2044, 2044, 2044, 2040, 2040, 2040, 2040, 2040, 2028, 2028, 2028, 2024, 2024, 2024
    .short 2024, 2024, 2012, 2012, 2012, 2008, 2008, 2008, 2008, 2008, 1996, 1996, 1996, 1992, 1992, 1992
    .short 1992, 1992, 1980, 1980, 1980, 1976, 1976, 1976, 1976, 1976, 1964, 1964, 1964, 1960, 1960, 1960
    .short 1960, 1960, 1948, 1948, 1948, 1944, 1944, 1944, 1944, 1944, 1932, 1932, 1932, 1928, 1928, 1928
    .short 1928, 1928, 1916, 1916, 1916, 1912, 1912, 1912, 1912, 1912, 1900, 1900, 1900, 1896, 1896, 1896
    .short 1896, 1896, 1884, 1884, 1884, 1880, 1880, 1880, 1880, 1880, 1868, 1868, 1868, 1864, 1864, 1864
    .short 1864, 1864, 1852, 1852, 1852, 1848, 1848, 1848, 1848, 1848, 1836, 1836, 1836, 1832, 1832, 1832
    .short 1832, 1832, 1820, 1820, 1820, 1816, 1816, 1816, 1816, 1816, 1804, 1804, 1804, 1800, 1800, 1800
    .short 1800, 1800, 2036, 2036, 2036, 2032, 2032, 2032, 2032, 2032, 2020, 2020, 2020, 2016, 2016, 2016
    .short 2016, 2016, 2004, 2004, 2004, 2000, 2000, 2000, 2000, 2000, 1988, 1988, 1988, 1984, 1984, 1984
    .short 1984, 1984, 1972, 1972, 1972, 1968, 1968, 1968, 1968, 1968, 1956, 1956, 1956, 1952, 1952, 1952
    .short 1952, 1952, 1940, 1940, 1940, 1936, 1936, 1936, 1936, 1936, 1924, 1924, 1924, 1920, 1920, 1920
    .short 1920, 1920, 1908, 1908, 1908, 1904, 1904, 1904, 1904, 1904, 1892, 1892, 1892, 1888, 1888, 1888
    .short 1888, 1888, 1876, 1876, 1876, 1872, 1872, 1872, 1872, 1872, 1860, 1860, 1860, 1856, 1856, 1856
    .short 1856, 1856, 1844, 1844, 1844, 1840, 1840, 1840, 1840, 1840, 1828, 1828, 1828, 1824, 1824, 1824
    .short 1824, 1824, 1812, 1812, 1812, 1808, 1808, 1808, 1808, 1808, 1796, 1796, 1796, 1792, 1792, 1792
    .short 1792, 1792, 1788, 1788, 1788, 1784, 1784, 1784, 1784, 1784, 1772, 1772, 1772, 1768, 1768, 1768
    .short 1768, 1768, 1756, 1756, 1756, 1752, 1752, 1752, 1752, 1752, 1740, 1740, 1740, 1736, 1736, 1736
    .short 1736, 1736, 1724, 1724, 1724, 1720, 1720, 1720, 1720, 1720, 1708, 1708, 1708, 1704, 1704, 1704
    .short 1704, 1704, 1692, 1692, 1692, 1688, 1688, 1688, 1688, 1688, 1676, 1676, 1676, 1672, 1672, 1672
    .short 1672, 1672, 1660, 1660, 1660, 1656, 1656, 1656, 1656, 1656, 1644, 1644, 1644, 1640, 1640, 1640
    .short 1640, 1640, 1628, 1628, 1628, 1624, 1624, 1624, 1624, 1624, 1612, 1612, 1612, 1608, 1608, 1608
    .short 1608, 1608, 1596, 1596, 1596, 1592, 1592, 1592, 1592, 1592, 1580, 1580, 1580, 1576, 1576, 1576
    .short 1576, 1576, 1564, 1564, 1564, 1560, 1560, 1560, 1560, 1560, 1548, 1548, 1548, 1544, 1544, 1544
    .short 1544, 1544, 1780, 1780, 1780, 1776, 1776, 1776, 1776, 1776, 1764, 1764, 1764, 1760, 1760, 1760
    .short 1760, 1760, 1748, 1748, 1748, 1744, 1744, 1744, 1744, 1744, 1732, 1732, 1732, 1728, 1728, 1728
    .short 1728, 1728, 1716, 1716, 1716, 1712, 1712, 1712, 1712, 1712, 1700, 1700, 1700, 1696, 1696, 1696
    .short 1696, 1696, 1684, 1684, 1684, 1680, 1680, 1680, 1680, 1680, 1668, 1668, 1668, 1664, 1664, 1664
    .short 1664, 1664, 1652, 1652, 1652, 1648, 1648, 1648, 1648, 1648, 1636, 1636, 1636, 1632, 1632, 1632
    .short 1632, 1632, 1620, 1620, 1620, 1616, 1616, 1616, 1616, 1616, 1604, 1604, 1604, 1600, 1600, 1600
    .short 1600, 1600, 1588, 1588, 1588, 1584, 1584, 1584, 1584, 1584, 1572, 1572, 1572, 1568, 1568, 1568
    .short 1568, 1568, 1556, 1556, 1556, 1552, 1552, 1552, 1552, 1552, 1540, 1540, 1540, 1536, 1536, 1536
    .short 1536, 1532, 1528, 1528, 1528, 1524, 1520, 1520, 1520, 1516, 1512, 1512, 1512, 1508, 1504, 1504
    .short 1504, 1500, 1496, 1496, 1496, 1492, 1488, 1488, 1488, 1484, 1480, 1480, 1480, 1476, 1472, 1472
    .short 1472, 1468, 1464, 1464, 1464, 1460, 1456, 1456, 1456, 1452, 1448, 1448, 1448, 1444, 1440, 1440
    .short 1440, 1436, 1432, 1432, 1432, 1428, 1424, 1424, 1424, 1420, 1416, 1416, 1416, 1412, 1408, 1408
    .short 1408, 1404, 1400, 1400, 1400, 1396, 1392, 1392, 1392, 1388, 1384, 1384, 1384, 1380, 1376, 1376
    .short 1376, 1372, 1368, 1368, 1368, 1364, 1360, 1360, 1360, 1356, 1352, 1352, 1352, 1348, 1344, 1344
    .short 1344, 1340, 1336, 1336, 1336, 1332, 1328, 1328, 1328, 1324, 1320, 1320, 1320, 1316, 1312, 1312
    .short 1312, 1308, 1304, 1304, 1304, 1300, 1296, 1296, 1296, 1292, 1288, 1288, 1288, 1284, 1280, 1280
    .short 1280, 1276, 1272, 1272, 1272, 1268, 1264, 1264, 1264, 1260, 1256, 1256, 1256, 1252, 1248, 1248
    .short 1248, 1244, 1240, 1240, 1240, 1236, 1232, 1232, 1232, 1228, 1224, 1224, 1224, 1220, 1216, 1216
    .short 1216, 1212, 1208, 1208, 1208, 1204, 1200, 1200, 1200, 1196, 1192, 1192, 1192, 1188, 1184, 1184
    .short 1184, 1180, 1176, 1176, 1176, 1172, 1168, 1168, 1168, 1164, 1160, 1160, 1160, 1156, 1152, 1152
    .short 1152, 1148, 1144, 1144, 1144, 1140, 1136, 1136, 1136, 1132, 1128, 1128, 1128, 1124, 1120, 1120
    .short 1120, 1116, 1112, 1112, 1112, 1108, 1104, 1104, 1104, 1100, 1096, 1096, 1096, 1092, 1088, 1088
    .short 1088, 1084, 1080, 1080, 1080, 1076, 1072, 1072, 1072, 1068, 1064, 1064, 1064, 1060, 1056, 1056
    .short 1056, 1052, 1048, 1048, 1048, 1044, 1040, 1040, 1040, 1036, 1032, 1032, 1032, 1028, 1024, 1024
    .short 1020, 1016, 1012, 1008, 764, 760, 756, 752, 1004, 1000, 996, 992, 748, 744, 740, 736
    .short 988, 984, 980, 976, 732, 728, 724, 720, 972, 968, 964, 960, 716, 712, 708, 704
    .short 956, 952, 948, 944, 700, 696, 692, 688, 940, 936, 932, 928, 684, 680, 676, 672
    .short 924, 920, 916, 912, 668, 664, 660, 656, 908, 904, 900, 896, 652, 648, 644, 640
    .short 892, 888, 884, 880, 636, 632, 628, 624, 876, 872, 868, 864, 620, 616, 612, 608
    .short 860, 856, 852, 848, 604, 600, 596, 592, 844, 840, 836, 832, 588, 584, 580, 576
    .short 828, 824, 820, 816, 572, 568, 564, 560, 812, 808, 804, 800, 556, 552, 548, 544
    .short 796, 792, 788, 784, 540, 536, 532, 528, 780, 776, 772, 768, 524, 520, 516, 512
    .short 508, 504, 500, 496, 252, 248, 244, 240, 492, 488, 484, 480, 236, 232, 228, 224
    .short 476, 472, 468, 464, 220, 216, 212, 208, 460, 456, 452, 448, 204, 200, 196, 192
    .short 444, 440, 436, 432, 188, 184, 180, 176, 428, 424, 420, 416, 172, 168, 164, 160
    .short 412, 408, 404, 400, 156, 152, 148, 144, 396, 392, 388, 384, 140, 136, 132, 128
    .short 380, 376, 372, 368, 124, 120, 116, 112, 364, 360, 356, 352, 108, 104, 100, 96
    .short 348, 344, 340, 336, 92, 88, 84, 80, 332, 328, 324, 320, 76, 72, 68, 64
    .short 316, 312, 308, 304, 60, 56, 52, 48, 300, 296, 292, 288, 44, 40, 36, 32
    .short 284, 280, 276, 272, 28, 24, 20, 16, 268, 264, 260, 256, 12, 8, 4, 0
    .short 3072, 3072, 3072, 3072, 3072, 3072, 3072, 3072, 3072, 3072, 3072, 3072, 3072, 3072, 3072, 3072
    .short 33792, 33792, 33792, 33792, 33788, 33788, 33788, 33788, 33788, 33788, 33788, 33772, 33772, 33772, 33772, 33772
    .short 33772, 33772, 33772, 33772, 33756, 33756, 33756, 33756, 33756, 33756, 33756, 33740, 33740, 33740, 33740, 33740
    .short 33740, 33740, 33740, 33740, 33724, 33724, 33724, 33724, 33724, 33724, 33724, 33708, 33708, 33708, 33708, 33708
    .short 33708, 33708, 33708, 33708, 33692, 33692, 33692, 33692, 33692, 33692, 33692, 33676, 33676, 33676, 33676, 33676
    .short 33676, 33676, 33676, 33676, 33660, 33660, 33660, 33660, 33660, 33660, 33660, 33644, 33644, 33644, 33644, 33644
    .short 33644, 33644, 33644, 33644, 33628, 33628, 33628, 33628, 33628, 33628, 33628, 33612, 33612, 33612, 33612, 33612
    .short 33612, 33612, 33612, 33612, 33596, 33596, 33596, 33596, 33596, 33596, 33596, 33580, 33580, 33580, 33580, 33580
    .short 33580, 33580, 33580, 33580, 33564, 33564, 33564, 33564, 33564, 33564, 33564, 33548, 33548, 33548, 33548, 33548
    .short 33548, 33548, 33548, 33548, 33784, 33784, 33784, 33784, 33784, 33784, 33784, 33768, 33768, 33768, 33768, 33768
    .short 33768, 33768, 33768, 33768, 33752, 33752, 33752, 33752, 33752, 33752, 33752, 33736, 33736, 33736, 33736, 33736
    .short 33736, 33736, 33736, 33736, 33720, 33720, 33720, 33720, 33720, 33720, 33720, 33704, 33704, 33704, 33704, 33704
    .short 33704, 33704, 33704, 33704, 33688, 33688, 33688, 33688, 33688, 33688, 33688, 33672, 33672, 33672, 33672, 33672
    .short 33672, 33672, 33672, 33672, 33656, 33656, 33656, 33656, 33656, 33656, 33656, 33640, 33640, 33640, 33640, 33640
    .short 33640, 33640, 33640, 33640, 33624, 33624, 33624, 33624, 33624, 33624, 33624, 33608, 33608, 33608, 33608, 33608
    .short 33608, 33608, 33608, 33608, 33592, 33592, 33592, 33592, 33592, 33592, 33592, 33576, 33576, 33576, 33576, 33576
    .short 33576, 33576, 33576, 33576, 33560, 33560, 33560, 33560, 33560, 33560, 33560, 33544, 33544, 33544, 33544, 33544
    .short 33544, 33544, 33544, 33544, 33780, 33780, 33780, 33780, 33780, 33780, 33780, 33764, 33764, 33764, 33764, 33764
    .short 33764, 33764, 33764, 33764, 33748, 33748, 33748, 33748, 33748, 33748, 33748, 33732, 33732, 33732, 33732, 33732
    .short 33732, 33732, 33732, 33732, 33716, 33716, 33716, 33716, 33716, 33716, 33716, 33700, 33700, 33700, 33700, 33700
    .short 33700, 33700, 33700, 33700, 33684, 33684, 33684, 33684, 33684, 33684, 33684, 33668, 33668, 33668, 33668, 33668
    .short 33668, 33668, 33668, 33668, 33652, 33652, 33652, 33652, 33652, 33652, 33652, 33636, 33636, 33636, 33636, 33636
    .short 33636, 33636, 33636, 33636, 33620, 33620, 33620, 33620, 33620, 33620, 33620, 33604, 33604, 33604, 33604, 33604
    .short 33604, 33604, 33604, 33604, 33588, 33588, 33588, 33588, 33588, 33588, 33588, 33572, 33572, 33572, 33572, 33572
    .short 33572, 33572, 33572, 33572, 33556, 33556, 33556, 33556, 33556, 33556, 33556, 33540, 33540, 33540, 33540, 33540
    .short 33540, 33540, 33540, 33540, 33776, 33776, 33776, 33776, 33776, 33776, 33776, 33760, 33760, 33760, 33760, 33760
    .short 33760, 33760, 33760, 33760, 33744, 33744, 33744, 33744, 33744, 33744, 33744, 33728, 33728, 33728, 33728, 33728
    .short 33728, 33728, 33728, 33728, 33712, 33712, 33712, 33712, 33712, 33712, 33712, 33696, 33696, 33696, 33696, 33696
    .short 33696, 33696, 33696, 33696, 33680, 33680, 33680, 33680, 33680, 33680, 33680, 33664, 33664, 33664, 33664, 33664
    .short 33664, 33664, 33664, 33664, 33648, 33648, 33648, 33648, 33648, 33648, 33648, 33632, 33632, 33632, 33632, 33632
    .short 33632, 33632, 33632, 33632, 33616, 33616, 33616, 33616, 33616, 33616, 33616, 33600, 33600, 33600, 33600, 33600
    .short 33600, 33600, 33600, 33600, 33584, 33584, 33584, 33584, 33584, 33584, 33584, 33568, 33568, 33568, 33568, 33568
    .short 33568, 33568, 33568, 33568, 33552, 33552, 33552, 33552, 33552, 33552, 33552, 33536, 33536, 33536, 33536, 33536
    .short 33536, 33536, 33536, 33536, 33532, 33532, 33532, 33532, 33532, 33532, 33532, 33516, 33516, 33516, 33516, 33516
    .short 33516, 33516, 33516, 33516, 33500, 33500, 33500, 33500, 33500, 33500, 33500, 33484, 33484, 33484, 33484, 33484
    .short 33484, 33484, 33484, 33484, 33468, 33468, 33468, 33468, 33468, 33468, 33468, 33452, 33452, 33452, 33452, 33452
    .short 33452, 33452, 33452, 33452, 33436, 33436, 33436, 33436, 33436, 33436, 33436, 33420, 33420, 33420, 33420, 33420
    .short 33420, 33420, 33420, 33420, 33404, 33404, 33404, 33404, 33404, 33404, 33404, 33388, 33388, 33388, 33388, 33388
    .short 33388, 33388, 33388, 33388, 33372, 33372, 33372, 33372, 33372, 33372, 33372, 33356, 33356, 33356, 33356, 33356
    .short 33356, 33356, 33356, 33356, 33340, 33340, 33340, 33340, 33340, 33340, 33340, 33324, 33324, 33324, 33324, 33324
    .short 33324, 33324, 33324, 33324, 33308, 33308, 33308, 33308, 33308, 33308, 33308, 33292, 33292, 33292, 33292, 33292
    .short 33292, 33292, 33292, 33292, 33528, 33528, 33528, 33528, 33528, 33528, 33528, 33512, 33512, 33512, 33512, 33512
    .short 33512, 33512, 33512, 33512, 33496, 33496, 33496, 33496, 33496, 33496, 33496, 33480, 33480, 33480, 33480, 33480
    .short 33480, 33480, 33480, 33480, 33464, 33464, 33464, 33464, 33464, 33464, 33464, 33448, 33448, 33448, 33448, 33448
    .short 33448, 33448, 33448, 33448, 33432, 33432, 33432, 33432, 33432, 33432, 33432, 33416, 33416, 33416, 33416, 33416
    .short 33416, 33416, 33416, 33416, 33400, 33400, 33400, 33400, 33400, 33400, 33400, 33384, 33384, 33384, 33384, 33384
    .short 33384, 33384, 33384, 33384, 33368, 33368, 33368, 33368, 33368, 33368, 33368, 33352, 33352, 33352, 33352, 33352
    .short 33352, 33352, 33352, 33352, 33336, 33336, 33336, 33336, 33336, 33336, 33336, 33320, 33320, 33320, 33320, 33320
    .short 33320, 33320, 33320, 33320, 33304, 33304, 33304, 33304, 33304, 33304, 33304, 33288, 33288, 33288, 33288, 33288
    .short 33288, 33288, 33288, 33288, 33524, 33524, 33524, 33524, 33524, 33524, 33524, 33508, 33508, 33508, 33508, 33508
    .short 33508, 33508, 33508, 33508, 33492, 33492, 33492, 33492, 33492, 33492, 33492, 33476, 33476, 33476, 33476, 33476
    .short 33476, 33476, 33476, 33476, 33460, 33460, 33460, 33460, 33460, 33460, 33460, 33444, 33444, 33444, 33444, 33444
    .short 33444, 33444, 33444, 33444, 33428, 33428, 33428, 33428, 33428, 33428, 33428, 33412, 33412, 33412, 33412, 33412
    .short 33412, 33412, 33412, 33412, 33396, 33396, 33396, 33396, 33396, 33396, 33396, 33380, 33380, 33380, 33380, 33380
    .short 33380, 33380, 33380, 33380, 33364, 33364, 33364, 33364, 33364, 33364, 33364, 33348, 33348, 33348, 33348, 33348
    .short 33348, 33348, 33348, 33348, 33332, 33332, 33332, 33332, 33332, 33332, 33332, 33316, 33316, 33316, 33316, 33316
    .short 33316, 33316, 33316, 33316, 33300, 33300, 33300, 33300, 33300, 33300, 33300, 33284, 33284, 33284, 33284, 33284
    .short 33284, 33284, 33284, 33284, 33520, 33520, 33520, 33520, 33520, 33520, 33520, 33504, 33504, 33504, 33504, 33504
    .short 33504, 33504, 33504, 33504, 33488, 33488, 33488, 33488, 33488, 33488, 33488, 33472, 33472, 33472, 33472, 33472
    .short 33472, 33472, 33472, 33472, 33456, 33456, 33456, 33456, 33456, 33456, 33456, 33440, 33440, 33440, 33440, 33440
    .short 33440, 33440, 33440, 33440, 33424, 33424, 33424, 33424, 33424, 33424, 33424, 33408, 33408, 33408, 33408, 33408
    .short 33408, 33408, 33408, 33408, 33392, 33392, 33392, 33392, 33392, 33392, 33392, 33376, 33376, 33376, 33376, 33376
    .short 33376, 33376, 33376, 33376, 33360, 33360, 33360, 33360, 33360, 33360, 33360, 33344, 33344, 33344, 33344, 33344
    .short 33344, 33344, 33344, 33344, 33328, 33328, 33328, 33328, 33328, 33328, 33328, 33312, 33312, 33312, 33312, 33312
    .short 33312, 33312, 33312, 33312, 33296, 33296, 33296, 33296, 33296, 33296, 33296, 33280, 33280, 33280, 33280, 33280
    .short 33280, 33280, 33276, 33276, 33276, 33272, 33272, 33272, 33272, 33272, 33260, 33260, 33260, 33256, 33256, 33256
    .short 33256, 33256, 33244, 33244, 33244, 33240, 33240, 33240, 33240, 33240, 33228, 33228, 33228, 33224, 33224, 33224
    .short 33224, 33224, 33212, 33212, 33212, 33208, 33208, 33208, 33208, 33208, 33196, 33196, 33196, 33192, 33192, 33192
    .short 33192, 33192, 33180, 33180, 33180, 33176, 33176, 33176, 33176, 33176, 33164, 33164, 33164, 33160, 33160, 33160
    .short 33160, 33160, 33148, 33148, 33148, 33144, 33144, 33144, 33144, 33144, 33132, 33132, 33132, 33128, 33128, 33128
    .short 33128, 33128, 33116, 33116, 33116, 33112, 33112, 33112, 33112, 33112, 33100, 33100, 33100, 33096, 33096, 33096
    .short 33096, 33096, 33084, 33084, 33084, 33080, 33080, 33080, 33080, 33080, 33068, 33068, 33068, 33064, 33064, 33064
    .short 33064, 33064, 33052, 33052, 33052, 33048, 33048, 33048, 33048, 33048, 33036, 33036, 33036, 33032, 33032, 33032
    .short 33032, 33032, 33268, 33268, 33268, 33264, 33264, 33264, 33264, 33264, 33252, 33252, 33252, 33248, 33248, 33248
    .short 33248, 33248, 33236, 33236, 33236, 33232, 33232, 33232, 33232, 33232, 33220, 33220, 33220, 33216, 33216, 33216
    .short 33216, 33216, 33204, 33204, 33204, 33200, 33200, 33200, 33200, 33200, 33188, 33188, 33188, 33184, 33184, 33184
    .short 33184, 33184, 33172, 33172, 33172, 33168, 33168, 33168, 33168, 33168, 33156, 33156, 33156, 33152, 33152, 33152
    .short 33152, 33152, 33140, 33140, 33140, 33136, 33136, 33136, 33136, 33136, 33124, 33124, 33124, 33120, 33120, 33120
    .short 33120, 33120, 33108, 33108, 33108, 33104, 33104, 33104, 33104, 33104, 33092, 33092, 33092, 33088, 33088, 33088
    .short 33088, 33088, 33076, 33076, 33076, 33072, 33072, 33072, 33072, 33072, 33060, 33060, 33060, 33056, 33056, 33056
    .short 33056, 33056, 33044, 33044, 33044, 33040, 33040, 33040, 33040, 33040, 33028, 33028, 33028, 33024, 33024, 33024
    .short 33024, 33024, 33020, 33020, 33020, 33016, 33016, 33016, 33016, 33016, 33004, 33004, 33004, 33000, 33000, 33000
    .short 33000, 33000, 32988, 32988, 32988, 32984, 32984, 32984, 32984, 32984, 32972, 32972, 32972, 32968, 32968, 32968
    .short 32968, 32968, 32956, 32956, 32956, 32952, 32952, 32952, 32952, 32952, 32940, 32940, 32940, 32936, 32936, 32936
    .short 32936, 32936, 32924, 32924, 32924, 32920, 32920, 32920, 32920, 32920, 32908, 32908, 32908, 32904, 32904, 32904
    .short 32904, 32904, 32892, 32892, 32892, 32888, 32888, 32888, 32888, 32888, 32876, 32876, 32876, 32872, 32872, 32872
    .short 32872, 32872, 32860, 32860, 32860, 32856, 32856, 32856, 32856, 32856, 32844, 32844, 32844, 32840, 32840, 32840
    .short 32840, 32840, 32828, 32828, 32828, 32824, 32824, 32824, 32824, 32824, 32812, 32812, 32812, 32808, 32808, 32808
    .short 32808, 32808, 32796, 32796, 32796, 32792, 32792, 32792, 32792, 32792, 32780, 32780, 32780, 32776, 32776, 32776
    .short 32776, 32776, 33012, 33012, 33012, 33008, 33008, 33008, 33008, 33008, 32996, 32996, 32996, 32992, 32992, 32992
    .short 32992, 32992, 32980, 32980, 32980, 32976, 32976, 32976, 32976, 32976, 32964, 32964, 32964, 32960, 32960, 32960
    .short 32960, 32960, 32948, 32948, 32948, 32944, 32944, 32944, 32944, 32944, 32932, 32932, 32932, 32928, 32928, 32928
    .short 32928, 32928, 32916, 32916, 32916, 32912, 32912, 32912, 32912, 32912, 32900, 32900, 32900, 32896, 32896, 32896
    .short 32896, 32896, 32884, 32884, 32884, 32880, 32880, 32880, 32880, 32880, 32868, 32868, 32868, 32864, 32864, 32864
    .short 32864, 32864, 32852, 32852, 32852, 32848, 32848, 32848, 32848, 32848, 32836, 32836, 32836, 32832, 32832, 32832
    .short 32832, 32832, 32820, 32820, 32820, 32816, 32816, 32816, 32816, 32816, 32804, 32804, 32804, 32800, 32800, 32800
    .short 32800, 32800, 32788, 32788, 32788, 32784, 32784, 32784, 32784, 32784, 32772, 32772, 32772, 32768, 32768, 32768
    .short 32768, 32764, 32760, 32760, 32760, 32756, 32752, 32752, 32752, 32748, 32744, 32744, 32744, 32740, 32736, 32736
    .short 32736, 32732, 32728, 32728, 32728, 32724, 32720, 32720, 32720, 32716, 32712, 32712, 32712, 32708, 32704, 32704
    .short 32704, 32700, 32696, 32696, 32696, 32692, 32688, 32688, 32688, 32684, 32680, 32680, 32680, 32676, 32672, 32672
    .short 32672, 32668, 32664, 32664, 32664, 32660, 32656, 32656, 32656, 32652, 32648, 32648, 32648, 32644, 32640, 32640
    .short 32640, 32636, 32632, 32632, 32632, 32628, 32624, 32624, 32624, 32620, 32616, 32616, 32616, 32612, 32608, 32608
    .short 32608, 32604, 32600, 32600, 32600, 32596, 32592, 32592, 32592, 32588, 32584, 32584, 32584, 32580, 32576, 32576
    .short 32576, 32572, 32568, 32568, 32568, 32564, 32560, 32560, 32560, 32556, 32552, 32552, 32552, 32548, 32544, 32544
    .short 32544, 32540, 32536, 32536, 32536, 32532, 32528, 32528, 32528, 32524, 32520, 32520, 32520, 32516, 32512, 32512
    .short 32512, 32508, 32504, 32504, 32504, 32500, 32496, 32496, 32496, 32492, 32488, 32488, 32488, 32484, 32480, 32480
    .short 32480, 32476, 32472, 32472, 32472, 32468, 32464, 32464, 32464, 32460, 32456, 32456, 32456, 32452, 32448, 32448
    .short 32448, 32444, 32440, 32440, 32440, 32436, 32432, 32432, 32432, 32428, 32424, 32424, 32424, 32420, 32416, 32416
    .short 32416, 32412, 32408, 32408, 32408, 32404, 32400, 32400, 32400, 32396, 32392, 32392, 32392, 32388, 32384, 32384
    .short 32384, 32380, 32376, 32376, 32376, 32372, 32368, 32368, 32368, 32364, 32360, 32360, 32360, 32356, 32352, 32352
    .short 32352, 32348, 32344, 32344, 32344, 32340, 32336, 32336, 32336, 32332, 32328, 32328, 32328, 32324, 32320, 32320
    .short 32320, 32316, 32312, 32312, 32312, 32308, 32304, 32304, 32304, 32300, 32296, 32296, 32296, 32292, 32288, 32288
    .short 32288, 32284, 32280, 32280, 32280, 32276, 32272, 32272, 32272, 32268, 32264, 32264, 32264, 32260, 32256, 32256
    .short 32252, 32248, 32244, 32240, 31996, 31992, 31988, 31984, 32236, 32232, 32228, 32224, 31980, 31976, 31972, 31968
    .short 32220, 32216, 32212, 32208, 31964, 31960, 31956, 31952, 32204, 32200, 32196, 32192, 31948, 31944, 31940, 31936
    .short 32188, 32184, 32180, 32176, 31932, 31928, 31924, 31920, 32172, 32168, 32164, 32160, 31916, 31912, 31908, 31904
    .short 32156, 32152, 32148, 32144, 31900, 31896, 31892, 31888, 32140, 32136, 32132, 32128, 31884, 31880, 31876, 31872
    .short 32124, 32120, 32116, 32112, 31868, 31864, 31860, 31856, 32108, 32104, 32100, 32096, 31852, 31848, 31844, 31840
    .short 32092, 32088, 32084, 32080, 31836, 31832, 31828, 31824, 32076, 32072, 32068, 32064, 31820, 31816, 31812, 31808
    .short 32060, 32056, 32052, 32048, 31804, 31800, 31796, 31792, 32044, 32040, 32036, 32032, 31788, 31784, 31780, 31776
    .short 32028, 32024, 32020, 32016, 31772, 31768, 31764, 31760, 32012, 32008, 32004, 32000, 31756, 31752, 31748, 31744
    .short 31740, 31736, 31732, 31728, 31484, 31480, 31476, 31472, 31724, 31720, 31716, 31712, 31468, 31464, 31460, 31456
    .short 31708, 31704, 31700, 31696, 31452, 31448, 31444, 31440, 31692, 31688, 31684, 31680, 31436, 31432, 31428, 31424
    .short 31676, 31672, 31668, 31664, 31420, 31416, 31412, 31408, 31660, 31656, 31652, 31648, 31404, 31400, 31396, 31392
    .short 31644, 31640, 31636, 31632, 31388, 31384, 31380, 31376, 31628, 31624, 31620, 31616, 31372, 31368, 31364, 31360
    .short 31612, 31608, 31604, 31600, 31356, 31352, 31348, 31344, 31596, 31592, 31588, 31584, 31340, 31336, 31332, 31328
    .short 31580, 31576, 31572, 31568, 31324, 31320, 31316, 31312, 31564, 31560, 31556, 31552, 31308, 31304, 31300, 31296
    .short 31548, 31544, 31540, 31536, 31292, 31288, 31284, 31280, 31532, 31528, 31524, 31520, 31276, 31272, 31268, 31264
    .short 31516, 31512, 31508, 31504, 31260, 31256, 31252, 31248, 31500, 31496, 31492, 31488, 31244, 31240, 31236, 31232
    .short 34304, 34304, 34304, 34304, 34304, 34304, 34304, 34304, 34304, 34304, 34304, 34304, 34304, 34304, 34304, 34304
.size ktab, 8256
.section .rodata,"a"
.p2align 6
.amdhsa_kernel interleave_layers__ssm_conv_s4__mixer_token_mlp__prompt_kernel
  .amdhsa_next_free_vgpr 512
  .amdhsa_next_free_sgpr 102
  .amdhsa_accum_offset 256
  .amdhsa_group_segment_fixed_size 0
  .amdhsa_kernarg_size 136
  .amdhsa_user_sgpr_count 2
  .amdhsa_user_sgpr_kernarg_segment_ptr 1
  .amdhsa_system_sgpr_workgroup_id_x 1
  .amdhsa_float_denorm_mode_32 3
.end_amdhsa_kernel
```
